```python
import torch

def _softmax(x, axis=-1):
    return torch.softmax(x, dim=axis)
def _gelu(x):
    return torch.nn.functional.gelu(x, approximate="tanh")
def _silu(x):
    return torch.nn.functional.silu(x)
def _sigmoid(x):
    return torch.sigmoid(x)
def _layernorm(x, axis=-1, eps=1e-5):
    m = x.mean(dim=axis, keepdim=True)
    v = x.var(dim=axis, keepdim=True, unbiased=False)
    return (x - m) / torch.sqrt(v + eps)
def _scatter_add(tgt, idx, src, axis=0):
    return tgt.clone().index_add_(axis, idx, src)
def _segment_sum(src, seg, n):
    out = torch.zeros((n,) + src.shape[1:], dtype=src.dtype)
    return out.index_add_(0, seg, src)
def _pad(x, pw):
    flat = tuple(v for pair in reversed(pw) for v in pair)
    return torch.nn.functional.pad(x, flat)

kernel_name = 'concat_heads__gqa_block_cached__gqa_block_cached__near_ridge'

def setup_inputs():

    _w = (lambda a: (lambda t: t.to(torch.bfloat16) if t.is_floating_point() else t)(torch.as_tensor(a)))
    def _A_setup():
        B, Sq, D = 32, 96, 576
        Hq, Hkv, Sk, Dh = 32, 16, 512, 128
        assert Hq % Hkv == 0, (Hq, Hkv)
        return {
            "x": _w((lambda *s: torch.randn(*s, dtype=torch.bfloat16) * 0.8)(B, Sq, D)),
            "k_cache": _w((lambda *s: torch.randn(*s, dtype=torch.bfloat16) * 0.8)(B, Hkv, Sk, Dh)),
            "v_cache": _w((lambda *s: torch.randn(*s, dtype=torch.bfloat16) * 0.05)(B, Hkv, Sk, Dh)),
            "wq": _w((lambda *s: torch.randn(*s, dtype=torch.bfloat16) * 0.8)(D, Hq * Dh) * (D ** -0.5)),
            "wo": _w((lambda *s: torch.randn(*s, dtype=torch.bfloat16) * 0.05)(Hq * Dh, D) * ((Hq * Dh) ** -0.5)),
        }
    _A_in = _A_setup()

    def _B_setup():
        B, Sq, D = 32, 96, 576
        Hq, Hkv, Sk, Dh = 32, 16, 512, 128
        assert Hq % Hkv == 0, (Hq, Hkv)
        return {
            "x": _w((lambda *s: torch.randn(*s, dtype=torch.bfloat16) * 0.8)(B, Sq, D)),
            "k_cache": _w((lambda *s: torch.randn(*s, dtype=torch.bfloat16) * 0.8)(B, Hkv, Sk, Dh)),
            "v_cache": _w((lambda *s: torch.randn(*s, dtype=torch.bfloat16) * 0.05)(B, Hkv, Sk, Dh)),
            "wq": _w((lambda *s: torch.randn(*s, dtype=torch.bfloat16) * 0.8)(D, Hq * Dh) * (D ** -0.5)),
            "wo": _w((lambda *s: torch.randn(*s, dtype=torch.bfloat16) * 0.05)(Hq * Dh, D) * ((Hq * Dh) ** -0.5)),
        }
    _B_in = _B_setup()

    return {
        "A_x": _A_in["x"],
        "A_k_cache": _A_in["k_cache"],
        "A_v_cache": _A_in["v_cache"],
        "A_wq": _A_in["wq"],
        "A_wo": _A_in["wo"],
        "B_x": _B_in["x"],
        "B_k_cache": _B_in["k_cache"],
        "B_v_cache": _B_in["v_cache"],
        "B_wq": _B_in["wq"],
        "B_wo": _B_in["wo"],
    }

def reference(A_x, A_k_cache, A_v_cache, A_wq, A_wo, B_x, B_k_cache, B_v_cache, B_wq, B_wo):
    def _A_ref(x, k_cache, v_cache, wq, wo):
        B, Sq, D = x.shape
        Hq, Dh = 32, 128
        Hkv = k_cache.shape[1]
        rep = Hq // Hkv
        q = (lambda x, *d: x.permute(*d))((x @ wq).reshape(B, Sq, Hq, Dh), 0, 2, 1, 3)
        k = (lambda x, n, axis: torch.repeat_interleave(x, n, dim=axis))(k_cache, rep, axis=1)
        v = (lambda x, n, axis: torch.repeat_interleave(x, n, dim=axis))(v_cache, rep, axis=1)
        scores = torch.einsum("bhqd,bhkd->bhqk", q, k) * (Dh ** -0.5)
        p = _softmax(scores, axis=-1)
        o = torch.einsum("bhqk,bhkd->bhqd", p, v)
        return (lambda x, *d: x.permute(*d))(o, 0, 2, 1, 3).reshape(B, Sq, Hq * Dh) @ wo

    def _B_ref(x, k_cache, v_cache, wq, wo):
        B, Sq, D = x.shape
        Hq, Dh = 32, 128
        Hkv = k_cache.shape[1]
        rep = Hq // Hkv
        q = (lambda x, *d: x.permute(*d))((x @ wq).reshape(B, Sq, Hq, Dh), 0, 2, 1, 3)
        k = (lambda x, n, axis: torch.repeat_interleave(x, n, dim=axis))(k_cache, rep, axis=1)
        v = (lambda x, n, axis: torch.repeat_interleave(x, n, dim=axis))(v_cache, rep, axis=1)
        scores = torch.einsum("bhqd,bhkd->bhqk", q, k) * (Dh ** -0.5)
        p = _softmax(scores, axis=-1)
        o = torch.einsum("bhqk,bhkd->bhqd", p, v)
        return (lambda x, *d: x.permute(*d))(o, 0, 2, 1, 3).reshape(B, Sq, Hq * Dh) @ wo

    a = _A_ref(A_x, A_k_cache, A_v_cache, A_wq, A_wo)
    b = _B_ref(B_x, B_k_cache, B_v_cache, B_wq, B_wo)
    return torch.concatenate([a, b], axis=-1)
```

```asm
; @launch grid=(256,1,1) block=(512,1,1) lds=163840
.amdgcn_target "amdgcn-amd-amdhsa--gfx950"
.text
.globl concat_heads__gqa_block_cached__gqa_block_cached__near_ridge_kernel
.p2align 8
.type concat_heads__gqa_block_cached__gqa_block_cached__near_ridge_kernel,@function
concat_heads__gqa_block_cached__gqa_block_cached__near_ridge_kernel:
    s_cmp_ge_u32 s2, 256
    s_cbranch_scc1 L_done
    s_load_dwordx16 s[64:79], s[0:1], 0
    s_load_dwordx8 s[80:87], s[0:1], 64
    s_load_dwordx2 s[88:89], s[0:1], 96
    v_lshrrev_b32 v1, 6, v0
    s_bfe_u32 s41, s2, 0x20003
    s_bfe_u32 s40, s2, 0x10002
    s_lshr_b32 s48, s2, 5
    s_and_b32 s3, s2, 3
    s_lshl_b32 s42, s3, 3
    s_add_u32 s42, s42, s48
    v_readfirstlane_b32 s43, v1
    v_and_b32 v0, 63, v0
    s_nop 3
    s_and_b32 s44, s43, 3
    s_lshl_b32 s50, s44, 10
    s_mul_i32 s49, s42, 110592
    s_lshl_b32 s59, s40, 5
    s_add_u32 s59, s59, s42
    s_mov_b32 s45, 0
    s_waitcnt lgkmcnt(0)
    s_cmp_eq_u32 s40, 0
    s_cselect_b32 s8, s64, s74
    s_cselect_b32 s9, s65, s75
    s_mov_b32 s10, 3538944
    s_mov_b32 s11, 0x00020000
    s_cselect_b32 s12, s66, s76
    s_cselect_b32 s13, s67, s77
    s_mov_b32 s14, 67108864
    s_mov_b32 s15, 0x00020000
    s_cselect_b32 s16, s68, s78
    s_cselect_b32 s17, s69, s79
    s_mov_b32 s18, 67108864
    s_mov_b32 s19, 0x00020000
    s_cselect_b32 s20, s70, s80
    s_cselect_b32 s21, s71, s81
    s_mov_b32 s22, 4718592
    s_mov_b32 s23, 0x00020000
    s_cselect_b32 s24, s72, s82
    s_cselect_b32 s25, s73, s83
    s_mov_b32 s26, 4718592
    s_mov_b32 s27, 0x00020000
    s_mov_b32 s28, s84
    s_mov_b32 s29, s85
    s_mov_b32 s30, 7077888
    s_mov_b32 s31, 0x00020000
    s_mov_b32 s36, s86
    s_mov_b32 s37, s87
    s_mov_b32 s38, 256
    s_mov_b32 s39, 0x00020000
    s_mov_b32 s32, s88
    s_mov_b32 s33, s89
    s_mov_b32 s34, 294387712
    s_mov_b32 s35, 0x00020000
    s_lshl_b32 s47, s41, 11
    s_cmp_ge_u32 s43, 4
    s_cbranch_scc1 L_G
    s_setprio 2
    v_mov_b32 v160, v0
    v_lshlrev_b32 v254, 7, v160
    v_and_b32 v156, 15, v160
    v_lshrrev_b32 v157, 4, v160
    v_lshrrev_b32 v158, 1, v156
    v_xor_b32 v159, v157, v158
    v_lshlrev_b32 v159, 4, v159
    v_lshl_add_u32 v248, v156, 7, v159
    v_xor_b32 v249, 64, v248
    v_add_u32 v248, 86016, v248
    v_add_u32 v249, 86016, v249
    v_bfe_u32 v161, v160, 2, 2
    v_and_b32 v162, 3, v160
    v_and_b32 v158, 1, v157
    v_lshlrev_b32 v158, 1, v158
    v_lshrrev_b32 v159, 1, v161
    v_or_b32 v163, v158, v159
    v_lshrrev_b32 v158, 2, v160
    v_lshlrev_b32 v158, 7, v158
    v_lshl_add_u32 v158, v162, 3, v158
    v_add_u32 v158, 86016, v158
    v_xor_b32 v156, 0, v163
    v_lshl_add_u32 v250, v156, 5, v158
    v_xor_b32 v156, 1, v163
    v_lshl_add_u32 v251, v156, 5, v158
    v_xor_b32 v156, 2, v163
    v_lshl_add_u32 v252, v156, 5, v158
    v_xor_b32 v156, 3, v163
    v_lshl_add_u32 v253, v156, 5, v158
    s_mov_b32 s58, 0x3e0293ee
    s_mov_b32 s54, 0x43800000
    s_mov_b32 m0, 159744
    s_lshl_b32 s88, s59, 2
    s_add_u32 s88, s88, s41
    s_lshl_b32 s88, s88, 2
    s_add_u32 s88, s88, s44
    s_mul_i32 s88, s88, 24576
    s_mul_i32 s89, s42, 221184
    s_mul_i32 s51, s40, 1152
    s_add_u32 s89, s89, s51
    s_lshl_b32 s51, s41, 8
    s_add_u32 s89, s89, s51
    s_and_b32 s52, s44, 1
    s_mul_i32 s55, s52, 6144
    s_add_u32 s55, s55, 49152
    s_lshr_b32 s51, s44, 1
    s_lshl_b32 s56, s51, 13
    s_mul_i32 s60, s51, 24
    s_mul_i32 s53, s52, 3
    s_add_u32 s60, s60, s53
    s_lshl_b32 s60, s60, 10
    s_cmp_lt_u32 s44, 2
    s_cselect_b32 s84, s12, s16
    s_cselect_b32 s85, s13, s17
    s_mov_b32 s86, 67108864
    s_mov_b32 s87, 0x00020000
    s_lshl_b32 s51, s42, 4
    s_lshl_b32 s53, s41, 2
    s_add_u32 s51, s51, s53
    s_lshl_b32 s46, s51, 17
    s_lshl_b32 s52, s52, 13
    s_add_u32 s46, s46, s52
    s_add_u32 s81, s46, 131072
    s_lshl_b32 s82, s44, 13
    s_add_u32 s49, s49, s82
    s_mul_i32 s51, s41, 27648
    s_add_u32 s49, s49, s51
    s_mul_i32 s73, s41, 1179648
    s_mul_i32 s51, s48, 36864
    s_add_u32 s73, s73, s51
    s_mul_i32 s51, s44, 9216
    s_add_u32 s73, s73, s51
    s_mul_i32 s51, s48, 72
    s_mul_i32 s52, s44, 18
    s_add_u32 s51, s51, s52
    s_lshl_b32 s51, s51, 13
    s_add_u32 s47, s47, s51
    s_mov_b32 s52, s3
    s_lshl_b32 s51, s52, 7
    s_add_u32 s83, s47, s51
    s_mul_i32 s51, s52, 9216
    s_add_u32 s93, s73, s51
    s_mul_i32 s51, s44, -6912
    s_add_u32 s93, s93, s51
    s_barrier
    s_add_u32 s51, s49, 0
    buffer_load_dword v254, s[8:11], s51 offen lds
    v_lshrrev_b32 v255, 9, v254
    v_lshlrev_b32 v255, 13, v255
    s_movk_i32 s52, 0x180
    v_and_or_b32 v255, v254, s52, v255
    s_add_u32 s51, s47, 0
    buffer_load_dword v255, s[20:23], s51 offen lds
    v_lshrrev_b32 v255, 9, v254
    v_lshlrev_b32 v255, 13, v255
    s_movk_i32 s52, 0x180
    v_and_or_b32 v255, v254, s52, v255
    s_mov_b64 exec, 0xff
    s_add_u32 s51, s47, 131072
    buffer_load_dword v255, s[20:23], s51 offen lds
    s_mov_b64 exec, -1
    s_cmp_lg_u32 s44, 0
    s_cbranch_scc1 L_noclr
    s_lshl_b32 s51, s59, 2
    s_add_u32 s51, s51, s41
    s_lshl_b32 s51, s51, 7
    s_add_u32 s51, s51, 26214400
    v_lshrrev_b32 v156, 5, v254
    v_mov_b32 v157, 0
    s_mov_b64 exec, 0xffff
    buffer_store_dword v157, v156, s[32:35], s51 offen sc1
    s_lshl_b32 s52, s41, 3
    s_lshl_b32 s52, 1, s52
    s_lshl_b32 s53, s59, 2
    v_mov_b32 v158, s52
    v_mov_b32 v159, s53
    s_waitcnt vmcnt(0)
    s_mov_b64 exec, 1
    buffer_atomic_add v158, v159, s[36:39], 0 offen sc1
    s_mov_b64 exec, -1
    s_nop 1
L_noclr:
    v_lshrrev_b32 v255, 9, v254
    v_lshlrev_b32 v255, 13, v255
    s_movk_i32 s52, 0x180
    v_and_or_b32 v255, v254, s52, v255
    s_add_u32 s51, s47, 512
    s_sub_u32 s52, s45, 0
    s_cmp_le_u32 s52, 2
    s_cselect_b32 s51, s51, 0x7f000000
    buffer_load_dword v255, s[20:23], s51 offen lds
    v_lshrrev_b32 v255, 9, v254
    v_lshlrev_b32 v255, 13, v255
    s_movk_i32 s52, 0x180
    v_and_or_b32 v255, v254, s52, v255
    s_mov_b64 exec, 0xff
    s_add_u32 s51, s47, 131584
    s_sub_u32 s52, s45, 0
    s_cmp_le_u32 s52, 2
    s_cselect_b32 s51, s51, 0x7f000000
    buffer_load_dword v255, s[20:23], s51 offen lds
    s_mov_b64 exec, -1
    v_lshrrev_b32 v243, 3, v254
    v_add_u32 v243, s60, v243
L_A_loop:
    s_barrier
    ds_write_b128 v243, v[144:147] offset:18432
    ds_write_b128 v243, v[148:151] offset:19456
    ds_write_b128 v243, v[152:155] offset:20480
    v_add_u32 v240, s55, v248
    v_add_u32 v241, s55, v249
    v_lshrrev_b32 v247, 11, v254
    v_lshlrev_b32 v247, 9, v247
    v_add_u32 v247, s56, v247
    v_add_u32 v236, v250, v247
    v_add_u32 v237, v251, v247
    v_add_u32 v238, v252, v247
    v_add_u32 v239, v253, v247
    ds_read_b128 v[220:223], v240 offset:12288
    ds_read_b64_tr_b16 v[156:157], v236 offset:0
    ds_read_b64_tr_b16 v[158:159], v236 offset:512
    ds_read_b128 v[224:227], v240 offset:14336
    ds_read_b128 v[228:231], v240 offset:16384
    ds_read_b64_tr_b16 v[160:161], v237 offset:0
    ds_read_b64_tr_b16 v[162:163], v237 offset:512
    ds_read_b64_tr_b16 v[164:165], v238 offset:0
    ds_read_b64_tr_b16 v[166:167], v238 offset:512
    ds_read_b64_tr_b16 v[168:169], v239 offset:0
    ds_read_b64_tr_b16 v[170:171], v239 offset:512
    ds_read_b64_tr_b16 v[172:173], v236 offset:4096
    ds_read_b64_tr_b16 v[174:175], v236 offset:4608
    ds_read_b64_tr_b16 v[176:177], v237 offset:4096
    ds_read_b64_tr_b16 v[178:179], v237 offset:4608
    ds_read_b64_tr_b16 v[180:181], v238 offset:4096
    ds_read_b64_tr_b16 v[182:183], v238 offset:4608
    ds_read_b64_tr_b16 v[184:185], v239 offset:4096
    ds_read_b64_tr_b16 v[186:187], v239 offset:4608
    s_waitcnt lgkmcnt(0)
    s_barrier
    v_mfma_f32_16x16x32_bf16 v[0:3], v[156:159], v[220:223], 0
    ds_read_b128 v[96:99], v241 offset:12288
    v_mfma_f32_16x16x32_bf16 v[4:7], v[156:159], v[224:227], 0
    ds_read_b64_tr_b16 v[188:189], v236 offset:16384
    v_mfma_f32_16x16x32_bf16 v[8:11], v[156:159], v[228:231], 0
    ds_read_b64_tr_b16 v[190:191], v236 offset:16896
    v_mfma_f32_16x16x32_bf16 v[12:15], v[160:163], v[220:223], 0
    ds_read_b128 v[100:103], v241 offset:14336
    v_mfma_f32_16x16x32_bf16 v[16:19], v[160:163], v[224:227], 0
    ds_read_b128 v[104:107], v241 offset:16384
    v_mfma_f32_16x16x32_bf16 v[20:23], v[160:163], v[228:231], 0
    ds_read_b64_tr_b16 v[192:193], v237 offset:16384
    v_mfma_f32_16x16x32_bf16 v[24:27], v[164:167], v[220:223], 0
    ds_read_b64_tr_b16 v[194:195], v237 offset:16896
    v_mfma_f32_16x16x32_bf16 v[28:31], v[164:167], v[224:227], 0
    ds_read_b64_tr_b16 v[196:197], v238 offset:16384
    v_mfma_f32_16x16x32_bf16 v[32:35], v[164:167], v[228:231], 0
    ds_read_b64_tr_b16 v[198:199], v238 offset:16896
    v_mfma_f32_16x16x32_bf16 v[36:39], v[168:171], v[220:223], 0
    ds_read_b64_tr_b16 v[200:201], v239 offset:16384
    v_mfma_f32_16x16x32_bf16 v[40:43], v[168:171], v[224:227], 0
    ds_read_b64_tr_b16 v[202:203], v239 offset:16896
    v_mfma_f32_16x16x32_bf16 v[44:47], v[168:171], v[228:231], 0
    ds_read_b64_tr_b16 v[204:205], v236 offset:20480
    v_mfma_f32_16x16x32_bf16 v[48:51], v[172:175], v[220:223], 0
    ds_read_b64_tr_b16 v[206:207], v236 offset:20992
    v_mfma_f32_16x16x32_bf16 v[52:55], v[172:175], v[224:227], 0
    ds_read_b64_tr_b16 v[208:209], v237 offset:20480
    v_mfma_f32_16x16x32_bf16 v[56:59], v[172:175], v[228:231], 0
    ds_read_b64_tr_b16 v[210:211], v237 offset:20992
    v_mfma_f32_16x16x32_bf16 v[60:63], v[176:179], v[220:223], 0
    ds_read_b64_tr_b16 v[212:213], v238 offset:20480
    v_mfma_f32_16x16x32_bf16 v[64:67], v[176:179], v[224:227], 0
    ds_read_b64_tr_b16 v[214:215], v238 offset:20992
    v_mfma_f32_16x16x32_bf16 v[68:71], v[176:179], v[228:231], 0
    ds_read_b64_tr_b16 v[216:217], v239 offset:20480
    v_mfma_f32_16x16x32_bf16 v[72:75], v[180:183], v[220:223], 0
    ds_read_b64_tr_b16 v[218:219], v239 offset:20992
    v_mfma_f32_16x16x32_bf16 v[76:79], v[180:183], v[224:227], 0
    v_mfma_f32_16x16x32_bf16 v[80:83], v[180:183], v[228:231], 0
    v_mfma_f32_16x16x32_bf16 v[84:87], v[184:187], v[220:223], 0
    v_mfma_f32_16x16x32_bf16 v[88:91], v[184:187], v[224:227], 0
    v_mfma_f32_16x16x32_bf16 v[92:95], v[184:187], v[228:231], 0
    s_waitcnt lgkmcnt(0)
    s_barrier
    v_mfma_f32_16x16x32_bf16 v[0:3], v[188:191], v[96:99], v[0:3]
    ds_read_b128 v[220:223], v240 offset:0
    v_mfma_f32_16x16x32_bf16 v[4:7], v[188:191], v[100:103], v[4:7]
    ds_read_b64_tr_b16 v[156:157], v236 offset:32768
    v_mfma_f32_16x16x32_bf16 v[8:11], v[188:191], v[104:107], v[8:11]
    ds_read_b64_tr_b16 v[158:159], v236 offset:33280
    v_mfma_f32_16x16x32_bf16 v[12:15], v[192:195], v[96:99], v[12:15]
    ds_read_b128 v[224:227], v240 offset:2048
    v_mfma_f32_16x16x32_bf16 v[16:19], v[192:195], v[100:103], v[16:19]
    ds_read_b128 v[228:231], v240 offset:4096
    v_mfma_f32_16x16x32_bf16 v[20:23], v[192:195], v[104:107], v[20:23]
    ds_read_b64_tr_b16 v[160:161], v237 offset:32768
    v_mfma_f32_16x16x32_bf16 v[24:27], v[196:199], v[96:99], v[24:27]
    ds_read_b64_tr_b16 v[162:163], v237 offset:33280
    v_mfma_f32_16x16x32_bf16 v[28:31], v[196:199], v[100:103], v[28:31]
    ds_read_b64_tr_b16 v[164:165], v238 offset:32768
    v_mfma_f32_16x16x32_bf16 v[32:35], v[196:199], v[104:107], v[32:35]
    ds_read_b64_tr_b16 v[166:167], v238 offset:33280
    v_mfma_f32_16x16x32_bf16 v[36:39], v[200:203], v[96:99], v[36:39]
    ds_read_b64_tr_b16 v[168:169], v239 offset:32768
    v_mfma_f32_16x16x32_bf16 v[40:43], v[200:203], v[100:103], v[40:43]
    ds_read_b64_tr_b16 v[170:171], v239 offset:33280
    v_mfma_f32_16x16x32_bf16 v[44:47], v[200:203], v[104:107], v[44:47]
    ds_read_b64_tr_b16 v[172:173], v236 offset:36864
    v_mfma_f32_16x16x32_bf16 v[48:51], v[204:207], v[96:99], v[48:51]
    ds_read_b64_tr_b16 v[174:175], v236 offset:37376
    v_mfma_f32_16x16x32_bf16 v[52:55], v[204:207], v[100:103], v[52:55]
    ds_read_b64_tr_b16 v[176:177], v237 offset:36864
    v_mfma_f32_16x16x32_bf16 v[56:59], v[204:207], v[104:107], v[56:59]
    ds_read_b64_tr_b16 v[178:179], v237 offset:37376
    v_mfma_f32_16x16x32_bf16 v[60:63], v[208:211], v[96:99], v[60:63]
    ds_read_b64_tr_b16 v[180:181], v238 offset:36864
    v_mfma_f32_16x16x32_bf16 v[64:67], v[208:211], v[100:103], v[64:67]
    ds_read_b64_tr_b16 v[182:183], v238 offset:37376
    v_mfma_f32_16x16x32_bf16 v[68:71], v[208:211], v[104:107], v[68:71]
    ds_read_b64_tr_b16 v[184:185], v239 offset:36864
    v_mfma_f32_16x16x32_bf16 v[72:75], v[212:215], v[96:99], v[72:75]
    ds_read_b64_tr_b16 v[186:187], v239 offset:37376
    v_mfma_f32_16x16x32_bf16 v[76:79], v[212:215], v[100:103], v[76:79]
    v_mfma_f32_16x16x32_bf16 v[80:83], v[212:215], v[104:107], v[80:83]
    v_mfma_f32_16x16x32_bf16 v[84:87], v[216:219], v[96:99], v[84:87]
    v_mfma_f32_16x16x32_bf16 v[88:91], v[216:219], v[100:103], v[88:91]
    v_mfma_f32_16x16x32_bf16 v[92:95], v[216:219], v[104:107], v[92:95]
    s_waitcnt lgkmcnt(0)
    s_barrier
    v_mfma_f32_16x16x32_bf16 v[0:3], v[156:159], v[220:223], v[0:3]
    ds_read_b128 v[96:99], v241 offset:0
    v_mfma_f32_16x16x32_bf16 v[4:7], v[156:159], v[224:227], v[4:7]
    ds_read_b64_tr_b16 v[188:189], v236 offset:0
    v_mfma_f32_16x16x32_bf16 v[8:11], v[156:159], v[228:231], v[8:11]
    ds_read_b64_tr_b16 v[190:191], v236 offset:512
    v_mfma_f32_16x16x32_bf16 v[12:15], v[160:163], v[220:223], v[12:15]
    ds_read_b128 v[100:103], v241 offset:2048
    v_mfma_f32_16x16x32_bf16 v[16:19], v[160:163], v[224:227], v[16:19]
    ds_read_b128 v[104:107], v241 offset:4096
    v_mfma_f32_16x16x32_bf16 v[20:23], v[160:163], v[228:231], v[20:23]
    ds_read_b64_tr_b16 v[192:193], v237 offset:0
    v_mfma_f32_16x16x32_bf16 v[24:27], v[164:167], v[220:223], v[24:27]
    ds_read_b64_tr_b16 v[194:195], v237 offset:512
    v_mfma_f32_16x16x32_bf16 v[28:31], v[164:167], v[224:227], v[28:31]
    ds_read_b64_tr_b16 v[196:197], v238 offset:0
    v_mfma_f32_16x16x32_bf16 v[32:35], v[164:167], v[228:231], v[32:35]
    ds_read_b64_tr_b16 v[198:199], v238 offset:512
    v_mfma_f32_16x16x32_bf16 v[36:39], v[168:171], v[220:223], v[36:39]
    ds_read_b64_tr_b16 v[200:201], v239 offset:0
    v_mfma_f32_16x16x32_bf16 v[40:43], v[168:171], v[224:227], v[40:43]
    ds_read_b64_tr_b16 v[202:203], v239 offset:512
    v_mfma_f32_16x16x32_bf16 v[44:47], v[168:171], v[228:231], v[44:47]
    ds_read_b64_tr_b16 v[204:205], v236 offset:4096
    v_mfma_f32_16x16x32_bf16 v[48:51], v[172:175], v[220:223], v[48:51]
    ds_read_b64_tr_b16 v[206:207], v236 offset:4608
    v_mfma_f32_16x16x32_bf16 v[52:55], v[172:175], v[224:227], v[52:55]
    ds_read_b64_tr_b16 v[208:209], v237 offset:4096
    v_mfma_f32_16x16x32_bf16 v[56:59], v[172:175], v[228:231], v[56:59]
    ds_read_b64_tr_b16 v[210:211], v237 offset:4608
    v_mfma_f32_16x16x32_bf16 v[60:63], v[176:179], v[220:223], v[60:63]
    ds_read_b64_tr_b16 v[212:213], v238 offset:4096
    v_mfma_f32_16x16x32_bf16 v[64:67], v[176:179], v[224:227], v[64:67]
    ds_read_b64_tr_b16 v[214:215], v238 offset:4608
    v_mfma_f32_16x16x32_bf16 v[68:71], v[176:179], v[228:231], v[68:71]
    ds_read_b64_tr_b16 v[216:217], v239 offset:4096
    v_mfma_f32_16x16x32_bf16 v[72:75], v[180:183], v[220:223], v[72:75]
    ds_read_b64_tr_b16 v[218:219], v239 offset:4608
    v_mfma_f32_16x16x32_bf16 v[76:79], v[180:183], v[224:227], v[76:79]
    v_mfma_f32_16x16x32_bf16 v[80:83], v[180:183], v[228:231], v[80:83]
    v_mfma_f32_16x16x32_bf16 v[84:87], v[184:187], v[220:223], v[84:87]
    v_mfma_f32_16x16x32_bf16 v[88:91], v[184:187], v[224:227], v[88:91]
    v_mfma_f32_16x16x32_bf16 v[92:95], v[184:187], v[228:231], v[92:95]
    s_waitcnt lgkmcnt(0)
    s_barrier
    v_mfma_f32_16x16x32_bf16 v[0:3], v[188:191], v[96:99], v[0:3]
    ds_read_b128 v[220:223], v240 offset:12288
    v_mfma_f32_16x16x32_bf16 v[4:7], v[188:191], v[100:103], v[4:7]
    ds_read_b64_tr_b16 v[156:157], v236 offset:16384
    v_mfma_f32_16x16x32_bf16 v[8:11], v[188:191], v[104:107], v[8:11]
    ds_read_b64_tr_b16 v[158:159], v236 offset:16896
    v_mfma_f32_16x16x32_bf16 v[12:15], v[192:195], v[96:99], v[12:15]
    ds_read_b128 v[224:227], v240 offset:14336
    v_mfma_f32_16x16x32_bf16 v[16:19], v[192:195], v[100:103], v[16:19]
    ds_read_b128 v[228:231], v240 offset:16384
    v_mfma_f32_16x16x32_bf16 v[20:23], v[192:195], v[104:107], v[20:23]
    ds_read_b64_tr_b16 v[160:161], v237 offset:16384
    v_mfma_f32_16x16x32_bf16 v[24:27], v[196:199], v[96:99], v[24:27]
    ds_read_b64_tr_b16 v[162:163], v237 offset:16896
    v_mfma_f32_16x16x32_bf16 v[28:31], v[196:199], v[100:103], v[28:31]
    ds_read_b64_tr_b16 v[164:165], v238 offset:16384
    v_mfma_f32_16x16x32_bf16 v[32:35], v[196:199], v[104:107], v[32:35]
    ds_read_b64_tr_b16 v[166:167], v238 offset:16896
    v_mfma_f32_16x16x32_bf16 v[36:39], v[200:203], v[96:99], v[36:39]
    ds_read_b64_tr_b16 v[168:169], v239 offset:16384
    v_mfma_f32_16x16x32_bf16 v[40:43], v[200:203], v[100:103], v[40:43]
    ds_read_b64_tr_b16 v[170:171], v239 offset:16896
    v_mfma_f32_16x16x32_bf16 v[44:47], v[200:203], v[104:107], v[44:47]
    ds_read_b64_tr_b16 v[172:173], v236 offset:20480
    v_mfma_f32_16x16x32_bf16 v[48:51], v[204:207], v[96:99], v[48:51]
    ds_read_b64_tr_b16 v[174:175], v236 offset:20992
    v_mfma_f32_16x16x32_bf16 v[52:55], v[204:207], v[100:103], v[52:55]
    ds_read_b64_tr_b16 v[176:177], v237 offset:20480
    v_mfma_f32_16x16x32_bf16 v[56:59], v[204:207], v[104:107], v[56:59]
    ds_read_b64_tr_b16 v[178:179], v237 offset:20992
    v_mfma_f32_16x16x32_bf16 v[60:63], v[208:211], v[96:99], v[60:63]
    ds_read_b64_tr_b16 v[180:181], v238 offset:20480
    v_mfma_f32_16x16x32_bf16 v[64:67], v[208:211], v[100:103], v[64:67]
    ds_read_b64_tr_b16 v[182:183], v238 offset:20992
    v_mfma_f32_16x16x32_bf16 v[68:71], v[208:211], v[104:107], v[68:71]
    ds_read_b64_tr_b16 v[184:185], v239 offset:20480
    v_mfma_f32_16x16x32_bf16 v[72:75], v[212:215], v[96:99], v[72:75]
    ds_read_b64_tr_b16 v[186:187], v239 offset:20992
    v_mfma_f32_16x16x32_bf16 v[76:79], v[212:215], v[100:103], v[76:79]
    v_mfma_f32_16x16x32_bf16 v[80:83], v[212:215], v[104:107], v[80:83]
    v_mfma_f32_16x16x32_bf16 v[84:87], v[216:219], v[96:99], v[84:87]
    v_mfma_f32_16x16x32_bf16 v[88:91], v[216:219], v[100:103], v[88:91]
    v_mfma_f32_16x16x32_bf16 v[92:95], v[216:219], v[104:107], v[92:95]
    s_waitcnt lgkmcnt(0)
    s_barrier
    v_mfma_f32_16x16x32_bf16 v[0:3], v[156:159], v[220:223], v[0:3]
    ds_read_b128 v[96:99], v241 offset:12288
    v_mfma_f32_16x16x32_bf16 v[4:7], v[156:159], v[224:227], v[4:7]
    ds_read_b64_tr_b16 v[188:189], v236 offset:32768
    v_mfma_f32_16x16x32_bf16 v[8:11], v[156:159], v[228:231], v[8:11]
    ds_read_b64_tr_b16 v[190:191], v236 offset:33280
    v_mfma_f32_16x16x32_bf16 v[12:15], v[160:163], v[220:223], v[12:15]
    ds_read_b128 v[100:103], v241 offset:14336
    v_mfma_f32_16x16x32_bf16 v[16:19], v[160:163], v[224:227], v[16:19]
    ds_read_b128 v[104:107], v241 offset:16384
    v_mfma_f32_16x16x32_bf16 v[20:23], v[160:163], v[228:231], v[20:23]
    ds_read_b64_tr_b16 v[192:193], v237 offset:32768
    v_mfma_f32_16x16x32_bf16 v[24:27], v[164:167], v[220:223], v[24:27]
    ds_read_b64_tr_b16 v[194:195], v237 offset:33280
    v_mfma_f32_16x16x32_bf16 v[28:31], v[164:167], v[224:227], v[28:31]
    ds_read_b64_tr_b16 v[196:197], v238 offset:32768
    v_mfma_f32_16x16x32_bf16 v[32:35], v[164:167], v[228:231], v[32:35]
    ds_read_b64_tr_b16 v[198:199], v238 offset:33280
    v_mfma_f32_16x16x32_bf16 v[36:39], v[168:171], v[220:223], v[36:39]
    ds_read_b64_tr_b16 v[200:201], v239 offset:32768
    v_mfma_f32_16x16x32_bf16 v[40:43], v[168:171], v[224:227], v[40:43]
    ds_read_b64_tr_b16 v[202:203], v239 offset:33280
    v_mfma_f32_16x16x32_bf16 v[44:47], v[168:171], v[228:231], v[44:47]
    ds_read_b64_tr_b16 v[204:205], v236 offset:36864
    v_mfma_f32_16x16x32_bf16 v[48:51], v[172:175], v[220:223], v[48:51]
    ds_read_b64_tr_b16 v[206:207], v236 offset:37376
    v_mfma_f32_16x16x32_bf16 v[52:55], v[172:175], v[224:227], v[52:55]
    ds_read_b64_tr_b16 v[208:209], v237 offset:36864
    v_mfma_f32_16x16x32_bf16 v[56:59], v[172:175], v[228:231], v[56:59]
    ds_read_b64_tr_b16 v[210:211], v237 offset:37376
    v_mfma_f32_16x16x32_bf16 v[60:63], v[176:179], v[220:223], v[60:63]
    ds_read_b64_tr_b16 v[212:213], v238 offset:36864
    v_mfma_f32_16x16x32_bf16 v[64:67], v[176:179], v[224:227], v[64:67]
    ds_read_b64_tr_b16 v[214:215], v238 offset:37376
    v_mfma_f32_16x16x32_bf16 v[68:71], v[176:179], v[228:231], v[68:71]
    ds_read_b64_tr_b16 v[216:217], v239 offset:36864
    v_mfma_f32_16x16x32_bf16 v[72:75], v[180:183], v[220:223], v[72:75]
    ds_read_b64_tr_b16 v[218:219], v239 offset:37376
    v_mfma_f32_16x16x32_bf16 v[76:79], v[180:183], v[224:227], v[76:79]
    v_mfma_f32_16x16x32_bf16 v[80:83], v[180:183], v[228:231], v[80:83]
    v_mfma_f32_16x16x32_bf16 v[84:87], v[184:187], v[220:223], v[84:87]
    v_mfma_f32_16x16x32_bf16 v[88:91], v[184:187], v[224:227], v[88:91]
    v_mfma_f32_16x16x32_bf16 v[92:95], v[184:187], v[228:231], v[92:95]
    s_waitcnt lgkmcnt(0)
    s_barrier
    v_mfma_f32_16x16x32_bf16 v[0:3], v[188:191], v[96:99], v[0:3]
    ds_read_b128 v[220:223], v240 offset:0
    v_mfma_f32_16x16x32_bf16 v[4:7], v[188:191], v[100:103], v[4:7]
    ds_read_b64_tr_b16 v[156:157], v236 offset:0
    v_mfma_f32_16x16x32_bf16 v[8:11], v[188:191], v[104:107], v[8:11]
    ds_read_b64_tr_b16 v[158:159], v236 offset:512
    v_mfma_f32_16x16x32_bf16 v[12:15], v[192:195], v[96:99], v[12:15]
    ds_read_b128 v[224:227], v240 offset:2048
    v_mfma_f32_16x16x32_bf16 v[16:19], v[192:195], v[100:103], v[16:19]
    ds_read_b128 v[228:231], v240 offset:4096
    v_mfma_f32_16x16x32_bf16 v[20:23], v[192:195], v[104:107], v[20:23]
    ds_read_b64_tr_b16 v[160:161], v237 offset:0
    v_mfma_f32_16x16x32_bf16 v[24:27], v[196:199], v[96:99], v[24:27]
    ds_read_b64_tr_b16 v[162:163], v237 offset:512
    v_mfma_f32_16x16x32_bf16 v[28:31], v[196:199], v[100:103], v[28:31]
    ds_read_b64_tr_b16 v[164:165], v238 offset:0
    v_mfma_f32_16x16x32_bf16 v[32:35], v[196:199], v[104:107], v[32:35]
    ds_read_b64_tr_b16 v[166:167], v238 offset:512
    v_mfma_f32_16x16x32_bf16 v[36:39], v[200:203], v[96:99], v[36:39]
    ds_read_b64_tr_b16 v[168:169], v239 offset:0
    v_mfma_f32_16x16x32_bf16 v[40:43], v[200:203], v[100:103], v[40:43]
    ds_read_b64_tr_b16 v[170:171], v239 offset:512
    v_mfma_f32_16x16x32_bf16 v[44:47], v[200:203], v[104:107], v[44:47]
    ds_read_b64_tr_b16 v[172:173], v236 offset:4096
    v_mfma_f32_16x16x32_bf16 v[48:51], v[204:207], v[96:99], v[48:51]
    ds_read_b64_tr_b16 v[174:175], v236 offset:4608
    v_mfma_f32_16x16x32_bf16 v[52:55], v[204:207], v[100:103], v[52:55]
    ds_read_b64_tr_b16 v[176:177], v237 offset:4096
    v_mfma_f32_16x16x32_bf16 v[56:59], v[204:207], v[104:107], v[56:59]
    ds_read_b64_tr_b16 v[178:179], v237 offset:4608
    v_mfma_f32_16x16x32_bf16 v[60:63], v[208:211], v[96:99], v[60:63]
    ds_read_b64_tr_b16 v[180:181], v238 offset:4096
    v_mfma_f32_16x16x32_bf16 v[64:67], v[208:211], v[100:103], v[64:67]
    ds_read_b64_tr_b16 v[182:183], v238 offset:4608
    v_mfma_f32_16x16x32_bf16 v[68:71], v[208:211], v[104:107], v[68:71]
    ds_read_b64_tr_b16 v[184:185], v239 offset:4096
    v_mfma_f32_16x16x32_bf16 v[72:75], v[212:215], v[96:99], v[72:75]
    ds_read_b64_tr_b16 v[186:187], v239 offset:4608
    v_mfma_f32_16x16x32_bf16 v[76:79], v[212:215], v[100:103], v[76:79]
    v_mfma_f32_16x16x32_bf16 v[80:83], v[212:215], v[104:107], v[80:83]
    v_mfma_f32_16x16x32_bf16 v[84:87], v[216:219], v[96:99], v[84:87]
    v_mfma_f32_16x16x32_bf16 v[88:91], v[216:219], v[100:103], v[88:91]
    v_mfma_f32_16x16x32_bf16 v[92:95], v[216:219], v[104:107], v[92:95]
    s_waitcnt lgkmcnt(0)
    s_barrier
    v_mfma_f32_16x16x32_bf16 v[0:3], v[156:159], v[220:223], v[0:3]
    ds_read_b128 v[96:99], v241 offset:0
    v_mfma_f32_16x16x32_bf16 v[4:7], v[156:159], v[224:227], v[4:7]
    ds_read_b64_tr_b16 v[188:189], v236 offset:16384
    v_mfma_f32_16x16x32_bf16 v[8:11], v[156:159], v[228:231], v[8:11]
    ds_read_b64_tr_b16 v[190:191], v236 offset:16896
    v_mfma_f32_16x16x32_bf16 v[12:15], v[160:163], v[220:223], v[12:15]
    ds_read_b128 v[100:103], v241 offset:2048
    v_mfma_f32_16x16x32_bf16 v[16:19], v[160:163], v[224:227], v[16:19]
    ds_read_b128 v[104:107], v241 offset:4096
    v_mfma_f32_16x16x32_bf16 v[20:23], v[160:163], v[228:231], v[20:23]
    ds_read_b64_tr_b16 v[192:193], v237 offset:16384
    v_mfma_f32_16x16x32_bf16 v[24:27], v[164:167], v[220:223], v[24:27]
    ds_read_b64_tr_b16 v[194:195], v237 offset:16896
    v_mfma_f32_16x16x32_bf16 v[28:31], v[164:167], v[224:227], v[28:31]
    ds_read_b64_tr_b16 v[196:197], v238 offset:16384
    v_mfma_f32_16x16x32_bf16 v[32:35], v[164:167], v[228:231], v[32:35]
    ds_read_b64_tr_b16 v[198:199], v238 offset:16896
    v_mfma_f32_16x16x32_bf16 v[36:39], v[168:171], v[220:223], v[36:39]
    ds_read_b64_tr_b16 v[200:201], v239 offset:16384
    v_mfma_f32_16x16x32_bf16 v[40:43], v[168:171], v[224:227], v[40:43]
    ds_read_b64_tr_b16 v[202:203], v239 offset:16896
    v_mfma_f32_16x16x32_bf16 v[44:47], v[168:171], v[228:231], v[44:47]
    ds_read_b64_tr_b16 v[204:205], v236 offset:20480
    v_mfma_f32_16x16x32_bf16 v[48:51], v[172:175], v[220:223], v[48:51]
    ds_read_b64_tr_b16 v[206:207], v236 offset:20992
    v_mfma_f32_16x16x32_bf16 v[52:55], v[172:175], v[224:227], v[52:55]
    ds_read_b64_tr_b16 v[208:209], v237 offset:20480
    v_mfma_f32_16x16x32_bf16 v[56:59], v[172:175], v[228:231], v[56:59]
    ds_read_b64_tr_b16 v[210:211], v237 offset:20992
    v_mfma_f32_16x16x32_bf16 v[60:63], v[176:179], v[220:223], v[60:63]
    ds_read_b64_tr_b16 v[212:213], v238 offset:20480
    v_mfma_f32_16x16x32_bf16 v[64:67], v[176:179], v[224:227], v[64:67]
    ds_read_b64_tr_b16 v[214:215], v238 offset:20992
    v_mfma_f32_16x16x32_bf16 v[68:71], v[176:179], v[228:231], v[68:71]
    ds_read_b64_tr_b16 v[216:217], v239 offset:20480
    v_mfma_f32_16x16x32_bf16 v[72:75], v[180:183], v[220:223], v[72:75]
    ds_read_b64_tr_b16 v[218:219], v239 offset:20992
    v_mfma_f32_16x16x32_bf16 v[76:79], v[180:183], v[224:227], v[76:79]
    v_mfma_f32_16x16x32_bf16 v[80:83], v[180:183], v[228:231], v[80:83]
    v_mfma_f32_16x16x32_bf16 v[84:87], v[184:187], v[220:223], v[84:87]
    v_mfma_f32_16x16x32_bf16 v[88:91], v[184:187], v[224:227], v[88:91]
    v_mfma_f32_16x16x32_bf16 v[92:95], v[184:187], v[228:231], v[92:95]
    s_waitcnt lgkmcnt(0)
    s_barrier
    v_mfma_f32_16x16x32_bf16 v[0:3], v[188:191], v[96:99], v[0:3]
    ds_read_b128 v[220:223], v240 offset:12288
    v_mfma_f32_16x16x32_bf16 v[4:7], v[188:191], v[100:103], v[4:7]
    ds_read_b64_tr_b16 v[156:157], v236 offset:32768
    v_mfma_f32_16x16x32_bf16 v[8:11], v[188:191], v[104:107], v[8:11]
    ds_read_b64_tr_b16 v[158:159], v236 offset:33280
    v_mfma_f32_16x16x32_bf16 v[12:15], v[192:195], v[96:99], v[12:15]
    ds_read_b128 v[224:227], v240 offset:14336
    v_mfma_f32_16x16x32_bf16 v[16:19], v[192:195], v[100:103], v[16:19]
    ds_read_b128 v[228:231], v240 offset:16384
    v_mfma_f32_16x16x32_bf16 v[20:23], v[192:195], v[104:107], v[20:23]
    ds_read_b64_tr_b16 v[160:161], v237 offset:32768
    v_mfma_f32_16x16x32_bf16 v[24:27], v[196:199], v[96:99], v[24:27]
    ds_read_b64_tr_b16 v[162:163], v237 offset:33280
    v_mfma_f32_16x16x32_bf16 v[28:31], v[196:199], v[100:103], v[28:31]
    ds_read_b64_tr_b16 v[164:165], v238 offset:32768
    v_mfma_f32_16x16x32_bf16 v[32:35], v[196:199], v[104:107], v[32:35]
    ds_read_b64_tr_b16 v[166:167], v238 offset:33280
    v_mfma_f32_16x16x32_bf16 v[36:39], v[200:203], v[96:99], v[36:39]
    ds_read_b64_tr_b16 v[168:169], v239 offset:32768
    v_mfma_f32_16x16x32_bf16 v[40:43], v[200:203], v[100:103], v[40:43]
    ds_read_b64_tr_b16 v[170:171], v239 offset:33280
    v_mfma_f32_16x16x32_bf16 v[44:47], v[200:203], v[104:107], v[44:47]
    ds_read_b64_tr_b16 v[172:173], v236 offset:36864
    v_mfma_f32_16x16x32_bf16 v[48:51], v[204:207], v[96:99], v[48:51]
    ds_read_b64_tr_b16 v[174:175], v236 offset:37376
    v_mfma_f32_16x16x32_bf16 v[52:55], v[204:207], v[100:103], v[52:55]
    ds_read_b64_tr_b16 v[176:177], v237 offset:36864
    v_mfma_f32_16x16x32_bf16 v[56:59], v[204:207], v[104:107], v[56:59]
    ds_read_b64_tr_b16 v[178:179], v237 offset:37376
    v_mfma_f32_16x16x32_bf16 v[60:63], v[208:211], v[96:99], v[60:63]
    ds_read_b64_tr_b16 v[180:181], v238 offset:36864
    v_mfma_f32_16x16x32_bf16 v[64:67], v[208:211], v[100:103], v[64:67]
    ds_read_b64_tr_b16 v[182:183], v238 offset:37376
    v_mfma_f32_16x16x32_bf16 v[68:71], v[208:211], v[104:107], v[68:71]
    ds_read_b64_tr_b16 v[184:185], v239 offset:36864
    v_mfma_f32_16x16x32_bf16 v[72:75], v[212:215], v[96:99], v[72:75]
    ds_read_b64_tr_b16 v[186:187], v239 offset:37376
    v_mfma_f32_16x16x32_bf16 v[76:79], v[212:215], v[100:103], v[76:79]
    v_mfma_f32_16x16x32_bf16 v[80:83], v[212:215], v[104:107], v[80:83]
    v_mfma_f32_16x16x32_bf16 v[84:87], v[216:219], v[96:99], v[84:87]
    v_mfma_f32_16x16x32_bf16 v[88:91], v[216:219], v[100:103], v[88:91]
    v_mfma_f32_16x16x32_bf16 v[92:95], v[216:219], v[104:107], v[92:95]
    s_waitcnt lgkmcnt(0)
    s_barrier
    v_mfma_f32_16x16x32_bf16 v[0:3], v[156:159], v[220:223], v[0:3]
    ds_read_b128 v[96:99], v241 offset:12288
    v_mfma_f32_16x16x32_bf16 v[4:7], v[156:159], v[224:227], v[4:7]
    ds_read_b64_tr_b16 v[188:189], v236 offset:0
    v_mfma_f32_16x16x32_bf16 v[8:11], v[156:159], v[228:231], v[8:11]
    ds_read_b64_tr_b16 v[190:191], v236 offset:512
    v_mfma_f32_16x16x32_bf16 v[12:15], v[160:163], v[220:223], v[12:15]
    ds_read_b128 v[100:103], v241 offset:14336
    v_mfma_f32_16x16x32_bf16 v[16:19], v[160:163], v[224:227], v[16:19]
    ds_read_b128 v[104:107], v241 offset:16384
    v_mfma_f32_16x16x32_bf16 v[20:23], v[160:163], v[228:231], v[20:23]
    ds_read_b64_tr_b16 v[192:193], v237 offset:0
    v_mfma_f32_16x16x32_bf16 v[24:27], v[164:167], v[220:223], v[24:27]
    ds_read_b64_tr_b16 v[194:195], v237 offset:512
    v_mfma_f32_16x16x32_bf16 v[28:31], v[164:167], v[224:227], v[28:31]
    ds_read_b64_tr_b16 v[196:197], v238 offset:0
    v_mfma_f32_16x16x32_bf16 v[32:35], v[164:167], v[228:231], v[32:35]
    ds_read_b64_tr_b16 v[198:199], v238 offset:512
    v_mfma_f32_16x16x32_bf16 v[36:39], v[168:171], v[220:223], v[36:39]
    ds_read_b64_tr_b16 v[200:201], v239 offset:0
    v_mfma_f32_16x16x32_bf16 v[40:43], v[168:171], v[224:227], v[40:43]
    ds_read_b64_tr_b16 v[202:203], v239 offset:512
    v_mfma_f32_16x16x32_bf16 v[44:47], v[168:171], v[228:231], v[44:47]
    ds_read_b64_tr_b16 v[204:205], v236 offset:4096
    v_mfma_f32_16x16x32_bf16 v[48:51], v[172:175], v[220:223], v[48:51]
    ds_read_b64_tr_b16 v[206:207], v236 offset:4608
    v_mfma_f32_16x16x32_bf16 v[52:55], v[172:175], v[224:227], v[52:55]
    ds_read_b64_tr_b16 v[208:209], v237 offset:4096
    v_mfma_f32_16x16x32_bf16 v[56:59], v[172:175], v[228:231], v[56:59]
    ds_read_b64_tr_b16 v[210:211], v237 offset:4608
    v_mfma_f32_16x16x32_bf16 v[60:63], v[176:179], v[220:223], v[60:63]
    ds_read_b64_tr_b16 v[212:213], v238 offset:4096
    v_mfma_f32_16x16x32_bf16 v[64:67], v[176:179], v[224:227], v[64:67]
    ds_read_b64_tr_b16 v[214:215], v238 offset:4608
    v_mfma_f32_16x16x32_bf16 v[68:71], v[176:179], v[228:231], v[68:71]
    ds_read_b64_tr_b16 v[216:217], v239 offset:4096
    v_mfma_f32_16x16x32_bf16 v[72:75], v[180:183], v[220:223], v[72:75]
    ds_read_b64_tr_b16 v[218:219], v239 offset:4608
    v_mfma_f32_16x16x32_bf16 v[76:79], v[180:183], v[224:227], v[76:79]
    v_mfma_f32_16x16x32_bf16 v[80:83], v[180:183], v[228:231], v[80:83]
    v_mfma_f32_16x16x32_bf16 v[84:87], v[184:187], v[220:223], v[84:87]
    v_mfma_f32_16x16x32_bf16 v[88:91], v[184:187], v[224:227], v[88:91]
    v_mfma_f32_16x16x32_bf16 v[92:95], v[184:187], v[228:231], v[92:95]
    s_waitcnt lgkmcnt(0)
    s_barrier
    v_mfma_f32_16x16x32_bf16 v[0:3], v[188:191], v[96:99], v[0:3]
    ds_read_b128 v[220:223], v240 offset:0
    v_mfma_f32_16x16x32_bf16 v[4:7], v[188:191], v[100:103], v[4:7]
    ds_read_b64_tr_b16 v[156:157], v236 offset:16384
    v_mfma_f32_16x16x32_bf16 v[8:11], v[188:191], v[104:107], v[8:11]
    ds_read_b64_tr_b16 v[158:159], v236 offset:16896
    v_mfma_f32_16x16x32_bf16 v[12:15], v[192:195], v[96:99], v[12:15]
    ds_read_b128 v[224:227], v240 offset:2048
    v_mfma_f32_16x16x32_bf16 v[16:19], v[192:195], v[100:103], v[16:19]
    ds_read_b128 v[228:231], v240 offset:4096
    v_mfma_f32_16x16x32_bf16 v[20:23], v[192:195], v[104:107], v[20:23]
    ds_read_b64_tr_b16 v[160:161], v237 offset:16384
    v_mfma_f32_16x16x32_bf16 v[24:27], v[196:199], v[96:99], v[24:27]
    ds_read_b64_tr_b16 v[162:163], v237 offset:16896
    v_mfma_f32_16x16x32_bf16 v[28:31], v[196:199], v[100:103], v[28:31]
    ds_read_b64_tr_b16 v[164:165], v238 offset:16384
    v_mfma_f32_16x16x32_bf16 v[32:35], v[196:199], v[104:107], v[32:35]
    ds_read_b64_tr_b16 v[166:167], v238 offset:16896
    v_mfma_f32_16x16x32_bf16 v[36:39], v[200:203], v[96:99], v[36:39]
    ds_read_b64_tr_b16 v[168:169], v239 offset:16384
    v_mfma_f32_16x16x32_bf16 v[40:43], v[200:203], v[100:103], v[40:43]
    ds_read_b64_tr_b16 v[170:171], v239 offset:16896
    v_mfma_f32_16x16x32_bf16 v[44:47], v[200:203], v[104:107], v[44:47]
    ds_read_b64_tr_b16 v[172:173], v236 offset:20480
    v_mfma_f32_16x16x32_bf16 v[48:51], v[204:207], v[96:99], v[48:51]
    ds_read_b64_tr_b16 v[174:175], v236 offset:20992
    v_mfma_f32_16x16x32_bf16 v[52:55], v[204:207], v[100:103], v[52:55]
    ds_read_b64_tr_b16 v[176:177], v237 offset:20480
    v_mfma_f32_16x16x32_bf16 v[56:59], v[204:207], v[104:107], v[56:59]
    ds_read_b64_tr_b16 v[178:179], v237 offset:20992
    v_mfma_f32_16x16x32_bf16 v[60:63], v[208:211], v[96:99], v[60:63]
    ds_read_b64_tr_b16 v[180:181], v238 offset:20480
    v_mfma_f32_16x16x32_bf16 v[64:67], v[208:211], v[100:103], v[64:67]
    ds_read_b64_tr_b16 v[182:183], v238 offset:20992
    v_mfma_f32_16x16x32_bf16 v[68:71], v[208:211], v[104:107], v[68:71]
    ds_read_b64_tr_b16 v[184:185], v239 offset:20480
    v_mfma_f32_16x16x32_bf16 v[72:75], v[212:215], v[96:99], v[72:75]
    ds_read_b64_tr_b16 v[186:187], v239 offset:20992
    v_mfma_f32_16x16x32_bf16 v[76:79], v[212:215], v[100:103], v[76:79]
    v_mfma_f32_16x16x32_bf16 v[80:83], v[212:215], v[104:107], v[80:83]
    v_mfma_f32_16x16x32_bf16 v[84:87], v[216:219], v[96:99], v[84:87]
    v_mfma_f32_16x16x32_bf16 v[88:91], v[216:219], v[100:103], v[88:91]
    v_mfma_f32_16x16x32_bf16 v[92:95], v[216:219], v[104:107], v[92:95]
    s_waitcnt lgkmcnt(0)
    s_barrier
    v_mfma_f32_16x16x32_bf16 v[0:3], v[156:159], v[220:223], v[0:3]
    ds_read_b128 v[96:99], v241 offset:0
    v_mfma_f32_16x16x32_bf16 v[4:7], v[156:159], v[224:227], v[4:7]
    ds_read_b64_tr_b16 v[188:189], v236 offset:32768
    v_mfma_f32_16x16x32_bf16 v[8:11], v[156:159], v[228:231], v[8:11]
    ds_read_b64_tr_b16 v[190:191], v236 offset:33280
    v_mfma_f32_16x16x32_bf16 v[12:15], v[160:163], v[220:223], v[12:15]
    ds_read_b128 v[100:103], v241 offset:2048
    v_mfma_f32_16x16x32_bf16 v[16:19], v[160:163], v[224:227], v[16:19]
    ds_read_b128 v[104:107], v241 offset:4096
    v_mfma_f32_16x16x32_bf16 v[20:23], v[160:163], v[228:231], v[20:23]
    ds_read_b64_tr_b16 v[192:193], v237 offset:32768
    v_mfma_f32_16x16x32_bf16 v[24:27], v[164:167], v[220:223], v[24:27]
    ds_read_b64_tr_b16 v[194:195], v237 offset:33280
    v_mfma_f32_16x16x32_bf16 v[28:31], v[164:167], v[224:227], v[28:31]
    ds_read_b64_tr_b16 v[196:197], v238 offset:32768
    v_mfma_f32_16x16x32_bf16 v[32:35], v[164:167], v[228:231], v[32:35]
    ds_read_b64_tr_b16 v[198:199], v238 offset:33280
    v_mfma_f32_16x16x32_bf16 v[36:39], v[168:171], v[220:223], v[36:39]
    ds_read_b64_tr_b16 v[200:201], v239 offset:32768
    v_mfma_f32_16x16x32_bf16 v[40:43], v[168:171], v[224:227], v[40:43]
    ds_read_b64_tr_b16 v[202:203], v239 offset:33280
    v_mfma_f32_16x16x32_bf16 v[44:47], v[168:171], v[228:231], v[44:47]
    ds_read_b64_tr_b16 v[204:205], v236 offset:36864
    v_mfma_f32_16x16x32_bf16 v[48:51], v[172:175], v[220:223], v[48:51]
    ds_read_b64_tr_b16 v[206:207], v236 offset:37376
    v_mfma_f32_16x16x32_bf16 v[52:55], v[172:175], v[224:227], v[52:55]
    ds_read_b64_tr_b16 v[208:209], v237 offset:36864
    v_mfma_f32_16x16x32_bf16 v[56:59], v[172:175], v[228:231], v[56:59]
    ds_read_b64_tr_b16 v[210:211], v237 offset:37376
    v_mfma_f32_16x16x32_bf16 v[60:63], v[176:179], v[220:223], v[60:63]
    ds_read_b64_tr_b16 v[212:213], v238 offset:36864
    v_mfma_f32_16x16x32_bf16 v[64:67], v[176:179], v[224:227], v[64:67]
    ds_read_b64_tr_b16 v[214:215], v238 offset:37376
    v_mfma_f32_16x16x32_bf16 v[68:71], v[176:179], v[228:231], v[68:71]
    ds_read_b64_tr_b16 v[216:217], v239 offset:36864
    v_mfma_f32_16x16x32_bf16 v[72:75], v[180:183], v[220:223], v[72:75]
    ds_read_b64_tr_b16 v[218:219], v239 offset:37376
    v_mfma_f32_16x16x32_bf16 v[76:79], v[180:183], v[224:227], v[76:79]
    v_mfma_f32_16x16x32_bf16 v[80:83], v[180:183], v[228:231], v[80:83]
    v_mfma_f32_16x16x32_bf16 v[84:87], v[184:187], v[220:223], v[84:87]
    v_mfma_f32_16x16x32_bf16 v[88:91], v[184:187], v[224:227], v[88:91]
    v_mfma_f32_16x16x32_bf16 v[92:95], v[184:187], v[228:231], v[92:95]
    s_waitcnt lgkmcnt(0)
    s_barrier
    v_mfma_f32_16x16x32_bf16 v[0:3], v[188:191], v[96:99], v[0:3]
    ds_read_b128 v[220:223], v240 offset:12288
    v_mfma_f32_16x16x32_bf16 v[4:7], v[188:191], v[100:103], v[4:7]
    ds_read_b64_tr_b16 v[156:157], v236 offset:0
    v_mfma_f32_16x16x32_bf16 v[8:11], v[188:191], v[104:107], v[8:11]
    ds_read_b64_tr_b16 v[158:159], v236 offset:512
    v_mfma_f32_16x16x32_bf16 v[12:15], v[192:195], v[96:99], v[12:15]
    ds_read_b128 v[224:227], v240 offset:14336
    v_mfma_f32_16x16x32_bf16 v[16:19], v[192:195], v[100:103], v[16:19]
    ds_read_b128 v[228:231], v240 offset:16384
    v_mfma_f32_16x16x32_bf16 v[20:23], v[192:195], v[104:107], v[20:23]
    ds_read_b64_tr_b16 v[160:161], v237 offset:0
    v_mfma_f32_16x16x32_bf16 v[24:27], v[196:199], v[96:99], v[24:27]
    ds_read_b64_tr_b16 v[162:163], v237 offset:512
    v_mfma_f32_16x16x32_bf16 v[28:31], v[196:199], v[100:103], v[28:31]
    ds_read_b64_tr_b16 v[164:165], v238 offset:0
    v_mfma_f32_16x16x32_bf16 v[32:35], v[196:199], v[104:107], v[32:35]
    ds_read_b64_tr_b16 v[166:167], v238 offset:512
    v_mfma_f32_16x16x32_bf16 v[36:39], v[200:203], v[96:99], v[36:39]
    ds_read_b64_tr_b16 v[168:169], v239 offset:0
    v_mfma_f32_16x16x32_bf16 v[40:43], v[200:203], v[100:103], v[40:43]
    ds_read_b64_tr_b16 v[170:171], v239 offset:512
    v_mfma_f32_16x16x32_bf16 v[44:47], v[200:203], v[104:107], v[44:47]
    ds_read_b64_tr_b16 v[172:173], v236 offset:4096
    v_mfma_f32_16x16x32_bf16 v[48:51], v[204:207], v[96:99], v[48:51]
    ds_read_b64_tr_b16 v[174:175], v236 offset:4608
    v_mfma_f32_16x16x32_bf16 v[52:55], v[204:207], v[100:103], v[52:55]
    ds_read_b64_tr_b16 v[176:177], v237 offset:4096
    v_mfma_f32_16x16x32_bf16 v[56:59], v[204:207], v[104:107], v[56:59]
    ds_read_b64_tr_b16 v[178:179], v237 offset:4608
    v_mfma_f32_16x16x32_bf16 v[60:63], v[208:211], v[96:99], v[60:63]
    ds_read_b64_tr_b16 v[180:181], v238 offset:4096
    v_mfma_f32_16x16x32_bf16 v[64:67], v[208:211], v[100:103], v[64:67]
    ds_read_b64_tr_b16 v[182:183], v238 offset:4608
    v_mfma_f32_16x16x32_bf16 v[68:71], v[208:211], v[104:107], v[68:71]
    ds_read_b64_tr_b16 v[184:185], v239 offset:4096
    v_mfma_f32_16x16x32_bf16 v[72:75], v[212:215], v[96:99], v[72:75]
    ds_read_b64_tr_b16 v[186:187], v239 offset:4608
    v_mfma_f32_16x16x32_bf16 v[76:79], v[212:215], v[100:103], v[76:79]
    v_mfma_f32_16x16x32_bf16 v[80:83], v[212:215], v[104:107], v[80:83]
    v_mfma_f32_16x16x32_bf16 v[84:87], v[216:219], v[96:99], v[84:87]
    v_mfma_f32_16x16x32_bf16 v[88:91], v[216:219], v[100:103], v[88:91]
    v_mfma_f32_16x16x32_bf16 v[92:95], v[216:219], v[104:107], v[92:95]
    s_waitcnt lgkmcnt(0)
    s_barrier
    v_mfma_f32_16x16x32_bf16 v[0:3], v[156:159], v[220:223], v[0:3]
    ds_read_b128 v[96:99], v241 offset:12288
    v_mfma_f32_16x16x32_bf16 v[4:7], v[156:159], v[224:227], v[4:7]
    ds_read_b64_tr_b16 v[188:189], v236 offset:16384
    v_mfma_f32_16x16x32_bf16 v[8:11], v[156:159], v[228:231], v[8:11]
    ds_read_b64_tr_b16 v[190:191], v236 offset:16896
    v_mfma_f32_16x16x32_bf16 v[12:15], v[160:163], v[220:223], v[12:15]
    ds_read_b128 v[100:103], v241 offset:14336
    v_mfma_f32_16x16x32_bf16 v[16:19], v[160:163], v[224:227], v[16:19]
    ds_read_b128 v[104:107], v241 offset:16384
    v_mfma_f32_16x16x32_bf16 v[20:23], v[160:163], v[228:231], v[20:23]
    ds_read_b64_tr_b16 v[192:193], v237 offset:16384
    v_mfma_f32_16x16x32_bf16 v[24:27], v[164:167], v[220:223], v[24:27]
    ds_read_b64_tr_b16 v[194:195], v237 offset:16896
    v_mfma_f32_16x16x32_bf16 v[28:31], v[164:167], v[224:227], v[28:31]
    ds_read_b64_tr_b16 v[196:197], v238 offset:16384
    v_mfma_f32_16x16x32_bf16 v[32:35], v[164:167], v[228:231], v[32:35]
    ds_read_b64_tr_b16 v[198:199], v238 offset:16896
    v_mfma_f32_16x16x32_bf16 v[36:39], v[168:171], v[220:223], v[36:39]
    ds_read_b64_tr_b16 v[200:201], v239 offset:16384
    v_mfma_f32_16x16x32_bf16 v[40:43], v[168:171], v[224:227], v[40:43]
    ds_read_b64_tr_b16 v[202:203], v239 offset:16896
    v_mfma_f32_16x16x32_bf16 v[44:47], v[168:171], v[228:231], v[44:47]
    ds_read_b64_tr_b16 v[204:205], v236 offset:20480
    v_mfma_f32_16x16x32_bf16 v[48:51], v[172:175], v[220:223], v[48:51]
    ds_read_b64_tr_b16 v[206:207], v236 offset:20992
    v_mfma_f32_16x16x32_bf16 v[52:55], v[172:175], v[224:227], v[52:55]
    ds_read_b64_tr_b16 v[208:209], v237 offset:20480
    v_mfma_f32_16x16x32_bf16 v[56:59], v[172:175], v[228:231], v[56:59]
    ds_read_b64_tr_b16 v[210:211], v237 offset:20992
    v_mfma_f32_16x16x32_bf16 v[60:63], v[176:179], v[220:223], v[60:63]
    ds_read_b64_tr_b16 v[212:213], v238 offset:20480
    v_mfma_f32_16x16x32_bf16 v[64:67], v[176:179], v[224:227], v[64:67]
    ds_read_b64_tr_b16 v[214:215], v238 offset:20992
    v_mfma_f32_16x16x32_bf16 v[68:71], v[176:179], v[228:231], v[68:71]
    ds_read_b64_tr_b16 v[216:217], v239 offset:20480
    v_mfma_f32_16x16x32_bf16 v[72:75], v[180:183], v[220:223], v[72:75]
    ds_read_b64_tr_b16 v[218:219], v239 offset:20992
    v_mfma_f32_16x16x32_bf16 v[76:79], v[180:183], v[224:227], v[76:79]
    v_mfma_f32_16x16x32_bf16 v[80:83], v[180:183], v[228:231], v[80:83]
    v_mfma_f32_16x16x32_bf16 v[84:87], v[184:187], v[220:223], v[84:87]
    v_mfma_f32_16x16x32_bf16 v[88:91], v[184:187], v[224:227], v[88:91]
    v_mfma_f32_16x16x32_bf16 v[92:95], v[184:187], v[228:231], v[92:95]
    s_waitcnt lgkmcnt(0)
    s_barrier
    v_mfma_f32_16x16x32_bf16 v[0:3], v[188:191], v[96:99], v[0:3]
    ds_read_b128 v[220:223], v240 offset:0
    v_mfma_f32_16x16x32_bf16 v[4:7], v[188:191], v[100:103], v[4:7]
    ds_read_b64_tr_b16 v[156:157], v236 offset:32768
    v_mfma_f32_16x16x32_bf16 v[8:11], v[188:191], v[104:107], v[8:11]
    ds_read_b64_tr_b16 v[158:159], v236 offset:33280
    v_mfma_f32_16x16x32_bf16 v[12:15], v[192:195], v[96:99], v[12:15]
    ds_read_b128 v[224:227], v240 offset:2048
    v_mfma_f32_16x16x32_bf16 v[16:19], v[192:195], v[100:103], v[16:19]
    ds_read_b128 v[228:231], v240 offset:4096
    v_mfma_f32_16x16x32_bf16 v[20:23], v[192:195], v[104:107], v[20:23]
    ds_read_b64_tr_b16 v[160:161], v237 offset:32768
    v_mfma_f32_16x16x32_bf16 v[24:27], v[196:199], v[96:99], v[24:27]
    ds_read_b64_tr_b16 v[162:163], v237 offset:33280
    v_mfma_f32_16x16x32_bf16 v[28:31], v[196:199], v[100:103], v[28:31]
    ds_read_b64_tr_b16 v[164:165], v238 offset:32768
    v_mfma_f32_16x16x32_bf16 v[32:35], v[196:199], v[104:107], v[32:35]
    ds_read_b64_tr_b16 v[166:167], v238 offset:33280
    v_mfma_f32_16x16x32_bf16 v[36:39], v[200:203], v[96:99], v[36:39]
    ds_read_b64_tr_b16 v[168:169], v239 offset:32768
    v_mfma_f32_16x16x32_bf16 v[40:43], v[200:203], v[100:103], v[40:43]
    ds_read_b64_tr_b16 v[170:171], v239 offset:33280
    v_mfma_f32_16x16x32_bf16 v[44:47], v[200:203], v[104:107], v[44:47]
    ds_read_b64_tr_b16 v[172:173], v236 offset:36864
    v_mfma_f32_16x16x32_bf16 v[48:51], v[204:207], v[96:99], v[48:51]
    ds_read_b64_tr_b16 v[174:175], v236 offset:37376
    v_mfma_f32_16x16x32_bf16 v[52:55], v[204:207], v[100:103], v[52:55]
    ds_read_b64_tr_b16 v[176:177], v237 offset:36864
    v_mfma_f32_16x16x32_bf16 v[56:59], v[204:207], v[104:107], v[56:59]
    ds_read_b64_tr_b16 v[178:179], v237 offset:37376
    v_mfma_f32_16x16x32_bf16 v[60:63], v[208:211], v[96:99], v[60:63]
    ds_read_b64_tr_b16 v[180:181], v238 offset:36864
    v_mfma_f32_16x16x32_bf16 v[64:67], v[208:211], v[100:103], v[64:67]
    ds_read_b64_tr_b16 v[182:183], v238 offset:37376
    v_mfma_f32_16x16x32_bf16 v[68:71], v[208:211], v[104:107], v[68:71]
    ds_read_b64_tr_b16 v[184:185], v239 offset:36864
    v_mfma_f32_16x16x32_bf16 v[72:75], v[212:215], v[96:99], v[72:75]
    ds_read_b64_tr_b16 v[186:187], v239 offset:37376
    v_mfma_f32_16x16x32_bf16 v[76:79], v[212:215], v[100:103], v[76:79]
    v_mfma_f32_16x16x32_bf16 v[80:83], v[212:215], v[104:107], v[80:83]
    v_mfma_f32_16x16x32_bf16 v[84:87], v[216:219], v[96:99], v[84:87]
    v_mfma_f32_16x16x32_bf16 v[88:91], v[216:219], v[100:103], v[88:91]
    v_mfma_f32_16x16x32_bf16 v[92:95], v[216:219], v[104:107], v[92:95]
    s_waitcnt lgkmcnt(0)
    s_barrier
    v_mfma_f32_16x16x32_bf16 v[0:3], v[156:159], v[220:223], v[0:3]
    ds_read_b128 v[96:99], v241 offset:0
    v_mfma_f32_16x16x32_bf16 v[4:7], v[156:159], v[224:227], v[4:7]
    ds_read_b64_tr_b16 v[188:189], v236 offset:0
    v_mfma_f32_16x16x32_bf16 v[8:11], v[156:159], v[228:231], v[8:11]
    ds_read_b64_tr_b16 v[190:191], v236 offset:512
    v_mfma_f32_16x16x32_bf16 v[12:15], v[160:163], v[220:223], v[12:15]
    ds_read_b128 v[100:103], v241 offset:2048
    v_mfma_f32_16x16x32_bf16 v[16:19], v[160:163], v[224:227], v[16:19]
    ds_read_b128 v[104:107], v241 offset:4096
    v_mfma_f32_16x16x32_bf16 v[20:23], v[160:163], v[228:231], v[20:23]
    ds_read_b64_tr_b16 v[192:193], v237 offset:0
    v_mfma_f32_16x16x32_bf16 v[24:27], v[164:167], v[220:223], v[24:27]
    ds_read_b64_tr_b16 v[194:195], v237 offset:512
    v_mfma_f32_16x16x32_bf16 v[28:31], v[164:167], v[224:227], v[28:31]
    ds_read_b64_tr_b16 v[196:197], v238 offset:0
    v_mfma_f32_16x16x32_bf16 v[32:35], v[164:167], v[228:231], v[32:35]
    ds_read_b64_tr_b16 v[198:199], v238 offset:512
    v_mfma_f32_16x16x32_bf16 v[36:39], v[168:171], v[220:223], v[36:39]
    ds_read_b64_tr_b16 v[200:201], v239 offset:0
    v_mfma_f32_16x16x32_bf16 v[40:43], v[168:171], v[224:227], v[40:43]
    ds_read_b64_tr_b16 v[202:203], v239 offset:512
    v_mfma_f32_16x16x32_bf16 v[44:47], v[168:171], v[228:231], v[44:47]
    ds_read_b64_tr_b16 v[204:205], v236 offset:4096
    v_mfma_f32_16x16x32_bf16 v[48:51], v[172:175], v[220:223], v[48:51]
    ds_read_b64_tr_b16 v[206:207], v236 offset:4608
    v_mfma_f32_16x16x32_bf16 v[52:55], v[172:175], v[224:227], v[52:55]
    ds_read_b64_tr_b16 v[208:209], v237 offset:4096
    v_mfma_f32_16x16x32_bf16 v[56:59], v[172:175], v[228:231], v[56:59]
    ds_read_b64_tr_b16 v[210:211], v237 offset:4608
    v_mfma_f32_16x16x32_bf16 v[60:63], v[176:179], v[220:223], v[60:63]
    ds_read_b64_tr_b16 v[212:213], v238 offset:4096
    v_mfma_f32_16x16x32_bf16 v[64:67], v[176:179], v[224:227], v[64:67]
    ds_read_b64_tr_b16 v[214:215], v238 offset:4608
    v_mfma_f32_16x16x32_bf16 v[68:71], v[176:179], v[228:231], v[68:71]
    ds_read_b64_tr_b16 v[216:217], v239 offset:4096
    v_mfma_f32_16x16x32_bf16 v[72:75], v[180:183], v[220:223], v[72:75]
    ds_read_b64_tr_b16 v[218:219], v239 offset:4608
    v_mfma_f32_16x16x32_bf16 v[76:79], v[180:183], v[224:227], v[76:79]
    v_mfma_f32_16x16x32_bf16 v[80:83], v[180:183], v[228:231], v[80:83]
    v_mfma_f32_16x16x32_bf16 v[84:87], v[184:187], v[220:223], v[84:87]
    v_mfma_f32_16x16x32_bf16 v[88:91], v[184:187], v[224:227], v[88:91]
    v_mfma_f32_16x16x32_bf16 v[92:95], v[184:187], v[228:231], v[92:95]
    s_waitcnt lgkmcnt(0)
    s_barrier
    v_mfma_f32_16x16x32_bf16 v[0:3], v[188:191], v[96:99], v[0:3]
    ds_read_b128 v[220:223], v240 offset:12288
    v_mfma_f32_16x16x32_bf16 v[4:7], v[188:191], v[100:103], v[4:7]
    ds_read_b64_tr_b16 v[156:157], v236 offset:16384
    v_mfma_f32_16x16x32_bf16 v[8:11], v[188:191], v[104:107], v[8:11]
    ds_read_b64_tr_b16 v[158:159], v236 offset:16896
    v_mfma_f32_16x16x32_bf16 v[12:15], v[192:195], v[96:99], v[12:15]
    ds_read_b128 v[224:227], v240 offset:14336
    v_mfma_f32_16x16x32_bf16 v[16:19], v[192:195], v[100:103], v[16:19]
    ds_read_b128 v[228:231], v240 offset:16384
    v_mfma_f32_16x16x32_bf16 v[20:23], v[192:195], v[104:107], v[20:23]
    ds_read_b64_tr_b16 v[160:161], v237 offset:16384
    v_mfma_f32_16x16x32_bf16 v[24:27], v[196:199], v[96:99], v[24:27]
    ds_read_b64_tr_b16 v[162:163], v237 offset:16896
    v_mfma_f32_16x16x32_bf16 v[28:31], v[196:199], v[100:103], v[28:31]
    ds_read_b64_tr_b16 v[164:165], v238 offset:16384
    v_mfma_f32_16x16x32_bf16 v[32:35], v[196:199], v[104:107], v[32:35]
    ds_read_b64_tr_b16 v[166:167], v238 offset:16896
    v_mfma_f32_16x16x32_bf16 v[36:39], v[200:203], v[96:99], v[36:39]
    ds_read_b64_tr_b16 v[168:169], v239 offset:16384
    v_mfma_f32_16x16x32_bf16 v[40:43], v[200:203], v[100:103], v[40:43]
    ds_read_b64_tr_b16 v[170:171], v239 offset:16896
    v_mfma_f32_16x16x32_bf16 v[44:47], v[200:203], v[104:107], v[44:47]
    ds_read_b64_tr_b16 v[172:173], v236 offset:20480
    v_mfma_f32_16x16x32_bf16 v[48:51], v[204:207], v[96:99], v[48:51]
    ds_read_b64_tr_b16 v[174:175], v236 offset:20992
    v_mfma_f32_16x16x32_bf16 v[52:55], v[204:207], v[100:103], v[52:55]
    ds_read_b64_tr_b16 v[176:177], v237 offset:20480
    v_mfma_f32_16x16x32_bf16 v[56:59], v[204:207], v[104:107], v[56:59]
    ds_read_b64_tr_b16 v[178:179], v237 offset:20992
    v_mfma_f32_16x16x32_bf16 v[60:63], v[208:211], v[96:99], v[60:63]
    ds_read_b64_tr_b16 v[180:181], v238 offset:20480
    v_mfma_f32_16x16x32_bf16 v[64:67], v[208:211], v[100:103], v[64:67]
    ds_read_b64_tr_b16 v[182:183], v238 offset:20992
    v_mfma_f32_16x16x32_bf16 v[68:71], v[208:211], v[104:107], v[68:71]
    ds_read_b64_tr_b16 v[184:185], v239 offset:20480
    v_mfma_f32_16x16x32_bf16 v[72:75], v[212:215], v[96:99], v[72:75]
    ds_read_b64_tr_b16 v[186:187], v239 offset:20992
    v_mfma_f32_16x16x32_bf16 v[76:79], v[212:215], v[100:103], v[76:79]
    v_mfma_f32_16x16x32_bf16 v[80:83], v[212:215], v[104:107], v[80:83]
    v_mfma_f32_16x16x32_bf16 v[84:87], v[216:219], v[96:99], v[84:87]
    v_mfma_f32_16x16x32_bf16 v[88:91], v[216:219], v[100:103], v[88:91]
    v_mfma_f32_16x16x32_bf16 v[92:95], v[216:219], v[104:107], v[92:95]
    s_waitcnt lgkmcnt(0)
    s_barrier
    v_mfma_f32_16x16x32_bf16 v[0:3], v[156:159], v[220:223], v[0:3]
    ds_read_b128 v[96:99], v241 offset:12288
    v_mfma_f32_16x16x32_bf16 v[4:7], v[156:159], v[224:227], v[4:7]
    ds_read_b64_tr_b16 v[188:189], v236 offset:32768
    v_mfma_f32_16x16x32_bf16 v[8:11], v[156:159], v[228:231], v[8:11]
    ds_read_b64_tr_b16 v[190:191], v236 offset:33280
    v_mfma_f32_16x16x32_bf16 v[12:15], v[160:163], v[220:223], v[12:15]
    ds_read_b128 v[100:103], v241 offset:14336
    v_mfma_f32_16x16x32_bf16 v[16:19], v[160:163], v[224:227], v[16:19]
    ds_read_b128 v[104:107], v241 offset:16384
    v_mfma_f32_16x16x32_bf16 v[20:23], v[160:163], v[228:231], v[20:23]
    ds_read_b64_tr_b16 v[192:193], v237 offset:32768
    v_mfma_f32_16x16x32_bf16 v[24:27], v[164:167], v[220:223], v[24:27]
    ds_read_b64_tr_b16 v[194:195], v237 offset:33280
    v_mfma_f32_16x16x32_bf16 v[28:31], v[164:167], v[224:227], v[28:31]
    ds_read_b64_tr_b16 v[196:197], v238 offset:32768
    v_mfma_f32_16x16x32_bf16 v[32:35], v[164:167], v[228:231], v[32:35]
    ds_read_b64_tr_b16 v[198:199], v238 offset:33280
    v_mfma_f32_16x16x32_bf16 v[36:39], v[168:171], v[220:223], v[36:39]
    ds_read_b64_tr_b16 v[200:201], v239 offset:32768
    v_mfma_f32_16x16x32_bf16 v[40:43], v[168:171], v[224:227], v[40:43]
    ds_read_b64_tr_b16 v[202:203], v239 offset:33280
    v_mfma_f32_16x16x32_bf16 v[44:47], v[168:171], v[228:231], v[44:47]
    ds_read_b64_tr_b16 v[204:205], v236 offset:36864
    v_mfma_f32_16x16x32_bf16 v[48:51], v[172:175], v[220:223], v[48:51]
    ds_read_b64_tr_b16 v[206:207], v236 offset:37376
    v_mfma_f32_16x16x32_bf16 v[52:55], v[172:175], v[224:227], v[52:55]
    ds_read_b64_tr_b16 v[208:209], v237 offset:36864
    v_mfma_f32_16x16x32_bf16 v[56:59], v[172:175], v[228:231], v[56:59]
    ds_read_b64_tr_b16 v[210:211], v237 offset:37376
    v_mfma_f32_16x16x32_bf16 v[60:63], v[176:179], v[220:223], v[60:63]
    ds_read_b64_tr_b16 v[212:213], v238 offset:36864
    v_mfma_f32_16x16x32_bf16 v[64:67], v[176:179], v[224:227], v[64:67]
    ds_read_b64_tr_b16 v[214:215], v238 offset:37376
    v_mfma_f32_16x16x32_bf16 v[68:71], v[176:179], v[228:231], v[68:71]
    ds_read_b64_tr_b16 v[216:217], v239 offset:36864
    v_mfma_f32_16x16x32_bf16 v[72:75], v[180:183], v[220:223], v[72:75]
    ds_read_b64_tr_b16 v[218:219], v239 offset:37376
    v_mfma_f32_16x16x32_bf16 v[76:79], v[180:183], v[224:227], v[76:79]
    v_mfma_f32_16x16x32_bf16 v[80:83], v[180:183], v[228:231], v[80:83]
    v_mfma_f32_16x16x32_bf16 v[84:87], v[184:187], v[220:223], v[84:87]
    v_mfma_f32_16x16x32_bf16 v[88:91], v[184:187], v[224:227], v[88:91]
    v_mfma_f32_16x16x32_bf16 v[92:95], v[184:187], v[228:231], v[92:95]
    s_waitcnt lgkmcnt(0)
    s_barrier
    v_mfma_f32_16x16x32_bf16 v[0:3], v[188:191], v[96:99], v[0:3]
    v_mfma_f32_16x16x32_bf16 v[4:7], v[188:191], v[100:103], v[4:7]
    v_mfma_f32_16x16x32_bf16 v[8:11], v[188:191], v[104:107], v[8:11]
    v_mfma_f32_16x16x32_bf16 v[12:15], v[192:195], v[96:99], v[12:15]
    v_mfma_f32_16x16x32_bf16 v[16:19], v[192:195], v[100:103], v[16:19]
    v_mfma_f32_16x16x32_bf16 v[20:23], v[192:195], v[104:107], v[20:23]
    v_mfma_f32_16x16x32_bf16 v[24:27], v[196:199], v[96:99], v[24:27]
    v_mfma_f32_16x16x32_bf16 v[28:31], v[196:199], v[100:103], v[28:31]
    v_mfma_f32_16x16x32_bf16 v[32:35], v[196:199], v[104:107], v[32:35]
    v_mfma_f32_16x16x32_bf16 v[36:39], v[200:203], v[96:99], v[36:39]
    v_mfma_f32_16x16x32_bf16 v[40:43], v[200:203], v[100:103], v[40:43]
    v_mfma_f32_16x16x32_bf16 v[44:47], v[200:203], v[104:107], v[44:47]
    v_mfma_f32_16x16x32_bf16 v[48:51], v[204:207], v[96:99], v[48:51]
    v_mfma_f32_16x16x32_bf16 v[52:55], v[204:207], v[100:103], v[52:55]
    v_mfma_f32_16x16x32_bf16 v[56:59], v[204:207], v[104:107], v[56:59]
    v_mfma_f32_16x16x32_bf16 v[60:63], v[208:211], v[96:99], v[60:63]
    v_mfma_f32_16x16x32_bf16 v[64:67], v[208:211], v[100:103], v[64:67]
    v_mfma_f32_16x16x32_bf16 v[68:71], v[208:211], v[104:107], v[68:71]
    v_mfma_f32_16x16x32_bf16 v[72:75], v[212:215], v[96:99], v[72:75]
    v_mfma_f32_16x16x32_bf16 v[76:79], v[212:215], v[100:103], v[76:79]
    v_mfma_f32_16x16x32_bf16 v[80:83], v[212:215], v[104:107], v[80:83]
    v_mfma_f32_16x16x32_bf16 v[84:87], v[216:219], v[96:99], v[84:87]
    v_mfma_f32_16x16x32_bf16 v[88:91], v[216:219], v[100:103], v[88:91]
    v_mfma_f32_16x16x32_bf16 v[92:95], v[216:219], v[104:107], v[92:95]
    s_waitcnt lgkmcnt(0)
    s_barrier
    ds_read_b128 v[156:159], v248 offset:49152
    ds_read_b128 v[160:163], v248 offset:51200
    ds_read_b128 v[164:167], v249 offset:49152
    ds_read_b128 v[168:171], v249 offset:51200
    ds_read_b128 v[172:175], v248 offset:53248
    ds_read_b128 v[176:179], v248 offset:55296
    ds_read_b128 v[180:183], v249 offset:53248
    ds_read_b128 v[184:187], v249 offset:55296
    v_mul_f32 v0, s58, v0
    v_mul_f32 v1, s58, v1
    v_mul_f32 v2, s58, v2
    v_mul_f32 v3, s58, v3
    v_mul_f32 v12, s58, v12
    v_mul_f32 v13, s58, v13
    v_mul_f32 v14, s58, v14
    v_mul_f32 v15, s58, v15
    v_cvt_pk_bf16_f32 v96, v0, v1
    v_cvt_pk_bf16_f32 v97, v2, v3
    v_cvt_pk_bf16_f32 v98, v12, v13
    v_cvt_pk_bf16_f32 v99, v14, v15
    v_mul_f32 v24, s58, v24
    v_mul_f32 v25, s58, v25
    v_mul_f32 v26, s58, v26
    v_mul_f32 v27, s58, v27
    v_mul_f32 v36, s58, v36
    v_mul_f32 v37, s58, v37
    v_mul_f32 v38, s58, v38
    v_mul_f32 v39, s58, v39
    v_cvt_pk_bf16_f32 v108, v24, v25
    v_cvt_pk_bf16_f32 v109, v26, v27
    v_cvt_pk_bf16_f32 v110, v36, v37
    v_cvt_pk_bf16_f32 v111, v38, v39
    v_mul_f32 v48, s58, v48
    v_mul_f32 v49, s58, v49
    v_mul_f32 v50, s58, v50
    v_mul_f32 v51, s58, v51
    v_mul_f32 v60, s58, v60
    v_mul_f32 v61, s58, v61
    v_mul_f32 v62, s58, v62
    v_mul_f32 v63, s58, v63
    v_cvt_pk_bf16_f32 v120, v48, v49
    v_cvt_pk_bf16_f32 v121, v50, v51
    v_cvt_pk_bf16_f32 v122, v60, v61
    v_cvt_pk_bf16_f32 v123, v62, v63
    v_mul_f32 v72, s58, v72
    v_mul_f32 v73, s58, v73
    v_mul_f32 v74, s58, v74
    v_mul_f32 v75, s58, v75
    v_mul_f32 v84, s58, v84
    v_mul_f32 v85, s58, v85
    v_mul_f32 v86, s58, v86
    v_mul_f32 v87, s58, v87
    v_cvt_pk_bf16_f32 v132, v72, v73
    v_cvt_pk_bf16_f32 v133, v74, v75
    v_cvt_pk_bf16_f32 v134, v84, v85
    v_cvt_pk_bf16_f32 v135, v86, v87
    v_permlane32_swap_b32 v96, v98
    v_permlane32_swap_b32 v97, v99
    v_permlane32_swap_b32 v108, v110
    v_permlane32_swap_b32 v109, v111
    v_permlane32_swap_b32 v120, v122
    v_permlane32_swap_b32 v121, v123
    v_permlane32_swap_b32 v132, v134
    v_permlane32_swap_b32 v133, v135
    v_permlane16_swap_b32 v96, v98
    v_permlane16_swap_b32 v97, v99
    v_permlane16_swap_b32 v108, v110
    v_permlane16_swap_b32 v109, v111
    v_permlane16_swap_b32 v120, v122
    v_permlane16_swap_b32 v121, v123
    v_permlane16_swap_b32 v132, v134
    v_permlane16_swap_b32 v133, v135
    s_waitcnt lgkmcnt(7)
    v_mfma_f32_16x16x32_bf16 v[220:223], v[156:159], v[96:99], 0
    v_mul_f32 v4, s58, v4
    v_mul_f32 v5, s58, v5
    v_mul_f32 v6, s58, v6
    v_mul_f32 v7, s58, v7
    v_mul_f32 v16, s58, v16
    v_mul_f32 v17, s58, v17
    v_mul_f32 v18, s58, v18
    v_mul_f32 v19, s58, v19
    v_cvt_pk_bf16_f32 v100, v4, v5
    v_cvt_pk_bf16_f32 v101, v6, v7
    v_cvt_pk_bf16_f32 v102, v16, v17
    v_cvt_pk_bf16_f32 v103, v18, v19
    v_mul_f32 v28, s58, v28
    v_mul_f32 v29, s58, v29
    v_mul_f32 v30, s58, v30
    v_mul_f32 v31, s58, v31
    v_mul_f32 v40, s58, v40
    v_mul_f32 v41, s58, v41
    v_mul_f32 v42, s58, v42
    v_mul_f32 v43, s58, v43
    s_waitcnt lgkmcnt(6)
    v_mfma_f32_16x16x32_bf16 v[224:227], v[160:163], v[96:99], 0
    v_cvt_pk_bf16_f32 v112, v28, v29
    v_cvt_pk_bf16_f32 v113, v30, v31
    v_cvt_pk_bf16_f32 v114, v40, v41
    v_cvt_pk_bf16_f32 v115, v42, v43
    v_mul_f32 v52, s58, v52
    v_mul_f32 v53, s58, v53
    v_mul_f32 v54, s58, v54
    v_mul_f32 v55, s58, v55
    v_mul_f32 v64, s58, v64
    v_mul_f32 v65, s58, v65
    v_mul_f32 v66, s58, v66
    v_mul_f32 v67, s58, v67
    v_cvt_pk_bf16_f32 v124, v52, v53
    v_cvt_pk_bf16_f32 v125, v54, v55
    v_cvt_pk_bf16_f32 v126, v64, v65
    v_cvt_pk_bf16_f32 v127, v66, v67
    v_mul_f32 v76, s58, v76
    v_mul_f32 v77, s58, v77
    v_mul_f32 v78, s58, v78
    v_mul_f32 v79, s58, v79
    s_waitcnt lgkmcnt(5)
    v_mfma_f32_16x16x32_bf16 v[220:223], v[164:167], v[108:111], v[220:223]
    v_mul_f32 v88, s58, v88
    v_mul_f32 v89, s58, v89
    v_mul_f32 v90, s58, v90
    v_mul_f32 v91, s58, v91
    v_cvt_pk_bf16_f32 v136, v76, v77
    v_cvt_pk_bf16_f32 v137, v78, v79
    v_cvt_pk_bf16_f32 v138, v88, v89
    v_cvt_pk_bf16_f32 v139, v90, v91
    v_permlane32_swap_b32 v100, v102
    v_permlane32_swap_b32 v101, v103
    v_permlane32_swap_b32 v112, v114
    v_permlane32_swap_b32 v113, v115
    v_permlane32_swap_b32 v124, v126
    v_permlane32_swap_b32 v125, v127
    s_waitcnt lgkmcnt(4)
    v_mfma_f32_16x16x32_bf16 v[224:227], v[168:171], v[108:111], v[224:227]
    v_permlane32_swap_b32 v136, v138
    v_permlane32_swap_b32 v137, v139
    v_permlane16_swap_b32 v100, v102
    v_permlane16_swap_b32 v101, v103
    v_permlane16_swap_b32 v112, v114
    v_permlane16_swap_b32 v113, v115
    v_permlane16_swap_b32 v124, v126
    v_permlane16_swap_b32 v125, v127
    v_permlane16_swap_b32 v136, v138
    v_permlane16_swap_b32 v137, v139
    s_waitcnt lgkmcnt(3)
    v_mfma_f32_16x16x32_bf16 v[220:223], v[172:175], v[120:123], v[220:223]
    v_mul_f32 v8, s58, v8
    v_mul_f32 v9, s58, v9
    v_mul_f32 v10, s58, v10
    v_mul_f32 v11, s58, v11
    v_mul_f32 v20, s58, v20
    v_mul_f32 v21, s58, v21
    v_mul_f32 v22, s58, v22
    v_mul_f32 v23, s58, v23
    v_cvt_pk_bf16_f32 v104, v8, v9
    v_cvt_pk_bf16_f32 v105, v10, v11
    v_cvt_pk_bf16_f32 v106, v20, v21
    v_cvt_pk_bf16_f32 v107, v22, v23
    v_mul_f32 v32, s58, v32
    v_mul_f32 v33, s58, v33
    v_mul_f32 v34, s58, v34
    v_mul_f32 v35, s58, v35
    v_mul_f32 v44, s58, v44
    v_mul_f32 v45, s58, v45
    v_mul_f32 v46, s58, v46
    v_mul_f32 v47, s58, v47
    s_waitcnt lgkmcnt(2)
    v_mfma_f32_16x16x32_bf16 v[224:227], v[176:179], v[120:123], v[224:227]
    v_cvt_pk_bf16_f32 v116, v32, v33
    v_cvt_pk_bf16_f32 v117, v34, v35
    v_cvt_pk_bf16_f32 v118, v44, v45
    v_cvt_pk_bf16_f32 v119, v46, v47
    v_mul_f32 v56, s58, v56
    v_mul_f32 v57, s58, v57
    v_mul_f32 v58, s58, v58
    v_mul_f32 v59, s58, v59
    v_mul_f32 v68, s58, v68
    v_mul_f32 v69, s58, v69
    v_mul_f32 v70, s58, v70
    v_mul_f32 v71, s58, v71
    v_cvt_pk_bf16_f32 v128, v56, v57
    v_cvt_pk_bf16_f32 v129, v58, v59
    v_cvt_pk_bf16_f32 v130, v68, v69
    v_cvt_pk_bf16_f32 v131, v70, v71
    v_mul_f32 v80, s58, v80
    v_mul_f32 v81, s58, v81
    v_mul_f32 v82, s58, v82
    v_mul_f32 v83, s58, v83
    s_waitcnt lgkmcnt(1)
    v_mfma_f32_16x16x32_bf16 v[220:223], v[180:183], v[132:135], v[220:223]
    v_mul_f32 v92, s58, v92
    v_mul_f32 v93, s58, v93
    v_mul_f32 v94, s58, v94
    v_mul_f32 v95, s58, v95
    v_cvt_pk_bf16_f32 v140, v80, v81
    v_cvt_pk_bf16_f32 v141, v82, v83
    v_cvt_pk_bf16_f32 v142, v92, v93
    v_cvt_pk_bf16_f32 v143, v94, v95
    v_permlane32_swap_b32 v104, v106
    v_permlane32_swap_b32 v105, v107
    v_permlane32_swap_b32 v116, v118
    v_permlane32_swap_b32 v117, v119
    v_permlane32_swap_b32 v128, v130
    v_permlane32_swap_b32 v129, v131
    s_waitcnt lgkmcnt(0)
    v_mfma_f32_16x16x32_bf16 v[224:227], v[184:187], v[132:135], v[224:227]
    v_permlane32_swap_b32 v140, v142
    v_permlane32_swap_b32 v141, v143
    v_permlane16_swap_b32 v104, v106
    v_permlane16_swap_b32 v105, v107
    v_permlane16_swap_b32 v116, v118
    v_permlane16_swap_b32 v117, v119
    v_permlane16_swap_b32 v128, v130
    v_permlane16_swap_b32 v129, v131
    v_permlane16_swap_b32 v140, v142
    v_permlane16_swap_b32 v141, v143
    s_waitcnt lgkmcnt(0)
L_S0:
    s_nop 1
    s_barrier
    ds_read_b64_tr_b16 v[188:189], v250 offset:0
    ds_read_b64_tr_b16 v[190:191], v250 offset:2048
    ds_read_b64_tr_b16 v[192:193], v251 offset:0
    ds_read_b64_tr_b16 v[194:195], v251 offset:2048
    v_max3_f32 v243, v220, v221, v222
    v_max3_f32 v247, v223, v224, v225
    v_max3_f32 v243, v243, v226, v227
    v_max_f32 v243, v243, v247
    v_mov_b32 v247, v243
    s_nop 1
    v_permlane32_swap_b32 v243, v247
    v_mfma_f32_16x16x32_bf16 v[228:231], v[156:159], v[100:103], 0
    ds_read_b64_tr_b16 v[196:197], v252 offset:0
    ds_read_b64_tr_b16 v[198:199], v252 offset:2048
    ds_read_b64_tr_b16 v[200:201], v253 offset:0
    ds_read_b64_tr_b16 v[202:203], v253 offset:2048
    v_max_f32 v243, v243, v247
    v_mov_b32 v247, v243
    s_nop 1
    v_permlane16_swap_b32 v243, v247
    v_max_f32 v243, v243, v247
    v_sub_f32 v144, 0, v243
    v_mfma_f32_16x16x32_bf16 v[232:235], v[160:163], v[100:103], 0
    ds_read_b64_tr_b16 v[204:205], v250 offset:4096
    ds_read_b64_tr_b16 v[206:207], v250 offset:6144
    ds_read_b64_tr_b16 v[208:209], v251 offset:4096
    ds_read_b64_tr_b16 v[210:211], v251 offset:6144
    v_sub_f32 v145, 0, v243
    v_sub_f32 v146, 0, v243
    v_sub_f32 v147, 0, v243
    v_sub_f32 v220, v220, v243
    v_sub_f32 v221, v221, v243
    v_sub_f32 v222, v222, v243
    v_sub_f32 v223, v223, v243
    v_mfma_f32_16x16x32_bf16 v[228:231], v[164:167], v[112:115], v[228:231]
    ds_read_b64_tr_b16 v[212:213], v252 offset:4096
    ds_read_b64_tr_b16 v[214:215], v252 offset:6144
    ds_read_b64_tr_b16 v[216:217], v253 offset:4096
    ds_read_b64_tr_b16 v[218:219], v253 offset:6144
    v_sub_f32 v224, v224, v243
    v_sub_f32 v225, v225, v243
    v_sub_f32 v226, v226, v243
    v_sub_f32 v227, v227, v243
    v_exp_f32 v236, v220
    v_mfma_f32_16x16x32_bf16 v[232:235], v[168:171], v[112:115], v[232:235]
    v_exp_f32 v237, v221
    v_exp_f32 v238, v222
    v_exp_f32 v239, v223
    v_mfma_f32_16x16x32_bf16 v[228:231], v[172:175], v[124:127], v[228:231]
    v_add_f32 v247, v236, v237
    v_add_f32 v255, v238, v239
    v_exp_f32 v240, v224
    v_exp_f32 v241, v225
    v_add_f32 v247, v247, v240
    v_mfma_f32_16x16x32_bf16 v[232:235], v[176:179], v[124:127], v[232:235]
    v_add_f32 v255, v255, v241
    v_exp_f32 v242, v226
    v_exp_f32 v243, v227
    v_add_f32 v247, v247, v242
    v_mfma_f32_16x16x32_bf16 v[228:231], v[180:183], v[136:139], v[228:231]
    v_add_f32 v255, v255, v243
    v_add_f32 v244, v247, v255
    v_cvt_pk_bf16_f32 v220, v236, v237
    v_cvt_pk_bf16_f32 v221, v238, v239
    v_cvt_pk_bf16_f32 v222, v240, v241
    v_cvt_pk_bf16_f32 v223, v242, v243
    v_mfma_f32_16x16x32_bf16 v[232:235], v[184:187], v[136:139], v[232:235]
    s_waitcnt lgkmcnt(0)
    v_mfma_f32_16x16x32_bf16 v[0:3], v[188:191], v[220:223], 0
    v_mfma_f32_16x16x32_bf16 v[12:15], v[192:195], v[220:223], 0
    v_max3_f32 v243, v228, v229, v230
    s_nop 3
    v_max3_f32 v247, v231, v232, v233
    v_max3_f32 v243, v243, v234, v235
    v_max_f32 v243, v243, v247
    v_mfma_f32_16x16x32_bf16 v[24:27], v[196:199], v[220:223], 0
    v_mov_b32 v247, v243
    s_nop 1
    v_permlane32_swap_b32 v243, v247
    v_max_f32 v243, v243, v247
    v_mfma_f32_16x16x32_bf16 v[36:39], v[200:203], v[220:223], 0
    v_mov_b32 v247, v243
    s_nop 1
    v_permlane16_swap_b32 v243, v247
    s_waitcnt lgkmcnt(0)
    v_mfma_f32_16x16x32_bf16 v[48:51], v[204:207], v[220:223], 0
    v_max_f32 v243, v243, v247
    v_sub_f32 v148, 0, v243
    v_sub_f32 v149, 0, v243
    v_sub_f32 v150, 0, v243
    v_mfma_f32_16x16x32_bf16 v[60:63], v[208:211], v[220:223], 0
    v_sub_f32 v151, 0, v243
    v_sub_f32 v228, v228, v243
    v_sub_f32 v229, v229, v243
    v_sub_f32 v230, v230, v243
    v_mfma_f32_16x16x32_bf16 v[72:75], v[212:215], v[220:223], 0
    v_sub_f32 v231, v231, v243
    v_sub_f32 v232, v232, v243
    v_sub_f32 v233, v233, v243
    v_mfma_f32_16x16x32_bf16 v[84:87], v[216:219], v[220:223], 0
    v_sub_f32 v234, v234, v243
    v_sub_f32 v235, v235, v243
    v_exp_f32 v236, v228
    v_mfma_f32_16x16x32_bf16 v[220:223], v[156:159], v[104:107], 0
    ds_read_b128 v[156:159], v248 offset:8192
    v_exp_f32 v237, v229
    v_exp_f32 v238, v230
    v_mfma_f32_16x16x32_bf16 v[224:227], v[160:163], v[104:107], 0
    ds_read_b128 v[160:163], v248 offset:10240
    v_exp_f32 v239, v231
    v_add_f32 v247, v236, v237
    v_mfma_f32_16x16x32_bf16 v[220:223], v[164:167], v[116:119], v[220:223]
    ds_read_b128 v[164:167], v249 offset:8192
    v_add_f32 v255, v238, v239
    v_exp_f32 v240, v232
    v_exp_f32 v241, v233
    v_mfma_f32_16x16x32_bf16 v[224:227], v[168:171], v[116:119], v[224:227]
    ds_read_b128 v[168:171], v249 offset:10240
    v_add_f32 v247, v247, v240
    v_add_f32 v255, v255, v241
    v_exp_f32 v242, v234
    v_mfma_f32_16x16x32_bf16 v[220:223], v[172:175], v[128:131], v[220:223]
    ds_read_b128 v[172:175], v248 offset:12288
    v_exp_f32 v243, v235
    v_mfma_f32_16x16x32_bf16 v[224:227], v[176:179], v[128:131], v[224:227]
    ds_read_b128 v[176:179], v248 offset:14336
    v_add_f32 v247, v247, v242
    v_add_f32 v255, v255, v243
    v_add_f32 v245, v247, v255
    v_cvt_pk_bf16_f32 v228, v236, v237
    v_mfma_f32_16x16x32_bf16 v[220:223], v[180:183], v[140:143], v[220:223]
    ds_read_b128 v[180:183], v249 offset:12288
    v_cvt_pk_bf16_f32 v229, v238, v239
    v_cvt_pk_bf16_f32 v230, v240, v241
    v_cvt_pk_bf16_f32 v231, v242, v243
    v_mfma_f32_16x16x32_bf16 v[224:227], v[184:187], v[140:143], v[224:227]
    ds_read_b128 v[184:187], v249 offset:14336
    v_mfma_f32_16x16x32_bf16 v[4:7], v[188:191], v[228:231], 0
    v_mfma_f32_16x16x32_bf16 v[16:19], v[192:195], v[228:231], 0
    v_max3_f32 v243, v220, v221, v222
    s_nop 3
    v_max3_f32 v247, v223, v224, v225
    v_max3_f32 v243, v243, v226, v227
    v_max_f32 v243, v243, v247
    v_mfma_f32_16x16x32_bf16 v[28:31], v[196:199], v[228:231], 0
    v_mov_b32 v247, v243
    s_nop 1
    v_permlane32_swap_b32 v243, v247
    v_max_f32 v243, v243, v247
    v_mfma_f32_16x16x32_bf16 v[40:43], v[200:203], v[228:231], 0
    v_mov_b32 v247, v243
    s_nop 1
    v_permlane16_swap_b32 v243, v247
    v_mfma_f32_16x16x32_bf16 v[52:55], v[204:207], v[228:231], 0
    v_max_f32 v243, v243, v247
    v_sub_f32 v152, 0, v243
    v_sub_f32 v153, 0, v243
    v_sub_f32 v154, 0, v243
    v_mfma_f32_16x16x32_bf16 v[64:67], v[208:211], v[228:231], 0
    v_sub_f32 v155, 0, v243
    v_sub_f32 v220, v220, v243
    v_sub_f32 v221, v221, v243
    v_sub_f32 v222, v222, v243
    v_mfma_f32_16x16x32_bf16 v[76:79], v[212:215], v[228:231], 0
    v_sub_f32 v223, v223, v243
    v_sub_f32 v224, v224, v243
    v_sub_f32 v225, v225, v243
    v_mfma_f32_16x16x32_bf16 v[88:91], v[216:219], v[228:231], 0
    v_sub_f32 v226, v226, v243
    v_sub_f32 v227, v227, v243
    v_exp_f32 v236, v220
    s_waitcnt lgkmcnt(0)
    v_mfma_f32_16x16x32_bf16 v[228:231], v[156:159], v[96:99], v[144:147]
    v_exp_f32 v237, v221
    v_exp_f32 v238, v222
    v_mfma_f32_16x16x32_bf16 v[232:235], v[160:163], v[96:99], v[144:147]
    v_exp_f32 v239, v223
    v_add_f32 v247, v236, v237
    v_mfma_f32_16x16x32_bf16 v[228:231], v[164:167], v[108:111], v[228:231]
    v_add_f32 v255, v238, v239
    v_exp_f32 v240, v224
    v_exp_f32 v241, v225
    v_mfma_f32_16x16x32_bf16 v[232:235], v[168:171], v[108:111], v[232:235]
    v_add_f32 v247, v247, v240
    v_add_f32 v255, v255, v241
    v_exp_f32 v242, v226
    v_mfma_f32_16x16x32_bf16 v[228:231], v[172:175], v[120:123], v[228:231]
    v_exp_f32 v243, v227
    v_mfma_f32_16x16x32_bf16 v[232:235], v[176:179], v[120:123], v[232:235]
    v_add_f32 v247, v247, v242
    v_add_f32 v255, v255, v243
    v_add_f32 v246, v247, v255
    v_cvt_pk_bf16_f32 v220, v236, v237
    v_mfma_f32_16x16x32_bf16 v[228:231], v[180:183], v[132:135], v[228:231]
    v_cvt_pk_bf16_f32 v221, v238, v239
    v_cvt_pk_bf16_f32 v222, v240, v241
    v_cvt_pk_bf16_f32 v223, v242, v243
    v_mfma_f32_16x16x32_bf16 v[232:235], v[184:187], v[132:135], v[232:235]
    s_waitcnt lgkmcnt(0)
    s_barrier
    v_mfma_f32_16x16x32_bf16 v[8:11], v[188:191], v[220:223], 0
    s_mov_b32 s57, 1
    ds_read_b64_tr_b16 v[188:189], v250 offset:16384
    v_exp_f32 v236, v228
    v_mfma_f32_16x16x32_bf16 v[20:23], v[192:195], v[220:223], 0
    ds_read_b64_tr_b16 v[192:193], v251 offset:16384
    v_exp_f32 v237, v229
    v_mfma_f32_16x16x32_bf16 v[32:35], v[196:199], v[220:223], 0
    ds_read_b64_tr_b16 v[196:197], v252 offset:16384
    v_exp_f32 v238, v230
    v_mfma_f32_16x16x32_bf16 v[44:47], v[200:203], v[220:223], 0
    ds_read_b64_tr_b16 v[200:201], v253 offset:16384
    v_exp_f32 v239, v231
    v_mfma_f32_16x16x32_bf16 v[56:59], v[204:207], v[220:223], 0
    ds_read_b64_tr_b16 v[204:205], v250 offset:20480
    v_add_f32 v247, v236, v237
    v_add_f32 v255, v238, v239
    v_mfma_f32_16x16x32_bf16 v[68:71], v[208:211], v[220:223], 0
    ds_read_b64_tr_b16 v[208:209], v251 offset:20480
    v_exp_f32 v240, v232
    v_mfma_f32_16x16x32_bf16 v[80:83], v[212:215], v[220:223], 0
    ds_read_b64_tr_b16 v[212:213], v252 offset:20480
    v_exp_f32 v241, v233
    v_mfma_f32_16x16x32_bf16 v[92:95], v[216:219], v[220:223], 0
    ds_read_b64_tr_b16 v[216:217], v253 offset:20480
    v_add_f32 v247, v247, v240
    v_add_f32 v255, v255, v241
    v_mfma_f32_16x16x32_bf16 v[220:223], v[156:159], v[100:103], v[148:151]
    ds_read_b64_tr_b16 v[190:191], v250 offset:18432
    v_exp_f32 v242, v234
    v_mfma_f32_16x16x32_bf16 v[224:227], v[160:163], v[100:103], v[148:151]
    ds_read_b64_tr_b16 v[194:195], v251 offset:18432
    v_exp_f32 v243, v235
    v_mfma_f32_16x16x32_bf16 v[220:223], v[164:167], v[112:115], v[220:223]
    ds_read_b64_tr_b16 v[198:199], v252 offset:18432
    v_add_f32 v247, v247, v242
    v_add_f32 v255, v255, v243
    v_mfma_f32_16x16x32_bf16 v[224:227], v[168:171], v[112:115], v[224:227]
    ds_read_b64_tr_b16 v[202:203], v253 offset:18432
    v_add_f32 v247, v247, v255
    v_cmp_lt_f32 vcc, s54, v247
    v_mfma_f32_16x16x32_bf16 v[220:223], v[172:175], v[124:127], v[220:223]
    ds_read_b64_tr_b16 v[206:207], v250 offset:22528
    v_mfma_f32_16x16x32_bf16 v[224:227], v[176:179], v[124:127], v[224:227]
    ds_read_b64_tr_b16 v[210:211], v251 offset:22528
    s_cbranch_vccnz L_fix0_1
L_ret0_1:
    v_cvt_pk_bf16_f32 v228, v236, v237
    v_cvt_pk_bf16_f32 v229, v238, v239
    v_mfma_f32_16x16x32_bf16 v[220:223], v[180:183], v[136:139], v[220:223]
    ds_read_b64_tr_b16 v[214:215], v252 offset:22528
    v_cvt_pk_bf16_f32 v230, v240, v241
    v_cvt_pk_bf16_f32 v231, v242, v243
    v_mfma_f32_16x16x32_bf16 v[224:227], v[184:187], v[136:139], v[224:227]
    ds_read_b64_tr_b16 v[218:219], v253 offset:22528
    v_add_f32 v244, v244, v247
    s_waitcnt lgkmcnt(4)
    v_mfma_f32_16x16x32_bf16 v[0:3], v[188:191], v[228:231], v[0:3]
    v_exp_f32 v236, v220
    v_mfma_f32_16x16x32_bf16 v[12:15], v[192:195], v[228:231], v[12:15]
    v_exp_f32 v237, v221
    v_mfma_f32_16x16x32_bf16 v[24:27], v[196:199], v[228:231], v[24:27]
    v_exp_f32 v238, v222
    v_mfma_f32_16x16x32_bf16 v[36:39], v[200:203], v[228:231], v[36:39]
    v_exp_f32 v239, v223
    s_waitcnt lgkmcnt(0)
    v_mfma_f32_16x16x32_bf16 v[48:51], v[204:207], v[228:231], v[48:51]
    v_add_f32 v247, v236, v237
    v_add_f32 v255, v238, v239
    v_mfma_f32_16x16x32_bf16 v[60:63], v[208:211], v[228:231], v[60:63]
    v_exp_f32 v240, v224
    v_mfma_f32_16x16x32_bf16 v[72:75], v[212:215], v[228:231], v[72:75]
    v_exp_f32 v241, v225
    v_mfma_f32_16x16x32_bf16 v[84:87], v[216:219], v[228:231], v[84:87]
    v_add_f32 v247, v247, v240
    v_add_f32 v255, v255, v241
    v_mfma_f32_16x16x32_bf16 v[228:231], v[156:159], v[104:107], v[152:155]
    ds_read_b128 v[156:159], v248 offset:24576
    v_exp_f32 v242, v226
    v_mfma_f32_16x16x32_bf16 v[232:235], v[160:163], v[104:107], v[152:155]
    ds_read_b128 v[160:163], v248 offset:26624
    v_exp_f32 v243, v227
    v_mfma_f32_16x16x32_bf16 v[228:231], v[164:167], v[116:119], v[228:231]
    ds_read_b128 v[164:167], v249 offset:24576
    v_add_f32 v247, v247, v242
    v_add_f32 v255, v255, v243
    v_mfma_f32_16x16x32_bf16 v[232:235], v[168:171], v[116:119], v[232:235]
    ds_read_b128 v[168:171], v249 offset:26624
    v_add_f32 v247, v247, v255
    v_cmp_lt_f32 vcc, s54, v247
    v_mfma_f32_16x16x32_bf16 v[228:231], v[172:175], v[128:131], v[228:231]
    ds_read_b128 v[172:175], v248 offset:28672
    v_mfma_f32_16x16x32_bf16 v[232:235], v[176:179], v[128:131], v[232:235]
    ds_read_b128 v[176:179], v248 offset:30720
    s_cbranch_vccnz L_fix1_0
L_ret1_1:
    v_cvt_pk_bf16_f32 v220, v236, v237
    v_cvt_pk_bf16_f32 v221, v238, v239
    v_mfma_f32_16x16x32_bf16 v[228:231], v[180:183], v[140:143], v[228:231]
    ds_read_b128 v[180:183], v249 offset:28672
    v_cvt_pk_bf16_f32 v222, v240, v241
    v_cvt_pk_bf16_f32 v223, v242, v243
    v_mfma_f32_16x16x32_bf16 v[232:235], v[184:187], v[140:143], v[232:235]
    ds_read_b128 v[184:187], v249 offset:30720
    v_add_f32 v245, v245, v247
    v_mfma_f32_16x16x32_bf16 v[4:7], v[188:191], v[220:223], v[4:7]
    s_nop 0
    v_exp_f32 v236, v228
    v_mfma_f32_16x16x32_bf16 v[16:19], v[192:195], v[220:223], v[16:19]
    v_exp_f32 v237, v229
    v_mfma_f32_16x16x32_bf16 v[28:31], v[196:199], v[220:223], v[28:31]
    v_exp_f32 v238, v230
    v_mfma_f32_16x16x32_bf16 v[40:43], v[200:203], v[220:223], v[40:43]
    v_exp_f32 v239, v231
    v_mfma_f32_16x16x32_bf16 v[52:55], v[204:207], v[220:223], v[52:55]
    v_add_f32 v247, v236, v237
    v_add_f32 v255, v238, v239
    v_mfma_f32_16x16x32_bf16 v[64:67], v[208:211], v[220:223], v[64:67]
    v_exp_f32 v240, v232
    v_mfma_f32_16x16x32_bf16 v[76:79], v[212:215], v[220:223], v[76:79]
    v_exp_f32 v241, v233
    v_mfma_f32_16x16x32_bf16 v[88:91], v[216:219], v[220:223], v[88:91]
    v_add_f32 v247, v247, v240
    v_add_f32 v255, v255, v241
    s_waitcnt lgkmcnt(0)
    v_mfma_f32_16x16x32_bf16 v[220:223], v[156:159], v[96:99], v[144:147]
    v_exp_f32 v242, v234
    v_mfma_f32_16x16x32_bf16 v[224:227], v[160:163], v[96:99], v[144:147]
    v_exp_f32 v243, v235
    v_mfma_f32_16x16x32_bf16 v[220:223], v[164:167], v[108:111], v[220:223]
    v_add_f32 v247, v247, v242
    v_add_f32 v255, v255, v243
    v_mfma_f32_16x16x32_bf16 v[224:227], v[168:171], v[108:111], v[224:227]
    v_add_f32 v247, v247, v255
    v_cmp_lt_f32 vcc, s54, v247
    v_mfma_f32_16x16x32_bf16 v[220:223], v[172:175], v[120:123], v[220:223]
    v_mfma_f32_16x16x32_bf16 v[224:227], v[176:179], v[120:123], v[224:227]
    s_cbranch_vccnz L_fix2_1
L_ret2_1:
    v_cvt_pk_bf16_f32 v228, v236, v237
    v_cvt_pk_bf16_f32 v229, v238, v239
    v_mfma_f32_16x16x32_bf16 v[220:223], v[180:183], v[132:135], v[220:223]
    v_cvt_pk_bf16_f32 v230, v240, v241
    v_cvt_pk_bf16_f32 v231, v242, v243
    v_mfma_f32_16x16x32_bf16 v[224:227], v[184:187], v[132:135], v[224:227]
    v_add_f32 v246, v246, v247
    s_waitcnt lgkmcnt(0)
    s_barrier
    v_mfma_f32_16x16x32_bf16 v[8:11], v[188:191], v[228:231], v[8:11]
    s_mov_b32 s57, 2
    ds_read_b64_tr_b16 v[188:189], v250 offset:32768
    v_exp_f32 v236, v220
    v_mfma_f32_16x16x32_bf16 v[20:23], v[192:195], v[228:231], v[20:23]
    ds_read_b64_tr_b16 v[192:193], v251 offset:32768
    v_exp_f32 v237, v221
    v_mfma_f32_16x16x32_bf16 v[32:35], v[196:199], v[228:231], v[32:35]
    ds_read_b64_tr_b16 v[196:197], v252 offset:32768
    v_exp_f32 v238, v222
    v_mfma_f32_16x16x32_bf16 v[44:47], v[200:203], v[228:231], v[44:47]
    ds_read_b64_tr_b16 v[200:201], v253 offset:32768
    v_exp_f32 v239, v223
    v_mfma_f32_16x16x32_bf16 v[56:59], v[204:207], v[228:231], v[56:59]
    ds_read_b64_tr_b16 v[204:205], v250 offset:36864
    v_add_f32 v247, v236, v237
    v_add_f32 v255, v238, v239
    v_mfma_f32_16x16x32_bf16 v[68:71], v[208:211], v[228:231], v[68:71]
    ds_read_b64_tr_b16 v[208:209], v251 offset:36864
    v_exp_f32 v240, v224
    v_mfma_f32_16x16x32_bf16 v[80:83], v[212:215], v[228:231], v[80:83]
    ds_read_b64_tr_b16 v[212:213], v252 offset:36864
    v_exp_f32 v241, v225
    v_mfma_f32_16x16x32_bf16 v[92:95], v[216:219], v[228:231], v[92:95]
    ds_read_b64_tr_b16 v[216:217], v253 offset:36864
    v_add_f32 v247, v247, v240
    v_add_f32 v255, v255, v241
    v_mfma_f32_16x16x32_bf16 v[228:231], v[156:159], v[100:103], v[148:151]
    ds_read_b64_tr_b16 v[190:191], v250 offset:34816
    v_exp_f32 v242, v226
    v_mfma_f32_16x16x32_bf16 v[232:235], v[160:163], v[100:103], v[148:151]
    ds_read_b64_tr_b16 v[194:195], v251 offset:34816
    v_exp_f32 v243, v227
    v_mfma_f32_16x16x32_bf16 v[228:231], v[164:167], v[112:115], v[228:231]
    ds_read_b64_tr_b16 v[198:199], v252 offset:34816
    v_add_f32 v247, v247, v242
    v_add_f32 v255, v255, v243
    v_mfma_f32_16x16x32_bf16 v[232:235], v[168:171], v[112:115], v[232:235]
    ds_read_b64_tr_b16 v[202:203], v253 offset:34816
    v_add_f32 v247, v247, v255
    v_cmp_lt_f32 vcc, s54, v247
    v_mfma_f32_16x16x32_bf16 v[228:231], v[172:175], v[124:127], v[228:231]
    ds_read_b64_tr_b16 v[206:207], v250 offset:38912
    v_mfma_f32_16x16x32_bf16 v[232:235], v[176:179], v[124:127], v[232:235]
    ds_read_b64_tr_b16 v[210:211], v251 offset:38912
    s_cbranch_vccnz L_fix0_0
L_ret0_2:
    v_cvt_pk_bf16_f32 v220, v236, v237
    v_cvt_pk_bf16_f32 v221, v238, v239
    v_mfma_f32_16x16x32_bf16 v[228:231], v[180:183], v[136:139], v[228:231]
    ds_read_b64_tr_b16 v[214:215], v252 offset:38912
    v_cvt_pk_bf16_f32 v222, v240, v241
    v_cvt_pk_bf16_f32 v223, v242, v243
    v_mfma_f32_16x16x32_bf16 v[232:235], v[184:187], v[136:139], v[232:235]
    ds_read_b64_tr_b16 v[218:219], v253 offset:38912
    v_add_f32 v244, v244, v247
    s_waitcnt lgkmcnt(4)
    v_mfma_f32_16x16x32_bf16 v[0:3], v[188:191], v[220:223], v[0:3]
    v_exp_f32 v236, v228
    v_mfma_f32_16x16x32_bf16 v[12:15], v[192:195], v[220:223], v[12:15]
    v_exp_f32 v237, v229
    v_mfma_f32_16x16x32_bf16 v[24:27], v[196:199], v[220:223], v[24:27]
    v_exp_f32 v238, v230
    v_mfma_f32_16x16x32_bf16 v[36:39], v[200:203], v[220:223], v[36:39]
    v_exp_f32 v239, v231
    s_waitcnt lgkmcnt(0)
    v_mfma_f32_16x16x32_bf16 v[48:51], v[204:207], v[220:223], v[48:51]
    v_add_f32 v247, v236, v237
    v_add_f32 v255, v238, v239
    v_mfma_f32_16x16x32_bf16 v[60:63], v[208:211], v[220:223], v[60:63]
    v_exp_f32 v240, v232
    v_mfma_f32_16x16x32_bf16 v[72:75], v[212:215], v[220:223], v[72:75]
    v_exp_f32 v241, v233
    v_mfma_f32_16x16x32_bf16 v[84:87], v[216:219], v[220:223], v[84:87]
    v_add_f32 v247, v247, v240
    v_add_f32 v255, v255, v241
    v_mfma_f32_16x16x32_bf16 v[220:223], v[156:159], v[104:107], v[152:155]
    ds_read_b128 v[156:159], v248 offset:40960
    v_exp_f32 v242, v234
    v_mfma_f32_16x16x32_bf16 v[224:227], v[160:163], v[104:107], v[152:155]
    ds_read_b128 v[160:163], v248 offset:43008
    v_exp_f32 v243, v235
    v_mfma_f32_16x16x32_bf16 v[220:223], v[164:167], v[116:119], v[220:223]
    ds_read_b128 v[164:167], v249 offset:40960
    v_add_f32 v247, v247, v242
    v_add_f32 v255, v255, v243
    v_mfma_f32_16x16x32_bf16 v[224:227], v[168:171], v[116:119], v[224:227]
    ds_read_b128 v[168:171], v249 offset:43008
    v_add_f32 v247, v247, v255
    v_cmp_lt_f32 vcc, s54, v247
    v_mfma_f32_16x16x32_bf16 v[220:223], v[172:175], v[128:131], v[220:223]
    ds_read_b128 v[172:175], v248 offset:45056
    v_mfma_f32_16x16x32_bf16 v[224:227], v[176:179], v[128:131], v[224:227]
    ds_read_b128 v[176:179], v248 offset:47104
    s_cbranch_vccnz L_fix1_1
L_ret1_2:
    v_cvt_pk_bf16_f32 v228, v236, v237
    v_cvt_pk_bf16_f32 v229, v238, v239
    v_mfma_f32_16x16x32_bf16 v[220:223], v[180:183], v[140:143], v[220:223]
    ds_read_b128 v[180:183], v249 offset:45056
    v_cvt_pk_bf16_f32 v230, v240, v241
    v_cvt_pk_bf16_f32 v231, v242, v243
    v_mfma_f32_16x16x32_bf16 v[224:227], v[184:187], v[140:143], v[224:227]
    ds_read_b128 v[184:187], v249 offset:47104
    v_add_f32 v245, v245, v247
    v_mfma_f32_16x16x32_bf16 v[4:7], v[188:191], v[228:231], v[4:7]
    s_nop 0
    v_exp_f32 v236, v220
    v_mfma_f32_16x16x32_bf16 v[16:19], v[192:195], v[228:231], v[16:19]
    v_exp_f32 v237, v221
    v_mfma_f32_16x16x32_bf16 v[28:31], v[196:199], v[228:231], v[28:31]
    v_exp_f32 v238, v222
    v_mfma_f32_16x16x32_bf16 v[40:43], v[200:203], v[228:231], v[40:43]
    v_exp_f32 v239, v223
    v_mfma_f32_16x16x32_bf16 v[52:55], v[204:207], v[228:231], v[52:55]
    v_add_f32 v247, v236, v237
    v_add_f32 v255, v238, v239
    v_mfma_f32_16x16x32_bf16 v[64:67], v[208:211], v[228:231], v[64:67]
    v_exp_f32 v240, v224
    v_mfma_f32_16x16x32_bf16 v[76:79], v[212:215], v[228:231], v[76:79]
    v_exp_f32 v241, v225
    v_mfma_f32_16x16x32_bf16 v[88:91], v[216:219], v[228:231], v[88:91]
    v_add_f32 v247, v247, v240
    v_add_f32 v255, v255, v241
    s_waitcnt lgkmcnt(0)
    v_mfma_f32_16x16x32_bf16 v[228:231], v[156:159], v[96:99], v[144:147]
    v_exp_f32 v242, v226
    v_mfma_f32_16x16x32_bf16 v[232:235], v[160:163], v[96:99], v[144:147]
    v_exp_f32 v243, v227
    v_mfma_f32_16x16x32_bf16 v[228:231], v[164:167], v[108:111], v[228:231]
    v_add_f32 v247, v247, v242
    v_add_f32 v255, v255, v243
    v_mfma_f32_16x16x32_bf16 v[232:235], v[168:171], v[108:111], v[232:235]
    v_add_f32 v247, v247, v255
    v_cmp_lt_f32 vcc, s54, v247
    v_mfma_f32_16x16x32_bf16 v[228:231], v[172:175], v[120:123], v[228:231]
    v_mfma_f32_16x16x32_bf16 v[232:235], v[176:179], v[120:123], v[232:235]
    s_cbranch_vccnz L_fix2_0
L_ret2_2:
    v_cvt_pk_bf16_f32 v220, v236, v237
    v_cvt_pk_bf16_f32 v221, v238, v239
    v_mfma_f32_16x16x32_bf16 v[228:231], v[180:183], v[132:135], v[228:231]
    v_cvt_pk_bf16_f32 v222, v240, v241
    v_cvt_pk_bf16_f32 v223, v242, v243
    v_mfma_f32_16x16x32_bf16 v[232:235], v[184:187], v[132:135], v[232:235]
    v_add_f32 v246, v246, v247
    s_waitcnt lgkmcnt(0)
    s_barrier
    v_mfma_f32_16x16x32_bf16 v[8:11], v[188:191], v[220:223], v[8:11]
    s_mov_b32 s57, 3
    ds_read_b64_tr_b16 v[188:189], v250 offset:49152
    v_exp_f32 v236, v228
    v_mfma_f32_16x16x32_bf16 v[20:23], v[192:195], v[220:223], v[20:23]
    ds_read_b64_tr_b16 v[192:193], v251 offset:49152
    v_exp_f32 v237, v229
    v_mfma_f32_16x16x32_bf16 v[32:35], v[196:199], v[220:223], v[32:35]
    ds_read_b64_tr_b16 v[196:197], v252 offset:49152
    v_exp_f32 v238, v230
    v_mfma_f32_16x16x32_bf16 v[44:47], v[200:203], v[220:223], v[44:47]
    ds_read_b64_tr_b16 v[200:201], v253 offset:49152
    v_exp_f32 v239, v231
    v_mfma_f32_16x16x32_bf16 v[56:59], v[204:207], v[220:223], v[56:59]
    ds_read_b64_tr_b16 v[204:205], v250 offset:53248
    v_add_f32 v247, v236, v237
    v_add_f32 v255, v238, v239
    v_mfma_f32_16x16x32_bf16 v[68:71], v[208:211], v[220:223], v[68:71]
    ds_read_b64_tr_b16 v[208:209], v251 offset:53248
    v_exp_f32 v240, v232
    v_mfma_f32_16x16x32_bf16 v[80:83], v[212:215], v[220:223], v[80:83]
    ds_read_b64_tr_b16 v[212:213], v252 offset:53248
    v_exp_f32 v241, v233
    v_mfma_f32_16x16x32_bf16 v[92:95], v[216:219], v[220:223], v[92:95]
    ds_read_b64_tr_b16 v[216:217], v253 offset:53248
    v_add_f32 v247, v247, v240
    v_add_f32 v255, v255, v241
    v_mfma_f32_16x16x32_bf16 v[220:223], v[156:159], v[100:103], v[148:151]
    ds_read_b64_tr_b16 v[190:191], v250 offset:51200
    v_exp_f32 v242, v234
    v_mfma_f32_16x16x32_bf16 v[224:227], v[160:163], v[100:103], v[148:151]
    ds_read_b64_tr_b16 v[194:195], v251 offset:51200
    v_exp_f32 v243, v235
    v_mfma_f32_16x16x32_bf16 v[220:223], v[164:167], v[112:115], v[220:223]
    ds_read_b64_tr_b16 v[198:199], v252 offset:51200
    v_add_f32 v247, v247, v242
    v_add_f32 v255, v255, v243
    v_mfma_f32_16x16x32_bf16 v[224:227], v[168:171], v[112:115], v[224:227]
    ds_read_b64_tr_b16 v[202:203], v253 offset:51200
    v_add_f32 v247, v247, v255
    v_cmp_lt_f32 vcc, s54, v247
    v_mfma_f32_16x16x32_bf16 v[220:223], v[172:175], v[124:127], v[220:223]
    ds_read_b64_tr_b16 v[206:207], v250 offset:55296
    v_mfma_f32_16x16x32_bf16 v[224:227], v[176:179], v[124:127], v[224:227]
    ds_read_b64_tr_b16 v[210:211], v251 offset:55296
    s_cbranch_vccnz L_fix0_1
L_ret0_3:
    v_cvt_pk_bf16_f32 v228, v236, v237
    v_cvt_pk_bf16_f32 v229, v238, v239
    v_mfma_f32_16x16x32_bf16 v[220:223], v[180:183], v[136:139], v[220:223]
    ds_read_b64_tr_b16 v[214:215], v252 offset:55296
    v_cvt_pk_bf16_f32 v230, v240, v241
    v_cvt_pk_bf16_f32 v231, v242, v243
    v_mfma_f32_16x16x32_bf16 v[224:227], v[184:187], v[136:139], v[224:227]
    ds_read_b64_tr_b16 v[218:219], v253 offset:55296
    v_add_f32 v244, v244, v247
    s_waitcnt lgkmcnt(4)
    v_mfma_f32_16x16x32_bf16 v[0:3], v[188:191], v[228:231], v[0:3]
    v_exp_f32 v236, v220
    v_mfma_f32_16x16x32_bf16 v[12:15], v[192:195], v[228:231], v[12:15]
    v_exp_f32 v237, v221
    v_mfma_f32_16x16x32_bf16 v[24:27], v[196:199], v[228:231], v[24:27]
    v_exp_f32 v238, v222
    v_mfma_f32_16x16x32_bf16 v[36:39], v[200:203], v[228:231], v[36:39]
    v_exp_f32 v239, v223
    s_waitcnt lgkmcnt(0)
    v_mfma_f32_16x16x32_bf16 v[48:51], v[204:207], v[228:231], v[48:51]
    v_add_f32 v247, v236, v237
    v_add_f32 v255, v238, v239
    v_mfma_f32_16x16x32_bf16 v[60:63], v[208:211], v[228:231], v[60:63]
    v_exp_f32 v240, v224
    v_mfma_f32_16x16x32_bf16 v[72:75], v[212:215], v[228:231], v[72:75]
    v_exp_f32 v241, v225
    v_mfma_f32_16x16x32_bf16 v[84:87], v[216:219], v[228:231], v[84:87]
    v_add_f32 v247, v247, v240
    v_add_f32 v255, v255, v241
    v_mfma_f32_16x16x32_bf16 v[228:231], v[156:159], v[104:107], v[152:155]
    ds_read_b128 v[156:159], v248 offset:57344
    v_exp_f32 v242, v226
    v_mfma_f32_16x16x32_bf16 v[232:235], v[160:163], v[104:107], v[152:155]
    ds_read_b128 v[160:163], v248 offset:59392
    v_exp_f32 v243, v227
    v_mfma_f32_16x16x32_bf16 v[228:231], v[164:167], v[116:119], v[228:231]
    ds_read_b128 v[164:167], v249 offset:57344
    v_add_f32 v247, v247, v242
    v_add_f32 v255, v255, v243
    v_mfma_f32_16x16x32_bf16 v[232:235], v[168:171], v[116:119], v[232:235]
    ds_read_b128 v[168:171], v249 offset:59392
    v_add_f32 v247, v247, v255
    v_cmp_lt_f32 vcc, s54, v247
    v_mfma_f32_16x16x32_bf16 v[228:231], v[172:175], v[128:131], v[228:231]
    ds_read_b128 v[172:175], v248 offset:61440
    v_mfma_f32_16x16x32_bf16 v[232:235], v[176:179], v[128:131], v[232:235]
    ds_read_b128 v[176:179], v248 offset:63488
    s_cbranch_vccnz L_fix1_0
L_ret1_3:
    v_cvt_pk_bf16_f32 v220, v236, v237
    v_cvt_pk_bf16_f32 v221, v238, v239
    v_mfma_f32_16x16x32_bf16 v[228:231], v[180:183], v[140:143], v[228:231]
    ds_read_b128 v[180:183], v249 offset:61440
    v_cvt_pk_bf16_f32 v222, v240, v241
    v_cvt_pk_bf16_f32 v223, v242, v243
    v_mfma_f32_16x16x32_bf16 v[232:235], v[184:187], v[140:143], v[232:235]
    ds_read_b128 v[184:187], v249 offset:63488
    v_add_f32 v245, v245, v247
    v_mfma_f32_16x16x32_bf16 v[4:7], v[188:191], v[220:223], v[4:7]
    s_nop 0
    v_exp_f32 v236, v228
    v_mfma_f32_16x16x32_bf16 v[16:19], v[192:195], v[220:223], v[16:19]
    v_exp_f32 v237, v229
    v_mfma_f32_16x16x32_bf16 v[28:31], v[196:199], v[220:223], v[28:31]
    v_exp_f32 v238, v230
    v_mfma_f32_16x16x32_bf16 v[40:43], v[200:203], v[220:223], v[40:43]
    v_exp_f32 v239, v231
    v_mfma_f32_16x16x32_bf16 v[52:55], v[204:207], v[220:223], v[52:55]
    v_add_f32 v247, v236, v237
    v_add_f32 v255, v238, v239
    v_mfma_f32_16x16x32_bf16 v[64:67], v[208:211], v[220:223], v[64:67]
    v_exp_f32 v240, v232
    v_mfma_f32_16x16x32_bf16 v[76:79], v[212:215], v[220:223], v[76:79]
    v_exp_f32 v241, v233
    v_mfma_f32_16x16x32_bf16 v[88:91], v[216:219], v[220:223], v[88:91]
    v_add_f32 v247, v247, v240
    v_add_f32 v255, v255, v241
    s_waitcnt lgkmcnt(0)
    v_mfma_f32_16x16x32_bf16 v[220:223], v[156:159], v[96:99], v[144:147]
    v_exp_f32 v242, v234
    v_mfma_f32_16x16x32_bf16 v[224:227], v[160:163], v[96:99], v[144:147]
    v_exp_f32 v243, v235
    v_mfma_f32_16x16x32_bf16 v[220:223], v[164:167], v[108:111], v[220:223]
    v_add_f32 v247, v247, v242
    v_add_f32 v255, v255, v243
    v_mfma_f32_16x16x32_bf16 v[224:227], v[168:171], v[108:111], v[224:227]
    v_add_f32 v247, v247, v255
    v_cmp_lt_f32 vcc, s54, v247
    v_mfma_f32_16x16x32_bf16 v[220:223], v[172:175], v[120:123], v[220:223]
    v_mfma_f32_16x16x32_bf16 v[224:227], v[176:179], v[120:123], v[224:227]
    s_cbranch_vccnz L_fix2_1
L_ret2_3:
    v_cvt_pk_bf16_f32 v228, v236, v237
    v_cvt_pk_bf16_f32 v229, v238, v239
    v_mfma_f32_16x16x32_bf16 v[220:223], v[180:183], v[132:135], v[220:223]
    v_cvt_pk_bf16_f32 v230, v240, v241
    v_cvt_pk_bf16_f32 v231, v242, v243
    v_mfma_f32_16x16x32_bf16 v[224:227], v[184:187], v[132:135], v[224:227]
    v_add_f32 v246, v246, v247
    s_waitcnt lgkmcnt(0)
    s_barrier
    v_mfma_f32_16x16x32_bf16 v[8:11], v[188:191], v[228:231], v[8:11]
    s_mov_b32 s57, 4
    ds_read_b64_tr_b16 v[188:189], v250 offset:0
    v_exp_f32 v236, v220
    v_mfma_f32_16x16x32_bf16 v[20:23], v[192:195], v[228:231], v[20:23]
    ds_read_b64_tr_b16 v[192:193], v251 offset:0
    v_exp_f32 v237, v221
    v_mfma_f32_16x16x32_bf16 v[32:35], v[196:199], v[228:231], v[32:35]
    ds_read_b64_tr_b16 v[196:197], v252 offset:0
    v_exp_f32 v238, v222
    v_mfma_f32_16x16x32_bf16 v[44:47], v[200:203], v[228:231], v[44:47]
    ds_read_b64_tr_b16 v[200:201], v253 offset:0
    v_exp_f32 v239, v223
    v_mfma_f32_16x16x32_bf16 v[56:59], v[204:207], v[228:231], v[56:59]
    ds_read_b64_tr_b16 v[204:205], v250 offset:4096
    v_add_f32 v247, v236, v237
    v_add_f32 v255, v238, v239
    v_mfma_f32_16x16x32_bf16 v[68:71], v[208:211], v[228:231], v[68:71]
    ds_read_b64_tr_b16 v[208:209], v251 offset:4096
    v_exp_f32 v240, v224
    v_mfma_f32_16x16x32_bf16 v[80:83], v[212:215], v[228:231], v[80:83]
    ds_read_b64_tr_b16 v[212:213], v252 offset:4096
    v_exp_f32 v241, v225
    v_mfma_f32_16x16x32_bf16 v[92:95], v[216:219], v[228:231], v[92:95]
    ds_read_b64_tr_b16 v[216:217], v253 offset:4096
    v_add_f32 v247, v247, v240
    v_add_f32 v255, v255, v241
    v_mfma_f32_16x16x32_bf16 v[228:231], v[156:159], v[100:103], v[148:151]
    ds_read_b64_tr_b16 v[190:191], v250 offset:2048
    v_exp_f32 v242, v226
    v_mfma_f32_16x16x32_bf16 v[232:235], v[160:163], v[100:103], v[148:151]
    ds_read_b64_tr_b16 v[194:195], v251 offset:2048
    v_exp_f32 v243, v227
    v_mfma_f32_16x16x32_bf16 v[228:231], v[164:167], v[112:115], v[228:231]
    ds_read_b64_tr_b16 v[198:199], v252 offset:2048
    v_add_f32 v247, v247, v242
    v_add_f32 v255, v255, v243
    v_mfma_f32_16x16x32_bf16 v[232:235], v[168:171], v[112:115], v[232:235]
    ds_read_b64_tr_b16 v[202:203], v253 offset:2048
    v_add_f32 v247, v247, v255
    v_cmp_lt_f32 vcc, s54, v247
    v_mfma_f32_16x16x32_bf16 v[228:231], v[172:175], v[124:127], v[228:231]
    ds_read_b64_tr_b16 v[206:207], v250 offset:6144
    v_mfma_f32_16x16x32_bf16 v[232:235], v[176:179], v[124:127], v[232:235]
    ds_read_b64_tr_b16 v[210:211], v251 offset:6144
    s_cbranch_vccnz L_fix0_0
L_ret0_4:
    v_cvt_pk_bf16_f32 v220, v236, v237
    v_cvt_pk_bf16_f32 v221, v238, v239
    v_mfma_f32_16x16x32_bf16 v[228:231], v[180:183], v[136:139], v[228:231]
    ds_read_b64_tr_b16 v[214:215], v252 offset:6144
    v_cvt_pk_bf16_f32 v222, v240, v241
    v_cvt_pk_bf16_f32 v223, v242, v243
    v_mfma_f32_16x16x32_bf16 v[232:235], v[184:187], v[136:139], v[232:235]
    ds_read_b64_tr_b16 v[218:219], v253 offset:6144
    v_add_f32 v244, v244, v247
    s_waitcnt lgkmcnt(4)
    v_mfma_f32_16x16x32_bf16 v[0:3], v[188:191], v[220:223], v[0:3]
    v_exp_f32 v236, v228
    v_mfma_f32_16x16x32_bf16 v[12:15], v[192:195], v[220:223], v[12:15]
    v_exp_f32 v237, v229
    v_mfma_f32_16x16x32_bf16 v[24:27], v[196:199], v[220:223], v[24:27]
    v_exp_f32 v238, v230
    v_mfma_f32_16x16x32_bf16 v[36:39], v[200:203], v[220:223], v[36:39]
    v_exp_f32 v239, v231
    s_waitcnt lgkmcnt(0)
    v_mfma_f32_16x16x32_bf16 v[48:51], v[204:207], v[220:223], v[48:51]
    v_add_f32 v247, v236, v237
    v_add_f32 v255, v238, v239
    v_mfma_f32_16x16x32_bf16 v[60:63], v[208:211], v[220:223], v[60:63]
    v_exp_f32 v240, v232
    v_mfma_f32_16x16x32_bf16 v[72:75], v[212:215], v[220:223], v[72:75]
    v_exp_f32 v241, v233
    v_mfma_f32_16x16x32_bf16 v[84:87], v[216:219], v[220:223], v[84:87]
    v_add_f32 v247, v247, v240
    v_add_f32 v255, v255, v241
    v_mfma_f32_16x16x32_bf16 v[220:223], v[156:159], v[104:107], v[152:155]
    ds_read_b128 v[156:159], v248 offset:8192
    v_exp_f32 v242, v234
    v_mfma_f32_16x16x32_bf16 v[224:227], v[160:163], v[104:107], v[152:155]
    ds_read_b128 v[160:163], v248 offset:10240
    v_exp_f32 v243, v235
    v_mfma_f32_16x16x32_bf16 v[220:223], v[164:167], v[116:119], v[220:223]
    ds_read_b128 v[164:167], v249 offset:8192
    v_add_f32 v247, v247, v242
    v_add_f32 v255, v255, v243
    v_mfma_f32_16x16x32_bf16 v[224:227], v[168:171], v[116:119], v[224:227]
    ds_read_b128 v[168:171], v249 offset:10240
    v_add_f32 v247, v247, v255
    v_cmp_lt_f32 vcc, s54, v247
    v_mfma_f32_16x16x32_bf16 v[220:223], v[172:175], v[128:131], v[220:223]
    ds_read_b128 v[172:175], v248 offset:12288
    v_mfma_f32_16x16x32_bf16 v[224:227], v[176:179], v[128:131], v[224:227]
    ds_read_b128 v[176:179], v248 offset:14336
    s_cbranch_vccnz L_fix1_1
L_ret1_4:
    v_cvt_pk_bf16_f32 v228, v236, v237
    v_cvt_pk_bf16_f32 v229, v238, v239
    v_mfma_f32_16x16x32_bf16 v[220:223], v[180:183], v[140:143], v[220:223]
    ds_read_b128 v[180:183], v249 offset:12288
    v_cvt_pk_bf16_f32 v230, v240, v241
    v_cvt_pk_bf16_f32 v231, v242, v243
    v_mfma_f32_16x16x32_bf16 v[224:227], v[184:187], v[140:143], v[224:227]
    ds_read_b128 v[184:187], v249 offset:14336
    v_add_f32 v245, v245, v247
    v_mfma_f32_16x16x32_bf16 v[4:7], v[188:191], v[228:231], v[4:7]
    s_nop 0
    v_exp_f32 v236, v220
    v_mfma_f32_16x16x32_bf16 v[16:19], v[192:195], v[228:231], v[16:19]
    v_exp_f32 v237, v221
    v_mfma_f32_16x16x32_bf16 v[28:31], v[196:199], v[228:231], v[28:31]
    v_exp_f32 v238, v222
    v_mfma_f32_16x16x32_bf16 v[40:43], v[200:203], v[228:231], v[40:43]
    v_exp_f32 v239, v223
    v_mfma_f32_16x16x32_bf16 v[52:55], v[204:207], v[228:231], v[52:55]
    v_add_f32 v247, v236, v237
    v_add_f32 v255, v238, v239
    v_mfma_f32_16x16x32_bf16 v[64:67], v[208:211], v[228:231], v[64:67]
    v_exp_f32 v240, v224
    v_mfma_f32_16x16x32_bf16 v[76:79], v[212:215], v[228:231], v[76:79]
    v_exp_f32 v241, v225
    v_mfma_f32_16x16x32_bf16 v[88:91], v[216:219], v[228:231], v[88:91]
    v_add_f32 v247, v247, v240
    v_add_f32 v255, v255, v241
    s_waitcnt lgkmcnt(0)
    v_mfma_f32_16x16x32_bf16 v[228:231], v[156:159], v[96:99], v[144:147]
    v_exp_f32 v242, v226
    v_mfma_f32_16x16x32_bf16 v[232:235], v[160:163], v[96:99], v[144:147]
    v_exp_f32 v243, v227
    v_mfma_f32_16x16x32_bf16 v[228:231], v[164:167], v[108:111], v[228:231]
    v_add_f32 v247, v247, v242
    v_add_f32 v255, v255, v243
    v_mfma_f32_16x16x32_bf16 v[232:235], v[168:171], v[108:111], v[232:235]
    v_add_f32 v247, v247, v255
    v_cmp_lt_f32 vcc, s54, v247
    v_mfma_f32_16x16x32_bf16 v[228:231], v[172:175], v[120:123], v[228:231]
    v_mfma_f32_16x16x32_bf16 v[232:235], v[176:179], v[120:123], v[232:235]
    s_cbranch_vccnz L_fix2_0
L_ret2_4:
    v_cvt_pk_bf16_f32 v220, v236, v237
    v_cvt_pk_bf16_f32 v221, v238, v239
    v_mfma_f32_16x16x32_bf16 v[228:231], v[180:183], v[132:135], v[228:231]
    v_cvt_pk_bf16_f32 v222, v240, v241
    v_cvt_pk_bf16_f32 v223, v242, v243
    v_mfma_f32_16x16x32_bf16 v[232:235], v[184:187], v[132:135], v[232:235]
    v_add_f32 v246, v246, v247
    s_waitcnt lgkmcnt(0)
    s_barrier
    v_mfma_f32_16x16x32_bf16 v[8:11], v[188:191], v[220:223], v[8:11]
    s_mov_b32 s57, 5
    ds_read_b64_tr_b16 v[188:189], v250 offset:16384
    v_exp_f32 v236, v228
    v_mfma_f32_16x16x32_bf16 v[20:23], v[192:195], v[220:223], v[20:23]
    ds_read_b64_tr_b16 v[192:193], v251 offset:16384
    v_exp_f32 v237, v229
    v_mfma_f32_16x16x32_bf16 v[32:35], v[196:199], v[220:223], v[32:35]
    ds_read_b64_tr_b16 v[196:197], v252 offset:16384
    v_exp_f32 v238, v230
    v_mfma_f32_16x16x32_bf16 v[44:47], v[200:203], v[220:223], v[44:47]
    ds_read_b64_tr_b16 v[200:201], v253 offset:16384
    v_exp_f32 v239, v231
    v_mfma_f32_16x16x32_bf16 v[56:59], v[204:207], v[220:223], v[56:59]
    ds_read_b64_tr_b16 v[204:205], v250 offset:20480
    v_add_f32 v247, v236, v237
    v_add_f32 v255, v238, v239
    v_mfma_f32_16x16x32_bf16 v[68:71], v[208:211], v[220:223], v[68:71]
    ds_read_b64_tr_b16 v[208:209], v251 offset:20480
    v_exp_f32 v240, v232
    v_mfma_f32_16x16x32_bf16 v[80:83], v[212:215], v[220:223], v[80:83]
    ds_read_b64_tr_b16 v[212:213], v252 offset:20480
    v_exp_f32 v241, v233
    v_mfma_f32_16x16x32_bf16 v[92:95], v[216:219], v[220:223], v[92:95]
    ds_read_b64_tr_b16 v[216:217], v253 offset:20480
    v_add_f32 v247, v247, v240
    v_add_f32 v255, v255, v241
    v_mfma_f32_16x16x32_bf16 v[220:223], v[156:159], v[100:103], v[148:151]
    ds_read_b64_tr_b16 v[190:191], v250 offset:18432
    v_exp_f32 v242, v234
    v_mfma_f32_16x16x32_bf16 v[224:227], v[160:163], v[100:103], v[148:151]
    ds_read_b64_tr_b16 v[194:195], v251 offset:18432
    v_exp_f32 v243, v235
    v_mfma_f32_16x16x32_bf16 v[220:223], v[164:167], v[112:115], v[220:223]
    ds_read_b64_tr_b16 v[198:199], v252 offset:18432
    v_add_f32 v247, v247, v242
    v_add_f32 v255, v255, v243
    v_mfma_f32_16x16x32_bf16 v[224:227], v[168:171], v[112:115], v[224:227]
    ds_read_b64_tr_b16 v[202:203], v253 offset:18432
    v_add_f32 v247, v247, v255
    v_cmp_lt_f32 vcc, s54, v247
    v_mfma_f32_16x16x32_bf16 v[220:223], v[172:175], v[124:127], v[220:223]
    ds_read_b64_tr_b16 v[206:207], v250 offset:22528
    v_mfma_f32_16x16x32_bf16 v[224:227], v[176:179], v[124:127], v[224:227]
    ds_read_b64_tr_b16 v[210:211], v251 offset:22528
    s_cbranch_vccnz L_fix0_1
L_ret0_5:
    v_cvt_pk_bf16_f32 v228, v236, v237
    v_cvt_pk_bf16_f32 v229, v238, v239
    v_mfma_f32_16x16x32_bf16 v[220:223], v[180:183], v[136:139], v[220:223]
    ds_read_b64_tr_b16 v[214:215], v252 offset:22528
    v_cvt_pk_bf16_f32 v230, v240, v241
    v_cvt_pk_bf16_f32 v231, v242, v243
    v_mfma_f32_16x16x32_bf16 v[224:227], v[184:187], v[136:139], v[224:227]
    ds_read_b64_tr_b16 v[218:219], v253 offset:22528
    v_add_f32 v244, v244, v247
    s_waitcnt lgkmcnt(4)
    v_mfma_f32_16x16x32_bf16 v[0:3], v[188:191], v[228:231], v[0:3]
    v_exp_f32 v236, v220
    v_mfma_f32_16x16x32_bf16 v[12:15], v[192:195], v[228:231], v[12:15]
    v_exp_f32 v237, v221
    v_mfma_f32_16x16x32_bf16 v[24:27], v[196:199], v[228:231], v[24:27]
    v_exp_f32 v238, v222
    v_mfma_f32_16x16x32_bf16 v[36:39], v[200:203], v[228:231], v[36:39]
    v_exp_f32 v239, v223
    s_waitcnt lgkmcnt(0)
    v_mfma_f32_16x16x32_bf16 v[48:51], v[204:207], v[228:231], v[48:51]
    v_add_f32 v247, v236, v237
    v_add_f32 v255, v238, v239
    v_mfma_f32_16x16x32_bf16 v[60:63], v[208:211], v[228:231], v[60:63]
    v_exp_f32 v240, v224
    v_mfma_f32_16x16x32_bf16 v[72:75], v[212:215], v[228:231], v[72:75]
    v_exp_f32 v241, v225
    v_mfma_f32_16x16x32_bf16 v[84:87], v[216:219], v[228:231], v[84:87]
    v_add_f32 v247, v247, v240
    v_add_f32 v255, v255, v241
    v_mfma_f32_16x16x32_bf16 v[228:231], v[156:159], v[104:107], v[152:155]
    ds_read_b128 v[156:159], v248 offset:24576
    v_exp_f32 v242, v226
    v_mfma_f32_16x16x32_bf16 v[232:235], v[160:163], v[104:107], v[152:155]
    ds_read_b128 v[160:163], v248 offset:26624
    v_exp_f32 v243, v227
    v_mfma_f32_16x16x32_bf16 v[228:231], v[164:167], v[116:119], v[228:231]
    ds_read_b128 v[164:167], v249 offset:24576
    v_add_f32 v247, v247, v242
    v_add_f32 v255, v255, v243
    v_mfma_f32_16x16x32_bf16 v[232:235], v[168:171], v[116:119], v[232:235]
    ds_read_b128 v[168:171], v249 offset:26624
    v_add_f32 v247, v247, v255
    v_cmp_lt_f32 vcc, s54, v247
    v_mfma_f32_16x16x32_bf16 v[228:231], v[172:175], v[128:131], v[228:231]
    ds_read_b128 v[172:175], v248 offset:28672
    v_mfma_f32_16x16x32_bf16 v[232:235], v[176:179], v[128:131], v[232:235]
    ds_read_b128 v[176:179], v248 offset:30720
    s_cbranch_vccnz L_fix1_0
L_ret1_5:
    v_cvt_pk_bf16_f32 v220, v236, v237
    v_cvt_pk_bf16_f32 v221, v238, v239
    v_mfma_f32_16x16x32_bf16 v[228:231], v[180:183], v[140:143], v[228:231]
    ds_read_b128 v[180:183], v249 offset:28672
    v_cvt_pk_bf16_f32 v222, v240, v241
    v_cvt_pk_bf16_f32 v223, v242, v243
    v_mfma_f32_16x16x32_bf16 v[232:235], v[184:187], v[140:143], v[232:235]
    ds_read_b128 v[184:187], v249 offset:30720
    v_add_f32 v245, v245, v247
    v_mfma_f32_16x16x32_bf16 v[4:7], v[188:191], v[220:223], v[4:7]
    s_nop 0
    v_exp_f32 v236, v228
    v_mfma_f32_16x16x32_bf16 v[16:19], v[192:195], v[220:223], v[16:19]
    v_exp_f32 v237, v229
    v_mfma_f32_16x16x32_bf16 v[28:31], v[196:199], v[220:223], v[28:31]
    v_exp_f32 v238, v230
    v_mfma_f32_16x16x32_bf16 v[40:43], v[200:203], v[220:223], v[40:43]
    v_exp_f32 v239, v231
    v_mfma_f32_16x16x32_bf16 v[52:55], v[204:207], v[220:223], v[52:55]
    v_add_f32 v247, v236, v237
    v_add_f32 v255, v238, v239
    v_mfma_f32_16x16x32_bf16 v[64:67], v[208:211], v[220:223], v[64:67]
    v_exp_f32 v240, v232
    v_mfma_f32_16x16x32_bf16 v[76:79], v[212:215], v[220:223], v[76:79]
    v_exp_f32 v241, v233
    v_mfma_f32_16x16x32_bf16 v[88:91], v[216:219], v[220:223], v[88:91]
    v_add_f32 v247, v247, v240
    v_add_f32 v255, v255, v241
    s_waitcnt lgkmcnt(0)
    v_mfma_f32_16x16x32_bf16 v[220:223], v[156:159], v[96:99], v[144:147]
    v_exp_f32 v242, v234
    v_mfma_f32_16x16x32_bf16 v[224:227], v[160:163], v[96:99], v[144:147]
    v_exp_f32 v243, v235
    v_mfma_f32_16x16x32_bf16 v[220:223], v[164:167], v[108:111], v[220:223]
    v_add_f32 v247, v247, v242
    v_add_f32 v255, v255, v243
    v_mfma_f32_16x16x32_bf16 v[224:227], v[168:171], v[108:111], v[224:227]
    v_add_f32 v247, v247, v255
    v_cmp_lt_f32 vcc, s54, v247
    v_mfma_f32_16x16x32_bf16 v[220:223], v[172:175], v[120:123], v[220:223]
    v_mfma_f32_16x16x32_bf16 v[224:227], v[176:179], v[120:123], v[224:227]
    s_cbranch_vccnz L_fix2_1
L_ret2_5:
    v_cvt_pk_bf16_f32 v228, v236, v237
    v_cvt_pk_bf16_f32 v229, v238, v239
    v_mfma_f32_16x16x32_bf16 v[220:223], v[180:183], v[132:135], v[220:223]
    v_cvt_pk_bf16_f32 v230, v240, v241
    v_cvt_pk_bf16_f32 v231, v242, v243
    v_mfma_f32_16x16x32_bf16 v[224:227], v[184:187], v[132:135], v[224:227]
    v_add_f32 v246, v246, v247
    s_waitcnt lgkmcnt(0)
    s_barrier
    v_mfma_f32_16x16x32_bf16 v[8:11], v[188:191], v[228:231], v[8:11]
    s_mov_b32 s57, 6
    ds_read_b64_tr_b16 v[188:189], v250 offset:32768
    v_exp_f32 v236, v220
    v_mfma_f32_16x16x32_bf16 v[20:23], v[192:195], v[228:231], v[20:23]
    ds_read_b64_tr_b16 v[192:193], v251 offset:32768
    v_exp_f32 v237, v221
    v_mfma_f32_16x16x32_bf16 v[32:35], v[196:199], v[228:231], v[32:35]
    ds_read_b64_tr_b16 v[196:197], v252 offset:32768
    v_exp_f32 v238, v222
    v_mfma_f32_16x16x32_bf16 v[44:47], v[200:203], v[228:231], v[44:47]
    ds_read_b64_tr_b16 v[200:201], v253 offset:32768
    v_exp_f32 v239, v223
    v_mfma_f32_16x16x32_bf16 v[56:59], v[204:207], v[228:231], v[56:59]
    ds_read_b64_tr_b16 v[204:205], v250 offset:36864
    v_add_f32 v247, v236, v237
    v_add_f32 v255, v238, v239
    v_mfma_f32_16x16x32_bf16 v[68:71], v[208:211], v[228:231], v[68:71]
    ds_read_b64_tr_b16 v[208:209], v251 offset:36864
    v_exp_f32 v240, v224
    v_mfma_f32_16x16x32_bf16 v[80:83], v[212:215], v[228:231], v[80:83]
    ds_read_b64_tr_b16 v[212:213], v252 offset:36864
    v_exp_f32 v241, v225
    v_mfma_f32_16x16x32_bf16 v[92:95], v[216:219], v[228:231], v[92:95]
    ds_read_b64_tr_b16 v[216:217], v253 offset:36864
    v_add_f32 v247, v247, v240
    v_add_f32 v255, v255, v241
    v_mfma_f32_16x16x32_bf16 v[228:231], v[156:159], v[100:103], v[148:151]
    ds_read_b64_tr_b16 v[190:191], v250 offset:34816
    v_exp_f32 v242, v226
    v_mfma_f32_16x16x32_bf16 v[232:235], v[160:163], v[100:103], v[148:151]
    ds_read_b64_tr_b16 v[194:195], v251 offset:34816
    v_exp_f32 v243, v227
    v_mfma_f32_16x16x32_bf16 v[228:231], v[164:167], v[112:115], v[228:231]
    ds_read_b64_tr_b16 v[198:199], v252 offset:34816
    v_add_f32 v247, v247, v242
    v_add_f32 v255, v255, v243
    v_mfma_f32_16x16x32_bf16 v[232:235], v[168:171], v[112:115], v[232:235]
    ds_read_b64_tr_b16 v[202:203], v253 offset:34816
    v_add_f32 v247, v247, v255
    v_cmp_lt_f32 vcc, s54, v247
    v_mfma_f32_16x16x32_bf16 v[228:231], v[172:175], v[124:127], v[228:231]
    ds_read_b64_tr_b16 v[206:207], v250 offset:38912
    v_mfma_f32_16x16x32_bf16 v[232:235], v[176:179], v[124:127], v[232:235]
    ds_read_b64_tr_b16 v[210:211], v251 offset:38912
    s_cbranch_vccnz L_fix0_0
L_ret0_6:
    v_cvt_pk_bf16_f32 v220, v236, v237
    v_cvt_pk_bf16_f32 v221, v238, v239
    v_mfma_f32_16x16x32_bf16 v[228:231], v[180:183], v[136:139], v[228:231]
    ds_read_b64_tr_b16 v[214:215], v252 offset:38912
    v_cvt_pk_bf16_f32 v222, v240, v241
    v_cvt_pk_bf16_f32 v223, v242, v243
    v_mfma_f32_16x16x32_bf16 v[232:235], v[184:187], v[136:139], v[232:235]
    ds_read_b64_tr_b16 v[218:219], v253 offset:38912
    v_add_f32 v244, v244, v247
    s_waitcnt lgkmcnt(4)
    v_mfma_f32_16x16x32_bf16 v[0:3], v[188:191], v[220:223], v[0:3]
    v_exp_f32 v236, v228
    v_mfma_f32_16x16x32_bf16 v[12:15], v[192:195], v[220:223], v[12:15]
    v_exp_f32 v237, v229
    v_mfma_f32_16x16x32_bf16 v[24:27], v[196:199], v[220:223], v[24:27]
    v_exp_f32 v238, v230
    v_mfma_f32_16x16x32_bf16 v[36:39], v[200:203], v[220:223], v[36:39]
    v_exp_f32 v239, v231
    s_waitcnt lgkmcnt(0)
    v_mfma_f32_16x16x32_bf16 v[48:51], v[204:207], v[220:223], v[48:51]
    v_add_f32 v247, v236, v237
    v_add_f32 v255, v238, v239
    v_mfma_f32_16x16x32_bf16 v[60:63], v[208:211], v[220:223], v[60:63]
    v_exp_f32 v240, v232
    v_mfma_f32_16x16x32_bf16 v[72:75], v[212:215], v[220:223], v[72:75]
    v_exp_f32 v241, v233
    v_mfma_f32_16x16x32_bf16 v[84:87], v[216:219], v[220:223], v[84:87]
    v_add_f32 v247, v247, v240
    v_add_f32 v255, v255, v241
    v_mfma_f32_16x16x32_bf16 v[220:223], v[156:159], v[104:107], v[152:155]
    ds_read_b128 v[156:159], v248 offset:40960
    v_exp_f32 v242, v234
    v_mfma_f32_16x16x32_bf16 v[224:227], v[160:163], v[104:107], v[152:155]
    ds_read_b128 v[160:163], v248 offset:43008
    v_exp_f32 v243, v235
    v_mfma_f32_16x16x32_bf16 v[220:223], v[164:167], v[116:119], v[220:223]
    ds_read_b128 v[164:167], v249 offset:40960
    v_add_f32 v247, v247, v242
    v_add_f32 v255, v255, v243
    v_mfma_f32_16x16x32_bf16 v[224:227], v[168:171], v[116:119], v[224:227]
    ds_read_b128 v[168:171], v249 offset:43008
    v_add_f32 v247, v247, v255
    v_cmp_lt_f32 vcc, s54, v247
    v_mfma_f32_16x16x32_bf16 v[220:223], v[172:175], v[128:131], v[220:223]
    ds_read_b128 v[172:175], v248 offset:45056
    v_mfma_f32_16x16x32_bf16 v[224:227], v[176:179], v[128:131], v[224:227]
    ds_read_b128 v[176:179], v248 offset:47104
    s_cbranch_vccnz L_fix1_1
L_ret1_6:
    v_cvt_pk_bf16_f32 v228, v236, v237
    v_cvt_pk_bf16_f32 v229, v238, v239
    v_mfma_f32_16x16x32_bf16 v[220:223], v[180:183], v[140:143], v[220:223]
    ds_read_b128 v[180:183], v249 offset:45056
    v_cvt_pk_bf16_f32 v230, v240, v241
    v_cvt_pk_bf16_f32 v231, v242, v243
    v_mfma_f32_16x16x32_bf16 v[224:227], v[184:187], v[140:143], v[224:227]
    ds_read_b128 v[184:187], v249 offset:47104
    v_add_f32 v245, v245, v247
    v_mfma_f32_16x16x32_bf16 v[4:7], v[188:191], v[228:231], v[4:7]
    s_nop 0
    v_exp_f32 v236, v220
    v_mfma_f32_16x16x32_bf16 v[16:19], v[192:195], v[228:231], v[16:19]
    v_exp_f32 v237, v221
    v_mfma_f32_16x16x32_bf16 v[28:31], v[196:199], v[228:231], v[28:31]
    v_exp_f32 v238, v222
    v_mfma_f32_16x16x32_bf16 v[40:43], v[200:203], v[228:231], v[40:43]
    v_exp_f32 v239, v223
    v_mfma_f32_16x16x32_bf16 v[52:55], v[204:207], v[228:231], v[52:55]
    v_add_f32 v247, v236, v237
    v_add_f32 v255, v238, v239
    v_mfma_f32_16x16x32_bf16 v[64:67], v[208:211], v[228:231], v[64:67]
    v_exp_f32 v240, v224
    v_mfma_f32_16x16x32_bf16 v[76:79], v[212:215], v[228:231], v[76:79]
    v_exp_f32 v241, v225
    v_mfma_f32_16x16x32_bf16 v[88:91], v[216:219], v[228:231], v[88:91]
    v_add_f32 v247, v247, v240
    v_add_f32 v255, v255, v241
    s_waitcnt lgkmcnt(0)
    v_mfma_f32_16x16x32_bf16 v[228:231], v[156:159], v[96:99], v[144:147]
    v_exp_f32 v242, v226
    v_mfma_f32_16x16x32_bf16 v[232:235], v[160:163], v[96:99], v[144:147]
    v_exp_f32 v243, v227
    v_mfma_f32_16x16x32_bf16 v[228:231], v[164:167], v[108:111], v[228:231]
    v_add_f32 v247, v247, v242
    v_add_f32 v255, v255, v243
    v_mfma_f32_16x16x32_bf16 v[232:235], v[168:171], v[108:111], v[232:235]
    v_add_f32 v247, v247, v255
    v_cmp_lt_f32 vcc, s54, v247
    v_mfma_f32_16x16x32_bf16 v[228:231], v[172:175], v[120:123], v[228:231]
    v_mfma_f32_16x16x32_bf16 v[232:235], v[176:179], v[120:123], v[232:235]
    s_cbranch_vccnz L_fix2_0
L_ret2_6:
    v_cvt_pk_bf16_f32 v220, v236, v237
    v_cvt_pk_bf16_f32 v221, v238, v239
    v_mfma_f32_16x16x32_bf16 v[228:231], v[180:183], v[132:135], v[228:231]
    v_cvt_pk_bf16_f32 v222, v240, v241
    v_cvt_pk_bf16_f32 v223, v242, v243
    v_mfma_f32_16x16x32_bf16 v[232:235], v[184:187], v[132:135], v[232:235]
    v_add_f32 v246, v246, v247
    s_waitcnt lgkmcnt(0)
    s_barrier
    v_mfma_f32_16x16x32_bf16 v[8:11], v[188:191], v[220:223], v[8:11]
    s_mov_b32 s57, 7
    ds_read_b64_tr_b16 v[188:189], v250 offset:49152
    v_exp_f32 v236, v228
    v_mfma_f32_16x16x32_bf16 v[20:23], v[192:195], v[220:223], v[20:23]
    ds_read_b64_tr_b16 v[192:193], v251 offset:49152
    v_exp_f32 v237, v229
    v_mfma_f32_16x16x32_bf16 v[32:35], v[196:199], v[220:223], v[32:35]
    ds_read_b64_tr_b16 v[196:197], v252 offset:49152
    v_exp_f32 v238, v230
    v_mfma_f32_16x16x32_bf16 v[44:47], v[200:203], v[220:223], v[44:47]
    ds_read_b64_tr_b16 v[200:201], v253 offset:49152
    v_exp_f32 v239, v231
    v_mfma_f32_16x16x32_bf16 v[56:59], v[204:207], v[220:223], v[56:59]
    ds_read_b64_tr_b16 v[204:205], v250 offset:53248
    v_add_f32 v247, v236, v237
    v_add_f32 v255, v238, v239
    v_mfma_f32_16x16x32_bf16 v[68:71], v[208:211], v[220:223], v[68:71]
    ds_read_b64_tr_b16 v[208:209], v251 offset:53248
    v_exp_f32 v240, v232
    v_mfma_f32_16x16x32_bf16 v[80:83], v[212:215], v[220:223], v[80:83]
    ds_read_b64_tr_b16 v[212:213], v252 offset:53248
    v_exp_f32 v241, v233
    v_mfma_f32_16x16x32_bf16 v[92:95], v[216:219], v[220:223], v[92:95]
    ds_read_b64_tr_b16 v[216:217], v253 offset:53248
    v_add_f32 v247, v247, v240
    v_add_f32 v255, v255, v241
    v_mfma_f32_16x16x32_bf16 v[220:223], v[156:159], v[100:103], v[148:151]
    ds_read_b64_tr_b16 v[190:191], v250 offset:51200
    v_exp_f32 v242, v234
    v_mfma_f32_16x16x32_bf16 v[224:227], v[160:163], v[100:103], v[148:151]
    ds_read_b64_tr_b16 v[194:195], v251 offset:51200
    v_exp_f32 v243, v235
    v_mfma_f32_16x16x32_bf16 v[220:223], v[164:167], v[112:115], v[220:223]
    ds_read_b64_tr_b16 v[198:199], v252 offset:51200
    v_add_f32 v247, v247, v242
    v_add_f32 v255, v255, v243
    v_mfma_f32_16x16x32_bf16 v[224:227], v[168:171], v[112:115], v[224:227]
    ds_read_b64_tr_b16 v[202:203], v253 offset:51200
    v_add_f32 v247, v247, v255
    v_cmp_lt_f32 vcc, s54, v247
    v_mfma_f32_16x16x32_bf16 v[220:223], v[172:175], v[124:127], v[220:223]
    ds_read_b64_tr_b16 v[206:207], v250 offset:55296
    v_mfma_f32_16x16x32_bf16 v[224:227], v[176:179], v[124:127], v[224:227]
    ds_read_b64_tr_b16 v[210:211], v251 offset:55296
    s_cbranch_vccnz L_fix0_1
L_ret0_7:
    v_cvt_pk_bf16_f32 v228, v236, v237
    v_cvt_pk_bf16_f32 v229, v238, v239
    v_mfma_f32_16x16x32_bf16 v[220:223], v[180:183], v[136:139], v[220:223]
    ds_read_b64_tr_b16 v[214:215], v252 offset:55296
    v_cvt_pk_bf16_f32 v230, v240, v241
    v_cvt_pk_bf16_f32 v231, v242, v243
    v_mfma_f32_16x16x32_bf16 v[224:227], v[184:187], v[136:139], v[224:227]
    ds_read_b64_tr_b16 v[218:219], v253 offset:55296
    v_add_f32 v244, v244, v247
    s_waitcnt lgkmcnt(4)
    v_mfma_f32_16x16x32_bf16 v[0:3], v[188:191], v[228:231], v[0:3]
    v_exp_f32 v236, v220
    v_mfma_f32_16x16x32_bf16 v[12:15], v[192:195], v[228:231], v[12:15]
    v_exp_f32 v237, v221
    v_mfma_f32_16x16x32_bf16 v[24:27], v[196:199], v[228:231], v[24:27]
    v_exp_f32 v238, v222
    v_mfma_f32_16x16x32_bf16 v[36:39], v[200:203], v[228:231], v[36:39]
    v_exp_f32 v239, v223
    s_waitcnt lgkmcnt(0)
    v_mfma_f32_16x16x32_bf16 v[48:51], v[204:207], v[228:231], v[48:51]
    v_add_f32 v247, v236, v237
    v_add_f32 v255, v238, v239
    v_mfma_f32_16x16x32_bf16 v[60:63], v[208:211], v[228:231], v[60:63]
    v_exp_f32 v240, v224
    v_mfma_f32_16x16x32_bf16 v[72:75], v[212:215], v[228:231], v[72:75]
    v_exp_f32 v241, v225
    v_mfma_f32_16x16x32_bf16 v[84:87], v[216:219], v[228:231], v[84:87]
    v_add_f32 v247, v247, v240
    v_add_f32 v255, v255, v241
    v_mfma_f32_16x16x32_bf16 v[228:231], v[156:159], v[104:107], v[152:155]
    ds_read_b128 v[156:159], v248 offset:57344
    v_exp_f32 v242, v226
    v_mfma_f32_16x16x32_bf16 v[232:235], v[160:163], v[104:107], v[152:155]
    ds_read_b128 v[160:163], v248 offset:59392
    v_exp_f32 v243, v227
    v_mfma_f32_16x16x32_bf16 v[228:231], v[164:167], v[116:119], v[228:231]
    ds_read_b128 v[164:167], v249 offset:57344
    v_add_f32 v247, v247, v242
    v_add_f32 v255, v255, v243
    v_mfma_f32_16x16x32_bf16 v[232:235], v[168:171], v[116:119], v[232:235]
    ds_read_b128 v[168:171], v249 offset:59392
    v_add_f32 v247, v247, v255
    v_cmp_lt_f32 vcc, s54, v247
    v_mfma_f32_16x16x32_bf16 v[228:231], v[172:175], v[128:131], v[228:231]
    ds_read_b128 v[172:175], v248 offset:61440
    v_mfma_f32_16x16x32_bf16 v[232:235], v[176:179], v[128:131], v[232:235]
    ds_read_b128 v[176:179], v248 offset:63488
    s_cbranch_vccnz L_fix1_0
L_ret1_7:
    v_cvt_pk_bf16_f32 v220, v236, v237
    v_cvt_pk_bf16_f32 v221, v238, v239
    v_mfma_f32_16x16x32_bf16 v[228:231], v[180:183], v[140:143], v[228:231]
    ds_read_b128 v[180:183], v249 offset:61440
    v_cvt_pk_bf16_f32 v222, v240, v241
    v_cvt_pk_bf16_f32 v223, v242, v243
    v_mfma_f32_16x16x32_bf16 v[232:235], v[184:187], v[140:143], v[232:235]
    ds_read_b128 v[184:187], v249 offset:63488
    v_add_f32 v245, v245, v247
    v_mfma_f32_16x16x32_bf16 v[4:7], v[188:191], v[220:223], v[4:7]
    s_nop 0
    v_exp_f32 v236, v228
    v_mfma_f32_16x16x32_bf16 v[16:19], v[192:195], v[220:223], v[16:19]
    v_exp_f32 v237, v229
    v_mfma_f32_16x16x32_bf16 v[28:31], v[196:199], v[220:223], v[28:31]
    v_exp_f32 v238, v230
    v_mfma_f32_16x16x32_bf16 v[40:43], v[200:203], v[220:223], v[40:43]
    v_exp_f32 v239, v231
    v_mfma_f32_16x16x32_bf16 v[52:55], v[204:207], v[220:223], v[52:55]
    v_add_f32 v247, v236, v237
    v_add_f32 v255, v238, v239
    v_mfma_f32_16x16x32_bf16 v[64:67], v[208:211], v[220:223], v[64:67]
    v_exp_f32 v240, v232
    v_mfma_f32_16x16x32_bf16 v[76:79], v[212:215], v[220:223], v[76:79]
    v_exp_f32 v241, v233
    v_mfma_f32_16x16x32_bf16 v[88:91], v[216:219], v[220:223], v[88:91]
    v_add_f32 v247, v247, v240
    v_add_f32 v255, v255, v241
    s_waitcnt lgkmcnt(0)
    v_mfma_f32_16x16x32_bf16 v[220:223], v[156:159], v[96:99], v[144:147]
    v_exp_f32 v242, v234
    v_mfma_f32_16x16x32_bf16 v[224:227], v[160:163], v[96:99], v[144:147]
    v_exp_f32 v243, v235
    v_mfma_f32_16x16x32_bf16 v[220:223], v[164:167], v[108:111], v[220:223]
    v_add_f32 v247, v247, v242
    v_add_f32 v255, v255, v243
    v_mfma_f32_16x16x32_bf16 v[224:227], v[168:171], v[108:111], v[224:227]
    v_add_f32 v247, v247, v255
    v_cmp_lt_f32 vcc, s54, v247
    v_mfma_f32_16x16x32_bf16 v[220:223], v[172:175], v[120:123], v[220:223]
    v_mfma_f32_16x16x32_bf16 v[224:227], v[176:179], v[120:123], v[224:227]
    s_cbranch_vccnz L_fix2_1
L_ret2_7:
    v_cvt_pk_bf16_f32 v228, v236, v237
    v_cvt_pk_bf16_f32 v229, v238, v239
    v_mfma_f32_16x16x32_bf16 v[220:223], v[180:183], v[132:135], v[220:223]
    v_cvt_pk_bf16_f32 v230, v240, v241
    v_cvt_pk_bf16_f32 v231, v242, v243
    v_mfma_f32_16x16x32_bf16 v[224:227], v[184:187], v[132:135], v[224:227]
    v_add_f32 v246, v246, v247
    s_waitcnt lgkmcnt(0)
    s_barrier
    v_mfma_f32_16x16x32_bf16 v[8:11], v[188:191], v[228:231], v[8:11]
    s_mov_b32 s57, 8
    ds_read_b64_tr_b16 v[188:189], v250 offset:0
    v_exp_f32 v236, v220
    v_mfma_f32_16x16x32_bf16 v[20:23], v[192:195], v[228:231], v[20:23]
    ds_read_b64_tr_b16 v[192:193], v251 offset:0
    v_exp_f32 v237, v221
    v_mfma_f32_16x16x32_bf16 v[32:35], v[196:199], v[228:231], v[32:35]
    ds_read_b64_tr_b16 v[196:197], v252 offset:0
    v_exp_f32 v238, v222
    v_mfma_f32_16x16x32_bf16 v[44:47], v[200:203], v[228:231], v[44:47]
    ds_read_b64_tr_b16 v[200:201], v253 offset:0
    v_exp_f32 v239, v223
    v_mfma_f32_16x16x32_bf16 v[56:59], v[204:207], v[228:231], v[56:59]
    ds_read_b64_tr_b16 v[204:205], v250 offset:4096
    v_add_f32 v247, v236, v237
    v_add_f32 v255, v238, v239
    v_mfma_f32_16x16x32_bf16 v[68:71], v[208:211], v[228:231], v[68:71]
    ds_read_b64_tr_b16 v[208:209], v251 offset:4096
    v_exp_f32 v240, v224
    v_mfma_f32_16x16x32_bf16 v[80:83], v[212:215], v[228:231], v[80:83]
    ds_read_b64_tr_b16 v[212:213], v252 offset:4096
    v_exp_f32 v241, v225
    v_mfma_f32_16x16x32_bf16 v[92:95], v[216:219], v[228:231], v[92:95]
    ds_read_b64_tr_b16 v[216:217], v253 offset:4096
    v_add_f32 v247, v247, v240
    v_add_f32 v255, v255, v241
    v_mfma_f32_16x16x32_bf16 v[228:231], v[156:159], v[100:103], v[148:151]
    ds_read_b64_tr_b16 v[190:191], v250 offset:2048
    v_exp_f32 v242, v226
    v_mfma_f32_16x16x32_bf16 v[232:235], v[160:163], v[100:103], v[148:151]
    ds_read_b64_tr_b16 v[194:195], v251 offset:2048
    v_exp_f32 v243, v227
    v_mfma_f32_16x16x32_bf16 v[228:231], v[164:167], v[112:115], v[228:231]
    ds_read_b64_tr_b16 v[198:199], v252 offset:2048
    v_add_f32 v247, v247, v242
    v_add_f32 v255, v255, v243
    v_mfma_f32_16x16x32_bf16 v[232:235], v[168:171], v[112:115], v[232:235]
    ds_read_b64_tr_b16 v[202:203], v253 offset:2048
    v_add_f32 v247, v247, v255
    v_cmp_lt_f32 vcc, s54, v247
    v_mfma_f32_16x16x32_bf16 v[228:231], v[172:175], v[124:127], v[228:231]
    ds_read_b64_tr_b16 v[206:207], v250 offset:6144
    v_mfma_f32_16x16x32_bf16 v[232:235], v[176:179], v[124:127], v[232:235]
    ds_read_b64_tr_b16 v[210:211], v251 offset:6144
    s_cbranch_vccnz L_fix0_0
L_ret0_8:
    v_cvt_pk_bf16_f32 v220, v236, v237
    v_cvt_pk_bf16_f32 v221, v238, v239
    v_mfma_f32_16x16x32_bf16 v[228:231], v[180:183], v[136:139], v[228:231]
    ds_read_b64_tr_b16 v[214:215], v252 offset:6144
    v_cvt_pk_bf16_f32 v222, v240, v241
    v_cvt_pk_bf16_f32 v223, v242, v243
    v_mfma_f32_16x16x32_bf16 v[232:235], v[184:187], v[136:139], v[232:235]
    ds_read_b64_tr_b16 v[218:219], v253 offset:6144
    v_add_f32 v244, v244, v247
    s_waitcnt lgkmcnt(4)
    v_mfma_f32_16x16x32_bf16 v[0:3], v[188:191], v[220:223], v[0:3]
    v_exp_f32 v236, v228
    v_mfma_f32_16x16x32_bf16 v[12:15], v[192:195], v[220:223], v[12:15]
    v_exp_f32 v237, v229
    v_mfma_f32_16x16x32_bf16 v[24:27], v[196:199], v[220:223], v[24:27]
    v_exp_f32 v238, v230
    v_mfma_f32_16x16x32_bf16 v[36:39], v[200:203], v[220:223], v[36:39]
    v_exp_f32 v239, v231
    s_waitcnt lgkmcnt(0)
    v_mfma_f32_16x16x32_bf16 v[48:51], v[204:207], v[220:223], v[48:51]
    v_add_f32 v247, v236, v237
    v_add_f32 v255, v238, v239
    v_mfma_f32_16x16x32_bf16 v[60:63], v[208:211], v[220:223], v[60:63]
    v_exp_f32 v240, v232
    v_mfma_f32_16x16x32_bf16 v[72:75], v[212:215], v[220:223], v[72:75]
    v_exp_f32 v241, v233
    v_mfma_f32_16x16x32_bf16 v[84:87], v[216:219], v[220:223], v[84:87]
    v_add_f32 v247, v247, v240
    v_add_f32 v255, v255, v241
    v_mfma_f32_16x16x32_bf16 v[220:223], v[156:159], v[104:107], v[152:155]
    ds_read_b128 v[156:159], v248 offset:8192
    v_exp_f32 v242, v234
    v_mfma_f32_16x16x32_bf16 v[224:227], v[160:163], v[104:107], v[152:155]
    ds_read_b128 v[160:163], v248 offset:10240
    v_exp_f32 v243, v235
    v_mfma_f32_16x16x32_bf16 v[220:223], v[164:167], v[116:119], v[220:223]
    ds_read_b128 v[164:167], v249 offset:8192
    v_add_f32 v247, v247, v242
    v_add_f32 v255, v255, v243
    v_mfma_f32_16x16x32_bf16 v[224:227], v[168:171], v[116:119], v[224:227]
    ds_read_b128 v[168:171], v249 offset:10240
    v_add_f32 v247, v247, v255
    v_cmp_lt_f32 vcc, s54, v247
    v_mfma_f32_16x16x32_bf16 v[220:223], v[172:175], v[128:131], v[220:223]
    ds_read_b128 v[172:175], v248 offset:12288
    v_mfma_f32_16x16x32_bf16 v[224:227], v[176:179], v[128:131], v[224:227]
    ds_read_b128 v[176:179], v248 offset:14336
    s_cbranch_vccnz L_fix1_1
L_ret1_8:
    v_cvt_pk_bf16_f32 v228, v236, v237
    v_cvt_pk_bf16_f32 v229, v238, v239
    v_mfma_f32_16x16x32_bf16 v[220:223], v[180:183], v[140:143], v[220:223]
    ds_read_b128 v[180:183], v249 offset:12288
    v_cvt_pk_bf16_f32 v230, v240, v241
    v_cvt_pk_bf16_f32 v231, v242, v243
    v_mfma_f32_16x16x32_bf16 v[224:227], v[184:187], v[140:143], v[224:227]
    ds_read_b128 v[184:187], v249 offset:14336
    v_add_f32 v245, v245, v247
    v_mfma_f32_16x16x32_bf16 v[4:7], v[188:191], v[228:231], v[4:7]
    s_nop 0
    v_exp_f32 v236, v220
    v_mfma_f32_16x16x32_bf16 v[16:19], v[192:195], v[228:231], v[16:19]
    v_exp_f32 v237, v221
    v_mfma_f32_16x16x32_bf16 v[28:31], v[196:199], v[228:231], v[28:31]
    v_exp_f32 v238, v222
    v_mfma_f32_16x16x32_bf16 v[40:43], v[200:203], v[228:231], v[40:43]
    v_exp_f32 v239, v223
    v_mfma_f32_16x16x32_bf16 v[52:55], v[204:207], v[228:231], v[52:55]
    v_add_f32 v247, v236, v237
    v_add_f32 v255, v238, v239
    v_mfma_f32_16x16x32_bf16 v[64:67], v[208:211], v[228:231], v[64:67]
    v_exp_f32 v240, v224
    v_mfma_f32_16x16x32_bf16 v[76:79], v[212:215], v[228:231], v[76:79]
    v_exp_f32 v241, v225
    v_mfma_f32_16x16x32_bf16 v[88:91], v[216:219], v[228:231], v[88:91]
    v_add_f32 v247, v247, v240
    v_add_f32 v255, v255, v241
    s_waitcnt lgkmcnt(0)
    v_mfma_f32_16x16x32_bf16 v[228:231], v[156:159], v[96:99], v[144:147]
    v_exp_f32 v242, v226
    v_mfma_f32_16x16x32_bf16 v[232:235], v[160:163], v[96:99], v[144:147]
    v_exp_f32 v243, v227
    v_mfma_f32_16x16x32_bf16 v[228:231], v[164:167], v[108:111], v[228:231]
    v_add_f32 v247, v247, v242
    v_add_f32 v255, v255, v243
    v_mfma_f32_16x16x32_bf16 v[232:235], v[168:171], v[108:111], v[232:235]
    v_add_f32 v247, v247, v255
    v_cmp_lt_f32 vcc, s54, v247
    v_mfma_f32_16x16x32_bf16 v[228:231], v[172:175], v[120:123], v[228:231]
    v_mfma_f32_16x16x32_bf16 v[232:235], v[176:179], v[120:123], v[232:235]
    s_cbranch_vccnz L_fix2_0
L_ret2_8:
    v_cvt_pk_bf16_f32 v220, v236, v237
    v_cvt_pk_bf16_f32 v221, v238, v239
    v_mfma_f32_16x16x32_bf16 v[228:231], v[180:183], v[132:135], v[228:231]
    v_cvt_pk_bf16_f32 v222, v240, v241
    v_cvt_pk_bf16_f32 v223, v242, v243
    v_mfma_f32_16x16x32_bf16 v[232:235], v[184:187], v[132:135], v[232:235]
    v_add_f32 v246, v246, v247
    s_waitcnt lgkmcnt(0)
    s_barrier
    v_mfma_f32_16x16x32_bf16 v[8:11], v[188:191], v[220:223], v[8:11]
    s_mov_b32 s57, 9
    ds_read_b64_tr_b16 v[188:189], v250 offset:16384
    v_exp_f32 v236, v228
    v_mfma_f32_16x16x32_bf16 v[20:23], v[192:195], v[220:223], v[20:23]
    ds_read_b64_tr_b16 v[192:193], v251 offset:16384
    v_exp_f32 v237, v229
    v_mfma_f32_16x16x32_bf16 v[32:35], v[196:199], v[220:223], v[32:35]
    ds_read_b64_tr_b16 v[196:197], v252 offset:16384
    v_exp_f32 v238, v230
    v_mfma_f32_16x16x32_bf16 v[44:47], v[200:203], v[220:223], v[44:47]
    ds_read_b64_tr_b16 v[200:201], v253 offset:16384
    v_exp_f32 v239, v231
    v_mfma_f32_16x16x32_bf16 v[56:59], v[204:207], v[220:223], v[56:59]
    ds_read_b64_tr_b16 v[204:205], v250 offset:20480
    v_add_f32 v247, v236, v237
    v_add_f32 v255, v238, v239
    v_mfma_f32_16x16x32_bf16 v[68:71], v[208:211], v[220:223], v[68:71]
    ds_read_b64_tr_b16 v[208:209], v251 offset:20480
    v_exp_f32 v240, v232
    v_mfma_f32_16x16x32_bf16 v[80:83], v[212:215], v[220:223], v[80:83]
    ds_read_b64_tr_b16 v[212:213], v252 offset:20480
    v_exp_f32 v241, v233
    v_mfma_f32_16x16x32_bf16 v[92:95], v[216:219], v[220:223], v[92:95]
    ds_read_b64_tr_b16 v[216:217], v253 offset:20480
    v_add_f32 v247, v247, v240
    v_add_f32 v255, v255, v241
    v_mfma_f32_16x16x32_bf16 v[220:223], v[156:159], v[100:103], v[148:151]
    ds_read_b64_tr_b16 v[190:191], v250 offset:18432
    v_exp_f32 v242, v234
    v_mfma_f32_16x16x32_bf16 v[224:227], v[160:163], v[100:103], v[148:151]
    ds_read_b64_tr_b16 v[194:195], v251 offset:18432
    v_exp_f32 v243, v235
    v_mfma_f32_16x16x32_bf16 v[220:223], v[164:167], v[112:115], v[220:223]
    ds_read_b64_tr_b16 v[198:199], v252 offset:18432
    v_add_f32 v247, v247, v242
    v_add_f32 v255, v255, v243
    v_mfma_f32_16x16x32_bf16 v[224:227], v[168:171], v[112:115], v[224:227]
    ds_read_b64_tr_b16 v[202:203], v253 offset:18432
    v_add_f32 v247, v247, v255
    v_cmp_lt_f32 vcc, s54, v247
    v_mfma_f32_16x16x32_bf16 v[220:223], v[172:175], v[124:127], v[220:223]
    ds_read_b64_tr_b16 v[206:207], v250 offset:22528
    v_mfma_f32_16x16x32_bf16 v[224:227], v[176:179], v[124:127], v[224:227]
    ds_read_b64_tr_b16 v[210:211], v251 offset:22528
    s_cbranch_vccnz L_fix0_1
L_ret0_9:
    v_cvt_pk_bf16_f32 v228, v236, v237
    v_cvt_pk_bf16_f32 v229, v238, v239
    v_mfma_f32_16x16x32_bf16 v[220:223], v[180:183], v[136:139], v[220:223]
    ds_read_b64_tr_b16 v[214:215], v252 offset:22528
    v_cvt_pk_bf16_f32 v230, v240, v241
    v_cvt_pk_bf16_f32 v231, v242, v243
    v_mfma_f32_16x16x32_bf16 v[224:227], v[184:187], v[136:139], v[224:227]
    ds_read_b64_tr_b16 v[218:219], v253 offset:22528
    v_add_f32 v244, v244, v247
    s_waitcnt lgkmcnt(4)
    v_mfma_f32_16x16x32_bf16 v[0:3], v[188:191], v[228:231], v[0:3]
    v_exp_f32 v236, v220
    v_mfma_f32_16x16x32_bf16 v[12:15], v[192:195], v[228:231], v[12:15]
    v_exp_f32 v237, v221
    v_mfma_f32_16x16x32_bf16 v[24:27], v[196:199], v[228:231], v[24:27]
    v_exp_f32 v238, v222
    v_mfma_f32_16x16x32_bf16 v[36:39], v[200:203], v[228:231], v[36:39]
    v_exp_f32 v239, v223
    s_waitcnt lgkmcnt(0)
    v_mfma_f32_16x16x32_bf16 v[48:51], v[204:207], v[228:231], v[48:51]
    v_add_f32 v247, v236, v237
    v_add_f32 v255, v238, v239
    v_mfma_f32_16x16x32_bf16 v[60:63], v[208:211], v[228:231], v[60:63]
    v_exp_f32 v240, v224
    v_mfma_f32_16x16x32_bf16 v[72:75], v[212:215], v[228:231], v[72:75]
    v_exp_f32 v241, v225
    v_mfma_f32_16x16x32_bf16 v[84:87], v[216:219], v[228:231], v[84:87]
    v_add_f32 v247, v247, v240
    v_add_f32 v255, v255, v241
    v_mfma_f32_16x16x32_bf16 v[228:231], v[156:159], v[104:107], v[152:155]
    ds_read_b128 v[156:159], v248 offset:24576
    v_exp_f32 v242, v226
    v_mfma_f32_16x16x32_bf16 v[232:235], v[160:163], v[104:107], v[152:155]
    ds_read_b128 v[160:163], v248 offset:26624
    v_exp_f32 v243, v227
    v_mfma_f32_16x16x32_bf16 v[228:231], v[164:167], v[116:119], v[228:231]
    ds_read_b128 v[164:167], v249 offset:24576
    v_add_f32 v247, v247, v242
    v_add_f32 v255, v255, v243
    v_mfma_f32_16x16x32_bf16 v[232:235], v[168:171], v[116:119], v[232:235]
    ds_read_b128 v[168:171], v249 offset:26624
    v_add_f32 v247, v247, v255
    v_cmp_lt_f32 vcc, s54, v247
    v_mfma_f32_16x16x32_bf16 v[228:231], v[172:175], v[128:131], v[228:231]
    ds_read_b128 v[172:175], v248 offset:28672
    v_mfma_f32_16x16x32_bf16 v[232:235], v[176:179], v[128:131], v[232:235]
    ds_read_b128 v[176:179], v248 offset:30720
    s_cbranch_vccnz L_fix1_0
L_ret1_9:
    v_cvt_pk_bf16_f32 v220, v236, v237
    v_cvt_pk_bf16_f32 v221, v238, v239
    v_mfma_f32_16x16x32_bf16 v[228:231], v[180:183], v[140:143], v[228:231]
    ds_read_b128 v[180:183], v249 offset:28672
    v_cvt_pk_bf16_f32 v222, v240, v241
    v_cvt_pk_bf16_f32 v223, v242, v243
    v_mfma_f32_16x16x32_bf16 v[232:235], v[184:187], v[140:143], v[232:235]
    ds_read_b128 v[184:187], v249 offset:30720
    v_add_f32 v245, v245, v247
    v_mfma_f32_16x16x32_bf16 v[4:7], v[188:191], v[220:223], v[4:7]
    s_nop 0
    v_exp_f32 v236, v228
    v_mfma_f32_16x16x32_bf16 v[16:19], v[192:195], v[220:223], v[16:19]
    v_exp_f32 v237, v229
    v_mfma_f32_16x16x32_bf16 v[28:31], v[196:199], v[220:223], v[28:31]
    v_exp_f32 v238, v230
    v_mfma_f32_16x16x32_bf16 v[40:43], v[200:203], v[220:223], v[40:43]
    v_exp_f32 v239, v231
    v_mfma_f32_16x16x32_bf16 v[52:55], v[204:207], v[220:223], v[52:55]
    v_add_f32 v247, v236, v237
    v_add_f32 v255, v238, v239
    v_mfma_f32_16x16x32_bf16 v[64:67], v[208:211], v[220:223], v[64:67]
    v_exp_f32 v240, v232
    v_mfma_f32_16x16x32_bf16 v[76:79], v[212:215], v[220:223], v[76:79]
    v_exp_f32 v241, v233
    v_mfma_f32_16x16x32_bf16 v[88:91], v[216:219], v[220:223], v[88:91]
    v_add_f32 v247, v247, v240
    v_add_f32 v255, v255, v241
    s_waitcnt lgkmcnt(0)
    v_mfma_f32_16x16x32_bf16 v[220:223], v[156:159], v[96:99], v[144:147]
    v_exp_f32 v242, v234
    v_mfma_f32_16x16x32_bf16 v[224:227], v[160:163], v[96:99], v[144:147]
    v_exp_f32 v243, v235
    v_mfma_f32_16x16x32_bf16 v[220:223], v[164:167], v[108:111], v[220:223]
    v_add_f32 v247, v247, v242
    v_add_f32 v255, v255, v243
    v_mfma_f32_16x16x32_bf16 v[224:227], v[168:171], v[108:111], v[224:227]
    v_add_f32 v247, v247, v255
    v_cmp_lt_f32 vcc, s54, v247
    v_mfma_f32_16x16x32_bf16 v[220:223], v[172:175], v[120:123], v[220:223]
    v_mfma_f32_16x16x32_bf16 v[224:227], v[176:179], v[120:123], v[224:227]
    s_cbranch_vccnz L_fix2_1
L_ret2_9:
    v_cvt_pk_bf16_f32 v228, v236, v237
    v_cvt_pk_bf16_f32 v229, v238, v239
    v_mfma_f32_16x16x32_bf16 v[220:223], v[180:183], v[132:135], v[220:223]
    v_cvt_pk_bf16_f32 v230, v240, v241
    v_cvt_pk_bf16_f32 v231, v242, v243
    v_mfma_f32_16x16x32_bf16 v[224:227], v[184:187], v[132:135], v[224:227]
    v_add_f32 v246, v246, v247
    s_waitcnt lgkmcnt(0)
    s_barrier
    v_mfma_f32_16x16x32_bf16 v[8:11], v[188:191], v[228:231], v[8:11]
    s_mov_b32 s57, 10
    ds_read_b64_tr_b16 v[188:189], v250 offset:32768
    v_exp_f32 v236, v220
    v_mfma_f32_16x16x32_bf16 v[20:23], v[192:195], v[228:231], v[20:23]
    ds_read_b64_tr_b16 v[192:193], v251 offset:32768
    v_exp_f32 v237, v221
    v_mfma_f32_16x16x32_bf16 v[32:35], v[196:199], v[228:231], v[32:35]
    ds_read_b64_tr_b16 v[196:197], v252 offset:32768
    v_exp_f32 v238, v222
    v_mfma_f32_16x16x32_bf16 v[44:47], v[200:203], v[228:231], v[44:47]
    ds_read_b64_tr_b16 v[200:201], v253 offset:32768
    v_exp_f32 v239, v223
    v_mfma_f32_16x16x32_bf16 v[56:59], v[204:207], v[228:231], v[56:59]
    ds_read_b64_tr_b16 v[204:205], v250 offset:36864
    v_add_f32 v247, v236, v237
    v_add_f32 v255, v238, v239
    v_mfma_f32_16x16x32_bf16 v[68:71], v[208:211], v[228:231], v[68:71]
    ds_read_b64_tr_b16 v[208:209], v251 offset:36864
    v_exp_f32 v240, v224
    v_mfma_f32_16x16x32_bf16 v[80:83], v[212:215], v[228:231], v[80:83]
    ds_read_b64_tr_b16 v[212:213], v252 offset:36864
    v_exp_f32 v241, v225
    v_mfma_f32_16x16x32_bf16 v[92:95], v[216:219], v[228:231], v[92:95]
    ds_read_b64_tr_b16 v[216:217], v253 offset:36864
    v_add_f32 v247, v247, v240
    v_add_f32 v255, v255, v241
    v_mfma_f32_16x16x32_bf16 v[228:231], v[156:159], v[100:103], v[148:151]
    ds_read_b64_tr_b16 v[190:191], v250 offset:34816
    v_exp_f32 v242, v226
    v_mfma_f32_16x16x32_bf16 v[232:235], v[160:163], v[100:103], v[148:151]
    ds_read_b64_tr_b16 v[194:195], v251 offset:34816
    v_exp_f32 v243, v227
    v_mfma_f32_16x16x32_bf16 v[228:231], v[164:167], v[112:115], v[228:231]
    ds_read_b64_tr_b16 v[198:199], v252 offset:34816
    v_add_f32 v247, v247, v242
    v_add_f32 v255, v255, v243
    v_mfma_f32_16x16x32_bf16 v[232:235], v[168:171], v[112:115], v[232:235]
    ds_read_b64_tr_b16 v[202:203], v253 offset:34816
    v_add_f32 v247, v247, v255
    v_cmp_lt_f32 vcc, s54, v247
    v_mfma_f32_16x16x32_bf16 v[228:231], v[172:175], v[124:127], v[228:231]
    ds_read_b64_tr_b16 v[206:207], v250 offset:38912
    v_mfma_f32_16x16x32_bf16 v[232:235], v[176:179], v[124:127], v[232:235]
    ds_read_b64_tr_b16 v[210:211], v251 offset:38912
    s_cbranch_vccnz L_fix0_0
L_ret0_10:
    v_cvt_pk_bf16_f32 v220, v236, v237
    v_cvt_pk_bf16_f32 v221, v238, v239
    v_mfma_f32_16x16x32_bf16 v[228:231], v[180:183], v[136:139], v[228:231]
    ds_read_b64_tr_b16 v[214:215], v252 offset:38912
    v_cvt_pk_bf16_f32 v222, v240, v241
    v_cvt_pk_bf16_f32 v223, v242, v243
    v_mfma_f32_16x16x32_bf16 v[232:235], v[184:187], v[136:139], v[232:235]
    ds_read_b64_tr_b16 v[218:219], v253 offset:38912
    v_add_f32 v244, v244, v247
    s_waitcnt lgkmcnt(4)
    v_mfma_f32_16x16x32_bf16 v[0:3], v[188:191], v[220:223], v[0:3]
    v_exp_f32 v236, v228
    v_mfma_f32_16x16x32_bf16 v[12:15], v[192:195], v[220:223], v[12:15]
    v_exp_f32 v237, v229
    v_mfma_f32_16x16x32_bf16 v[24:27], v[196:199], v[220:223], v[24:27]
    v_exp_f32 v238, v230
    v_mfma_f32_16x16x32_bf16 v[36:39], v[200:203], v[220:223], v[36:39]
    v_exp_f32 v239, v231
    s_waitcnt lgkmcnt(0)
    v_mfma_f32_16x16x32_bf16 v[48:51], v[204:207], v[220:223], v[48:51]
    v_add_f32 v247, v236, v237
    v_add_f32 v255, v238, v239
    v_mfma_f32_16x16x32_bf16 v[60:63], v[208:211], v[220:223], v[60:63]
    v_exp_f32 v240, v232
    v_mfma_f32_16x16x32_bf16 v[72:75], v[212:215], v[220:223], v[72:75]
    v_exp_f32 v241, v233
    v_mfma_f32_16x16x32_bf16 v[84:87], v[216:219], v[220:223], v[84:87]
    v_add_f32 v247, v247, v240
    v_add_f32 v255, v255, v241
    v_mfma_f32_16x16x32_bf16 v[220:223], v[156:159], v[104:107], v[152:155]
    ds_read_b128 v[156:159], v248 offset:40960
    v_exp_f32 v242, v234
    v_mfma_f32_16x16x32_bf16 v[224:227], v[160:163], v[104:107], v[152:155]
    ds_read_b128 v[160:163], v248 offset:43008
    v_exp_f32 v243, v235
    v_mfma_f32_16x16x32_bf16 v[220:223], v[164:167], v[116:119], v[220:223]
    ds_read_b128 v[164:167], v249 offset:40960
    v_add_f32 v247, v247, v242
    v_add_f32 v255, v255, v243
    v_mfma_f32_16x16x32_bf16 v[224:227], v[168:171], v[116:119], v[224:227]
    ds_read_b128 v[168:171], v249 offset:43008
    v_add_f32 v247, v247, v255
    v_cmp_lt_f32 vcc, s54, v247
    v_mfma_f32_16x16x32_bf16 v[220:223], v[172:175], v[128:131], v[220:223]
    ds_read_b128 v[172:175], v248 offset:45056
    v_mfma_f32_16x16x32_bf16 v[224:227], v[176:179], v[128:131], v[224:227]
    ds_read_b128 v[176:179], v248 offset:47104
    s_cbranch_vccnz L_fix1_1
L_ret1_10:
    v_cvt_pk_bf16_f32 v228, v236, v237
    v_cvt_pk_bf16_f32 v229, v238, v239
    v_mfma_f32_16x16x32_bf16 v[220:223], v[180:183], v[140:143], v[220:223]
    ds_read_b128 v[180:183], v249 offset:45056
    v_cvt_pk_bf16_f32 v230, v240, v241
    v_cvt_pk_bf16_f32 v231, v242, v243
    v_mfma_f32_16x16x32_bf16 v[224:227], v[184:187], v[140:143], v[224:227]
    ds_read_b128 v[184:187], v249 offset:47104
    v_add_f32 v245, v245, v247
    v_mfma_f32_16x16x32_bf16 v[4:7], v[188:191], v[228:231], v[4:7]
    s_nop 0
    v_exp_f32 v236, v220
    v_mfma_f32_16x16x32_bf16 v[16:19], v[192:195], v[228:231], v[16:19]
    v_exp_f32 v237, v221
    v_mfma_f32_16x16x32_bf16 v[28:31], v[196:199], v[228:231], v[28:31]
    v_exp_f32 v238, v222
    v_mfma_f32_16x16x32_bf16 v[40:43], v[200:203], v[228:231], v[40:43]
    v_exp_f32 v239, v223
    v_mfma_f32_16x16x32_bf16 v[52:55], v[204:207], v[228:231], v[52:55]
    v_add_f32 v247, v236, v237
    v_add_f32 v255, v238, v239
    v_mfma_f32_16x16x32_bf16 v[64:67], v[208:211], v[228:231], v[64:67]
    v_exp_f32 v240, v224
    v_mfma_f32_16x16x32_bf16 v[76:79], v[212:215], v[228:231], v[76:79]
    v_exp_f32 v241, v225
    v_mfma_f32_16x16x32_bf16 v[88:91], v[216:219], v[228:231], v[88:91]
    v_add_f32 v247, v247, v240
    v_add_f32 v255, v255, v241
    s_waitcnt lgkmcnt(0)
    v_mfma_f32_16x16x32_bf16 v[228:231], v[156:159], v[96:99], v[144:147]
    v_exp_f32 v242, v226
    v_mfma_f32_16x16x32_bf16 v[232:235], v[160:163], v[96:99], v[144:147]
    v_exp_f32 v243, v227
    v_mfma_f32_16x16x32_bf16 v[228:231], v[164:167], v[108:111], v[228:231]
    v_add_f32 v247, v247, v242
    v_add_f32 v255, v255, v243
    v_mfma_f32_16x16x32_bf16 v[232:235], v[168:171], v[108:111], v[232:235]
    v_add_f32 v247, v247, v255
    v_cmp_lt_f32 vcc, s54, v247
    v_mfma_f32_16x16x32_bf16 v[228:231], v[172:175], v[120:123], v[228:231]
    v_mfma_f32_16x16x32_bf16 v[232:235], v[176:179], v[120:123], v[232:235]
    s_cbranch_vccnz L_fix2_0
L_ret2_10:
    v_cvt_pk_bf16_f32 v220, v236, v237
    v_cvt_pk_bf16_f32 v221, v238, v239
    v_mfma_f32_16x16x32_bf16 v[228:231], v[180:183], v[132:135], v[228:231]
    v_cvt_pk_bf16_f32 v222, v240, v241
    v_cvt_pk_bf16_f32 v223, v242, v243
    v_mfma_f32_16x16x32_bf16 v[232:235], v[184:187], v[132:135], v[232:235]
    v_add_f32 v246, v246, v247
    s_waitcnt lgkmcnt(0)
    s_barrier
    v_mfma_f32_16x16x32_bf16 v[8:11], v[188:191], v[220:223], v[8:11]
    s_mov_b32 s57, 11
    ds_read_b64_tr_b16 v[188:189], v250 offset:49152
    v_exp_f32 v236, v228
    v_mfma_f32_16x16x32_bf16 v[20:23], v[192:195], v[220:223], v[20:23]
    ds_read_b64_tr_b16 v[192:193], v251 offset:49152
    v_exp_f32 v237, v229
    v_mfma_f32_16x16x32_bf16 v[32:35], v[196:199], v[220:223], v[32:35]
    ds_read_b64_tr_b16 v[196:197], v252 offset:49152
    v_exp_f32 v238, v230
    v_mfma_f32_16x16x32_bf16 v[44:47], v[200:203], v[220:223], v[44:47]
    ds_read_b64_tr_b16 v[200:201], v253 offset:49152
    v_exp_f32 v239, v231
    v_mfma_f32_16x16x32_bf16 v[56:59], v[204:207], v[220:223], v[56:59]
    ds_read_b64_tr_b16 v[204:205], v250 offset:53248
    v_add_f32 v247, v236, v237
    v_add_f32 v255, v238, v239
    v_mfma_f32_16x16x32_bf16 v[68:71], v[208:211], v[220:223], v[68:71]
    ds_read_b64_tr_b16 v[208:209], v251 offset:53248
    v_exp_f32 v240, v232
    v_mfma_f32_16x16x32_bf16 v[80:83], v[212:215], v[220:223], v[80:83]
    ds_read_b64_tr_b16 v[212:213], v252 offset:53248
    v_exp_f32 v241, v233
    v_mfma_f32_16x16x32_bf16 v[92:95], v[216:219], v[220:223], v[92:95]
    ds_read_b64_tr_b16 v[216:217], v253 offset:53248
    v_add_f32 v247, v247, v240
    v_add_f32 v255, v255, v241
    v_mfma_f32_16x16x32_bf16 v[220:223], v[156:159], v[100:103], v[148:151]
    ds_read_b64_tr_b16 v[190:191], v250 offset:51200
    v_exp_f32 v242, v234
    v_mfma_f32_16x16x32_bf16 v[224:227], v[160:163], v[100:103], v[148:151]
    ds_read_b64_tr_b16 v[194:195], v251 offset:51200
    v_exp_f32 v243, v235
    v_mfma_f32_16x16x32_bf16 v[220:223], v[164:167], v[112:115], v[220:223]
    ds_read_b64_tr_b16 v[198:199], v252 offset:51200
    v_add_f32 v247, v247, v242
    v_add_f32 v255, v255, v243
    v_mfma_f32_16x16x32_bf16 v[224:227], v[168:171], v[112:115], v[224:227]
    ds_read_b64_tr_b16 v[202:203], v253 offset:51200
    v_add_f32 v247, v247, v255
    v_cmp_lt_f32 vcc, s54, v247
    v_mfma_f32_16x16x32_bf16 v[220:223], v[172:175], v[124:127], v[220:223]
    ds_read_b64_tr_b16 v[206:207], v250 offset:55296
    v_mfma_f32_16x16x32_bf16 v[224:227], v[176:179], v[124:127], v[224:227]
    ds_read_b64_tr_b16 v[210:211], v251 offset:55296
    s_cbranch_vccnz L_fix0_1
L_ret0_11:
    v_cvt_pk_bf16_f32 v228, v236, v237
    v_cvt_pk_bf16_f32 v229, v238, v239
    v_mfma_f32_16x16x32_bf16 v[220:223], v[180:183], v[136:139], v[220:223]
    ds_read_b64_tr_b16 v[214:215], v252 offset:55296
    v_cvt_pk_bf16_f32 v230, v240, v241
    v_cvt_pk_bf16_f32 v231, v242, v243
    v_mfma_f32_16x16x32_bf16 v[224:227], v[184:187], v[136:139], v[224:227]
    ds_read_b64_tr_b16 v[218:219], v253 offset:55296
    v_add_f32 v244, v244, v247
    s_waitcnt lgkmcnt(4)
    v_mfma_f32_16x16x32_bf16 v[0:3], v[188:191], v[228:231], v[0:3]
    v_exp_f32 v236, v220
    v_mfma_f32_16x16x32_bf16 v[12:15], v[192:195], v[228:231], v[12:15]
    v_exp_f32 v237, v221
    v_mfma_f32_16x16x32_bf16 v[24:27], v[196:199], v[228:231], v[24:27]
    v_exp_f32 v238, v222
    v_mfma_f32_16x16x32_bf16 v[36:39], v[200:203], v[228:231], v[36:39]
    v_exp_f32 v239, v223
    s_waitcnt lgkmcnt(0)
    v_mfma_f32_16x16x32_bf16 v[48:51], v[204:207], v[228:231], v[48:51]
    v_add_f32 v247, v236, v237
    v_add_f32 v255, v238, v239
    v_mfma_f32_16x16x32_bf16 v[60:63], v[208:211], v[228:231], v[60:63]
    v_exp_f32 v240, v224
    v_mfma_f32_16x16x32_bf16 v[72:75], v[212:215], v[228:231], v[72:75]
    v_exp_f32 v241, v225
    v_mfma_f32_16x16x32_bf16 v[84:87], v[216:219], v[228:231], v[84:87]
    v_add_f32 v247, v247, v240
    v_add_f32 v255, v255, v241
    v_mfma_f32_16x16x32_bf16 v[228:231], v[156:159], v[104:107], v[152:155]
    ds_read_b128 v[156:159], v248 offset:57344
    v_exp_f32 v242, v226
    v_mfma_f32_16x16x32_bf16 v[232:235], v[160:163], v[104:107], v[152:155]
    ds_read_b128 v[160:163], v248 offset:59392
    v_exp_f32 v243, v227
    v_mfma_f32_16x16x32_bf16 v[228:231], v[164:167], v[116:119], v[228:231]
    ds_read_b128 v[164:167], v249 offset:57344
    v_add_f32 v247, v247, v242
    v_add_f32 v255, v255, v243
    v_mfma_f32_16x16x32_bf16 v[232:235], v[168:171], v[116:119], v[232:235]
    ds_read_b128 v[168:171], v249 offset:59392
    v_add_f32 v247, v247, v255
    v_cmp_lt_f32 vcc, s54, v247
    v_mfma_f32_16x16x32_bf16 v[228:231], v[172:175], v[128:131], v[228:231]
    ds_read_b128 v[172:175], v248 offset:61440
    v_mfma_f32_16x16x32_bf16 v[232:235], v[176:179], v[128:131], v[232:235]
    ds_read_b128 v[176:179], v248 offset:63488
    s_cbranch_vccnz L_fix1_0
L_ret1_11:
    v_cvt_pk_bf16_f32 v220, v236, v237
    v_cvt_pk_bf16_f32 v221, v238, v239
    v_mfma_f32_16x16x32_bf16 v[228:231], v[180:183], v[140:143], v[228:231]
    ds_read_b128 v[180:183], v249 offset:61440
    v_cvt_pk_bf16_f32 v222, v240, v241
    v_cvt_pk_bf16_f32 v223, v242, v243
    v_mfma_f32_16x16x32_bf16 v[232:235], v[184:187], v[140:143], v[232:235]
    ds_read_b128 v[184:187], v249 offset:63488
    v_add_f32 v245, v245, v247
    v_mfma_f32_16x16x32_bf16 v[4:7], v[188:191], v[220:223], v[4:7]
    s_nop 0
    v_exp_f32 v236, v228
    v_mfma_f32_16x16x32_bf16 v[16:19], v[192:195], v[220:223], v[16:19]
    v_exp_f32 v237, v229
    v_mfma_f32_16x16x32_bf16 v[28:31], v[196:199], v[220:223], v[28:31]
    v_exp_f32 v238, v230
    v_mfma_f32_16x16x32_bf16 v[40:43], v[200:203], v[220:223], v[40:43]
    v_exp_f32 v239, v231
    v_mfma_f32_16x16x32_bf16 v[52:55], v[204:207], v[220:223], v[52:55]
    v_add_f32 v247, v236, v237
    v_add_f32 v255, v238, v239
    v_mfma_f32_16x16x32_bf16 v[64:67], v[208:211], v[220:223], v[64:67]
    v_exp_f32 v240, v232
    v_mfma_f32_16x16x32_bf16 v[76:79], v[212:215], v[220:223], v[76:79]
    v_exp_f32 v241, v233
    v_mfma_f32_16x16x32_bf16 v[88:91], v[216:219], v[220:223], v[88:91]
    v_add_f32 v247, v247, v240
    v_add_f32 v255, v255, v241
    s_waitcnt lgkmcnt(0)
    v_mfma_f32_16x16x32_bf16 v[220:223], v[156:159], v[96:99], v[144:147]
    v_exp_f32 v242, v234
    v_mfma_f32_16x16x32_bf16 v[224:227], v[160:163], v[96:99], v[144:147]
    v_exp_f32 v243, v235
    v_mfma_f32_16x16x32_bf16 v[220:223], v[164:167], v[108:111], v[220:223]
    v_add_f32 v247, v247, v242
    v_add_f32 v255, v255, v243
    v_mfma_f32_16x16x32_bf16 v[224:227], v[168:171], v[108:111], v[224:227]
    v_add_f32 v247, v247, v255
    v_cmp_lt_f32 vcc, s54, v247
    v_mfma_f32_16x16x32_bf16 v[220:223], v[172:175], v[120:123], v[220:223]
    v_mfma_f32_16x16x32_bf16 v[224:227], v[176:179], v[120:123], v[224:227]
    s_cbranch_vccnz L_fix2_1
L_ret2_11:
    v_cvt_pk_bf16_f32 v228, v236, v237
    v_cvt_pk_bf16_f32 v229, v238, v239
    v_mfma_f32_16x16x32_bf16 v[220:223], v[180:183], v[132:135], v[220:223]
    v_cvt_pk_bf16_f32 v230, v240, v241
    v_cvt_pk_bf16_f32 v231, v242, v243
    v_mfma_f32_16x16x32_bf16 v[224:227], v[184:187], v[132:135], v[224:227]
    v_add_f32 v246, v246, v247
    s_waitcnt lgkmcnt(0)
    s_barrier
    v_mfma_f32_16x16x32_bf16 v[8:11], v[188:191], v[228:231], v[8:11]
    s_mov_b32 s57, 12
    ds_read_b64_tr_b16 v[188:189], v250 offset:0
    v_exp_f32 v236, v220
    v_mfma_f32_16x16x32_bf16 v[20:23], v[192:195], v[228:231], v[20:23]
    ds_read_b64_tr_b16 v[192:193], v251 offset:0
    v_exp_f32 v237, v221
    v_mfma_f32_16x16x32_bf16 v[32:35], v[196:199], v[228:231], v[32:35]
    ds_read_b64_tr_b16 v[196:197], v252 offset:0
    v_exp_f32 v238, v222
    v_mfma_f32_16x16x32_bf16 v[44:47], v[200:203], v[228:231], v[44:47]
    ds_read_b64_tr_b16 v[200:201], v253 offset:0
    v_exp_f32 v239, v223
    v_mfma_f32_16x16x32_bf16 v[56:59], v[204:207], v[228:231], v[56:59]
    ds_read_b64_tr_b16 v[204:205], v250 offset:4096
    v_add_f32 v247, v236, v237
    v_add_f32 v255, v238, v239
    v_mfma_f32_16x16x32_bf16 v[68:71], v[208:211], v[228:231], v[68:71]
    ds_read_b64_tr_b16 v[208:209], v251 offset:4096
    v_exp_f32 v240, v224
    v_mfma_f32_16x16x32_bf16 v[80:83], v[212:215], v[228:231], v[80:83]
    ds_read_b64_tr_b16 v[212:213], v252 offset:4096
    v_exp_f32 v241, v225
    v_mfma_f32_16x16x32_bf16 v[92:95], v[216:219], v[228:231], v[92:95]
    ds_read_b64_tr_b16 v[216:217], v253 offset:4096
    v_add_f32 v247, v247, v240
    v_add_f32 v255, v255, v241
    v_mfma_f32_16x16x32_bf16 v[228:231], v[156:159], v[100:103], v[148:151]
    ds_read_b64_tr_b16 v[190:191], v250 offset:2048
    v_exp_f32 v242, v226
    v_mfma_f32_16x16x32_bf16 v[232:235], v[160:163], v[100:103], v[148:151]
    ds_read_b64_tr_b16 v[194:195], v251 offset:2048
    v_exp_f32 v243, v227
    v_mfma_f32_16x16x32_bf16 v[228:231], v[164:167], v[112:115], v[228:231]
    ds_read_b64_tr_b16 v[198:199], v252 offset:2048
    v_add_f32 v247, v247, v242
    v_add_f32 v255, v255, v243
    v_mfma_f32_16x16x32_bf16 v[232:235], v[168:171], v[112:115], v[232:235]
    ds_read_b64_tr_b16 v[202:203], v253 offset:2048
    v_add_f32 v247, v247, v255
    v_cmp_lt_f32 vcc, s54, v247
    v_mfma_f32_16x16x32_bf16 v[228:231], v[172:175], v[124:127], v[228:231]
    ds_read_b64_tr_b16 v[206:207], v250 offset:6144
    v_mfma_f32_16x16x32_bf16 v[232:235], v[176:179], v[124:127], v[232:235]
    ds_read_b64_tr_b16 v[210:211], v251 offset:6144
    s_cbranch_vccnz L_fix0_0
L_ret0_12:
    v_cvt_pk_bf16_f32 v220, v236, v237
    v_cvt_pk_bf16_f32 v221, v238, v239
    v_mfma_f32_16x16x32_bf16 v[228:231], v[180:183], v[136:139], v[228:231]
    ds_read_b64_tr_b16 v[214:215], v252 offset:6144
    v_cvt_pk_bf16_f32 v222, v240, v241
    v_cvt_pk_bf16_f32 v223, v242, v243
    v_mfma_f32_16x16x32_bf16 v[232:235], v[184:187], v[136:139], v[232:235]
    ds_read_b64_tr_b16 v[218:219], v253 offset:6144
    v_add_f32 v244, v244, v247
    s_waitcnt lgkmcnt(4)
    v_mfma_f32_16x16x32_bf16 v[0:3], v[188:191], v[220:223], v[0:3]
    v_exp_f32 v236, v228
    v_mfma_f32_16x16x32_bf16 v[12:15], v[192:195], v[220:223], v[12:15]
    v_exp_f32 v237, v229
    v_mfma_f32_16x16x32_bf16 v[24:27], v[196:199], v[220:223], v[24:27]
    v_exp_f32 v238, v230
    v_mfma_f32_16x16x32_bf16 v[36:39], v[200:203], v[220:223], v[36:39]
    v_exp_f32 v239, v231
    s_waitcnt lgkmcnt(0)
    v_mfma_f32_16x16x32_bf16 v[48:51], v[204:207], v[220:223], v[48:51]
    v_add_f32 v247, v236, v237
    v_add_f32 v255, v238, v239
    v_mfma_f32_16x16x32_bf16 v[60:63], v[208:211], v[220:223], v[60:63]
    v_exp_f32 v240, v232
    v_mfma_f32_16x16x32_bf16 v[72:75], v[212:215], v[220:223], v[72:75]
    v_exp_f32 v241, v233
    v_mfma_f32_16x16x32_bf16 v[84:87], v[216:219], v[220:223], v[84:87]
    v_add_f32 v247, v247, v240
    v_add_f32 v255, v255, v241
    v_mfma_f32_16x16x32_bf16 v[220:223], v[156:159], v[104:107], v[152:155]
    ds_read_b128 v[156:159], v248 offset:8192
    v_exp_f32 v242, v234
    v_mfma_f32_16x16x32_bf16 v[224:227], v[160:163], v[104:107], v[152:155]
    ds_read_b128 v[160:163], v248 offset:10240
    v_exp_f32 v243, v235
    v_mfma_f32_16x16x32_bf16 v[220:223], v[164:167], v[116:119], v[220:223]
    ds_read_b128 v[164:167], v249 offset:8192
    v_add_f32 v247, v247, v242
    v_add_f32 v255, v255, v243
    v_mfma_f32_16x16x32_bf16 v[224:227], v[168:171], v[116:119], v[224:227]
    ds_read_b128 v[168:171], v249 offset:10240
    v_add_f32 v247, v247, v255
    v_cmp_lt_f32 vcc, s54, v247
    v_mfma_f32_16x16x32_bf16 v[220:223], v[172:175], v[128:131], v[220:223]
    ds_read_b128 v[172:175], v248 offset:12288
    v_mfma_f32_16x16x32_bf16 v[224:227], v[176:179], v[128:131], v[224:227]
    ds_read_b128 v[176:179], v248 offset:14336
    s_cbranch_vccnz L_fix1_1
L_ret1_12:
    v_cvt_pk_bf16_f32 v228, v236, v237
    v_cvt_pk_bf16_f32 v229, v238, v239
    v_mfma_f32_16x16x32_bf16 v[220:223], v[180:183], v[140:143], v[220:223]
    ds_read_b128 v[180:183], v249 offset:12288
    v_cvt_pk_bf16_f32 v230, v240, v241
    v_cvt_pk_bf16_f32 v231, v242, v243
    v_mfma_f32_16x16x32_bf16 v[224:227], v[184:187], v[140:143], v[224:227]
    ds_read_b128 v[184:187], v249 offset:14336
    v_add_f32 v245, v245, v247
    v_mfma_f32_16x16x32_bf16 v[4:7], v[188:191], v[228:231], v[4:7]
    s_nop 0
    v_exp_f32 v236, v220
    v_mfma_f32_16x16x32_bf16 v[16:19], v[192:195], v[228:231], v[16:19]
    v_exp_f32 v237, v221
    v_mfma_f32_16x16x32_bf16 v[28:31], v[196:199], v[228:231], v[28:31]
    v_exp_f32 v238, v222
    v_mfma_f32_16x16x32_bf16 v[40:43], v[200:203], v[228:231], v[40:43]
    v_exp_f32 v239, v223
    v_mfma_f32_16x16x32_bf16 v[52:55], v[204:207], v[228:231], v[52:55]
    v_add_f32 v247, v236, v237
    v_add_f32 v255, v238, v239
    v_mfma_f32_16x16x32_bf16 v[64:67], v[208:211], v[228:231], v[64:67]
    v_exp_f32 v240, v224
    v_mfma_f32_16x16x32_bf16 v[76:79], v[212:215], v[228:231], v[76:79]
    v_exp_f32 v241, v225
    v_mfma_f32_16x16x32_bf16 v[88:91], v[216:219], v[228:231], v[88:91]
    v_add_f32 v247, v247, v240
    v_add_f32 v255, v255, v241
    s_waitcnt lgkmcnt(0)
    v_mfma_f32_16x16x32_bf16 v[228:231], v[156:159], v[96:99], v[144:147]
    v_exp_f32 v242, v226
    v_mfma_f32_16x16x32_bf16 v[232:235], v[160:163], v[96:99], v[144:147]
    v_exp_f32 v243, v227
    v_mfma_f32_16x16x32_bf16 v[228:231], v[164:167], v[108:111], v[228:231]
    v_add_f32 v247, v247, v242
    v_add_f32 v255, v255, v243
    v_mfma_f32_16x16x32_bf16 v[232:235], v[168:171], v[108:111], v[232:235]
    v_add_f32 v247, v247, v255
    v_cmp_lt_f32 vcc, s54, v247
    v_mfma_f32_16x16x32_bf16 v[228:231], v[172:175], v[120:123], v[228:231]
    v_mfma_f32_16x16x32_bf16 v[232:235], v[176:179], v[120:123], v[232:235]
    s_cbranch_vccnz L_fix2_0
L_ret2_12:
    v_cvt_pk_bf16_f32 v220, v236, v237
    v_cvt_pk_bf16_f32 v221, v238, v239
    v_mfma_f32_16x16x32_bf16 v[228:231], v[180:183], v[132:135], v[228:231]
    v_cvt_pk_bf16_f32 v222, v240, v241
    v_cvt_pk_bf16_f32 v223, v242, v243
    v_mfma_f32_16x16x32_bf16 v[232:235], v[184:187], v[132:135], v[232:235]
    v_add_f32 v246, v246, v247
    s_waitcnt lgkmcnt(0)
    s_barrier
    v_mfma_f32_16x16x32_bf16 v[8:11], v[188:191], v[220:223], v[8:11]
    s_mov_b32 s57, 13
    ds_read_b64_tr_b16 v[188:189], v250 offset:16384
    v_exp_f32 v236, v228
    v_mfma_f32_16x16x32_bf16 v[20:23], v[192:195], v[220:223], v[20:23]
    ds_read_b64_tr_b16 v[192:193], v251 offset:16384
    v_exp_f32 v237, v229
    v_mfma_f32_16x16x32_bf16 v[32:35], v[196:199], v[220:223], v[32:35]
    ds_read_b64_tr_b16 v[196:197], v252 offset:16384
    v_exp_f32 v238, v230
    v_mfma_f32_16x16x32_bf16 v[44:47], v[200:203], v[220:223], v[44:47]
    ds_read_b64_tr_b16 v[200:201], v253 offset:16384
    v_exp_f32 v239, v231
    v_mfma_f32_16x16x32_bf16 v[56:59], v[204:207], v[220:223], v[56:59]
    ds_read_b64_tr_b16 v[204:205], v250 offset:20480
    v_add_f32 v247, v236, v237
    v_add_f32 v255, v238, v239
    v_mfma_f32_16x16x32_bf16 v[68:71], v[208:211], v[220:223], v[68:71]
    ds_read_b64_tr_b16 v[208:209], v251 offset:20480
    v_exp_f32 v240, v232
    v_mfma_f32_16x16x32_bf16 v[80:83], v[212:215], v[220:223], v[80:83]
    ds_read_b64_tr_b16 v[212:213], v252 offset:20480
    v_exp_f32 v241, v233
    v_mfma_f32_16x16x32_bf16 v[92:95], v[216:219], v[220:223], v[92:95]
    ds_read_b64_tr_b16 v[216:217], v253 offset:20480
    v_add_f32 v247, v247, v240
    v_add_f32 v255, v255, v241
    v_mfma_f32_16x16x32_bf16 v[220:223], v[156:159], v[100:103], v[148:151]
    ds_read_b64_tr_b16 v[190:191], v250 offset:18432
    v_exp_f32 v242, v234
    v_mfma_f32_16x16x32_bf16 v[224:227], v[160:163], v[100:103], v[148:151]
    ds_read_b64_tr_b16 v[194:195], v251 offset:18432
    v_exp_f32 v243, v235
    v_mfma_f32_16x16x32_bf16 v[220:223], v[164:167], v[112:115], v[220:223]
    ds_read_b64_tr_b16 v[198:199], v252 offset:18432
    v_add_f32 v247, v247, v242
    v_add_f32 v255, v255, v243
    v_mfma_f32_16x16x32_bf16 v[224:227], v[168:171], v[112:115], v[224:227]
    ds_read_b64_tr_b16 v[202:203], v253 offset:18432
    v_add_f32 v247, v247, v255
    v_cmp_lt_f32 vcc, s54, v247
    v_mfma_f32_16x16x32_bf16 v[220:223], v[172:175], v[124:127], v[220:223]
    ds_read_b64_tr_b16 v[206:207], v250 offset:22528
    v_mfma_f32_16x16x32_bf16 v[224:227], v[176:179], v[124:127], v[224:227]
    ds_read_b64_tr_b16 v[210:211], v251 offset:22528
    s_cbranch_vccnz L_fix0_1
L_ret0_13:
    v_cvt_pk_bf16_f32 v228, v236, v237
    v_cvt_pk_bf16_f32 v229, v238, v239
    v_mfma_f32_16x16x32_bf16 v[220:223], v[180:183], v[136:139], v[220:223]
    ds_read_b64_tr_b16 v[214:215], v252 offset:22528
    v_cvt_pk_bf16_f32 v230, v240, v241
    v_cvt_pk_bf16_f32 v231, v242, v243
    v_mfma_f32_16x16x32_bf16 v[224:227], v[184:187], v[136:139], v[224:227]
    ds_read_b64_tr_b16 v[218:219], v253 offset:22528
    v_add_f32 v244, v244, v247
    s_waitcnt lgkmcnt(4)
    v_mfma_f32_16x16x32_bf16 v[0:3], v[188:191], v[228:231], v[0:3]
    v_exp_f32 v236, v220
    v_mfma_f32_16x16x32_bf16 v[12:15], v[192:195], v[228:231], v[12:15]
    v_exp_f32 v237, v221
    v_mfma_f32_16x16x32_bf16 v[24:27], v[196:199], v[228:231], v[24:27]
    v_exp_f32 v238, v222
    v_mfma_f32_16x16x32_bf16 v[36:39], v[200:203], v[228:231], v[36:39]
    v_exp_f32 v239, v223
    s_waitcnt lgkmcnt(0)
    v_mfma_f32_16x16x32_bf16 v[48:51], v[204:207], v[228:231], v[48:51]
    v_add_f32 v247, v236, v237
    v_add_f32 v255, v238, v239
    v_mfma_f32_16x16x32_bf16 v[60:63], v[208:211], v[228:231], v[60:63]
    v_exp_f32 v240, v224
    v_mfma_f32_16x16x32_bf16 v[72:75], v[212:215], v[228:231], v[72:75]
    v_exp_f32 v241, v225
    v_mfma_f32_16x16x32_bf16 v[84:87], v[216:219], v[228:231], v[84:87]
    v_add_f32 v247, v247, v240
    v_add_f32 v255, v255, v241
    v_mfma_f32_16x16x32_bf16 v[228:231], v[156:159], v[104:107], v[152:155]
    ds_read_b128 v[156:159], v248 offset:24576
    v_exp_f32 v242, v226
    v_mfma_f32_16x16x32_bf16 v[232:235], v[160:163], v[104:107], v[152:155]
    ds_read_b128 v[160:163], v248 offset:26624
    v_exp_f32 v243, v227
    v_mfma_f32_16x16x32_bf16 v[228:231], v[164:167], v[116:119], v[228:231]
    ds_read_b128 v[164:167], v249 offset:24576
    v_add_f32 v247, v247, v242
    v_add_f32 v255, v255, v243
    v_mfma_f32_16x16x32_bf16 v[232:235], v[168:171], v[116:119], v[232:235]
    ds_read_b128 v[168:171], v249 offset:26624
    v_add_f32 v247, v247, v255
    v_cmp_lt_f32 vcc, s54, v247
    v_mfma_f32_16x16x32_bf16 v[228:231], v[172:175], v[128:131], v[228:231]
    ds_read_b128 v[172:175], v248 offset:28672
    v_lshrrev_b32 v255, 9, v254
    v_lshlrev_b32 v255, 13, v255
    s_movk_i32 s52, 0x180
    v_and_or_b32 v255, v254, s52, v255
    s_add_u32 s51, s47, 512
    s_sub_u32 s52, s45, 1
    s_cmp_le_u32 s52, 1
    s_cselect_b32 s51, s51, 0x7f000000
    buffer_load_dword v255, s[20:23], s51 offen lds
    v_mfma_f32_16x16x32_bf16 v[232:235], v[176:179], v[128:131], v[232:235]
    ds_read_b128 v[176:179], v248 offset:30720
    v_lshrrev_b32 v255, 9, v254
    v_lshlrev_b32 v255, 13, v255
    s_movk_i32 s52, 0x180
    v_and_or_b32 v255, v254, s52, v255
    s_mov_b64 exec, 0xff
    s_add_u32 s51, s47, 131584
    s_sub_u32 s52, s45, 1
    s_cmp_le_u32 s52, 1
    s_cselect_b32 s51, s51, 0x7f000000
    buffer_load_dword v255, s[20:23], s51 offen lds
    s_mov_b64 exec, -1
    s_cbranch_vccnz L_fix1_0
L_ret1_13:
    v_cvt_pk_bf16_f32 v220, v236, v237
    v_cvt_pk_bf16_f32 v221, v238, v239
    v_mfma_f32_16x16x32_bf16 v[228:231], v[180:183], v[140:143], v[228:231]
    ds_read_b128 v[180:183], v249 offset:28672
    s_add_u32 s51, s49, 0
    s_sub_u32 s52, s45, 1
    s_cmp_le_u32 s52, 1
    s_cselect_b32 s51, s51, 0x7f000000
    buffer_load_dword v254, s[8:11], s51 offen lds
    v_cvt_pk_bf16_f32 v222, v240, v241
    v_cvt_pk_bf16_f32 v223, v242, v243
    v_mfma_f32_16x16x32_bf16 v[232:235], v[184:187], v[140:143], v[232:235]
    ds_read_b128 v[184:187], v249 offset:30720
    v_add_f32 v245, v245, v247
    v_mfma_f32_16x16x32_bf16 v[4:7], v[188:191], v[220:223], v[4:7]
    v_exp_f32 v236, v228
    v_mfma_f32_16x16x32_bf16 v[16:19], v[192:195], v[220:223], v[16:19]
    v_exp_f32 v237, v229
    v_mfma_f32_16x16x32_bf16 v[28:31], v[196:199], v[220:223], v[28:31]
    v_exp_f32 v238, v230
    v_mfma_f32_16x16x32_bf16 v[40:43], v[200:203], v[220:223], v[40:43]
    v_exp_f32 v239, v231
    v_mfma_f32_16x16x32_bf16 v[52:55], v[204:207], v[220:223], v[52:55]
    v_add_f32 v247, v236, v237
    v_add_f32 v255, v238, v239
    v_mfma_f32_16x16x32_bf16 v[64:67], v[208:211], v[220:223], v[64:67]
    v_exp_f32 v240, v232
    v_mfma_f32_16x16x32_bf16 v[76:79], v[212:215], v[220:223], v[76:79]
    v_exp_f32 v241, v233
    v_mfma_f32_16x16x32_bf16 v[88:91], v[216:219], v[220:223], v[88:91]
    v_add_f32 v247, v247, v240
    v_add_f32 v255, v255, v241
    s_waitcnt lgkmcnt(0)
    v_mfma_f32_16x16x32_bf16 v[220:223], v[156:159], v[96:99], v[144:147]
    v_exp_f32 v242, v234
    v_mfma_f32_16x16x32_bf16 v[224:227], v[160:163], v[96:99], v[144:147]
    v_exp_f32 v243, v235
    v_mfma_f32_16x16x32_bf16 v[220:223], v[164:167], v[108:111], v[220:223]
    v_add_f32 v247, v247, v242
    v_add_f32 v255, v255, v243
    v_mfma_f32_16x16x32_bf16 v[224:227], v[168:171], v[108:111], v[224:227]
    v_add_f32 v247, v247, v255
    v_cmp_lt_f32 vcc, s54, v247
    v_mfma_f32_16x16x32_bf16 v[220:223], v[172:175], v[120:123], v[220:223]
    v_mfma_f32_16x16x32_bf16 v[224:227], v[176:179], v[120:123], v[224:227]
    s_cbranch_vccnz L_fix2_1
L_ret2_13:
    v_cvt_pk_bf16_f32 v228, v236, v237
    v_cvt_pk_bf16_f32 v229, v238, v239
    v_mfma_f32_16x16x32_bf16 v[220:223], v[180:183], v[132:135], v[220:223]
    v_cvt_pk_bf16_f32 v230, v240, v241
    v_cvt_pk_bf16_f32 v231, v242, v243
    v_mfma_f32_16x16x32_bf16 v[224:227], v[184:187], v[132:135], v[224:227]
    v_add_f32 v246, v246, v247
    s_waitcnt lgkmcnt(0)
    s_barrier
    v_mfma_f32_16x16x32_bf16 v[8:11], v[188:191], v[228:231], v[8:11]
    s_mov_b32 s57, 14
    ds_read_b64_tr_b16 v[188:189], v250 offset:32768
    v_exp_f32 v236, v220
    v_mfma_f32_16x16x32_bf16 v[20:23], v[192:195], v[228:231], v[20:23]
    ds_read_b64_tr_b16 v[192:193], v251 offset:32768
    v_exp_f32 v237, v221
    v_mfma_f32_16x16x32_bf16 v[32:35], v[196:199], v[228:231], v[32:35]
    ds_read_b64_tr_b16 v[196:197], v252 offset:32768
    v_exp_f32 v238, v222
    v_mfma_f32_16x16x32_bf16 v[44:47], v[200:203], v[228:231], v[44:47]
    ds_read_b64_tr_b16 v[200:201], v253 offset:32768
    v_exp_f32 v239, v223
    v_mfma_f32_16x16x32_bf16 v[56:59], v[204:207], v[228:231], v[56:59]
    ds_read_b64_tr_b16 v[204:205], v250 offset:36864
    v_add_f32 v247, v236, v237
    v_add_f32 v255, v238, v239
    v_mfma_f32_16x16x32_bf16 v[68:71], v[208:211], v[228:231], v[68:71]
    ds_read_b64_tr_b16 v[208:209], v251 offset:36864
    v_exp_f32 v240, v224
    v_mfma_f32_16x16x32_bf16 v[80:83], v[212:215], v[228:231], v[80:83]
    ds_read_b64_tr_b16 v[212:213], v252 offset:36864
    v_exp_f32 v241, v225
    v_mfma_f32_16x16x32_bf16 v[92:95], v[216:219], v[228:231], v[92:95]
    ds_read_b64_tr_b16 v[216:217], v253 offset:36864
    v_add_f32 v247, v247, v240
    v_add_f32 v255, v255, v241
    v_mfma_f32_16x16x32_bf16 v[228:231], v[156:159], v[100:103], v[148:151]
    ds_read_b64_tr_b16 v[190:191], v250 offset:34816
    v_exp_f32 v242, v226
    v_mfma_f32_16x16x32_bf16 v[232:235], v[160:163], v[100:103], v[148:151]
    ds_read_b64_tr_b16 v[194:195], v251 offset:34816
    v_exp_f32 v243, v227
    v_mfma_f32_16x16x32_bf16 v[228:231], v[164:167], v[112:115], v[228:231]
    ds_read_b64_tr_b16 v[198:199], v252 offset:34816
    v_add_f32 v247, v247, v242
    v_add_f32 v255, v255, v243
    v_mfma_f32_16x16x32_bf16 v[232:235], v[168:171], v[112:115], v[232:235]
    ds_read_b64_tr_b16 v[202:203], v253 offset:34816
    v_add_f32 v247, v247, v255
    v_cmp_lt_f32 vcc, s54, v247
    v_mfma_f32_16x16x32_bf16 v[228:231], v[172:175], v[124:127], v[228:231]
    ds_read_b64_tr_b16 v[206:207], v250 offset:38912
    v_mfma_f32_16x16x32_bf16 v[232:235], v[176:179], v[124:127], v[232:235]
    ds_read_b64_tr_b16 v[210:211], v251 offset:38912
    s_cbranch_vccnz L_fix0_0
L_ret0_14:
    v_cvt_pk_bf16_f32 v220, v236, v237
    v_cvt_pk_bf16_f32 v221, v238, v239
    v_mfma_f32_16x16x32_bf16 v[228:231], v[180:183], v[136:139], v[228:231]
    ds_read_b64_tr_b16 v[214:215], v252 offset:38912
    v_cvt_pk_bf16_f32 v222, v240, v241
    v_cvt_pk_bf16_f32 v223, v242, v243
    v_mfma_f32_16x16x32_bf16 v[232:235], v[184:187], v[136:139], v[232:235]
    ds_read_b64_tr_b16 v[218:219], v253 offset:38912
    v_add_f32 v244, v244, v247
    s_waitcnt lgkmcnt(4)
    v_mfma_f32_16x16x32_bf16 v[0:3], v[188:191], v[220:223], v[0:3]
    v_exp_f32 v236, v228
    v_mfma_f32_16x16x32_bf16 v[12:15], v[192:195], v[220:223], v[12:15]
    v_exp_f32 v237, v229
    v_mfma_f32_16x16x32_bf16 v[24:27], v[196:199], v[220:223], v[24:27]
    v_exp_f32 v238, v230
    v_mfma_f32_16x16x32_bf16 v[36:39], v[200:203], v[220:223], v[36:39]
    v_exp_f32 v239, v231
    s_waitcnt lgkmcnt(0)
    v_mfma_f32_16x16x32_bf16 v[48:51], v[204:207], v[220:223], v[48:51]
    v_add_f32 v247, v236, v237
    v_add_f32 v255, v238, v239
    v_mfma_f32_16x16x32_bf16 v[60:63], v[208:211], v[220:223], v[60:63]
    v_exp_f32 v240, v232
    v_mfma_f32_16x16x32_bf16 v[72:75], v[212:215], v[220:223], v[72:75]
    v_exp_f32 v241, v233
    v_mfma_f32_16x16x32_bf16 v[84:87], v[216:219], v[220:223], v[84:87]
    v_add_f32 v247, v247, v240
    v_add_f32 v255, v255, v241
    v_mfma_f32_16x16x32_bf16 v[220:223], v[156:159], v[104:107], v[152:155]
    ds_read_b128 v[156:159], v248 offset:40960
    v_exp_f32 v242, v234
    v_mfma_f32_16x16x32_bf16 v[224:227], v[160:163], v[104:107], v[152:155]
    ds_read_b128 v[160:163], v248 offset:43008
    v_exp_f32 v243, v235
    v_mfma_f32_16x16x32_bf16 v[220:223], v[164:167], v[116:119], v[220:223]
    ds_read_b128 v[164:167], v249 offset:40960
    v_add_f32 v247, v247, v242
    v_add_f32 v255, v255, v243
    v_mfma_f32_16x16x32_bf16 v[224:227], v[168:171], v[116:119], v[224:227]
    ds_read_b128 v[168:171], v249 offset:43008
    v_add_f32 v247, v247, v255
    v_cmp_lt_f32 vcc, s54, v247
    v_mfma_f32_16x16x32_bf16 v[220:223], v[172:175], v[128:131], v[220:223]
    ds_read_b128 v[172:175], v248 offset:45056
    v_mfma_f32_16x16x32_bf16 v[224:227], v[176:179], v[128:131], v[224:227]
    ds_read_b128 v[176:179], v248 offset:47104
    s_cbranch_vccnz L_fix1_1
L_ret1_14:
    v_cvt_pk_bf16_f32 v228, v236, v237
    v_cvt_pk_bf16_f32 v229, v238, v239
    v_mfma_f32_16x16x32_bf16 v[220:223], v[180:183], v[140:143], v[220:223]
    ds_read_b128 v[180:183], v249 offset:45056
    v_cvt_pk_bf16_f32 v230, v240, v241
    v_cvt_pk_bf16_f32 v231, v242, v243
    v_mfma_f32_16x16x32_bf16 v[224:227], v[184:187], v[140:143], v[224:227]
    ds_read_b128 v[184:187], v249 offset:47104
    v_add_f32 v245, v245, v247
    v_mfma_f32_16x16x32_bf16 v[4:7], v[188:191], v[228:231], v[4:7]
    s_nop 0
    v_exp_f32 v236, v220
    v_mfma_f32_16x16x32_bf16 v[16:19], v[192:195], v[228:231], v[16:19]
    v_exp_f32 v237, v221
    v_mfma_f32_16x16x32_bf16 v[28:31], v[196:199], v[228:231], v[28:31]
    v_exp_f32 v238, v222
    v_mfma_f32_16x16x32_bf16 v[40:43], v[200:203], v[228:231], v[40:43]
    v_exp_f32 v239, v223
    v_mfma_f32_16x16x32_bf16 v[52:55], v[204:207], v[228:231], v[52:55]
    v_add_f32 v247, v236, v237
    v_add_f32 v255, v238, v239
    v_mfma_f32_16x16x32_bf16 v[64:67], v[208:211], v[228:231], v[64:67]
    v_exp_f32 v240, v224
    v_mfma_f32_16x16x32_bf16 v[76:79], v[212:215], v[228:231], v[76:79]
    v_exp_f32 v241, v225
    v_mfma_f32_16x16x32_bf16 v[88:91], v[216:219], v[228:231], v[88:91]
    v_add_f32 v247, v247, v240
    v_add_f32 v255, v255, v241
    s_waitcnt lgkmcnt(0)
    v_mfma_f32_16x16x32_bf16 v[228:231], v[156:159], v[96:99], v[144:147]
    v_exp_f32 v242, v226
    v_mfma_f32_16x16x32_bf16 v[232:235], v[160:163], v[96:99], v[144:147]
    v_exp_f32 v243, v227
    v_mfma_f32_16x16x32_bf16 v[228:231], v[164:167], v[108:111], v[228:231]
    v_add_f32 v247, v247, v242
    v_add_f32 v255, v255, v243
    v_mfma_f32_16x16x32_bf16 v[232:235], v[168:171], v[108:111], v[232:235]
    v_add_f32 v247, v247, v255
    v_cmp_lt_f32 vcc, s54, v247
    v_mfma_f32_16x16x32_bf16 v[228:231], v[172:175], v[120:123], v[228:231]
    v_mfma_f32_16x16x32_bf16 v[232:235], v[176:179], v[120:123], v[232:235]
    s_cbranch_vccnz L_fix2_0
L_ret2_14:
    v_cvt_pk_bf16_f32 v220, v236, v237
    v_cvt_pk_bf16_f32 v221, v238, v239
    v_mfma_f32_16x16x32_bf16 v[228:231], v[180:183], v[132:135], v[228:231]
    v_cvt_pk_bf16_f32 v222, v240, v241
    v_cvt_pk_bf16_f32 v223, v242, v243
    v_mfma_f32_16x16x32_bf16 v[232:235], v[184:187], v[132:135], v[232:235]
    v_add_f32 v246, v246, v247
    s_waitcnt lgkmcnt(0)
    s_barrier
    v_mfma_f32_16x16x32_bf16 v[8:11], v[188:191], v[220:223], v[8:11]
    s_mov_b32 s57, 15
    ds_read_b64_tr_b16 v[188:189], v250 offset:49152
    v_exp_f32 v236, v228
    v_mfma_f32_16x16x32_bf16 v[20:23], v[192:195], v[220:223], v[20:23]
    ds_read_b64_tr_b16 v[192:193], v251 offset:49152
    v_exp_f32 v237, v229
    v_mfma_f32_16x16x32_bf16 v[32:35], v[196:199], v[220:223], v[32:35]
    ds_read_b64_tr_b16 v[196:197], v252 offset:49152
    v_exp_f32 v238, v230
    v_mfma_f32_16x16x32_bf16 v[44:47], v[200:203], v[220:223], v[44:47]
    ds_read_b64_tr_b16 v[200:201], v253 offset:49152
    v_exp_f32 v239, v231
    v_mfma_f32_16x16x32_bf16 v[56:59], v[204:207], v[220:223], v[56:59]
    ds_read_b64_tr_b16 v[204:205], v250 offset:53248
    v_add_f32 v247, v236, v237
    v_add_f32 v255, v238, v239
    v_mfma_f32_16x16x32_bf16 v[68:71], v[208:211], v[220:223], v[68:71]
    ds_read_b64_tr_b16 v[208:209], v251 offset:53248
    v_exp_f32 v240, v232
    v_mfma_f32_16x16x32_bf16 v[80:83], v[212:215], v[220:223], v[80:83]
    ds_read_b64_tr_b16 v[212:213], v252 offset:53248
    v_exp_f32 v241, v233
    v_mfma_f32_16x16x32_bf16 v[92:95], v[216:219], v[220:223], v[92:95]
    ds_read_b64_tr_b16 v[216:217], v253 offset:53248
    v_add_f32 v247, v247, v240
    v_add_f32 v255, v255, v241
    v_mfma_f32_16x16x32_bf16 v[220:223], v[156:159], v[100:103], v[148:151]
    ds_read_b64_tr_b16 v[190:191], v250 offset:51200
    v_exp_f32 v242, v234
    v_mfma_f32_16x16x32_bf16 v[224:227], v[160:163], v[100:103], v[148:151]
    ds_read_b64_tr_b16 v[194:195], v251 offset:51200
    v_exp_f32 v243, v235
    v_mfma_f32_16x16x32_bf16 v[220:223], v[164:167], v[112:115], v[220:223]
    ds_read_b64_tr_b16 v[198:199], v252 offset:51200
    v_add_f32 v247, v247, v242
    v_add_f32 v255, v255, v243
    v_mfma_f32_16x16x32_bf16 v[224:227], v[168:171], v[112:115], v[224:227]
    ds_read_b64_tr_b16 v[202:203], v253 offset:51200
    v_add_f32 v247, v247, v255
    v_cmp_lt_f32 vcc, s54, v247
    v_mfma_f32_16x16x32_bf16 v[220:223], v[172:175], v[124:127], v[220:223]
    ds_read_b64_tr_b16 v[206:207], v250 offset:55296
    v_mfma_f32_16x16x32_bf16 v[224:227], v[176:179], v[124:127], v[224:227]
    ds_read_b64_tr_b16 v[210:211], v251 offset:55296
    s_cbranch_vccnz L_fix0_1
L_ret0_15:
    v_cvt_pk_bf16_f32 v228, v236, v237
    v_cvt_pk_bf16_f32 v229, v238, v239
    v_mfma_f32_16x16x32_bf16 v[220:223], v[180:183], v[136:139], v[220:223]
    ds_read_b64_tr_b16 v[214:215], v252 offset:55296
    v_cvt_pk_bf16_f32 v230, v240, v241
    v_cvt_pk_bf16_f32 v231, v242, v243
    v_mfma_f32_16x16x32_bf16 v[224:227], v[184:187], v[136:139], v[224:227]
    ds_read_b64_tr_b16 v[218:219], v253 offset:55296
    v_add_f32 v244, v244, v247
    s_waitcnt lgkmcnt(4)
    v_mfma_f32_16x16x32_bf16 v[0:3], v[188:191], v[228:231], v[0:3]
    v_exp_f32 v236, v220
    v_mfma_f32_16x16x32_bf16 v[12:15], v[192:195], v[228:231], v[12:15]
    v_exp_f32 v237, v221
    v_mfma_f32_16x16x32_bf16 v[24:27], v[196:199], v[228:231], v[24:27]
    v_exp_f32 v238, v222
    v_mfma_f32_16x16x32_bf16 v[36:39], v[200:203], v[228:231], v[36:39]
    v_exp_f32 v239, v223
    s_waitcnt lgkmcnt(0)
    v_mfma_f32_16x16x32_bf16 v[48:51], v[204:207], v[228:231], v[48:51]
    v_add_f32 v247, v236, v237
    v_add_f32 v255, v238, v239
    v_mfma_f32_16x16x32_bf16 v[60:63], v[208:211], v[228:231], v[60:63]
    v_exp_f32 v240, v224
    v_mfma_f32_16x16x32_bf16 v[72:75], v[212:215], v[228:231], v[72:75]
    v_exp_f32 v241, v225
    v_mfma_f32_16x16x32_bf16 v[84:87], v[216:219], v[228:231], v[84:87]
    v_add_f32 v247, v247, v240
    v_add_f32 v255, v255, v241
    v_mfma_f32_16x16x32_bf16 v[228:231], v[156:159], v[104:107], v[152:155]
    v_exp_f32 v242, v226
    v_mfma_f32_16x16x32_bf16 v[232:235], v[160:163], v[104:107], v[152:155]
    v_exp_f32 v243, v227
    v_mfma_f32_16x16x32_bf16 v[228:231], v[164:167], v[116:119], v[228:231]
    v_add_f32 v247, v247, v242
    v_add_f32 v255, v255, v243
    v_mfma_f32_16x16x32_bf16 v[232:235], v[168:171], v[116:119], v[232:235]
    v_add_f32 v247, v247, v255
    v_cmp_lt_f32 vcc, s54, v247
    v_mfma_f32_16x16x32_bf16 v[228:231], v[172:175], v[128:131], v[228:231]
    s_add_u32 s51, s73, 0
    buffer_load_dword v254, s[24:27], s51 offen lds
    v_mfma_f32_16x16x32_bf16 v[232:235], v[176:179], v[128:131], v[232:235]
    s_mov_b64 exec, 0xff
    s_add_u32 s51, s73, 8192
    buffer_load_dword v254, s[24:27], s51 offen lds
    s_mov_b64 exec, -1
    s_cbranch_vccnz L_fix1_0
L_ret1_15:
    v_cvt_pk_bf16_f32 v220, v236, v237
    v_cvt_pk_bf16_f32 v221, v238, v239
    v_mfma_f32_16x16x32_bf16 v[228:231], v[180:183], v[140:143], v[228:231]
    v_cvt_pk_bf16_f32 v222, v240, v241
    v_cvt_pk_bf16_f32 v223, v242, v243
    v_mfma_f32_16x16x32_bf16 v[232:235], v[184:187], v[140:143], v[232:235]
    v_add_f32 v245, v245, v247
    v_mfma_f32_16x16x32_bf16 v[4:7], v[188:191], v[220:223], v[4:7]
    s_nop 2
    v_exp_f32 v236, v228
    v_mfma_f32_16x16x32_bf16 v[16:19], v[192:195], v[220:223], v[16:19]
    v_exp_f32 v237, v229
    v_mfma_f32_16x16x32_bf16 v[28:31], v[196:199], v[220:223], v[28:31]
    v_exp_f32 v238, v230
    v_mfma_f32_16x16x32_bf16 v[40:43], v[200:203], v[220:223], v[40:43]
    v_exp_f32 v239, v231
    v_mfma_f32_16x16x32_bf16 v[52:55], v[204:207], v[220:223], v[52:55]
    v_add_f32 v247, v236, v237
    v_add_f32 v255, v238, v239
    v_mfma_f32_16x16x32_bf16 v[64:67], v[208:211], v[220:223], v[64:67]
    v_exp_f32 v240, v232
    v_mfma_f32_16x16x32_bf16 v[76:79], v[212:215], v[220:223], v[76:79]
    v_exp_f32 v241, v233
    v_mfma_f32_16x16x32_bf16 v[88:91], v[216:219], v[220:223], v[88:91]
    v_add_f32 v247, v247, v240
    v_add_f32 v255, v255, v241
    v_exp_f32 v242, v234
    v_exp_f32 v243, v235
    v_add_f32 v247, v247, v242
    v_add_f32 v255, v255, v243
    v_add_f32 v247, v247, v255
    v_cmp_lt_f32 vcc, s54, v247
    s_cbranch_vccnz L_fix2_1
L_ret2_15:
    v_cvt_pk_bf16_f32 v228, v236, v237
    v_cvt_pk_bf16_f32 v229, v238, v239
    v_cvt_pk_bf16_f32 v230, v240, v241
    v_cvt_pk_bf16_f32 v231, v242, v243
    v_add_f32 v246, v246, v247
    s_waitcnt lgkmcnt(0)
    s_barrier
    v_lshrrev_b32 v243, 3, v254
    v_add_u32 v243, s60, v243
    s_cmp_lg_u32 s45, 0
    s_cbranch_scc1 L_noq1
    ds_read_b128 v[96:99], v243 offset:0
    ds_read_b128 v[100:103], v243 offset:1024
    ds_read_b128 v[104:107], v243 offset:2048
    ds_read_b128 v[108:111], v243 offset:6144
    ds_read_b128 v[112:115], v243 offset:7168
    ds_read_b128 v[116:119], v243 offset:8192
    ds_read_b128 v[120:123], v243 offset:12288
    ds_read_b128 v[124:127], v243 offset:13312
    ds_read_b128 v[128:131], v243 offset:14336
    ds_read_b128 v[132:135], v243 offset:18432
    ds_read_b128 v[136:139], v243 offset:19456
    ds_read_b128 v[140:143], v243 offset:20480
    s_waitcnt lgkmcnt(0)
L_noq1:
    v_mfma_f32_16x16x32_bf16 v[8:11], v[188:191], v[228:231], v[8:11]
    v_mov_b32 v239, v244
    s_nop 1
    v_permlane32_swap_b32 v244, v239
    v_add_f32 v244, v244, v239
    v_mfma_f32_16x16x32_bf16 v[20:23], v[192:195], v[228:231], v[20:23]
    v_mov_b32 v239, v244
    s_nop 1
    v_permlane16_swap_b32 v244, v239
    v_add_f32 v244, v244, v239
    v_mfma_f32_16x16x32_bf16 v[32:35], v[196:199], v[228:231], v[32:35]
    v_mov_b32 v240, v245
    s_nop 1
    v_permlane32_swap_b32 v245, v240
    v_add_f32 v245, v245, v240
    v_mfma_f32_16x16x32_bf16 v[44:47], v[200:203], v[228:231], v[44:47]
    v_mov_b32 v240, v245
    s_nop 1
    v_permlane16_swap_b32 v245, v240
    v_mfma_f32_16x16x32_bf16 v[56:59], v[204:207], v[228:231], v[56:59]
    v_add_f32 v245, v245, v240
    v_mov_b32 v241, v246
    s_nop 1
    v_permlane32_swap_b32 v246, v241
    v_mfma_f32_16x16x32_bf16 v[68:71], v[208:211], v[228:231], v[68:71]
    v_add_f32 v246, v246, v241
    v_mov_b32 v241, v246
    s_nop 1
    v_permlane16_swap_b32 v246, v241
    v_mfma_f32_16x16x32_bf16 v[80:83], v[212:215], v[228:231], v[80:83]
    v_add_f32 v246, v246, v241
    v_rcp_f32 v236, v244
    v_rcp_f32 v237, v245
    v_mfma_f32_16x16x32_bf16 v[92:95], v[216:219], v[228:231], v[92:95]
    v_rcp_f32 v238, v246
    v_mul_f32 v0, v0, v236
    v_mul_f32 v1, v1, v236
    v_mul_f32 v2, v2, v236
    v_mul_f32 v3, v3, v236
    v_mul_f32 v12, v12, v236
    v_mul_f32 v13, v13, v236
    v_mul_f32 v14, v14, v236
    v_mul_f32 v15, v15, v236
    v_cvt_pk_bf16_f32 v156, v0, v1
    v_cvt_pk_bf16_f32 v157, v2, v3
    v_cvt_pk_bf16_f32 v158, v12, v13
    v_cvt_pk_bf16_f32 v159, v14, v15
    ds_write_b128 v243, v[156:159] offset:0
    v_mul_f32 v24, v24, v236
    v_mul_f32 v25, v25, v236
    v_mul_f32 v26, v26, v236
    v_mul_f32 v27, v27, v236
    v_mul_f32 v36, v36, v236
    v_mul_f32 v37, v37, v236
    v_mul_f32 v38, v38, v236
    v_mul_f32 v39, v39, v236
    v_cvt_pk_bf16_f32 v160, v24, v25
    v_cvt_pk_bf16_f32 v161, v26, v27
    v_cvt_pk_bf16_f32 v162, v36, v37
    v_cvt_pk_bf16_f32 v163, v38, v39
    ds_write_b128 v243, v[160:163] offset:6144
    v_mul_f32 v48, v48, v236
    v_mul_f32 v49, v49, v236
    v_mul_f32 v50, v50, v236
    v_mul_f32 v51, v51, v236
    v_mul_f32 v60, v60, v236
    v_mul_f32 v61, v61, v236
    v_mul_f32 v62, v62, v236
    v_mul_f32 v63, v63, v236
    v_cvt_pk_bf16_f32 v164, v48, v49
    v_cvt_pk_bf16_f32 v165, v50, v51
    v_cvt_pk_bf16_f32 v166, v60, v61
    v_cvt_pk_bf16_f32 v167, v62, v63
    ds_write_b128 v243, v[164:167] offset:12288
    v_mul_f32 v72, v72, v236
    v_mul_f32 v73, v73, v236
    v_mul_f32 v74, v74, v236
    v_mul_f32 v75, v75, v236
    v_mul_f32 v84, v84, v236
    v_mul_f32 v85, v85, v236
    v_mul_f32 v86, v86, v236
    v_mul_f32 v87, v87, v236
    v_cvt_pk_bf16_f32 v144, v72, v73
    v_cvt_pk_bf16_f32 v145, v74, v75
    v_cvt_pk_bf16_f32 v146, v84, v85
    v_cvt_pk_bf16_f32 v147, v86, v87
    v_mul_f32 v4, v4, v237
    v_mul_f32 v5, v5, v237
    v_mul_f32 v6, v6, v237
    v_mul_f32 v7, v7, v237
    v_mul_f32 v16, v16, v237
    v_mul_f32 v17, v17, v237
    v_mul_f32 v18, v18, v237
    v_mul_f32 v19, v19, v237
    v_cvt_pk_bf16_f32 v168, v4, v5
    v_cvt_pk_bf16_f32 v169, v6, v7
    v_cvt_pk_bf16_f32 v170, v16, v17
    v_cvt_pk_bf16_f32 v171, v18, v19
    ds_write_b128 v243, v[168:171] offset:1024
    v_mul_f32 v28, v28, v237
    v_mul_f32 v29, v29, v237
    v_mul_f32 v30, v30, v237
    v_mul_f32 v31, v31, v237
    v_mul_f32 v40, v40, v237
    v_mul_f32 v41, v41, v237
    v_mul_f32 v42, v42, v237
    v_mul_f32 v43, v43, v237
    v_cvt_pk_bf16_f32 v172, v28, v29
    v_cvt_pk_bf16_f32 v173, v30, v31
    v_cvt_pk_bf16_f32 v174, v40, v41
    v_cvt_pk_bf16_f32 v175, v42, v43
    ds_write_b128 v243, v[172:175] offset:7168
    v_mul_f32 v52, v52, v237
    v_mul_f32 v53, v53, v237
    v_mul_f32 v54, v54, v237
    v_mul_f32 v55, v55, v237
    v_mul_f32 v64, v64, v237
    v_mul_f32 v65, v65, v237
    v_mul_f32 v66, v66, v237
    v_mul_f32 v67, v67, v237
    v_cvt_pk_bf16_f32 v176, v52, v53
    v_cvt_pk_bf16_f32 v177, v54, v55
    v_cvt_pk_bf16_f32 v178, v64, v65
    v_cvt_pk_bf16_f32 v179, v66, v67
    ds_write_b128 v243, v[176:179] offset:13312
    v_mul_f32 v76, v76, v237
    v_mul_f32 v77, v77, v237
    v_mul_f32 v78, v78, v237
    v_mul_f32 v79, v79, v237
    v_mul_f32 v88, v88, v237
    v_mul_f32 v89, v89, v237
    v_mul_f32 v90, v90, v237
    v_mul_f32 v91, v91, v237
    v_cvt_pk_bf16_f32 v148, v76, v77
    v_cvt_pk_bf16_f32 v149, v78, v79
    v_cvt_pk_bf16_f32 v150, v88, v89
    v_cvt_pk_bf16_f32 v151, v90, v91
    v_mul_f32 v8, v8, v238
    v_mul_f32 v9, v9, v238
    v_mul_f32 v10, v10, v238
    v_mul_f32 v11, v11, v238
    v_mul_f32 v20, v20, v238
    v_mul_f32 v21, v21, v238
    v_mul_f32 v22, v22, v238
    v_mul_f32 v23, v23, v238
    v_cvt_pk_bf16_f32 v180, v8, v9
    v_cvt_pk_bf16_f32 v181, v10, v11
    v_cvt_pk_bf16_f32 v182, v20, v21
    v_cvt_pk_bf16_f32 v183, v22, v23
    ds_write_b128 v243, v[180:183] offset:2048
    v_mul_f32 v32, v32, v238
    v_mul_f32 v33, v33, v238
    v_mul_f32 v34, v34, v238
    v_mul_f32 v35, v35, v238
    v_mul_f32 v44, v44, v238
    v_mul_f32 v45, v45, v238
    v_mul_f32 v46, v46, v238
    v_mul_f32 v47, v47, v238
    v_cvt_pk_bf16_f32 v184, v32, v33
    v_cvt_pk_bf16_f32 v185, v34, v35
    v_cvt_pk_bf16_f32 v186, v44, v45
    v_cvt_pk_bf16_f32 v187, v46, v47
    ds_write_b128 v243, v[184:187] offset:8192
    v_mul_f32 v56, v56, v238
    v_mul_f32 v57, v57, v238
    v_mul_f32 v58, v58, v238
    v_mul_f32 v59, v59, v238
    v_mul_f32 v68, v68, v238
    v_mul_f32 v69, v69, v238
    v_mul_f32 v70, v70, v238
    v_mul_f32 v71, v71, v238
    v_cvt_pk_bf16_f32 v156, v56, v57
    v_cvt_pk_bf16_f32 v157, v58, v59
    v_cvt_pk_bf16_f32 v158, v68, v69
    v_cvt_pk_bf16_f32 v159, v70, v71
    ds_write_b128 v243, v[156:159] offset:14336
    v_mul_f32 v80, v80, v238
    v_mul_f32 v81, v81, v238
    v_mul_f32 v82, v82, v238
    v_mul_f32 v83, v83, v238
    v_mul_f32 v92, v92, v238
    v_mul_f32 v93, v93, v238
    v_mul_f32 v94, v94, v238
    v_mul_f32 v95, v95, v238
    v_cvt_pk_bf16_f32 v152, v80, v81
    v_cvt_pk_bf16_f32 v153, v82, v83
    v_cvt_pk_bf16_f32 v154, v92, v93
    v_cvt_pk_bf16_f32 v155, v94, v95
    s_add_u32 s47, s47, 512
    s_add_u32 s73, s73, 294912
    s_add_u32 s83, s83, 512
    s_add_u32 s93, s93, 294912
    s_add_u32 s45, s45, 1
    s_mov_b32 s46, s81
    s_add_u32 s81, s81, 131072
    s_cmp_eq_u32 s45, 3
    s_cselect_b32 s81, 0x7f000000, s81
    s_waitcnt lgkmcnt(0)
    s_cmp_eq_u32 s45, 1
    s_cbranch_scc1 L_PQ
    s_cmp_lt_u32 s45, 4
    s_cbranch_scc1 L_A_loop
    s_barrier
    ds_write_b128 v243, v[144:147] offset:18432
    ds_write_b128 v243, v[148:151] offset:19456
    ds_write_b128 v243, v[152:155] offset:20480
    s_setprio 0
    v_lshrrev_b32 v239, 10, v254
    v_bfe_u32 v240, v254, 7, 3
    v_and_b32 v241, 6, v239
    v_xor_b32 v241, v240, v241
    s_lshl_b32 s51, s44, 3
    v_add_u32 v239, s51, v239
    s_movk_i32 s51, 1152
    v_mul_lo_u32 v239, v239, s51
    v_lshl_add_u32 v241, v241, 4, v239
    s_lshl_b32 s51, s41, 2
    s_add_u32 s51, s51, 3
    s_mul_i32 s73, s51, 294912
    s_add_u32 s51, s41, 1
    s_and_b32 s51, s51, 3
    s_lshl_b32 s51, s51, 8
    s_add_u32 s64, s73, s51
    s_add_u32 s65, s64, 128
    s_add_u32 s51, s41, 2
    s_and_b32 s51, s51, 3
    s_lshl_b32 s51, s51, 8
    s_add_u32 s66, s73, s51
    s_add_u32 s67, s66, 128
    s_add_u32 s51, s41, 3
    s_and_b32 s51, s51, 3
    s_lshl_b32 s51, s51, 8
    s_add_u32 s68, s73, s51
    s_add_u32 s69, s68, 128
    s_add_u32 s51, s41, 4
    s_and_b32 s51, s51, 3
    s_lshl_b32 s51, s51, 8
    s_add_u32 s70, s73, s51
    s_add_u32 s71, s70, 128
    s_add_u32 s72, s73, 1024
    s_add_u32 m0, s50, 57344
    s_add_u32 s51, s72, 0
    buffer_load_dwordx4 v241, s[24:27], s51 offen lds
    s_add_u32 m0, s50, 61440
    s_add_u32 s51, s64, 0
    buffer_load_dwordx4 v241, s[24:27], s51 offen lds
    s_add_u32 m0, s50, 65536
    s_add_u32 s51, s65, 0
    buffer_load_dwordx4 v241, s[24:27], s51 offen lds
    s_add_u32 m0, s50, 69632
    s_add_u32 s51, s72, 147456
    buffer_load_dwordx4 v241, s[24:27], s51 offen lds
    s_add_u32 m0, s50, 73728
    s_add_u32 s51, s64, 147456
    buffer_load_dwordx4 v241, s[24:27], s51 offen lds
    s_add_u32 m0, s50, 77824
    s_add_u32 s51, s65, 147456
    buffer_load_dwordx4 v241, s[24:27], s51 offen lds
    s_add_u32 m0, s50, 81920
    s_add_u32 s51, s72, 36864
    buffer_load_dwordx4 v241, s[24:27], s51 offen lds
    s_add_u32 m0, s50, 86016
    s_add_u32 s51, s64, 36864
    buffer_load_dwordx4 v241, s[24:27], s51 offen lds
    s_add_u32 m0, s50, 90112
    s_add_u32 s51, s65, 36864
    buffer_load_dwordx4 v241, s[24:27], s51 offen lds
    s_add_u32 m0, s50, 94208
    s_add_u32 s51, s72, 184320
    buffer_load_dwordx4 v241, s[24:27], s51 offen lds
    s_add_u32 m0, s50, 98304
    s_add_u32 s51, s64, 184320
    buffer_load_dwordx4 v241, s[24:27], s51 offen lds
    s_add_u32 m0, s50, 102400
    s_add_u32 s51, s65, 184320
    buffer_load_dwordx4 v241, s[24:27], s51 offen lds
    v_lshrrev_b32 v236, 3, v254
    s_lshl_b32 s51, s59, 2
    s_add_u32 s51, s51, s41
    s_lshl_b32 s51, s51, 7
    s_lshl_b32 s52, s44, 2
    s_add_u32 s51, s51, s52
    s_add_u32 s81, s51, 26214400
    s_mul_i32 s52, s59, 393216
    s_mul_i32 s53, s44, 24576
    s_add_u32 s52, s52, s53
    s_add_u32 s51, s41, 1
    s_and_b32 s51, s51, 3
    s_mul_i32 s51, s51, 98304
    s_add_u32 s16, s52, s51
    s_add_u32 s12, s16, 15360
    s_add_u32 s51, s41, 2
    s_and_b32 s51, s51, 3
    s_mul_i32 s51, s51, 98304
    s_add_u32 s17, s52, s51
    s_add_u32 s13, s17, 6144
    s_add_u32 s51, s41, 3
    s_and_b32 s51, s51, 3
    s_mul_i32 s51, s51, 98304
    s_add_u32 s18, s52, s51
    s_add_u32 s14, s18, 0
    s_add_u32 s51, s41, 4
    s_and_b32 s51, s51, 3
    s_mul_i32 s51, s51, 98304
    s_add_u32 s19, s52, s51
    s_add_u32 s51, s41, 1
    s_and_b32 s51, s51, 3
    s_lshl_b32 s55, 1, s51
    s_add_u32 s51, s41, 2
    s_and_b32 s51, s51, 3
    s_lshl_b32 s54, 1, s51
    s_xor_b32 s56, s55, 0xf
    s_xor_b32 s56, s56, s54
    v_lshrrev_b32 v239, 4, v236
    v_and_b32 v237, 15, v239
    s_movk_i32 s51, 2304
    v_mul_lo_u32 v237, v237, s51
    v_lshrrev_b32 v239, 4, v239
    v_lshl_add_u32 v237, v239, 3, v237
    s_mul_i32 s52, s42, 221184
    s_mul_i32 s53, s40, 1152
    s_add_u32 s52, s52, s53
    s_lshl_b32 s53, s44, 5
    s_add_u32 s78, s52, s53
    s_lshl_b32 s53, s41, 8
    s_add_u32 s74, s78, s53
    s_mul_i32 s51, s44, 12288
    s_add_u32 s51, s51, 57344
    v_add_u32 v238, s51, v236
    s_waitcnt vmcnt(0)
    s_waitcnt lgkmcnt(0)
    s_barrier
    s_add_u32 m0, s50, 49152
    s_add_u32 s51, s72, 73728
    buffer_load_dwordx4 v241, s[24:27], s51 offen lds
    s_add_u32 m0, s50, 53248
    s_add_u32 s51, s64, 73728
    buffer_load_dwordx4 v241, s[24:27], s51 offen lds
    s_add_u32 m0, s50, 106496
    s_add_u32 s51, s65, 73728
    buffer_load_dwordx4 v241, s[24:27], s51 offen lds
    s_add_u32 m0, s50, 110592
    s_add_u32 s51, s72, 221184
    buffer_load_dwordx4 v241, s[24:27], s51 offen lds
    s_add_u32 m0, s50, 114688
    s_add_u32 s51, s64, 221184
    buffer_load_dwordx4 v241, s[24:27], s51 offen lds
    s_add_u32 m0, s50, 118784
    s_add_u32 s51, s65, 221184
    buffer_load_dwordx4 v241, s[24:27], s51 offen lds
    s_waitcnt vmcnt(0)
    s_barrier
    s_add_u32 m0, s50, 57344
    s_add_u32 s51, s72, 110592
    buffer_load_dwordx4 v241, s[24:27], s51 offen lds
    s_add_u32 m0, s50, 61440
    s_add_u32 s51, s64, 110592
    buffer_load_dwordx4 v241, s[24:27], s51 offen lds
    s_add_u32 m0, s50, 65536
    s_add_u32 s51, s65, 110592
    buffer_load_dwordx4 v241, s[24:27], s51 offen lds
    s_add_u32 m0, s50, 69632
    s_add_u32 s51, s72, 258048
    buffer_load_dwordx4 v241, s[24:27], s51 offen lds
    s_add_u32 m0, s50, 73728
    s_add_u32 s51, s64, 258048
    buffer_load_dwordx4 v241, s[24:27], s51 offen lds
    s_add_u32 m0, s50, 77824
    s_add_u32 s51, s65, 258048
    buffer_load_dwordx4 v241, s[24:27], s51 offen lds
    s_waitcnt vmcnt(0)
    s_barrier
    s_add_u32 m0, s50, 81920
    s_add_u32 s51, s66, 0
    buffer_load_dwordx4 v241, s[24:27], s51 offen lds
    s_add_u32 m0, s50, 86016
    s_add_u32 s51, s67, 0
    buffer_load_dwordx4 v241, s[24:27], s51 offen lds
    s_add_u32 m0, s50, 90112
    s_add_u32 s51, s66, 147456
    buffer_load_dwordx4 v241, s[24:27], s51 offen lds
    s_add_u32 m0, s50, 94208
    s_add_u32 s51, s67, 147456
    buffer_load_dwordx4 v241, s[24:27], s51 offen lds
    s_add_u32 m0, s50, 159744
    s_add_u32 s51, s70, 0
    buffer_load_dwordx4 v241, s[24:27], s51 offen lds
    s_add_u32 m0, s50, 155648
    s_add_u32 s51, s71, 0
    buffer_load_dwordx4 v241, s[24:27], s51 offen lds
    s_waitcnt vmcnt(2)
    s_barrier
    s_add_u32 m0, s50, 98304
    s_add_u32 s51, s66, 36864
    buffer_load_dwordx4 v241, s[24:27], s51 offen lds
    s_add_u32 m0, s50, 102400
    s_add_u32 s51, s67, 36864
    buffer_load_dwordx4 v241, s[24:27], s51 offen lds
    s_add_u32 m0, s50, 49152
    s_add_u32 s51, s66, 184320
    buffer_load_dwordx4 v241, s[24:27], s51 offen lds
    s_add_u32 m0, s50, 53248
    s_add_u32 s51, s67, 184320
    buffer_load_dwordx4 v241, s[24:27], s51 offen lds
    s_add_u32 m0, s50, 151552
    s_add_u32 s51, s70, 147456
    buffer_load_dwordx4 v241, s[24:27], s51 offen lds
    s_add_u32 m0, s50, 147456
    s_add_u32 s51, s71, 147456
    buffer_load_dwordx4 v241, s[24:27], s51 offen lds
    s_waitcnt vmcnt(2)
    s_barrier
    s_add_u32 m0, s50, 57344
    s_add_u32 s51, s66, 73728
    buffer_load_dwordx4 v241, s[24:27], s51 offen lds
    s_add_u32 m0, s50, 61440
    s_add_u32 s51, s67, 73728
    buffer_load_dwordx4 v241, s[24:27], s51 offen lds
    s_add_u32 m0, s50, 65536
    s_add_u32 s51, s66, 221184
    buffer_load_dwordx4 v241, s[24:27], s51 offen lds
    s_add_u32 m0, s50, 69632
    s_add_u32 s51, s67, 221184
    buffer_load_dwordx4 v241, s[24:27], s51 offen lds
    s_add_u32 m0, s50, 143360
    s_add_u32 s51, s70, 36864
    buffer_load_dwordx4 v241, s[24:27], s51 offen lds
    s_add_u32 m0, s50, 139264
    s_add_u32 s51, s71, 36864
    buffer_load_dwordx4 v241, s[24:27], s51 offen lds
    s_waitcnt vmcnt(2)
    s_barrier
    s_add_u32 m0, s50, 73728
    s_add_u32 s51, s66, 110592
    buffer_load_dwordx4 v241, s[24:27], s51 offen lds
    s_add_u32 m0, s50, 77824
    s_add_u32 s51, s67, 110592
    buffer_load_dwordx4 v241, s[24:27], s51 offen lds
    s_add_u32 m0, s50, 81920
    s_add_u32 s51, s66, 258048
    buffer_load_dwordx4 v241, s[24:27], s51 offen lds
    s_add_u32 m0, s50, 86016
    s_add_u32 s51, s67, 258048
    buffer_load_dwordx4 v241, s[24:27], s51 offen lds
    s_add_u32 m0, s50, 135168
    s_add_u32 s51, s70, 184320
    buffer_load_dwordx4 v241, s[24:27], s51 offen lds
    s_add_u32 m0, s50, 131072
    s_add_u32 s51, s71, 184320
    buffer_load_dwordx4 v241, s[24:27], s51 offen lds
    s_waitcnt vmcnt(2)
    s_barrier
    s_add_u32 m0, s50, 90112
    s_add_u32 s51, s68, 0
    buffer_load_dwordx4 v241, s[24:27], s51 offen lds
    s_add_u32 m0, s50, 94208
    s_add_u32 s51, s69, 0
    buffer_load_dwordx4 v241, s[24:27], s51 offen lds
    s_add_u32 m0, s50, 98304
    s_add_u32 s51, s68, 147456
    buffer_load_dwordx4 v241, s[24:27], s51 offen lds
    s_add_u32 m0, s50, 102400
    s_add_u32 s51, s69, 147456
    buffer_load_dwordx4 v241, s[24:27], s51 offen lds
    s_add_u32 m0, s50, 126976
    s_add_u32 s51, s70, 73728
    buffer_load_dwordx4 v241, s[24:27], s51 offen lds
    s_add_u32 m0, s50, 122880
    s_add_u32 s51, s71, 73728
    buffer_load_dwordx4 v241, s[24:27], s51 offen lds
    s_add_u32 m0, s50, 118784
    s_add_u32 s51, s70, 221184
    buffer_load_dwordx4 v241, s[24:27], s51 offen lds
    s_add_u32 m0, s50, 114688
    s_add_u32 s51, s71, 221184
    buffer_load_dwordx4 v241, s[24:27], s51 offen lds
    s_add_u32 m0, s50, 110592
    s_add_u32 s51, s70, 110592
    buffer_load_dwordx4 v241, s[24:27], s51 offen lds
    s_add_u32 m0, s50, 106496
    s_add_u32 s51, s71, 110592
    buffer_load_dwordx4 v241, s[24:27], s51 offen lds
    s_add_u32 m0, s50, 53248
    s_add_u32 s51, s70, 258048
    buffer_load_dwordx4 v241, s[24:27], s51 offen lds
    s_add_u32 m0, s50, 49152
    s_add_u32 s51, s71, 258048
    buffer_load_dwordx4 v241, s[24:27], s51 offen lds
    s_waitcnt vmcnt(8)
    s_barrier
    s_add_u32 m0, s50, 57344
    s_add_u32 s51, s68, 36864
    buffer_load_dwordx4 v241, s[24:27], s51 offen lds
    s_add_u32 m0, s50, 61440
    s_add_u32 s51, s69, 36864
    buffer_load_dwordx4 v241, s[24:27], s51 offen lds
    s_add_u32 m0, s50, 65536
    s_add_u32 s51, s68, 184320
    buffer_load_dwordx4 v241, s[24:27], s51 offen lds
    s_add_u32 m0, s50, 69632
    s_add_u32 s51, s69, 184320
    buffer_load_dwordx4 v241, s[24:27], s51 offen lds
    s_waitcnt vmcnt(0)
    s_barrier
    s_add_u32 m0, s50, 73728
    s_add_u32 s51, s68, 73728
    buffer_load_dwordx4 v241, s[24:27], s51 offen lds
    s_add_u32 m0, s50, 77824
    s_add_u32 s51, s69, 73728
    buffer_load_dwordx4 v241, s[24:27], s51 offen lds
    s_add_u32 m0, s50, 81920
    s_add_u32 s51, s68, 221184
    buffer_load_dwordx4 v241, s[24:27], s51 offen lds
    s_add_u32 m0, s50, 86016
    s_add_u32 s51, s69, 221184
    buffer_load_dwordx4 v241, s[24:27], s51 offen lds
    s_waitcnt vmcnt(0)
    s_barrier
    s_add_u32 m0, s50, 90112
    s_add_u32 s51, s68, 110592
    buffer_load_dwordx4 v241, s[24:27], s51 offen lds
    s_add_u32 m0, s50, 94208
    s_add_u32 s51, s69, 110592
    buffer_load_dwordx4 v241, s[24:27], s51 offen lds
    s_add_u32 m0, s50, 98304
    s_add_u32 s51, s68, 258048
    buffer_load_dwordx4 v241, s[24:27], s51 offen lds
    s_add_u32 m0, s50, 102400
    s_add_u32 s51, s69, 258048
    buffer_load_dwordx4 v241, s[24:27], s51 offen lds
    s_waitcnt vmcnt(0)
    s_barrier
    s_barrier
    s_barrier
    s_barrier
    s_mov_b32 s80, 0
    s_mov_b32 exec_lo, s56
    s_mov_b32 exec_hi, 0
L_polla2:
    buffer_load_dword v247, v236, s[32:35], s81 offen sc1
    s_waitcnt vmcnt(0)
    v_cmp_eq_u32 vcc, 0, v247
    s_nop 3
    s_cbranch_vccz L_polleda2
    s_sleep 2
    s_add_u32 s80, s80, 1
    s_cmp_lt_u32 s80, 4000000
    s_cbranch_scc1 L_polla2
L_polleda2:
    s_mov_b64 exec, -1
    s_add_u32 s51, s14, 3072
    buffer_load_dwordx4 v[92:95], v236, s[32:35], s51 offen sc1
    s_add_u32 s51, s14, 4096
    buffer_load_dwordx4 v[100:103], v236, s[32:35], s51 offen sc1
    s_add_u32 s51, s14, 5120
    buffer_load_dwordx4 v[108:111], v236, s[32:35], s51 offen sc1
    s_add_u32 s51, s14, 0
    buffer_load_dwordx4 v[68:71], v236, s[32:35], s51 offen sc1
    s_add_u32 s51, s14, 1024
    buffer_load_dwordx4 v[76:79], v236, s[32:35], s51 offen sc1
    s_add_u32 s51, s14, 2048
    buffer_load_dwordx4 v[84:87], v236, s[32:35], s51 offen sc1
    s_mov_b32 s80, 0
    s_mov_b32 exec_lo, s54
    s_mov_b32 exec_hi, 0
L_polla1:
    buffer_load_dword v247, v236, s[32:35], s81 offen sc1
    s_waitcnt vmcnt(0)
    v_cmp_eq_u32 vcc, 0, v247
    s_nop 3
    s_cbranch_vccz L_polleda1
    s_sleep 2
    s_add_u32 s80, s80, 1
    s_cmp_lt_u32 s80, 4000000
    s_cbranch_scc1 L_polla1
L_polleda1:
    s_mov_b64 exec, -1
    s_add_u32 s51, s13, 3072
    buffer_load_dwordx4 v[88:91], v236, s[32:35], s51 offen sc1
    s_add_u32 s51, s13, 4096
    buffer_load_dwordx4 v[96:99], v236, s[32:35], s51 offen sc1
    s_add_u32 s51, s13, 5120
    buffer_load_dwordx4 v[104:107], v236, s[32:35], s51 offen sc1
    s_add_u32 s51, s13, 0
    buffer_load_dwordx4 v[64:67], v236, s[32:35], s51 offen sc1
    s_add_u32 s51, s13, 1024
    buffer_load_dwordx4 v[72:75], v236, s[32:35], s51 offen sc1
    s_add_u32 s51, s13, 2048
    buffer_load_dwordx4 v[80:83], v236, s[32:35], s51 offen sc1
    s_waitcnt vmcnt(5)
    v_lshlrev_b32 v24, 16, v88
    v_and_b32 v25, 0xffff0000, v88
    v_lshlrev_b32 v26, 16, v89
    v_and_b32 v27, 0xffff0000, v89
    v_lshlrev_b32 v28, 16, v90
    v_and_b32 v29, 0xffff0000, v90
    v_lshlrev_b32 v30, 16, v91
    v_and_b32 v31, 0xffff0000, v91
    v_lshlrev_b32 v239, 16, v92
    v_and_b32 v240, 0xffff0000, v92
    v_add_f32 v24, v24, v239
    v_add_f32 v25, v25, v240
    v_lshlrev_b32 v239, 16, v93
    v_and_b32 v240, 0xffff0000, v93
    v_add_f32 v26, v26, v239
    v_add_f32 v27, v27, v240
    v_lshlrev_b32 v239, 16, v94
    v_and_b32 v240, 0xffff0000, v94
    v_add_f32 v28, v28, v239
    v_add_f32 v29, v29, v240
    v_lshlrev_b32 v239, 16, v95
    v_and_b32 v240, 0xffff0000, v95
    v_add_f32 v30, v30, v239
    v_add_f32 v31, v31, v240
    ds_write_b128 v238, v[24:27] offset:6144
    ds_write_b128 v238, v[28:31] offset:7168
    s_waitcnt vmcnt(4)
    v_lshlrev_b32 v32, 16, v96
    v_and_b32 v33, 0xffff0000, v96
    v_lshlrev_b32 v34, 16, v97
    v_and_b32 v35, 0xffff0000, v97
    v_lshlrev_b32 v36, 16, v98
    v_and_b32 v37, 0xffff0000, v98
    v_lshlrev_b32 v38, 16, v99
    v_and_b32 v39, 0xffff0000, v99
    v_lshlrev_b32 v239, 16, v100
    v_and_b32 v240, 0xffff0000, v100
    v_add_f32 v32, v32, v239
    v_add_f32 v33, v33, v240
    v_lshlrev_b32 v239, 16, v101
    v_and_b32 v240, 0xffff0000, v101
    v_add_f32 v34, v34, v239
    v_add_f32 v35, v35, v240
    v_lshlrev_b32 v239, 16, v102
    v_and_b32 v240, 0xffff0000, v102
    v_add_f32 v36, v36, v239
    v_add_f32 v37, v37, v240
    v_lshlrev_b32 v239, 16, v103
    v_and_b32 v240, 0xffff0000, v103
    v_add_f32 v38, v38, v239
    v_add_f32 v39, v39, v240
    ds_write_b128 v238, v[32:35] offset:8192
    ds_write_b128 v238, v[36:39] offset:9216
    s_waitcnt vmcnt(3)
    v_lshlrev_b32 v40, 16, v104
    v_and_b32 v41, 0xffff0000, v104
    v_lshlrev_b32 v42, 16, v105
    v_and_b32 v43, 0xffff0000, v105
    v_lshlrev_b32 v44, 16, v106
    v_and_b32 v45, 0xffff0000, v106
    v_lshlrev_b32 v46, 16, v107
    v_and_b32 v47, 0xffff0000, v107
    v_lshlrev_b32 v239, 16, v108
    v_and_b32 v240, 0xffff0000, v108
    v_add_f32 v40, v40, v239
    v_add_f32 v41, v41, v240
    v_lshlrev_b32 v239, 16, v109
    v_and_b32 v240, 0xffff0000, v109
    v_add_f32 v42, v42, v239
    v_add_f32 v43, v43, v240
    v_lshlrev_b32 v239, 16, v110
    v_and_b32 v240, 0xffff0000, v110
    v_add_f32 v44, v44, v239
    v_add_f32 v45, v45, v240
    v_lshlrev_b32 v239, 16, v111
    v_and_b32 v240, 0xffff0000, v111
    v_add_f32 v46, v46, v239
    v_add_f32 v47, v47, v240
    ds_write_b128 v238, v[40:43] offset:10240
    ds_write_b128 v238, v[44:47] offset:11264
    s_waitcnt lgkmcnt(0)
    s_barrier
    ds_read_b128 v[112:115], v238 offset:0
    ds_read_b128 v[116:119], v238 offset:1024
    ds_read_b128 v[120:123], v238 offset:2048
    ds_read_b128 v[124:127], v238 offset:3072
    ds_read_b128 v[128:131], v238 offset:4096
    ds_read_b128 v[132:135], v238 offset:5120
    s_waitcnt vmcnt(2)
    v_lshlrev_b32 v0, 16, v64
    v_and_b32 v1, 0xffff0000, v64
    v_lshlrev_b32 v2, 16, v65
    v_and_b32 v3, 0xffff0000, v65
    v_lshlrev_b32 v4, 16, v66
    v_and_b32 v5, 0xffff0000, v66
    v_lshlrev_b32 v6, 16, v67
    v_and_b32 v7, 0xffff0000, v67
    v_lshlrev_b32 v239, 16, v68
    v_and_b32 v240, 0xffff0000, v68
    v_add_f32 v0, v0, v239
    v_add_f32 v1, v1, v240
    v_lshlrev_b32 v239, 16, v69
    v_and_b32 v240, 0xffff0000, v69
    v_add_f32 v2, v2, v239
    v_add_f32 v3, v3, v240
    v_lshlrev_b32 v239, 16, v70
    v_and_b32 v240, 0xffff0000, v70
    v_add_f32 v4, v4, v239
    v_add_f32 v5, v5, v240
    v_lshlrev_b32 v239, 16, v71
    v_and_b32 v240, 0xffff0000, v71
    v_add_f32 v6, v6, v239
    v_add_f32 v7, v7, v240
    s_waitcnt vmcnt(1)
    v_lshlrev_b32 v8, 16, v72
    v_and_b32 v9, 0xffff0000, v72
    v_lshlrev_b32 v10, 16, v73
    v_and_b32 v11, 0xffff0000, v73
    v_lshlrev_b32 v12, 16, v74
    v_and_b32 v13, 0xffff0000, v74
    v_lshlrev_b32 v14, 16, v75
    v_and_b32 v15, 0xffff0000, v75
    v_lshlrev_b32 v239, 16, v76
    v_and_b32 v240, 0xffff0000, v76
    v_add_f32 v8, v8, v239
    v_add_f32 v9, v9, v240
    v_lshlrev_b32 v239, 16, v77
    v_and_b32 v240, 0xffff0000, v77
    v_add_f32 v10, v10, v239
    v_add_f32 v11, v11, v240
    v_lshlrev_b32 v239, 16, v78
    v_and_b32 v240, 0xffff0000, v78
    v_add_f32 v12, v12, v239
    v_add_f32 v13, v13, v240
    v_lshlrev_b32 v239, 16, v79
    v_and_b32 v240, 0xffff0000, v79
    v_add_f32 v14, v14, v239
    v_add_f32 v15, v15, v240
    s_waitcnt vmcnt(0)
    v_lshlrev_b32 v16, 16, v80
    v_and_b32 v17, 0xffff0000, v80
    v_lshlrev_b32 v18, 16, v81
    v_and_b32 v19, 0xffff0000, v81
    v_lshlrev_b32 v20, 16, v82
    v_and_b32 v21, 0xffff0000, v82
    v_lshlrev_b32 v22, 16, v83
    v_and_b32 v23, 0xffff0000, v83
    v_lshlrev_b32 v239, 16, v84
    v_and_b32 v240, 0xffff0000, v84
    v_add_f32 v16, v16, v239
    v_add_f32 v17, v17, v240
    v_lshlrev_b32 v239, 16, v85
    v_and_b32 v240, 0xffff0000, v85
    v_add_f32 v18, v18, v239
    v_add_f32 v19, v19, v240
    v_lshlrev_b32 v239, 16, v86
    v_and_b32 v240, 0xffff0000, v86
    v_add_f32 v20, v20, v239
    v_add_f32 v21, v21, v240
    v_lshlrev_b32 v239, 16, v87
    v_and_b32 v240, 0xffff0000, v87
    v_add_f32 v22, v22, v239
    v_add_f32 v23, v23, v240
    s_waitcnt lgkmcnt(5)
    v_add_f32 v0, v0, v112
    v_add_f32 v1, v1, v113
    v_add_f32 v2, v2, v114
    v_add_f32 v3, v3, v115
    s_waitcnt lgkmcnt(4)
    v_add_f32 v4, v4, v116
    v_add_f32 v5, v5, v117
    v_add_f32 v6, v6, v118
    v_add_f32 v7, v7, v119
    s_waitcnt lgkmcnt(3)
    v_add_f32 v8, v8, v120
    v_add_f32 v9, v9, v121
    v_add_f32 v10, v10, v122
    v_add_f32 v11, v11, v123
    s_waitcnt lgkmcnt(2)
    v_add_f32 v12, v12, v124
    v_add_f32 v13, v13, v125
    v_add_f32 v14, v14, v126
    v_add_f32 v15, v15, v127
    s_waitcnt lgkmcnt(1)
    v_add_f32 v16, v16, v128
    v_add_f32 v17, v17, v129
    v_add_f32 v18, v18, v130
    v_add_f32 v19, v19, v131
    s_waitcnt lgkmcnt(0)
    v_add_f32 v20, v20, v132
    v_add_f32 v21, v21, v133
    v_add_f32 v22, v22, v134
    v_add_f32 v23, v23, v135
    s_mov_b32 s80, 0
    s_mov_b32 exec_lo, s55
    s_mov_b32 exec_hi, 0
L_pollb:
    buffer_load_dword v247, v236, s[32:35], s81 offen sc1
    s_waitcnt vmcnt(0)
    v_cmp_eq_u32 vcc, 0, v247
    s_nop 3
    s_cbranch_vccz L_polledb
    s_sleep 2
    s_add_u32 s80, s80, 1
    s_cmp_lt_u32 s80, 4000000
    s_cbranch_scc1 L_pollb
L_polledb:
    s_mov_b64 exec, -1
    s_add_u32 s51, s12, 0
    buffer_load_dwordx4 v[64:67], v236, s[32:35], s51 offen sc1
    s_add_u32 s51, s12, 1024
    buffer_load_dwordx4 v[68:71], v236, s[32:35], s51 offen sc1
    s_add_u32 s51, s12, 2048
    buffer_load_dwordx4 v[72:75], v236, s[32:35], s51 offen sc1
    s_cmp_lg_u32 s44, s41
    s_cbranch_scc1 L_no8a
    s_add_u32 s51, s16, 12288
    buffer_load_dwordx4 v[136:139], v236, s[32:35], s51 offen sc1
    s_add_u32 s51, s17, 12288
    buffer_load_dwordx4 v[140:143], v236, s[32:35], s51 offen sc1
    s_add_u32 s51, s18, 12288
    buffer_load_dwordx4 v[144:147], v236, s[32:35], s51 offen sc1
    s_add_u32 s51, s19, 12288
    buffer_load_dwordx4 v[148:151], v236, s[32:35], s51 offen sc1
    s_add_u32 s51, s16, 13312
    buffer_load_dwordx4 v[152:155], v236, s[32:35], s51 offen sc1
    s_add_u32 s51, s17, 13312
    buffer_load_dwordx4 v[156:159], v236, s[32:35], s51 offen sc1
    s_add_u32 s51, s18, 13312
    buffer_load_dwordx4 v[160:163], v236, s[32:35], s51 offen sc1
    s_add_u32 s51, s19, 13312
    buffer_load_dwordx4 v[164:167], v236, s[32:35], s51 offen sc1
    s_add_u32 s51, s16, 14336
    buffer_load_dwordx4 v[168:171], v236, s[32:35], s51 offen sc1
    s_add_u32 s51, s17, 14336
    buffer_load_dwordx4 v[172:175], v236, s[32:35], s51 offen sc1
    s_add_u32 s51, s18, 14336
    buffer_load_dwordx4 v[176:179], v236, s[32:35], s51 offen sc1
    s_add_u32 s51, s19, 14336
    buffer_load_dwordx4 v[180:183], v236, s[32:35], s51 offen sc1
    s_waitcnt vmcnt(12)
L_no8a:
    s_cmp_eq_u32 s44, s41
    s_cbranch_scc1 L_no8b
    s_waitcnt vmcnt(0)
L_no8b:
    v_lshlrev_b32 v239, 16, v64
    v_and_b32 v240, 0xffff0000, v64
    v_add_f32 v0, v0, v239
    v_add_f32 v1, v1, v240
    v_lshlrev_b32 v239, 16, v65
    v_and_b32 v240, 0xffff0000, v65
    v_add_f32 v2, v2, v239
    v_add_f32 v3, v3, v240
    v_lshlrev_b32 v239, 16, v66
    v_and_b32 v240, 0xffff0000, v66
    v_add_f32 v4, v4, v239
    v_add_f32 v5, v5, v240
    v_lshlrev_b32 v239, 16, v67
    v_and_b32 v240, 0xffff0000, v67
    v_add_f32 v6, v6, v239
    v_add_f32 v7, v7, v240
    v_cvt_pk_bf16_f32 v0, v0, v1
    v_cvt_pk_bf16_f32 v1, v2, v3
    s_add_u32 s51, s74, 0
    buffer_store_dwordx2 v[0:1], v237, s[28:31], s51 offen
    v_cvt_pk_bf16_f32 v4, v4, v5
    v_cvt_pk_bf16_f32 v5, v6, v7
    s_add_u32 s51, s74, 36864
    buffer_store_dwordx2 v[4:5], v237, s[28:31], s51 offen
    v_lshlrev_b32 v239, 16, v68
    v_and_b32 v240, 0xffff0000, v68
    v_add_f32 v8, v8, v239
    v_add_f32 v9, v9, v240
    v_lshlrev_b32 v239, 16, v69
    v_and_b32 v240, 0xffff0000, v69
    v_add_f32 v10, v10, v239
    v_add_f32 v11, v11, v240
    v_lshlrev_b32 v239, 16, v70
    v_and_b32 v240, 0xffff0000, v70
    v_add_f32 v12, v12, v239
    v_add_f32 v13, v13, v240
    v_lshlrev_b32 v239, 16, v71
    v_and_b32 v240, 0xffff0000, v71
    v_add_f32 v14, v14, v239
    v_add_f32 v15, v15, v240
    v_cvt_pk_bf16_f32 v8, v8, v9
    v_cvt_pk_bf16_f32 v9, v10, v11
    s_add_u32 s51, s74, 73728
    buffer_store_dwordx2 v[8:9], v237, s[28:31], s51 offen
    v_cvt_pk_bf16_f32 v12, v12, v13
    v_cvt_pk_bf16_f32 v13, v14, v15
    s_add_u32 s51, s74, 110592
    buffer_store_dwordx2 v[12:13], v237, s[28:31], s51 offen
    v_lshlrev_b32 v239, 16, v72
    v_and_b32 v240, 0xffff0000, v72
    v_add_f32 v16, v16, v239
    v_add_f32 v17, v17, v240
    v_lshlrev_b32 v239, 16, v73
    v_and_b32 v240, 0xffff0000, v73
    v_add_f32 v18, v18, v239
    v_add_f32 v19, v19, v240
    v_lshlrev_b32 v239, 16, v74
    v_and_b32 v240, 0xffff0000, v74
    v_add_f32 v20, v20, v239
    v_add_f32 v21, v21, v240
    v_lshlrev_b32 v239, 16, v75
    v_and_b32 v240, 0xffff0000, v75
    v_add_f32 v22, v22, v239
    v_add_f32 v23, v23, v240
    v_cvt_pk_bf16_f32 v16, v16, v17
    v_cvt_pk_bf16_f32 v17, v18, v19
    s_add_u32 s51, s74, 147456
    buffer_store_dwordx2 v[16:17], v237, s[28:31], s51 offen
    v_cvt_pk_bf16_f32 v20, v20, v21
    v_cvt_pk_bf16_f32 v21, v22, v23
    s_add_u32 s51, s74, 184320
    buffer_store_dwordx2 v[20:21], v237, s[28:31], s51 offen
    s_cmp_lg_u32 s44, s41
    s_cbranch_scc1 L_no8
    s_waitcnt vmcnt(6)
    s_add_u32 s75, s78, 1024
    v_lshlrev_b32 v192, 16, v136
    v_and_b32 v193, 0xffff0000, v136
    v_lshlrev_b32 v194, 16, v137
    v_and_b32 v195, 0xffff0000, v137
    v_lshlrev_b32 v196, 16, v138
    v_and_b32 v197, 0xffff0000, v138
    v_lshlrev_b32 v198, 16, v139
    v_and_b32 v199, 0xffff0000, v139
    v_lshlrev_b32 v239, 16, v140
    v_and_b32 v240, 0xffff0000, v140
    v_add_f32 v192, v192, v239
    v_add_f32 v193, v193, v240
    v_lshlrev_b32 v239, 16, v141
    v_and_b32 v240, 0xffff0000, v141
    v_add_f32 v194, v194, v239
    v_add_f32 v195, v195, v240
    v_lshlrev_b32 v239, 16, v142
    v_and_b32 v240, 0xffff0000, v142
    v_add_f32 v196, v196, v239
    v_add_f32 v197, v197, v240
    v_lshlrev_b32 v239, 16, v143
    v_and_b32 v240, 0xffff0000, v143
    v_add_f32 v198, v198, v239
    v_add_f32 v199, v199, v240
    v_lshlrev_b32 v239, 16, v144
    v_and_b32 v240, 0xffff0000, v144
    v_add_f32 v192, v192, v239
    v_add_f32 v193, v193, v240
    v_lshlrev_b32 v239, 16, v145
    v_and_b32 v240, 0xffff0000, v145
    v_add_f32 v194, v194, v239
    v_add_f32 v195, v195, v240
    v_lshlrev_b32 v239, 16, v146
    v_and_b32 v240, 0xffff0000, v146
    v_add_f32 v196, v196, v239
    v_add_f32 v197, v197, v240
    v_lshlrev_b32 v239, 16, v147
    v_and_b32 v240, 0xffff0000, v147
    v_add_f32 v198, v198, v239
    v_add_f32 v199, v199, v240
    v_lshlrev_b32 v239, 16, v148
    v_and_b32 v240, 0xffff0000, v148
    v_add_f32 v192, v192, v239
    v_add_f32 v193, v193, v240
    v_lshlrev_b32 v239, 16, v149
    v_and_b32 v240, 0xffff0000, v149
    v_add_f32 v194, v194, v239
    v_add_f32 v195, v195, v240
    v_lshlrev_b32 v239, 16, v150
    v_and_b32 v240, 0xffff0000, v150
    v_add_f32 v196, v196, v239
    v_add_f32 v197, v197, v240
    v_lshlrev_b32 v239, 16, v151
    v_and_b32 v240, 0xffff0000, v151
    v_add_f32 v198, v198, v239
    v_add_f32 v199, v199, v240
    v_cvt_pk_bf16_f32 v192, v192, v193
    v_cvt_pk_bf16_f32 v193, v194, v195
    s_add_u32 s51, s75, 0
    buffer_store_dwordx2 v[192:193], v237, s[28:31], s51 offen
    v_cvt_pk_bf16_f32 v196, v196, v197
    v_cvt_pk_bf16_f32 v197, v198, v199
    s_add_u32 s51, s75, 36864
    buffer_store_dwordx2 v[196:197], v237, s[28:31], s51 offen
    v_lshlrev_b32 v200, 16, v152
    v_and_b32 v201, 0xffff0000, v152
    v_lshlrev_b32 v202, 16, v153
    v_and_b32 v203, 0xffff0000, v153
    v_lshlrev_b32 v204, 16, v154
    v_and_b32 v205, 0xffff0000, v154
    v_lshlrev_b32 v206, 16, v155
    v_and_b32 v207, 0xffff0000, v155
    v_lshlrev_b32 v239, 16, v156
    v_and_b32 v240, 0xffff0000, v156
    v_add_f32 v200, v200, v239
    v_add_f32 v201, v201, v240
    v_lshlrev_b32 v239, 16, v157
    v_and_b32 v240, 0xffff0000, v157
    v_add_f32 v202, v202, v239
    v_add_f32 v203, v203, v240
    v_lshlrev_b32 v239, 16, v158
    v_and_b32 v240, 0xffff0000, v158
    v_add_f32 v204, v204, v239
    v_add_f32 v205, v205, v240
    v_lshlrev_b32 v239, 16, v159
    v_and_b32 v240, 0xffff0000, v159
    v_add_f32 v206, v206, v239
    v_add_f32 v207, v207, v240
    v_lshlrev_b32 v239, 16, v160
    v_and_b32 v240, 0xffff0000, v160
    v_add_f32 v200, v200, v239
    v_add_f32 v201, v201, v240
    v_lshlrev_b32 v239, 16, v161
    v_and_b32 v240, 0xffff0000, v161
    v_add_f32 v202, v202, v239
    v_add_f32 v203, v203, v240
    v_lshlrev_b32 v239, 16, v162
    v_and_b32 v240, 0xffff0000, v162
    v_add_f32 v204, v204, v239
    v_add_f32 v205, v205, v240
    v_lshlrev_b32 v239, 16, v163
    v_and_b32 v240, 0xffff0000, v163
    v_add_f32 v206, v206, v239
    v_add_f32 v207, v207, v240
    v_lshlrev_b32 v239, 16, v164
    v_and_b32 v240, 0xffff0000, v164
    v_add_f32 v200, v200, v239
    v_add_f32 v201, v201, v240
    v_lshlrev_b32 v239, 16, v165
    v_and_b32 v240, 0xffff0000, v165
    v_add_f32 v202, v202, v239
    v_add_f32 v203, v203, v240
    v_lshlrev_b32 v239, 16, v166
    v_and_b32 v240, 0xffff0000, v166
    v_add_f32 v204, v204, v239
    v_add_f32 v205, v205, v240
    v_lshlrev_b32 v239, 16, v167
    v_and_b32 v240, 0xffff0000, v167
    v_add_f32 v206, v206, v239
    v_add_f32 v207, v207, v240
    v_cvt_pk_bf16_f32 v200, v200, v201
    v_cvt_pk_bf16_f32 v201, v202, v203
    s_add_u32 s51, s75, 73728
    buffer_store_dwordx2 v[200:201], v237, s[28:31], s51 offen
    v_cvt_pk_bf16_f32 v204, v204, v205
    v_cvt_pk_bf16_f32 v205, v206, v207
    s_add_u32 s51, s75, 110592
    buffer_store_dwordx2 v[204:205], v237, s[28:31], s51 offen
    v_lshlrev_b32 v208, 16, v168
    v_and_b32 v209, 0xffff0000, v168
    v_lshlrev_b32 v210, 16, v169
    v_and_b32 v211, 0xffff0000, v169
    v_lshlrev_b32 v212, 16, v170
    v_and_b32 v213, 0xffff0000, v170
    v_lshlrev_b32 v214, 16, v171
    v_and_b32 v215, 0xffff0000, v171
    v_lshlrev_b32 v239, 16, v172
    v_and_b32 v240, 0xffff0000, v172
    v_add_f32 v208, v208, v239
    v_add_f32 v209, v209, v240
    v_lshlrev_b32 v239, 16, v173
    v_and_b32 v240, 0xffff0000, v173
    v_add_f32 v210, v210, v239
    v_add_f32 v211, v211, v240
    v_lshlrev_b32 v239, 16, v174
    v_and_b32 v240, 0xffff0000, v174
    v_add_f32 v212, v212, v239
    v_add_f32 v213, v213, v240
    v_lshlrev_b32 v239, 16, v175
    v_and_b32 v240, 0xffff0000, v175
    v_add_f32 v214, v214, v239
    v_add_f32 v215, v215, v240
    v_lshlrev_b32 v239, 16, v176
    v_and_b32 v240, 0xffff0000, v176
    v_add_f32 v208, v208, v239
    v_add_f32 v209, v209, v240
    v_lshlrev_b32 v239, 16, v177
    v_and_b32 v240, 0xffff0000, v177
    v_add_f32 v210, v210, v239
    v_add_f32 v211, v211, v240
    v_lshlrev_b32 v239, 16, v178
    v_and_b32 v240, 0xffff0000, v178
    v_add_f32 v212, v212, v239
    v_add_f32 v213, v213, v240
    v_lshlrev_b32 v239, 16, v179
    v_and_b32 v240, 0xffff0000, v179
    v_add_f32 v214, v214, v239
    v_add_f32 v215, v215, v240
    v_lshlrev_b32 v239, 16, v180
    v_and_b32 v240, 0xffff0000, v180
    v_add_f32 v208, v208, v239
    v_add_f32 v209, v209, v240
    v_lshlrev_b32 v239, 16, v181
    v_and_b32 v240, 0xffff0000, v181
    v_add_f32 v210, v210, v239
    v_add_f32 v211, v211, v240
    v_lshlrev_b32 v239, 16, v182
    v_and_b32 v240, 0xffff0000, v182
    v_add_f32 v212, v212, v239
    v_add_f32 v213, v213, v240
    v_lshlrev_b32 v239, 16, v183
    v_and_b32 v240, 0xffff0000, v183
    v_add_f32 v214, v214, v239
    v_add_f32 v215, v215, v240
    v_cvt_pk_bf16_f32 v208, v208, v209
    v_cvt_pk_bf16_f32 v209, v210, v211
    s_add_u32 s51, s75, 147456
    buffer_store_dwordx2 v[208:209], v237, s[28:31], s51 offen
    v_cvt_pk_bf16_f32 v212, v212, v213
    v_cvt_pk_bf16_f32 v213, v214, v215
    s_add_u32 s51, s75, 184320
    buffer_store_dwordx2 v[212:213], v237, s[28:31], s51 offen
L_no8:
    s_endpgm
L_PQ:
    s_barrier
    ds_write_b128 v243, v[144:147] offset:18432
    ds_write_b128 v243, v[148:151] offset:19456
    ds_write_b128 v243, v[152:155] offset:20480
    v_add_u32 v236, 0x4000, v248
    v_add_u32 v237, 0x4000, v249
    ds_read_b128 v[156:159], v236 offset:49152
    ds_read_b128 v[160:163], v236 offset:51200
    ds_read_b128 v[164:167], v237 offset:49152
    ds_read_b128 v[168:171], v237 offset:51200
    ds_read_b128 v[172:175], v236 offset:53248
    ds_read_b128 v[176:179], v236 offset:55296
    ds_read_b128 v[180:183], v237 offset:53248
    ds_read_b128 v[184:187], v237 offset:55296
    s_waitcnt lgkmcnt(7)
    v_mfma_f32_16x16x32_bf16 v[220:223], v[156:159], v[96:99], 0
    s_waitcnt lgkmcnt(6)
    v_mfma_f32_16x16x32_bf16 v[224:227], v[160:163], v[96:99], 0
    s_waitcnt lgkmcnt(5)
    v_mfma_f32_16x16x32_bf16 v[220:223], v[164:167], v[108:111], v[220:223]
    s_waitcnt lgkmcnt(4)
    v_mfma_f32_16x16x32_bf16 v[224:227], v[168:171], v[108:111], v[224:227]
    s_waitcnt lgkmcnt(3)
    v_mfma_f32_16x16x32_bf16 v[220:223], v[172:175], v[120:123], v[220:223]
    s_waitcnt lgkmcnt(2)
    v_mfma_f32_16x16x32_bf16 v[224:227], v[176:179], v[120:123], v[224:227]
    s_waitcnt lgkmcnt(1)
    v_mfma_f32_16x16x32_bf16 v[220:223], v[180:183], v[132:135], v[220:223]
    s_waitcnt lgkmcnt(0)
    v_mfma_f32_16x16x32_bf16 v[224:227], v[184:187], v[132:135], v[224:227]
    s_waitcnt lgkmcnt(0)
    s_branch L_S0
L_fix0_0:
    s_nop 7
    s_nop 7
    v_max3_f32 v243, v220, v221, v222
    v_max3_f32 v247, v223, v224, v225
    v_max3_f32 v243, v243, v226, v227
    v_max_f32 v243, v243, v247
    v_mov_b32 v247, v243
    s_nop 1
    v_permlane32_swap_b32 v243, v247
    v_max_f32 v243, v243, v247
    v_mov_b32 v247, v243
    s_nop 1
    v_permlane16_swap_b32 v243, v247
    v_max_f32 v243, v243, v247
    v_max_f32 v243, 0, v243
    v_sub_f32 v247, 0, v243
    v_exp_f32 v247, v247
    v_sub_f32 v144, v144, v243
    v_sub_f32 v145, v145, v243
    v_sub_f32 v146, v146, v243
    v_sub_f32 v147, v147, v243
    v_sub_f32 v236, v220, v243
    v_sub_f32 v237, v221, v243
    v_sub_f32 v238, v222, v243
    v_sub_f32 v239, v223, v243
    v_sub_f32 v240, v224, v243
    v_sub_f32 v241, v225, v243
    v_sub_f32 v242, v226, v243
    v_sub_f32 v243, v227, v243
    v_exp_f32 v236, v236
    v_exp_f32 v237, v237
    v_exp_f32 v238, v238
    v_exp_f32 v239, v239
    v_exp_f32 v240, v240
    v_exp_f32 v241, v241
    v_exp_f32 v242, v242
    v_exp_f32 v243, v243
    v_mul_f32 v0, v0, v247
    v_mul_f32 v1, v1, v247
    v_mul_f32 v2, v2, v247
    v_mul_f32 v3, v3, v247
    v_mul_f32 v12, v12, v247
    v_mul_f32 v13, v13, v247
    v_mul_f32 v14, v14, v247
    v_mul_f32 v15, v15, v247
    v_mul_f32 v24, v24, v247
    v_mul_f32 v25, v25, v247
    v_mul_f32 v26, v26, v247
    v_mul_f32 v27, v27, v247
    v_mul_f32 v36, v36, v247
    v_mul_f32 v37, v37, v247
    v_mul_f32 v38, v38, v247
    v_mul_f32 v39, v39, v247
    v_mul_f32 v48, v48, v247
    v_mul_f32 v49, v49, v247
    v_mul_f32 v50, v50, v247
    v_mul_f32 v51, v51, v247
    v_mul_f32 v60, v60, v247
    v_mul_f32 v61, v61, v247
    v_mul_f32 v62, v62, v247
    v_mul_f32 v63, v63, v247
    v_mul_f32 v72, v72, v247
    v_mul_f32 v73, v73, v247
    v_mul_f32 v74, v74, v247
    v_mul_f32 v75, v75, v247
    v_mul_f32 v84, v84, v247
    v_mul_f32 v85, v85, v247
    v_mul_f32 v86, v86, v247
    v_mul_f32 v87, v87, v247
    v_mul_f32 v244, v244, v247
    v_add_f32 v247, v236, v237
    v_add_f32 v247, v247, v238
    v_add_f32 v247, v247, v239
    v_add_f32 v247, v247, v240
    v_add_f32 v247, v247, v241
    v_add_f32 v247, v247, v242
    v_add_f32 v247, v247, v243
    s_nop 3
    s_cmp_eq_u32 s57, 2
    s_cbranch_scc1 L_ret0_2
    s_cmp_eq_u32 s57, 4
    s_cbranch_scc1 L_ret0_4
    s_cmp_eq_u32 s57, 6
    s_cbranch_scc1 L_ret0_6
    s_cmp_eq_u32 s57, 8
    s_cbranch_scc1 L_ret0_8
    s_cmp_eq_u32 s57, 10
    s_cbranch_scc1 L_ret0_10
    s_cmp_eq_u32 s57, 12
    s_cbranch_scc1 L_ret0_12
    s_branch L_ret0_14
L_fix0_1:
    s_nop 7
    s_nop 7
    v_max3_f32 v243, v228, v229, v230
    v_max3_f32 v247, v231, v232, v233
    v_max3_f32 v243, v243, v234, v235
    v_max_f32 v243, v243, v247
    v_mov_b32 v247, v243
    s_nop 1
    v_permlane32_swap_b32 v243, v247
    v_max_f32 v243, v243, v247
    v_mov_b32 v247, v243
    s_nop 1
    v_permlane16_swap_b32 v243, v247
    v_max_f32 v243, v243, v247
    v_max_f32 v243, 0, v243
    v_sub_f32 v247, 0, v243
    v_exp_f32 v247, v247
    v_sub_f32 v144, v144, v243
    v_sub_f32 v145, v145, v243
    v_sub_f32 v146, v146, v243
    v_sub_f32 v147, v147, v243
    v_sub_f32 v236, v228, v243
    v_sub_f32 v237, v229, v243
    v_sub_f32 v238, v230, v243
    v_sub_f32 v239, v231, v243
    v_sub_f32 v240, v232, v243
    v_sub_f32 v241, v233, v243
    v_sub_f32 v242, v234, v243
    v_sub_f32 v243, v235, v243
    v_exp_f32 v236, v236
    v_exp_f32 v237, v237
    v_exp_f32 v238, v238
    v_exp_f32 v239, v239
    v_exp_f32 v240, v240
    v_exp_f32 v241, v241
    v_exp_f32 v242, v242
    v_exp_f32 v243, v243
    v_mul_f32 v0, v0, v247
    v_mul_f32 v1, v1, v247
    v_mul_f32 v2, v2, v247
    v_mul_f32 v3, v3, v247
    v_mul_f32 v12, v12, v247
    v_mul_f32 v13, v13, v247
    v_mul_f32 v14, v14, v247
    v_mul_f32 v15, v15, v247
    v_mul_f32 v24, v24, v247
    v_mul_f32 v25, v25, v247
    v_mul_f32 v26, v26, v247
    v_mul_f32 v27, v27, v247
    v_mul_f32 v36, v36, v247
    v_mul_f32 v37, v37, v247
    v_mul_f32 v38, v38, v247
    v_mul_f32 v39, v39, v247
    v_mul_f32 v48, v48, v247
    v_mul_f32 v49, v49, v247
    v_mul_f32 v50, v50, v247
    v_mul_f32 v51, v51, v247
    v_mul_f32 v60, v60, v247
    v_mul_f32 v61, v61, v247
    v_mul_f32 v62, v62, v247
    v_mul_f32 v63, v63, v247
    v_mul_f32 v72, v72, v247
    v_mul_f32 v73, v73, v247
    v_mul_f32 v74, v74, v247
    v_mul_f32 v75, v75, v247
    v_mul_f32 v84, v84, v247
    v_mul_f32 v85, v85, v247
    v_mul_f32 v86, v86, v247
    v_mul_f32 v87, v87, v247
    v_mul_f32 v244, v244, v247
    v_add_f32 v247, v236, v237
    v_add_f32 v247, v247, v238
    v_add_f32 v247, v247, v239
    v_add_f32 v247, v247, v240
    v_add_f32 v247, v247, v241
    v_add_f32 v247, v247, v242
    v_add_f32 v247, v247, v243
    s_nop 3
    s_cmp_eq_u32 s57, 1
    s_cbranch_scc1 L_ret0_1
    s_cmp_eq_u32 s57, 3
    s_cbranch_scc1 L_ret0_3
    s_cmp_eq_u32 s57, 5
    s_cbranch_scc1 L_ret0_5
    s_cmp_eq_u32 s57, 7
    s_cbranch_scc1 L_ret0_7
    s_cmp_eq_u32 s57, 9
    s_cbranch_scc1 L_ret0_9
    s_cmp_eq_u32 s57, 11
    s_cbranch_scc1 L_ret0_11
    s_cmp_eq_u32 s57, 13
    s_cbranch_scc1 L_ret0_13
    s_branch L_ret0_15
L_fix1_0:
    s_nop 7
    s_nop 7
    v_max3_f32 v243, v220, v221, v222
    v_max3_f32 v247, v223, v224, v225
    v_max3_f32 v243, v243, v226, v227
    v_max_f32 v243, v243, v247
    v_mov_b32 v247, v243
    s_nop 1
    v_permlane32_swap_b32 v243, v247
    v_max_f32 v243, v243, v247
    v_mov_b32 v247, v243
    s_nop 1
    v_permlane16_swap_b32 v243, v247
    v_max_f32 v243, v243, v247
    v_max_f32 v243, 0, v243
    v_sub_f32 v247, 0, v243
    v_exp_f32 v247, v247
    v_sub_f32 v148, v148, v243
    v_sub_f32 v149, v149, v243
    v_sub_f32 v150, v150, v243
    v_sub_f32 v151, v151, v243
    v_sub_f32 v236, v220, v243
    v_sub_f32 v237, v221, v243
    v_sub_f32 v238, v222, v243
    v_sub_f32 v239, v223, v243
    v_sub_f32 v240, v224, v243
    v_sub_f32 v241, v225, v243
    v_sub_f32 v242, v226, v243
    v_sub_f32 v243, v227, v243
    v_exp_f32 v236, v236
    v_exp_f32 v237, v237
    v_exp_f32 v238, v238
    v_exp_f32 v239, v239
    v_exp_f32 v240, v240
    v_exp_f32 v241, v241
    v_exp_f32 v242, v242
    v_exp_f32 v243, v243
    v_mul_f32 v4, v4, v247
    v_mul_f32 v5, v5, v247
    v_mul_f32 v6, v6, v247
    v_mul_f32 v7, v7, v247
    v_mul_f32 v16, v16, v247
    v_mul_f32 v17, v17, v247
    v_mul_f32 v18, v18, v247
    v_mul_f32 v19, v19, v247
    v_mul_f32 v28, v28, v247
    v_mul_f32 v29, v29, v247
    v_mul_f32 v30, v30, v247
    v_mul_f32 v31, v31, v247
    v_mul_f32 v40, v40, v247
    v_mul_f32 v41, v41, v247
    v_mul_f32 v42, v42, v247
    v_mul_f32 v43, v43, v247
    v_mul_f32 v52, v52, v247
    v_mul_f32 v53, v53, v247
    v_mul_f32 v54, v54, v247
    v_mul_f32 v55, v55, v247
    v_mul_f32 v64, v64, v247
    v_mul_f32 v65, v65, v247
    v_mul_f32 v66, v66, v247
    v_mul_f32 v67, v67, v247
    v_mul_f32 v76, v76, v247
    v_mul_f32 v77, v77, v247
    v_mul_f32 v78, v78, v247
    v_mul_f32 v79, v79, v247
    v_mul_f32 v88, v88, v247
    v_mul_f32 v89, v89, v247
    v_mul_f32 v90, v90, v247
    v_mul_f32 v91, v91, v247
    v_mul_f32 v245, v245, v247
    v_add_f32 v247, v236, v237
    v_add_f32 v247, v247, v238
    v_add_f32 v247, v247, v239
    v_add_f32 v247, v247, v240
    v_add_f32 v247, v247, v241
    v_add_f32 v247, v247, v242
    v_add_f32 v247, v247, v243
    s_nop 3
    s_cmp_eq_u32 s57, 1
    s_cbranch_scc1 L_ret1_1
    s_cmp_eq_u32 s57, 3
    s_cbranch_scc1 L_ret1_3
    s_cmp_eq_u32 s57, 5
    s_cbranch_scc1 L_ret1_5
    s_cmp_eq_u32 s57, 7
    s_cbranch_scc1 L_ret1_7
    s_cmp_eq_u32 s57, 9
    s_cbranch_scc1 L_ret1_9
    s_cmp_eq_u32 s57, 11
    s_cbranch_scc1 L_ret1_11
    s_cmp_eq_u32 s57, 13
    s_cbranch_scc1 L_ret1_13
    s_branch L_ret1_15
L_fix1_1:
    s_nop 7
    s_nop 7
    v_max3_f32 v243, v228, v229, v230
    v_max3_f32 v247, v231, v232, v233
    v_max3_f32 v243, v243, v234, v235
    v_max_f32 v243, v243, v247
    v_mov_b32 v247, v243
    s_nop 1
    v_permlane32_swap_b32 v243, v247
    v_max_f32 v243, v243, v247
    v_mov_b32 v247, v243
    s_nop 1
    v_permlane16_swap_b32 v243, v247
    v_max_f32 v243, v243, v247
    v_max_f32 v243, 0, v243
    v_sub_f32 v247, 0, v243
    v_exp_f32 v247, v247
    v_sub_f32 v148, v148, v243
    v_sub_f32 v149, v149, v243
    v_sub_f32 v150, v150, v243
    v_sub_f32 v151, v151, v243
    v_sub_f32 v236, v228, v243
    v_sub_f32 v237, v229, v243
    v_sub_f32 v238, v230, v243
    v_sub_f32 v239, v231, v243
    v_sub_f32 v240, v232, v243
    v_sub_f32 v241, v233, v243
    v_sub_f32 v242, v234, v243
    v_sub_f32 v243, v235, v243
    v_exp_f32 v236, v236
    v_exp_f32 v237, v237
    v_exp_f32 v238, v238
    v_exp_f32 v239, v239
    v_exp_f32 v240, v240
    v_exp_f32 v241, v241
    v_exp_f32 v242, v242
    v_exp_f32 v243, v243
    v_mul_f32 v4, v4, v247
    v_mul_f32 v5, v5, v247
    v_mul_f32 v6, v6, v247
    v_mul_f32 v7, v7, v247
    v_mul_f32 v16, v16, v247
    v_mul_f32 v17, v17, v247
    v_mul_f32 v18, v18, v247
    v_mul_f32 v19, v19, v247
    v_mul_f32 v28, v28, v247
    v_mul_f32 v29, v29, v247
    v_mul_f32 v30, v30, v247
    v_mul_f32 v31, v31, v247
    v_mul_f32 v40, v40, v247
    v_mul_f32 v41, v41, v247
    v_mul_f32 v42, v42, v247
    v_mul_f32 v43, v43, v247
    v_mul_f32 v52, v52, v247
    v_mul_f32 v53, v53, v247
    v_mul_f32 v54, v54, v247
    v_mul_f32 v55, v55, v247
    v_mul_f32 v64, v64, v247
    v_mul_f32 v65, v65, v247
    v_mul_f32 v66, v66, v247
    v_mul_f32 v67, v67, v247
    v_mul_f32 v76, v76, v247
    v_mul_f32 v77, v77, v247
    v_mul_f32 v78, v78, v247
    v_mul_f32 v79, v79, v247
    v_mul_f32 v88, v88, v247
    v_mul_f32 v89, v89, v247
    v_mul_f32 v90, v90, v247
    v_mul_f32 v91, v91, v247
    v_mul_f32 v245, v245, v247
    v_add_f32 v247, v236, v237
    v_add_f32 v247, v247, v238
    v_add_f32 v247, v247, v239
    v_add_f32 v247, v247, v240
    v_add_f32 v247, v247, v241
    v_add_f32 v247, v247, v242
    v_add_f32 v247, v247, v243
    s_nop 3
    s_cmp_eq_u32 s57, 2
    s_cbranch_scc1 L_ret1_2
    s_cmp_eq_u32 s57, 4
    s_cbranch_scc1 L_ret1_4
    s_cmp_eq_u32 s57, 6
    s_cbranch_scc1 L_ret1_6
    s_cmp_eq_u32 s57, 8
    s_cbranch_scc1 L_ret1_8
    s_cmp_eq_u32 s57, 10
    s_cbranch_scc1 L_ret1_10
    s_cmp_eq_u32 s57, 12
    s_cbranch_scc1 L_ret1_12
    s_branch L_ret1_14
L_fix2_0:
    s_nop 7
    s_nop 7
    v_max3_f32 v243, v220, v221, v222
    v_max3_f32 v247, v223, v224, v225
    v_max3_f32 v243, v243, v226, v227
    v_max_f32 v243, v243, v247
    v_mov_b32 v247, v243
    s_nop 1
    v_permlane32_swap_b32 v243, v247
    v_max_f32 v243, v243, v247
    v_mov_b32 v247, v243
    s_nop 1
    v_permlane16_swap_b32 v243, v247
    v_max_f32 v243, v243, v247
    v_max_f32 v243, 0, v243
    v_sub_f32 v247, 0, v243
    v_exp_f32 v247, v247
    v_sub_f32 v152, v152, v243
    v_sub_f32 v153, v153, v243
    v_sub_f32 v154, v154, v243
    v_sub_f32 v155, v155, v243
    v_sub_f32 v236, v220, v243
    v_sub_f32 v237, v221, v243
    v_sub_f32 v238, v222, v243
    v_sub_f32 v239, v223, v243
    v_sub_f32 v240, v224, v243
    v_sub_f32 v241, v225, v243
    v_sub_f32 v242, v226, v243
    v_sub_f32 v243, v227, v243
    v_exp_f32 v236, v236
    v_exp_f32 v237, v237
    v_exp_f32 v238, v238
    v_exp_f32 v239, v239
    v_exp_f32 v240, v240
    v_exp_f32 v241, v241
    v_exp_f32 v242, v242
    v_exp_f32 v243, v243
    v_mul_f32 v8, v8, v247
    v_mul_f32 v9, v9, v247
    v_mul_f32 v10, v10, v247
    v_mul_f32 v11, v11, v247
    v_mul_f32 v20, v20, v247
    v_mul_f32 v21, v21, v247
    v_mul_f32 v22, v22, v247
    v_mul_f32 v23, v23, v247
    v_mul_f32 v32, v32, v247
    v_mul_f32 v33, v33, v247
    v_mul_f32 v34, v34, v247
    v_mul_f32 v35, v35, v247
    v_mul_f32 v44, v44, v247
    v_mul_f32 v45, v45, v247
    v_mul_f32 v46, v46, v247
    v_mul_f32 v47, v47, v247
    v_mul_f32 v56, v56, v247
    v_mul_f32 v57, v57, v247
    v_mul_f32 v58, v58, v247
    v_mul_f32 v59, v59, v247
    v_mul_f32 v68, v68, v247
    v_mul_f32 v69, v69, v247
    v_mul_f32 v70, v70, v247
    v_mul_f32 v71, v71, v247
    v_mul_f32 v80, v80, v247
    v_mul_f32 v81, v81, v247
    v_mul_f32 v82, v82, v247
    v_mul_f32 v83, v83, v247
    v_mul_f32 v92, v92, v247
    v_mul_f32 v93, v93, v247
    v_mul_f32 v94, v94, v247
    v_mul_f32 v95, v95, v247
    v_mul_f32 v246, v246, v247
    v_add_f32 v247, v236, v237
    v_add_f32 v247, v247, v238
    v_add_f32 v247, v247, v239
    v_add_f32 v247, v247, v240
    v_add_f32 v247, v247, v241
    v_add_f32 v247, v247, v242
    v_add_f32 v247, v247, v243
    s_nop 3
    s_cmp_eq_u32 s57, 2
    s_cbranch_scc1 L_ret2_2
    s_cmp_eq_u32 s57, 4
    s_cbranch_scc1 L_ret2_4
    s_cmp_eq_u32 s57, 6
    s_cbranch_scc1 L_ret2_6
    s_cmp_eq_u32 s57, 8
    s_cbranch_scc1 L_ret2_8
    s_cmp_eq_u32 s57, 10
    s_cbranch_scc1 L_ret2_10
    s_cmp_eq_u32 s57, 12
    s_cbranch_scc1 L_ret2_12
    s_branch L_ret2_14
L_fix2_1:
    s_nop 7
    s_nop 7
    v_max3_f32 v243, v228, v229, v230
    v_max3_f32 v247, v231, v232, v233
    v_max3_f32 v243, v243, v234, v235
    v_max_f32 v243, v243, v247
    v_mov_b32 v247, v243
    s_nop 1
    v_permlane32_swap_b32 v243, v247
    v_max_f32 v243, v243, v247
    v_mov_b32 v247, v243
    s_nop 1
    v_permlane16_swap_b32 v243, v247
    v_max_f32 v243, v243, v247
    v_max_f32 v243, 0, v243
    v_sub_f32 v247, 0, v243
    v_exp_f32 v247, v247
    v_sub_f32 v152, v152, v243
    v_sub_f32 v153, v153, v243
    v_sub_f32 v154, v154, v243
    v_sub_f32 v155, v155, v243
    v_sub_f32 v236, v228, v243
    v_sub_f32 v237, v229, v243
    v_sub_f32 v238, v230, v243
    v_sub_f32 v239, v231, v243
    v_sub_f32 v240, v232, v243
    v_sub_f32 v241, v233, v243
    v_sub_f32 v242, v234, v243
    v_sub_f32 v243, v235, v243
    v_exp_f32 v236, v236
    v_exp_f32 v237, v237
    v_exp_f32 v238, v238
    v_exp_f32 v239, v239
    v_exp_f32 v240, v240
    v_exp_f32 v241, v241
    v_exp_f32 v242, v242
    v_exp_f32 v243, v243
    v_mul_f32 v8, v8, v247
    v_mul_f32 v9, v9, v247
    v_mul_f32 v10, v10, v247
    v_mul_f32 v11, v11, v247
    v_mul_f32 v20, v20, v247
    v_mul_f32 v21, v21, v247
    v_mul_f32 v22, v22, v247
    v_mul_f32 v23, v23, v247
    v_mul_f32 v32, v32, v247
    v_mul_f32 v33, v33, v247
    v_mul_f32 v34, v34, v247
    v_mul_f32 v35, v35, v247
    v_mul_f32 v44, v44, v247
    v_mul_f32 v45, v45, v247
    v_mul_f32 v46, v46, v247
    v_mul_f32 v47, v47, v247
    v_mul_f32 v56, v56, v247
    v_mul_f32 v57, v57, v247
    v_mul_f32 v58, v58, v247
    v_mul_f32 v59, v59, v247
    v_mul_f32 v68, v68, v247
    v_mul_f32 v69, v69, v247
    v_mul_f32 v70, v70, v247
    v_mul_f32 v71, v71, v247
    v_mul_f32 v80, v80, v247
    v_mul_f32 v81, v81, v247
    v_mul_f32 v82, v82, v247
    v_mul_f32 v83, v83, v247
    v_mul_f32 v92, v92, v247
    v_mul_f32 v93, v93, v247
    v_mul_f32 v94, v94, v247
    v_mul_f32 v95, v95, v247
    v_mul_f32 v246, v246, v247
    v_add_f32 v247, v236, v237
    v_add_f32 v247, v247, v238
    v_add_f32 v247, v247, v239
    v_add_f32 v247, v247, v240
    v_add_f32 v247, v247, v241
    v_add_f32 v247, v247, v242
    v_add_f32 v247, v247, v243
    s_nop 3
    s_cmp_eq_u32 s57, 1
    s_cbranch_scc1 L_ret2_1
    s_cmp_eq_u32 s57, 3
    s_cbranch_scc1 L_ret2_3
    s_cmp_eq_u32 s57, 5
    s_cbranch_scc1 L_ret2_5
    s_cmp_eq_u32 s57, 7
    s_cbranch_scc1 L_ret2_7
    s_cmp_eq_u32 s57, 9
    s_cbranch_scc1 L_ret2_9
    s_cmp_eq_u32 s57, 11
    s_cbranch_scc1 L_ret2_11
    s_cmp_eq_u32 s57, 13
    s_cbranch_scc1 L_ret2_13
    s_branch L_ret2_15
L_G:
    v_mov_b32 v216, v0
    v_lshrrev_b32 v221, 4, v216
    v_lshrrev_b32 v225, 3, v216
    v_and_b32 v226, 7, v216
    s_lshl_b32 s51, s44, 3
    v_add_u32 v217, s51, v225
    v_and_b32 v218, 1, v221
    s_and_b32 s52, s44, 1
    s_lshl_b32 s53, s52, 1
    v_or_b32 v218, s53, v218
    v_lshlrev_b32 v218, 1, v218
    v_xor_b32 v218, v226, v218
    v_lshlrev_b32 v219, 13, v217
    v_lshl_add_u32 v250, v218, 4, v219
    s_movk_i32 s51, 1152
    v_mul_lo_u32 v219, v217, s51
    v_lshlrev_b32 v220, 8, v217
    s_lshl_b32 s53, s52, 2
    v_or_b32 v218, s53, v221
    v_xor_b32 v218, v226, v218
    v_lshl_add_u32 v251, v218, 4, v219
    v_lshl_add_u32 v253, v218, 4, v220
    v_and_b32 v218, 6, v225
    v_xor_b32 v218, v226, v218
    v_lshl_add_u32 v252, v218, 4, v219
    v_lshl_add_u32 v254, v218, 4, v220
    s_add_u32 m0, s50, 147456
    s_add_u32 s51, s49, 0
    buffer_load_dwordx4 v251, s[8:11], s51 offen lds
    s_add_u32 m0, s50, 151552
    s_add_u32 s51, s49, 36864
    buffer_load_dwordx4 v251, s[8:11], s51 offen lds
    s_add_u32 m0, s50, 155648
    s_add_u32 s51, s49, 73728
    buffer_load_dwordx4 v251, s[8:11], s51 offen lds
    s_add_u32 m0, s50, 86016
    s_add_u32 s51, s47, 0
    buffer_load_dwordx4 v250, s[20:23], s51 offen lds
    s_add_u32 m0, s50, 90112
    s_add_u32 s51, s47, 128
    buffer_load_dwordx4 v250, s[20:23], s51 offen lds
    s_add_u32 m0, s50, 94208
    s_add_u32 s51, s47, 256
    buffer_load_dwordx4 v250, s[20:23], s51 offen lds
    s_add_u32 m0, s50, 98304
    s_add_u32 s51, s47, 384
    buffer_load_dwordx4 v250, s[20:23], s51 offen lds
    s_add_u32 m0, s50, 102400
    s_add_u32 s51, s47, 262144
    buffer_load_dwordx4 v250, s[20:23], s51 offen lds
    s_add_u32 m0, s50, 106496
    s_add_u32 s51, s47, 262272
    buffer_load_dwordx4 v250, s[20:23], s51 offen lds
    s_add_u32 m0, s50, 110592
    s_add_u32 s51, s47, 262400
    buffer_load_dwordx4 v250, s[20:23], s51 offen lds
    s_add_u32 m0, s50, 114688
    s_add_u32 s51, s47, 262528
    buffer_load_dwordx4 v250, s[20:23], s51 offen lds
    s_add_u32 m0, s50, 118784
    s_add_u32 s51, s47, 524288
    buffer_load_dwordx4 v250, s[20:23], s51 offen lds
    s_add_u32 m0, s50, 122880
    s_add_u32 s51, s47, 524416
    buffer_load_dwordx4 v250, s[20:23], s51 offen lds
    s_add_u32 m0, s50, 126976
    s_add_u32 s51, s47, 524544
    buffer_load_dwordx4 v250, s[20:23], s51 offen lds
    s_add_u32 m0, s50, 131072
    s_add_u32 s51, s47, 524672
    buffer_load_dwordx4 v250, s[20:23], s51 offen lds
    s_barrier
    v_bfe_u32 v222, v216, 2, 2
    v_and_b32 v223, 3, v216
    v_and_b32 v219, 1, v221
    v_lshlrev_b32 v219, 1, v219
    v_lshrrev_b32 v220, 1, v222
    v_or_b32 v224, v219, v220
    v_lshrrev_b32 v219, 2, v216
    v_lshlrev_b32 v219, 7, v219
    v_lshl_add_u32 v219, v223, 3, v219
    v_add_u32 v219, 49152, v219
    v_xor_b32 v217, s44, v224
    v_lshl_add_u32 v248, v217, 5, v219
    v_lshlrev_b32 v249, 4, v216
    s_lshl_b32 s51, s42, 4
    s_lshl_b32 s52, s41, 2
    s_add_u32 s51, s51, s52
    s_lshl_b32 s46, s51, 17
    s_lshl_b32 s51, s41, 2
    s_sub_u32 s51, s51, 1
    s_mul_i32 s73, s51, 294912
    s_add_u32 s51, s41, 1
    s_and_b32 s51, s51, 3
    s_lshl_b32 s51, s51, 8
    s_add_u32 s51, s51, 0
    s_add_u32 s64, s73, s51
    s_add_u32 s51, s41, 1
    s_and_b32 s51, s51, 3
    s_lshl_b32 s51, s51, 8
    s_add_u32 s51, s51, 128
    s_add_u32 s65, s73, s51
    s_add_u32 s51, s41, 2
    s_and_b32 s51, s51, 3
    s_lshl_b32 s51, s51, 8
    s_add_u32 s51, s51, 0
    s_add_u32 s66, s73, s51
    s_add_u32 s51, s41, 2
    s_and_b32 s51, s51, 3
    s_lshl_b32 s51, s51, 8
    s_add_u32 s51, s51, 128
    s_add_u32 s67, s73, s51
    s_add_u32 s51, s41, 3
    s_and_b32 s51, s51, 3
    s_lshl_b32 s51, s51, 8
    s_add_u32 s51, s51, 0
    s_add_u32 s68, s73, s51
    s_add_u32 s51, s41, 3
    s_and_b32 s51, s51, 3
    s_lshl_b32 s51, s51, 8
    s_add_u32 s51, s51, 128
    s_add_u32 s69, s73, s51
    s_add_u32 s51, s41, 4
    s_and_b32 s51, s51, 3
    s_lshl_b32 s51, s51, 8
    s_add_u32 s51, s51, 0
    s_add_u32 s70, s73, s51
    s_add_u32 s51, s41, 4
    s_and_b32 s51, s51, 3
    s_lshl_b32 s51, s51, 8
    s_add_u32 s51, s51, 128
    s_add_u32 s71, s73, s51
    s_add_u32 s72, s73, 1024
    s_mul_i32 s51, s48, 72
    s_mul_i32 s52, s44, 18
    s_add_u32 s51, s51, s52
    s_lshl_b32 s51, s51, 13
    s_add_u32 s83, s47, s51
    s_mov_b32 s52, s3
    s_lshl_b32 s51, s52, 7
    s_add_u32 s83, s83, s51
    s_mul_i32 s89, s41, 1179648
    s_mul_i32 s51, s48, 36864
    s_add_u32 s89, s89, s51
    s_mul_i32 s51, s52, 9216
    s_add_u32 s89, s89, s51
    s_mul_i32 s51, s44, 2304
    s_add_u32 s89, s89, s51
    v_lshrrev_b32 v200, 4, v249
    v_and_b32 v201, 15, v200
    v_lshrrev_b32 v202, 4, v200
    v_lshrrev_b32 v203, 1, v201
    v_xor_b32 v204, v202, v203
    v_lshlrev_b32 v204, 4, v204
    v_lshl_add_u32 v196, v201, 7, v204
    v_xor_b32 v197, 64, v196
    s_and_b32 s52, s44, 1
    s_mul_i32 s51, s52, 6144
    s_add_u32 s51, s51, 49152
    v_add_u32 v196, s51, v196
    v_add_u32 v197, s51, v197
    v_bfe_u32 v201, v200, 2, 2
    v_and_b32 v203, 1, v202
    v_lshlrev_b32 v203, 1, v203
    v_lshrrev_b32 v204, 1, v201
    v_or_b32 v205, v203, v204
    v_lshl_add_u32 v204, v202, 3, v201
    v_lshlrev_b32 v204, 7, v204
    v_and_b32 v201, 3, v200
    v_lshl_add_u32 v204, v201, 3, v204
    s_lshr_b32 s53, s44, 1
    s_lshl_b32 s51, s53, 13
    v_add_u32 v204, s51, v204
    v_xor_b32 v201, 0, v205
    v_lshl_add_u32 v192, v201, 5, v204
    v_xor_b32 v201, 1, v205
    v_lshl_add_u32 v193, v201, 5, v204
    v_xor_b32 v201, 2, v205
    v_lshl_add_u32 v194, v201, 5, v204
    v_xor_b32 v201, 3, v205
    v_lshl_add_u32 v195, v201, 5, v204
    s_mul_i32 s51, s53, 24
    s_mul_i32 s52, s52, 3
    s_add_u32 s51, s51, s52
    s_lshl_b32 s51, s51, 10
    v_add_u32 v198, s51, v249
    s_mov_b32 s58, 0x3e0293ee
    s_waitcnt vmcnt(8)
    s_barrier
    s_add_u32 m0, s50, 135168
    s_add_u32 s51, s49, 128
    buffer_load_dwordx4 v251, s[8:11], s51 offen lds
    s_add_u32 m0, s50, 139264
    s_add_u32 s51, s49, 36992
    buffer_load_dwordx4 v251, s[8:11], s51 offen lds
    s_add_u32 m0, s50, 143360
    s_add_u32 s51, s49, 73856
    buffer_load_dwordx4 v251, s[8:11], s51 offen lds
    s_waitcnt vmcnt(7)
    s_waitcnt lgkmcnt(0)
    s_barrier
    s_add_u32 m0, s50, 86016
    s_add_u32 s51, s47, 786432
    buffer_load_dwordx4 v250, s[20:23], s51 offen lds
    s_add_u32 m0, s50, 90112
    s_add_u32 s51, s47, 786560
    buffer_load_dwordx4 v250, s[20:23], s51 offen lds
    s_add_u32 m0, s50, 94208
    s_add_u32 s51, s47, 786688
    buffer_load_dwordx4 v250, s[20:23], s51 offen lds
    s_add_u32 m0, s50, 98304
    s_add_u32 s51, s47, 786816
    buffer_load_dwordx4 v250, s[20:23], s51 offen lds
    s_waitcnt vmcnt(4)
    s_waitcnt lgkmcnt(0)
    s_barrier
    s_add_u32 m0, s50, 102400
    s_add_u32 s51, s47, 1048576
    buffer_load_dwordx4 v250, s[20:23], s51 offen lds
    s_add_u32 m0, s50, 106496
    s_add_u32 s51, s47, 1048704
    buffer_load_dwordx4 v250, s[20:23], s51 offen lds
    s_add_u32 m0, s50, 110592
    s_add_u32 s51, s47, 1048832
    buffer_load_dwordx4 v250, s[20:23], s51 offen lds
    s_add_u32 m0, s50, 114688
    s_add_u32 s51, s47, 1048960
    buffer_load_dwordx4 v250, s[20:23], s51 offen lds
    s_add_u32 m0, s50, 147456
    s_add_u32 s51, s49, 256
    buffer_load_dwordx4 v251, s[8:11], s51 offen lds
    s_add_u32 m0, s50, 151552
    s_add_u32 s51, s49, 37120
    buffer_load_dwordx4 v251, s[8:11], s51 offen lds
    s_add_u32 m0, s50, 155648
    s_add_u32 s51, s49, 73984
    buffer_load_dwordx4 v251, s[8:11], s51 offen lds
    s_waitcnt vmcnt(7)
    s_waitcnt lgkmcnt(0)
    s_barrier
    s_add_u32 m0, s50, 118784
    s_add_u32 s51, s47, 1310720
    buffer_load_dwordx4 v250, s[20:23], s51 offen lds
    s_add_u32 m0, s50, 122880
    s_add_u32 s51, s47, 1310848
    buffer_load_dwordx4 v250, s[20:23], s51 offen lds
    s_add_u32 m0, s50, 126976
    s_add_u32 s51, s47, 1310976
    buffer_load_dwordx4 v250, s[20:23], s51 offen lds
    s_add_u32 m0, s50, 131072
    s_add_u32 s51, s47, 1311104
    buffer_load_dwordx4 v250, s[20:23], s51 offen lds
    s_waitcnt vmcnt(4)
    s_waitcnt lgkmcnt(0)
    s_barrier
    s_add_u32 m0, s50, 86016
    s_add_u32 s51, s47, 1572864
    buffer_load_dwordx4 v250, s[20:23], s51 offen lds
    s_add_u32 m0, s50, 90112
    s_add_u32 s51, s47, 1572992
    buffer_load_dwordx4 v250, s[20:23], s51 offen lds
    s_add_u32 m0, s50, 94208
    s_add_u32 s51, s47, 1573120
    buffer_load_dwordx4 v250, s[20:23], s51 offen lds
    s_add_u32 m0, s50, 98304
    s_add_u32 s51, s47, 1573248
    buffer_load_dwordx4 v250, s[20:23], s51 offen lds
    s_add_u32 m0, s50, 135168
    s_add_u32 s51, s49, 384
    buffer_load_dwordx4 v251, s[8:11], s51 offen lds
    s_add_u32 m0, s50, 139264
    s_add_u32 s51, s49, 37248
    buffer_load_dwordx4 v251, s[8:11], s51 offen lds
    s_add_u32 m0, s50, 143360
    s_add_u32 s51, s49, 74112
    buffer_load_dwordx4 v251, s[8:11], s51 offen lds
    s_waitcnt vmcnt(7)
    s_waitcnt lgkmcnt(0)
    s_barrier
    s_add_u32 m0, s50, 102400
    s_add_u32 s51, s47, 1835008
    buffer_load_dwordx4 v250, s[20:23], s51 offen lds
    s_add_u32 m0, s50, 106496
    s_add_u32 s51, s47, 1835136
    buffer_load_dwordx4 v250, s[20:23], s51 offen lds
    s_add_u32 m0, s50, 110592
    s_add_u32 s51, s47, 1835264
    buffer_load_dwordx4 v250, s[20:23], s51 offen lds
    s_add_u32 m0, s50, 114688
    s_add_u32 s51, s47, 1835392
    buffer_load_dwordx4 v250, s[20:23], s51 offen lds
    s_waitcnt vmcnt(4)
    s_waitcnt lgkmcnt(0)
    s_barrier
    s_add_u32 m0, s50, 118784
    s_add_u32 s51, s47, 2097152
    buffer_load_dwordx4 v250, s[20:23], s51 offen lds
    s_add_u32 m0, s50, 122880
    s_add_u32 s51, s47, 2097280
    buffer_load_dwordx4 v250, s[20:23], s51 offen lds
    s_add_u32 m0, s50, 126976
    s_add_u32 s51, s47, 2097408
    buffer_load_dwordx4 v250, s[20:23], s51 offen lds
    s_add_u32 m0, s50, 131072
    s_add_u32 s51, s47, 2097536
    buffer_load_dwordx4 v250, s[20:23], s51 offen lds
    s_add_u32 m0, s50, 147456
    s_add_u32 s51, s49, 512
    buffer_load_dwordx4 v251, s[8:11], s51 offen lds
    s_add_u32 m0, s50, 151552
    s_add_u32 s51, s49, 37376
    buffer_load_dwordx4 v251, s[8:11], s51 offen lds
    s_add_u32 m0, s50, 155648
    s_add_u32 s51, s49, 74240
    buffer_load_dwordx4 v251, s[8:11], s51 offen lds
    s_waitcnt vmcnt(7)
    s_waitcnt lgkmcnt(0)
    s_barrier
    s_add_u32 m0, s50, 86016
    s_add_u32 s51, s47, 2359296
    buffer_load_dwordx4 v250, s[20:23], s51 offen lds
    s_add_u32 m0, s50, 90112
    s_add_u32 s51, s47, 2359424
    buffer_load_dwordx4 v250, s[20:23], s51 offen lds
    s_add_u32 m0, s50, 94208
    s_add_u32 s51, s47, 2359552
    buffer_load_dwordx4 v250, s[20:23], s51 offen lds
    s_add_u32 m0, s50, 98304
    s_add_u32 s51, s47, 2359680
    buffer_load_dwordx4 v250, s[20:23], s51 offen lds
    s_waitcnt vmcnt(4)
    s_waitcnt lgkmcnt(0)
    s_barrier
    s_add_u32 m0, s50, 102400
    s_add_u32 s51, s47, 2621440
    buffer_load_dwordx4 v250, s[20:23], s51 offen lds
    s_add_u32 m0, s50, 106496
    s_add_u32 s51, s47, 2621568
    buffer_load_dwordx4 v250, s[20:23], s51 offen lds
    s_add_u32 m0, s50, 110592
    s_add_u32 s51, s47, 2621696
    buffer_load_dwordx4 v250, s[20:23], s51 offen lds
    s_add_u32 m0, s50, 114688
    s_add_u32 s51, s47, 2621824
    buffer_load_dwordx4 v250, s[20:23], s51 offen lds
    s_add_u32 m0, s50, 135168
    s_add_u32 s51, s49, 640
    buffer_load_dwordx4 v251, s[8:11], s51 offen lds
    s_add_u32 m0, s50, 139264
    s_add_u32 s51, s49, 37504
    buffer_load_dwordx4 v251, s[8:11], s51 offen lds
    s_add_u32 m0, s50, 143360
    s_add_u32 s51, s49, 74368
    buffer_load_dwordx4 v251, s[8:11], s51 offen lds
    s_waitcnt vmcnt(7)
    s_waitcnt lgkmcnt(0)
    s_barrier
    s_add_u32 m0, s50, 118784
    s_add_u32 s51, s47, 2883584
    buffer_load_dwordx4 v250, s[20:23], s51 offen lds
    s_add_u32 m0, s50, 122880
    s_add_u32 s51, s47, 2883712
    buffer_load_dwordx4 v250, s[20:23], s51 offen lds
    s_add_u32 m0, s50, 126976
    s_add_u32 s51, s47, 2883840
    buffer_load_dwordx4 v250, s[20:23], s51 offen lds
    s_add_u32 m0, s50, 131072
    s_add_u32 s51, s47, 2883968
    buffer_load_dwordx4 v250, s[20:23], s51 offen lds
    s_waitcnt vmcnt(4)
    s_waitcnt lgkmcnt(0)
    s_barrier
    s_add_u32 m0, s50, 86016
    s_add_u32 s51, s47, 3145728
    buffer_load_dwordx4 v250, s[20:23], s51 offen lds
    s_add_u32 m0, s50, 90112
    s_add_u32 s51, s47, 3145856
    buffer_load_dwordx4 v250, s[20:23], s51 offen lds
    s_add_u32 m0, s50, 94208
    s_add_u32 s51, s47, 3145984
    buffer_load_dwordx4 v250, s[20:23], s51 offen lds
    s_add_u32 m0, s50, 98304
    s_add_u32 s51, s47, 3146112
    buffer_load_dwordx4 v250, s[20:23], s51 offen lds
    s_add_u32 m0, s50, 147456
    s_add_u32 s51, s49, 768
    buffer_load_dwordx4 v251, s[8:11], s51 offen lds
    s_add_u32 m0, s50, 151552
    s_add_u32 s51, s49, 37632
    buffer_load_dwordx4 v251, s[8:11], s51 offen lds
    s_add_u32 m0, s50, 155648
    s_add_u32 s51, s49, 74496
    buffer_load_dwordx4 v251, s[8:11], s51 offen lds
    s_waitcnt vmcnt(7)
    s_waitcnt lgkmcnt(0)
    s_barrier
    s_add_u32 m0, s50, 102400
    s_add_u32 s51, s47, 3407872
    buffer_load_dwordx4 v250, s[20:23], s51 offen lds
    s_add_u32 m0, s50, 106496
    s_add_u32 s51, s47, 3408000
    buffer_load_dwordx4 v250, s[20:23], s51 offen lds
    s_add_u32 m0, s50, 110592
    s_add_u32 s51, s47, 3408128
    buffer_load_dwordx4 v250, s[20:23], s51 offen lds
    s_add_u32 m0, s50, 114688
    s_add_u32 s51, s47, 3408256
    buffer_load_dwordx4 v250, s[20:23], s51 offen lds
    s_waitcnt vmcnt(4)
    s_waitcnt lgkmcnt(0)
    s_barrier
    s_add_u32 m0, s50, 118784
    s_add_u32 s51, s47, 3670016
    buffer_load_dwordx4 v250, s[20:23], s51 offen lds
    s_add_u32 m0, s50, 122880
    s_add_u32 s51, s47, 3670144
    buffer_load_dwordx4 v250, s[20:23], s51 offen lds
    s_add_u32 m0, s50, 126976
    s_add_u32 s51, s47, 3670272
    buffer_load_dwordx4 v250, s[20:23], s51 offen lds
    s_add_u32 m0, s50, 131072
    s_add_u32 s51, s47, 3670400
    buffer_load_dwordx4 v250, s[20:23], s51 offen lds
    s_add_u32 m0, s50, 135168
    s_add_u32 s51, s49, 896
    buffer_load_dwordx4 v251, s[8:11], s51 offen lds
    s_add_u32 m0, s50, 139264
    s_add_u32 s51, s49, 37760
    buffer_load_dwordx4 v251, s[8:11], s51 offen lds
    s_add_u32 m0, s50, 143360
    s_add_u32 s51, s49, 74624
    buffer_load_dwordx4 v251, s[8:11], s51 offen lds
    s_waitcnt vmcnt(7)
    s_waitcnt lgkmcnt(0)
    s_barrier
    s_add_u32 m0, s50, 86016
    s_add_u32 s51, s47, 3932160
    buffer_load_dwordx4 v250, s[20:23], s51 offen lds
    s_add_u32 m0, s50, 90112
    s_add_u32 s51, s47, 3932288
    buffer_load_dwordx4 v250, s[20:23], s51 offen lds
    s_add_u32 m0, s50, 94208
    s_add_u32 s51, s47, 3932416
    buffer_load_dwordx4 v250, s[20:23], s51 offen lds
    s_add_u32 m0, s50, 98304
    s_add_u32 s51, s47, 3932544
    buffer_load_dwordx4 v250, s[20:23], s51 offen lds
    s_add_u32 m0, s50, 61440
    s_add_u32 s51, s49, 0
    buffer_load_dwordx4 v251, s[8:11], s51 offen lds
    s_add_u32 m0, s50, 65536
    s_add_u32 s51, s49, 36864
    buffer_load_dwordx4 v251, s[8:11], s51 offen lds
    s_add_u32 m0, s50, 69632
    s_add_u32 s51, s49, 73728
    buffer_load_dwordx4 v251, s[8:11], s51 offen lds
    s_waitcnt vmcnt(7)
    s_waitcnt lgkmcnt(0)
    s_barrier
    s_add_u32 m0, s50, 102400
    s_add_u32 s51, s47, 4194304
    buffer_load_dwordx4 v250, s[20:23], s51 offen lds
    s_add_u32 m0, s50, 106496
    s_add_u32 s51, s47, 4194432
    buffer_load_dwordx4 v250, s[20:23], s51 offen lds
    s_add_u32 m0, s50, 110592
    s_add_u32 s51, s47, 4194560
    buffer_load_dwordx4 v250, s[20:23], s51 offen lds
    s_add_u32 m0, s50, 114688
    s_add_u32 s51, s47, 4194688
    buffer_load_dwordx4 v250, s[20:23], s51 offen lds
    s_add_u32 m0, s50, 147456
    s_add_u32 s51, s49, 1024
    buffer_load_dwordx4 v251, s[8:11], s51 offen lds
    s_add_u32 m0, s50, 151552
    s_add_u32 s51, s49, 37888
    buffer_load_dwordx4 v251, s[8:11], s51 offen lds
    s_add_u32 m0, s50, 155648
    s_add_u32 s51, s49, 74752
    buffer_load_dwordx4 v251, s[8:11], s51 offen lds
    s_add_u32 m0, s50, 0
    s_add_u32 s51, s47, 512
    buffer_load_dwordx4 v250, s[20:23], s51 offen lds
    s_add_u32 m0, s50, 4096
    s_add_u32 s51, s47, 640
    buffer_load_dwordx4 v250, s[20:23], s51 offen lds
    s_add_u32 m0, s50, 8192
    s_add_u32 s51, s47, 768
    buffer_load_dwordx4 v250, s[20:23], s51 offen lds
    s_add_u32 m0, s50, 12288
    s_add_u32 s51, s47, 896
    buffer_load_dwordx4 v250, s[20:23], s51 offen lds
    s_waitcnt vmcnt(14)
    s_waitcnt lgkmcnt(0)
    s_barrier
    s_add_u32 m0, s50, 118784
    s_add_u32 s51, s47, 4456448
    buffer_load_dwordx4 v250, s[20:23], s51 offen lds
    s_add_u32 m0, s50, 122880
    s_add_u32 s51, s47, 4456576
    buffer_load_dwordx4 v250, s[20:23], s51 offen lds
    s_add_u32 m0, s50, 126976
    s_add_u32 s51, s47, 4456704
    buffer_load_dwordx4 v250, s[20:23], s51 offen lds
    s_add_u32 m0, s50, 131072
    s_add_u32 s51, s47, 4456832
    buffer_load_dwordx4 v250, s[20:23], s51 offen lds
    s_add_u32 m0, s50, 16384
    s_add_u32 s51, s47, 262656
    buffer_load_dwordx4 v250, s[20:23], s51 offen lds
    s_add_u32 m0, s50, 20480
    s_add_u32 s51, s47, 262784
    buffer_load_dwordx4 v250, s[20:23], s51 offen lds
    s_add_u32 m0, s50, 24576
    s_add_u32 s51, s47, 262912
    buffer_load_dwordx4 v250, s[20:23], s51 offen lds
    s_add_u32 m0, s50, 28672
    s_add_u32 s51, s47, 263040
    buffer_load_dwordx4 v250, s[20:23], s51 offen lds
    s_waitcnt vmcnt(12)
    s_waitcnt lgkmcnt(0)
    s_barrier
    s_add_u32 m0, s50, 32768
    s_add_u32 s51, s47, 524800
    buffer_load_dwordx4 v250, s[20:23], s51 offen lds
    s_add_u32 m0, s50, 36864
    s_add_u32 s51, s47, 524928
    buffer_load_dwordx4 v250, s[20:23], s51 offen lds
    s_add_u32 m0, s50, 40960
    s_add_u32 s51, s47, 525056
    buffer_load_dwordx4 v250, s[20:23], s51 offen lds
    s_add_u32 m0, s50, 45056
    s_add_u32 s51, s47, 525184
    buffer_load_dwordx4 v250, s[20:23], s51 offen lds
    s_add_u32 m0, s50, 135168
    s_add_u32 s51, s46, 0
    buffer_load_dwordx4 v253, s[12:15], s51 offen nt lds
    s_add_u32 m0, s50, 139264
    s_add_u32 s51, s46, 128
    buffer_load_dwordx4 v253, s[12:15], s51 offen nt lds
    s_add_u32 m0, s50, 86016
    s_add_u32 s51, s46, 0
    buffer_load_dwordx4 v254, s[16:19], s51 offen nt lds
    s_add_u32 m0, s50, 90112
    s_add_u32 s51, s46, 128
    buffer_load_dwordx4 v254, s[16:19], s51 offen nt lds
    s_add_u32 m0, s50, 94208
    s_add_u32 s51, s46, 8192
    buffer_load_dwordx4 v253, s[12:15], s51 offen nt lds
    s_add_u32 m0, s50, 98304
    s_add_u32 s51, s46, 8320
    buffer_load_dwordx4 v253, s[12:15], s51 offen nt lds
    s_waitcnt vmcnt(14)
    s_waitcnt lgkmcnt(0)
    s_barrier
    s_add_u32 m0, s50, 49152
    s_add_u32 s51, s49, 128
    buffer_load_dwordx4 v251, s[8:11], s51 offen lds
    s_add_u32 m0, s50, 53248
    s_add_u32 s51, s49, 36992
    buffer_load_dwordx4 v251, s[8:11], s51 offen lds
    s_add_u32 m0, s50, 57344
    s_add_u32 s51, s49, 73856
    buffer_load_dwordx4 v251, s[8:11], s51 offen lds
    s_add_u32 m0, s50, 102400
    s_add_u32 s51, s46, 8192
    buffer_load_dwordx4 v254, s[16:19], s51 offen nt lds
    s_add_u32 m0, s50, 106496
    s_add_u32 s51, s46, 8320
    buffer_load_dwordx4 v254, s[16:19], s51 offen nt lds
    s_add_u32 m0, s50, 110592
    s_add_u32 s51, s46, 16384
    buffer_load_dwordx4 v253, s[12:15], s51 offen nt lds
    s_add_u32 m0, s50, 114688
    s_add_u32 s51, s46, 16512
    buffer_load_dwordx4 v253, s[12:15], s51 offen nt lds
    s_waitcnt lgkmcnt(0)
    s_barrier
    ds_read_b128 v[128:131], v196 offset:12288
    ds_read_b128 v[132:135], v196 offset:14336
    ds_read_b128 v[136:139], v196 offset:16384
    ds_read_b64_tr_b16 v[96:97], v192 offset:0
    ds_read_b64_tr_b16 v[98:99], v192 offset:512
    ds_read_b64_tr_b16 v[100:101], v193 offset:0
    ds_read_b64_tr_b16 v[102:103], v193 offset:512
    ds_read_b64_tr_b16 v[104:105], v194 offset:0
    ds_read_b64_tr_b16 v[106:107], v194 offset:512
    ds_read_b64_tr_b16 v[108:109], v195 offset:0
    ds_read_b64_tr_b16 v[110:111], v195 offset:512
    ds_read_b64_tr_b16 v[112:113], v192 offset:4096
    ds_read_b64_tr_b16 v[114:115], v192 offset:4608
    ds_read_b64_tr_b16 v[116:117], v193 offset:4096
    ds_read_b64_tr_b16 v[118:119], v193 offset:4608
    ds_read_b64_tr_b16 v[120:121], v194 offset:4096
    ds_read_b64_tr_b16 v[122:123], v194 offset:4608
    ds_read_b64_tr_b16 v[124:125], v195 offset:4096
    ds_read_b64_tr_b16 v[126:127], v195 offset:4608
    s_add_u32 m0, s50, 118784
    s_add_u32 s51, s46, 16384
    buffer_load_dwordx4 v254, s[16:19], s51 offen nt lds
    s_add_u32 m0, s50, 122880
    s_add_u32 s51, s46, 16512
    buffer_load_dwordx4 v254, s[16:19], s51 offen nt lds
    s_waitcnt lgkmcnt(14)
    v_mfma_f32_16x16x32_bf16 v[0:3], v[96:99], v[128:131], 0
    v_mfma_f32_16x16x32_bf16 v[4:7], v[96:99], v[132:135], 0
    s_add_u32 m0, s50, 126976
    s_add_u32 s51, s46, 24576
    buffer_load_dwordx4 v253, s[12:15], s51 offen nt lds
    v_mfma_f32_16x16x32_bf16 v[8:11], v[96:99], v[136:139], 0
    s_waitcnt lgkmcnt(12)
    v_mfma_f32_16x16x32_bf16 v[12:15], v[100:103], v[128:131], 0
    v_mfma_f32_16x16x32_bf16 v[16:19], v[100:103], v[132:135], 0
    v_mfma_f32_16x16x32_bf16 v[20:23], v[100:103], v[136:139], 0
    s_waitcnt lgkmcnt(10)
    v_mfma_f32_16x16x32_bf16 v[24:27], v[104:107], v[128:131], 0
    v_mfma_f32_16x16x32_bf16 v[28:31], v[104:107], v[132:135], 0
    v_mfma_f32_16x16x32_bf16 v[32:35], v[104:107], v[136:139], 0
    s_waitcnt lgkmcnt(8)
    v_mfma_f32_16x16x32_bf16 v[36:39], v[108:111], v[128:131], 0
    v_mfma_f32_16x16x32_bf16 v[40:43], v[108:111], v[132:135], 0
    v_mfma_f32_16x16x32_bf16 v[44:47], v[108:111], v[136:139], 0
    s_waitcnt lgkmcnt(6)
    v_mfma_f32_16x16x32_bf16 v[48:51], v[112:115], v[128:131], 0
    s_add_u32 m0, s50, 131072
    s_add_u32 s51, s46, 24704
    buffer_load_dwordx4 v253, s[12:15], s51 offen nt lds
    v_mfma_f32_16x16x32_bf16 v[52:55], v[112:115], v[132:135], 0
    v_mfma_f32_16x16x32_bf16 v[56:59], v[112:115], v[136:139], 0
    s_waitcnt lgkmcnt(4)
    v_mfma_f32_16x16x32_bf16 v[60:63], v[116:119], v[128:131], 0
    v_mfma_f32_16x16x32_bf16 v[64:67], v[116:119], v[132:135], 0
    v_mfma_f32_16x16x32_bf16 v[68:71], v[116:119], v[136:139], 0
    s_waitcnt lgkmcnt(2)
    v_mfma_f32_16x16x32_bf16 v[72:75], v[120:123], v[128:131], 0
    v_mfma_f32_16x16x32_bf16 v[76:79], v[120:123], v[132:135], 0
    v_mfma_f32_16x16x32_bf16 v[80:83], v[120:123], v[136:139], 0
    s_waitcnt lgkmcnt(0)
    v_mfma_f32_16x16x32_bf16 v[84:87], v[124:127], v[128:131], 0
    v_mfma_f32_16x16x32_bf16 v[88:91], v[124:127], v[132:135], 0
    v_mfma_f32_16x16x32_bf16 v[92:95], v[124:127], v[136:139], 0
    s_waitcnt vmcnt(15)
    s_waitcnt lgkmcnt(0)
    s_barrier
    ds_read_b128 v[128:131], v197 offset:12288
    ds_read_b128 v[132:135], v197 offset:14336
    ds_read_b128 v[136:139], v197 offset:16384
    ds_read_b64_tr_b16 v[96:97], v192 offset:16384
    ds_read_b64_tr_b16 v[98:99], v192 offset:16896
    ds_read_b64_tr_b16 v[100:101], v193 offset:16384
    ds_read_b64_tr_b16 v[102:103], v193 offset:16896
    ds_read_b64_tr_b16 v[104:105], v194 offset:16384
    ds_read_b64_tr_b16 v[106:107], v194 offset:16896
    ds_read_b64_tr_b16 v[108:109], v195 offset:16384
    ds_read_b64_tr_b16 v[110:111], v195 offset:16896
    ds_read_b64_tr_b16 v[112:113], v192 offset:20480
    ds_read_b64_tr_b16 v[114:115], v192 offset:20992
    ds_read_b64_tr_b16 v[116:117], v193 offset:20480
    ds_read_b64_tr_b16 v[118:119], v193 offset:20992
    ds_read_b64_tr_b16 v[120:121], v194 offset:20480
    ds_read_b64_tr_b16 v[122:123], v194 offset:20992
    ds_read_b64_tr_b16 v[124:125], v195 offset:20480
    ds_read_b64_tr_b16 v[126:127], v195 offset:20992
    s_add_u32 m0, s50, 0
    s_add_u32 s51, s47, 786944
    buffer_load_dwordx4 v250, s[20:23], s51 offen lds
    s_add_u32 m0, s50, 4096
    s_add_u32 s51, s47, 787072
    buffer_load_dwordx4 v250, s[20:23], s51 offen lds
    s_waitcnt lgkmcnt(14)
    v_mfma_f32_16x16x32_bf16 v[0:3], v[96:99], v[128:131], v[0:3]
    v_mfma_f32_16x16x32_bf16 v[4:7], v[96:99], v[132:135], v[4:7]
    s_add_u32 m0, s50, 8192
    s_add_u32 s51, s47, 787200
    buffer_load_dwordx4 v250, s[20:23], s51 offen lds
    v_mfma_f32_16x16x32_bf16 v[8:11], v[96:99], v[136:139], v[8:11]
    s_waitcnt lgkmcnt(12)
    v_mfma_f32_16x16x32_bf16 v[12:15], v[100:103], v[128:131], v[12:15]
    v_mfma_f32_16x16x32_bf16 v[16:19], v[100:103], v[132:135], v[16:19]
    v_mfma_f32_16x16x32_bf16 v[20:23], v[100:103], v[136:139], v[20:23]
    s_waitcnt lgkmcnt(10)
    v_mfma_f32_16x16x32_bf16 v[24:27], v[104:107], v[128:131], v[24:27]
    v_mfma_f32_16x16x32_bf16 v[28:31], v[104:107], v[132:135], v[28:31]
    v_mfma_f32_16x16x32_bf16 v[32:35], v[104:107], v[136:139], v[32:35]
    s_waitcnt lgkmcnt(8)
    v_mfma_f32_16x16x32_bf16 v[36:39], v[108:111], v[128:131], v[36:39]
    v_mfma_f32_16x16x32_bf16 v[40:43], v[108:111], v[132:135], v[40:43]
    v_mfma_f32_16x16x32_bf16 v[44:47], v[108:111], v[136:139], v[44:47]
    s_waitcnt lgkmcnt(6)
    v_mfma_f32_16x16x32_bf16 v[48:51], v[112:115], v[128:131], v[48:51]
    s_add_u32 m0, s50, 12288
    s_add_u32 s51, s47, 787328
    buffer_load_dwordx4 v250, s[20:23], s51 offen lds
    v_mfma_f32_16x16x32_bf16 v[52:55], v[112:115], v[132:135], v[52:55]
    v_mfma_f32_16x16x32_bf16 v[56:59], v[112:115], v[136:139], v[56:59]
    s_waitcnt lgkmcnt(4)
    v_mfma_f32_16x16x32_bf16 v[60:63], v[116:119], v[128:131], v[60:63]
    v_mfma_f32_16x16x32_bf16 v[64:67], v[116:119], v[132:135], v[64:67]
    v_mfma_f32_16x16x32_bf16 v[68:71], v[116:119], v[136:139], v[68:71]
    s_waitcnt lgkmcnt(2)
    v_mfma_f32_16x16x32_bf16 v[72:75], v[120:123], v[128:131], v[72:75]
    v_mfma_f32_16x16x32_bf16 v[76:79], v[120:123], v[132:135], v[76:79]
    v_mfma_f32_16x16x32_bf16 v[80:83], v[120:123], v[136:139], v[80:83]
    s_waitcnt lgkmcnt(0)
    v_mfma_f32_16x16x32_bf16 v[84:87], v[124:127], v[128:131], v[84:87]
    v_mfma_f32_16x16x32_bf16 v[88:91], v[124:127], v[132:135], v[88:91]
    v_mfma_f32_16x16x32_bf16 v[92:95], v[124:127], v[136:139], v[92:95]
    s_waitcnt vmcnt(12)
    s_waitcnt lgkmcnt(0)
    s_barrier
    ds_read_b128 v[128:131], v196 offset:0
    ds_read_b128 v[132:135], v196 offset:2048
    ds_read_b128 v[136:139], v196 offset:4096
    ds_read_b64_tr_b16 v[96:97], v192 offset:32768
    ds_read_b64_tr_b16 v[98:99], v192 offset:33280
    ds_read_b64_tr_b16 v[100:101], v193 offset:32768
    ds_read_b64_tr_b16 v[102:103], v193 offset:33280
    ds_read_b64_tr_b16 v[104:105], v194 offset:32768
    ds_read_b64_tr_b16 v[106:107], v194 offset:33280
    ds_read_b64_tr_b16 v[108:109], v195 offset:32768
    ds_read_b64_tr_b16 v[110:111], v195 offset:33280
    ds_read_b64_tr_b16 v[112:113], v192 offset:36864
    ds_read_b64_tr_b16 v[114:115], v192 offset:37376
    ds_read_b64_tr_b16 v[116:117], v193 offset:36864
    ds_read_b64_tr_b16 v[118:119], v193 offset:37376
    ds_read_b64_tr_b16 v[120:121], v194 offset:36864
    ds_read_b64_tr_b16 v[122:123], v194 offset:37376
    ds_read_b64_tr_b16 v[124:125], v195 offset:36864
    ds_read_b64_tr_b16 v[126:127], v195 offset:37376
    s_add_u32 m0, s50, 16384
    s_add_u32 s51, s47, 1049088
    buffer_load_dwordx4 v250, s[20:23], s51 offen lds
    s_add_u32 m0, s50, 20480
    s_add_u32 s51, s47, 1049216
    buffer_load_dwordx4 v250, s[20:23], s51 offen lds
    s_waitcnt lgkmcnt(14)
    v_mfma_f32_16x16x32_bf16 v[0:3], v[96:99], v[128:131], v[0:3]
    v_mfma_f32_16x16x32_bf16 v[4:7], v[96:99], v[132:135], v[4:7]
    s_add_u32 m0, s50, 24576
    s_add_u32 s51, s47, 1049344
    buffer_load_dwordx4 v250, s[20:23], s51 offen lds
    v_mfma_f32_16x16x32_bf16 v[8:11], v[96:99], v[136:139], v[8:11]
    s_waitcnt lgkmcnt(12)
    v_mfma_f32_16x16x32_bf16 v[12:15], v[100:103], v[128:131], v[12:15]
    s_add_u32 m0, s50, 28672
    s_add_u32 s51, s47, 1049472
    buffer_load_dwordx4 v250, s[20:23], s51 offen lds
    v_mfma_f32_16x16x32_bf16 v[16:19], v[100:103], v[132:135], v[16:19]
    v_mfma_f32_16x16x32_bf16 v[20:23], v[100:103], v[136:139], v[20:23]
    s_add_u32 m0, s50, 61440
    s_add_u32 s51, s49, 256
    buffer_load_dwordx4 v251, s[8:11], s51 offen lds
    s_waitcnt lgkmcnt(10)
    v_mfma_f32_16x16x32_bf16 v[24:27], v[104:107], v[128:131], v[24:27]
    v_mfma_f32_16x16x32_bf16 v[28:31], v[104:107], v[132:135], v[28:31]
    v_mfma_f32_16x16x32_bf16 v[32:35], v[104:107], v[136:139], v[32:35]
    s_add_u32 m0, s50, 65536
    s_add_u32 s51, s49, 37120
    buffer_load_dwordx4 v251, s[8:11], s51 offen lds
    s_waitcnt lgkmcnt(8)
    v_mfma_f32_16x16x32_bf16 v[36:39], v[108:111], v[128:131], v[36:39]
    v_mfma_f32_16x16x32_bf16 v[40:43], v[108:111], v[132:135], v[40:43]
    s_add_u32 m0, s50, 69632
    s_add_u32 s51, s49, 73984
    buffer_load_dwordx4 v251, s[8:11], s51 offen lds
    v_mfma_f32_16x16x32_bf16 v[44:47], v[108:111], v[136:139], v[44:47]
    s_waitcnt lgkmcnt(6)
    v_mfma_f32_16x16x32_bf16 v[48:51], v[112:115], v[128:131], v[48:51]
    v_mfma_f32_16x16x32_bf16 v[52:55], v[112:115], v[132:135], v[52:55]
    s_add_u32 m0, s50, 135168
    s_add_u32 s51, s46, 24576
    buffer_load_dwordx4 v254, s[16:19], s51 offen nt lds
    v_mfma_f32_16x16x32_bf16 v[56:59], v[112:115], v[136:139], v[56:59]
    s_waitcnt lgkmcnt(4)
    v_mfma_f32_16x16x32_bf16 v[60:63], v[116:119], v[128:131], v[60:63]
    s_add_u32 m0, s50, 139264
    s_add_u32 s51, s46, 24704
    buffer_load_dwordx4 v254, s[16:19], s51 offen nt lds
    v_mfma_f32_16x16x32_bf16 v[64:67], v[116:119], v[132:135], v[64:67]
    v_mfma_f32_16x16x32_bf16 v[68:71], v[116:119], v[136:139], v[68:71]
    s_waitcnt lgkmcnt(2)
    v_mfma_f32_16x16x32_bf16 v[72:75], v[120:123], v[128:131], v[72:75]
    s_add_u32 m0, s50, 143360
    s_add_u32 s51, s46, 32768
    buffer_load_dwordx4 v253, s[12:15], s51 offen nt lds
    v_mfma_f32_16x16x32_bf16 v[76:79], v[120:123], v[132:135], v[76:79]
    v_mfma_f32_16x16x32_bf16 v[80:83], v[120:123], v[136:139], v[80:83]
    s_add_u32 m0, s50, 147456
    s_add_u32 s51, s46, 32896
    buffer_load_dwordx4 v253, s[12:15], s51 offen nt lds
    s_waitcnt lgkmcnt(0)
    v_mfma_f32_16x16x32_bf16 v[84:87], v[124:127], v[128:131], v[84:87]
    v_mfma_f32_16x16x32_bf16 v[88:91], v[124:127], v[132:135], v[88:91]
    v_mfma_f32_16x16x32_bf16 v[92:95], v[124:127], v[136:139], v[92:95]
    s_waitcnt vmcnt(11)
    s_waitcnt lgkmcnt(0)
    s_barrier
    ds_read_b128 v[128:131], v197 offset:0
    ds_read_b128 v[132:135], v197 offset:2048
    ds_read_b128 v[136:139], v197 offset:4096
    ds_read_b64_tr_b16 v[96:97], v192 offset:0
    ds_read_b64_tr_b16 v[98:99], v192 offset:512
    ds_read_b64_tr_b16 v[100:101], v193 offset:0
    ds_read_b64_tr_b16 v[102:103], v193 offset:512
    ds_read_b64_tr_b16 v[104:105], v194 offset:0
    ds_read_b64_tr_b16 v[106:107], v194 offset:512
    ds_read_b64_tr_b16 v[108:109], v195 offset:0
    ds_read_b64_tr_b16 v[110:111], v195 offset:512
    ds_read_b64_tr_b16 v[112:113], v192 offset:4096
    ds_read_b64_tr_b16 v[114:115], v192 offset:4608
    ds_read_b64_tr_b16 v[116:117], v193 offset:4096
    ds_read_b64_tr_b16 v[118:119], v193 offset:4608
    ds_read_b64_tr_b16 v[120:121], v194 offset:4096
    ds_read_b64_tr_b16 v[122:123], v194 offset:4608
    ds_read_b64_tr_b16 v[124:125], v195 offset:4096
    ds_read_b64_tr_b16 v[126:127], v195 offset:4608
    s_add_u32 m0, s50, 32768
    s_add_u32 s51, s47, 1311232
    buffer_load_dwordx4 v250, s[20:23], s51 offen lds
    s_add_u32 m0, s50, 36864
    s_add_u32 s51, s47, 1311360
    buffer_load_dwordx4 v250, s[20:23], s51 offen lds
    s_waitcnt lgkmcnt(14)
    v_mfma_f32_16x16x32_bf16 v[0:3], v[96:99], v[128:131], v[0:3]
    v_mfma_f32_16x16x32_bf16 v[4:7], v[96:99], v[132:135], v[4:7]
    s_add_u32 m0, s50, 40960
    s_add_u32 s51, s47, 1311488
    buffer_load_dwordx4 v250, s[20:23], s51 offen lds
    v_mfma_f32_16x16x32_bf16 v[8:11], v[96:99], v[136:139], v[8:11]
    s_waitcnt lgkmcnt(12)
    v_mfma_f32_16x16x32_bf16 v[12:15], v[100:103], v[128:131], v[12:15]
    v_mfma_f32_16x16x32_bf16 v[16:19], v[100:103], v[132:135], v[16:19]
    s_add_u32 m0, s50, 45056
    s_add_u32 s51, s47, 1311616
    buffer_load_dwordx4 v250, s[20:23], s51 offen lds
    v_mfma_f32_16x16x32_bf16 v[20:23], v[100:103], v[136:139], v[20:23]
    s_waitcnt lgkmcnt(10)
    v_mfma_f32_16x16x32_bf16 v[24:27], v[104:107], v[128:131], v[24:27]
    v_mfma_f32_16x16x32_bf16 v[28:31], v[104:107], v[132:135], v[28:31]
    v_mfma_f32_16x16x32_bf16 v[32:35], v[104:107], v[136:139], v[32:35]
    s_add_u32 m0, s50, 86016
    s_add_u32 s51, s46, 32768
    buffer_load_dwordx4 v254, s[16:19], s51 offen nt lds
    s_waitcnt lgkmcnt(8)
    v_mfma_f32_16x16x32_bf16 v[36:39], v[108:111], v[128:131], v[36:39]
    v_mfma_f32_16x16x32_bf16 v[40:43], v[108:111], v[132:135], v[40:43]
    v_mfma_f32_16x16x32_bf16 v[44:47], v[108:111], v[136:139], v[44:47]
    s_waitcnt lgkmcnt(6)
    v_mfma_f32_16x16x32_bf16 v[48:51], v[112:115], v[128:131], v[48:51]
    s_add_u32 m0, s50, 90112
    s_add_u32 s51, s46, 32896
    buffer_load_dwordx4 v254, s[16:19], s51 offen nt lds
    v_mfma_f32_16x16x32_bf16 v[52:55], v[112:115], v[132:135], v[52:55]
    v_mfma_f32_16x16x32_bf16 v[56:59], v[112:115], v[136:139], v[56:59]
    s_waitcnt lgkmcnt(4)
    v_mfma_f32_16x16x32_bf16 v[60:63], v[116:119], v[128:131], v[60:63]
    s_add_u32 m0, s50, 94208
    s_add_u32 s51, s46, 40960
    buffer_load_dwordx4 v253, s[12:15], s51 offen nt lds
    v_mfma_f32_16x16x32_bf16 v[64:67], v[116:119], v[132:135], v[64:67]
    v_mfma_f32_16x16x32_bf16 v[68:71], v[116:119], v[136:139], v[68:71]
    s_waitcnt lgkmcnt(2)
    v_mfma_f32_16x16x32_bf16 v[72:75], v[120:123], v[128:131], v[72:75]
    v_mfma_f32_16x16x32_bf16 v[76:79], v[120:123], v[132:135], v[76:79]
    s_add_u32 m0, s50, 98304
    s_add_u32 s51, s46, 41088
    buffer_load_dwordx4 v253, s[12:15], s51 offen nt lds
    v_mfma_f32_16x16x32_bf16 v[80:83], v[120:123], v[136:139], v[80:83]
    s_waitcnt lgkmcnt(0)
    v_mfma_f32_16x16x32_bf16 v[84:87], v[124:127], v[128:131], v[84:87]
    v_mfma_f32_16x16x32_bf16 v[88:91], v[124:127], v[132:135], v[88:91]
    v_mfma_f32_16x16x32_bf16 v[92:95], v[124:127], v[136:139], v[92:95]
    s_waitcnt vmcnt(12)
    s_waitcnt lgkmcnt(0)
    s_barrier
    ds_read_b128 v[128:131], v196 offset:12288
    ds_read_b128 v[132:135], v196 offset:14336
    ds_read_b128 v[136:139], v196 offset:16384
    ds_read_b64_tr_b16 v[96:97], v192 offset:16384
    ds_read_b64_tr_b16 v[98:99], v192 offset:16896
    ds_read_b64_tr_b16 v[100:101], v193 offset:16384
    ds_read_b64_tr_b16 v[102:103], v193 offset:16896
    ds_read_b64_tr_b16 v[104:105], v194 offset:16384
    ds_read_b64_tr_b16 v[106:107], v194 offset:16896
    ds_read_b64_tr_b16 v[108:109], v195 offset:16384
    ds_read_b64_tr_b16 v[110:111], v195 offset:16896
    ds_read_b64_tr_b16 v[112:113], v192 offset:20480
    ds_read_b64_tr_b16 v[114:115], v192 offset:20992
    ds_read_b64_tr_b16 v[116:117], v193 offset:20480
    ds_read_b64_tr_b16 v[118:119], v193 offset:20992
    ds_read_b64_tr_b16 v[120:121], v194 offset:20480
    ds_read_b64_tr_b16 v[122:123], v194 offset:20992
    ds_read_b64_tr_b16 v[124:125], v195 offset:20480
    ds_read_b64_tr_b16 v[126:127], v195 offset:20992
    s_add_u32 m0, s50, 0
    s_add_u32 s51, s47, 1573376
    buffer_load_dwordx4 v250, s[20:23], s51 offen lds
    s_add_u32 m0, s50, 4096
    s_add_u32 s51, s47, 1573504
    buffer_load_dwordx4 v250, s[20:23], s51 offen lds
    s_waitcnt lgkmcnt(14)
    v_mfma_f32_16x16x32_bf16 v[0:3], v[96:99], v[128:131], v[0:3]
    v_mfma_f32_16x16x32_bf16 v[4:7], v[96:99], v[132:135], v[4:7]
    s_add_u32 m0, s50, 8192
    s_add_u32 s51, s47, 1573632
    buffer_load_dwordx4 v250, s[20:23], s51 offen lds
    v_mfma_f32_16x16x32_bf16 v[8:11], v[96:99], v[136:139], v[8:11]
    s_waitcnt lgkmcnt(12)
    v_mfma_f32_16x16x32_bf16 v[12:15], v[100:103], v[128:131], v[12:15]
    s_add_u32 m0, s50, 12288
    s_add_u32 s51, s47, 1573760
    buffer_load_dwordx4 v250, s[20:23], s51 offen lds
    v_mfma_f32_16x16x32_bf16 v[16:19], v[100:103], v[132:135], v[16:19]
    v_mfma_f32_16x16x32_bf16 v[20:23], v[100:103], v[136:139], v[20:23]
    s_add_u32 m0, s50, 49152
    s_add_u32 s51, s49, 384
    buffer_load_dwordx4 v251, s[8:11], s51 offen lds
    s_waitcnt lgkmcnt(10)
    v_mfma_f32_16x16x32_bf16 v[24:27], v[104:107], v[128:131], v[24:27]
    v_mfma_f32_16x16x32_bf16 v[28:31], v[104:107], v[132:135], v[28:31]
    v_mfma_f32_16x16x32_bf16 v[32:35], v[104:107], v[136:139], v[32:35]
    s_add_u32 m0, s50, 53248
    s_add_u32 s51, s49, 37248
    buffer_load_dwordx4 v251, s[8:11], s51 offen lds
    s_waitcnt lgkmcnt(8)
    v_mfma_f32_16x16x32_bf16 v[36:39], v[108:111], v[128:131], v[36:39]
    v_mfma_f32_16x16x32_bf16 v[40:43], v[108:111], v[132:135], v[40:43]
    s_add_u32 m0, s50, 57344
    s_add_u32 s51, s49, 74112
    buffer_load_dwordx4 v251, s[8:11], s51 offen lds
    v_mfma_f32_16x16x32_bf16 v[44:47], v[108:111], v[136:139], v[44:47]
    s_waitcnt lgkmcnt(6)
    v_mfma_f32_16x16x32_bf16 v[48:51], v[112:115], v[128:131], v[48:51]
    v_mfma_f32_16x16x32_bf16 v[52:55], v[112:115], v[132:135], v[52:55]
    s_add_u32 m0, s50, 102400
    s_add_u32 s51, s46, 40960
    buffer_load_dwordx4 v254, s[16:19], s51 offen nt lds
    v_mfma_f32_16x16x32_bf16 v[56:59], v[112:115], v[136:139], v[56:59]
    s_waitcnt lgkmcnt(4)
    v_mfma_f32_16x16x32_bf16 v[60:63], v[116:119], v[128:131], v[60:63]
    s_add_u32 m0, s50, 106496
    s_add_u32 s51, s46, 41088
    buffer_load_dwordx4 v254, s[16:19], s51 offen nt lds
    v_mfma_f32_16x16x32_bf16 v[64:67], v[116:119], v[132:135], v[64:67]
    v_mfma_f32_16x16x32_bf16 v[68:71], v[116:119], v[136:139], v[68:71]
    s_waitcnt lgkmcnt(2)
    v_mfma_f32_16x16x32_bf16 v[72:75], v[120:123], v[128:131], v[72:75]
    s_add_u32 m0, s50, 110592
    s_add_u32 s51, s46, 49152
    buffer_load_dwordx4 v253, s[12:15], s51 offen nt lds
    v_mfma_f32_16x16x32_bf16 v[76:79], v[120:123], v[132:135], v[76:79]
    v_mfma_f32_16x16x32_bf16 v[80:83], v[120:123], v[136:139], v[80:83]
    s_add_u32 m0, s50, 114688
    s_add_u32 s51, s46, 49280
    buffer_load_dwordx4 v253, s[12:15], s51 offen nt lds
    s_waitcnt lgkmcnt(0)
    v_mfma_f32_16x16x32_bf16 v[84:87], v[124:127], v[128:131], v[84:87]
    v_mfma_f32_16x16x32_bf16 v[88:91], v[124:127], v[132:135], v[88:91]
    v_mfma_f32_16x16x32_bf16 v[92:95], v[124:127], v[136:139], v[92:95]
    s_waitcnt vmcnt(15)
    s_waitcnt lgkmcnt(0)
    s_barrier
    ds_read_b128 v[128:131], v197 offset:12288
    ds_read_b128 v[132:135], v197 offset:14336
    ds_read_b128 v[136:139], v197 offset:16384
    ds_read_b64_tr_b16 v[96:97], v192 offset:32768
    ds_read_b64_tr_b16 v[98:99], v192 offset:33280
    ds_read_b64_tr_b16 v[100:101], v193 offset:32768
    ds_read_b64_tr_b16 v[102:103], v193 offset:33280
    ds_read_b64_tr_b16 v[104:105], v194 offset:32768
    ds_read_b64_tr_b16 v[106:107], v194 offset:33280
    ds_read_b64_tr_b16 v[108:109], v195 offset:32768
    ds_read_b64_tr_b16 v[110:111], v195 offset:33280
    ds_read_b64_tr_b16 v[112:113], v192 offset:36864
    ds_read_b64_tr_b16 v[114:115], v192 offset:37376
    ds_read_b64_tr_b16 v[116:117], v193 offset:36864
    ds_read_b64_tr_b16 v[118:119], v193 offset:37376
    ds_read_b64_tr_b16 v[120:121], v194 offset:36864
    ds_read_b64_tr_b16 v[122:123], v194 offset:37376
    ds_read_b64_tr_b16 v[124:125], v195 offset:36864
    ds_read_b64_tr_b16 v[126:127], v195 offset:37376
    s_add_u32 m0, s50, 16384
    s_add_u32 s51, s47, 1835520
    buffer_load_dwordx4 v250, s[20:23], s51 offen lds
    s_add_u32 m0, s50, 20480
    s_add_u32 s51, s47, 1835648
    buffer_load_dwordx4 v250, s[20:23], s51 offen lds
    s_waitcnt lgkmcnt(14)
    v_mfma_f32_16x16x32_bf16 v[0:3], v[96:99], v[128:131], v[0:3]
    v_mfma_f32_16x16x32_bf16 v[4:7], v[96:99], v[132:135], v[4:7]
    s_add_u32 m0, s50, 24576
    s_add_u32 s51, s47, 1835776
    buffer_load_dwordx4 v250, s[20:23], s51 offen lds
    v_mfma_f32_16x16x32_bf16 v[8:11], v[96:99], v[136:139], v[8:11]
    s_waitcnt lgkmcnt(12)
    v_mfma_f32_16x16x32_bf16 v[12:15], v[100:103], v[128:131], v[12:15]
    v_mfma_f32_16x16x32_bf16 v[16:19], v[100:103], v[132:135], v[16:19]
    s_add_u32 m0, s50, 28672
    s_add_u32 s51, s47, 1835904
    buffer_load_dwordx4 v250, s[20:23], s51 offen lds
    v_mfma_f32_16x16x32_bf16 v[20:23], v[100:103], v[136:139], v[20:23]
    s_waitcnt lgkmcnt(10)
    v_mfma_f32_16x16x32_bf16 v[24:27], v[104:107], v[128:131], v[24:27]
    v_mfma_f32_16x16x32_bf16 v[28:31], v[104:107], v[132:135], v[28:31]
    v_mfma_f32_16x16x32_bf16 v[32:35], v[104:107], v[136:139], v[32:35]
    s_add_u32 m0, s50, 118784
    s_add_u32 s51, s46, 49152
    buffer_load_dwordx4 v254, s[16:19], s51 offen nt lds
    s_waitcnt lgkmcnt(8)
    v_mfma_f32_16x16x32_bf16 v[36:39], v[108:111], v[128:131], v[36:39]
    v_mfma_f32_16x16x32_bf16 v[40:43], v[108:111], v[132:135], v[40:43]
    v_mfma_f32_16x16x32_bf16 v[44:47], v[108:111], v[136:139], v[44:47]
    s_waitcnt lgkmcnt(6)
    v_mfma_f32_16x16x32_bf16 v[48:51], v[112:115], v[128:131], v[48:51]
    s_add_u32 m0, s50, 122880
    s_add_u32 s51, s46, 49280
    buffer_load_dwordx4 v254, s[16:19], s51 offen nt lds
    v_mfma_f32_16x16x32_bf16 v[52:55], v[112:115], v[132:135], v[52:55]
    v_mfma_f32_16x16x32_bf16 v[56:59], v[112:115], v[136:139], v[56:59]
    s_waitcnt lgkmcnt(4)
    v_mfma_f32_16x16x32_bf16 v[60:63], v[116:119], v[128:131], v[60:63]
    s_add_u32 m0, s50, 126976
    s_add_u32 s51, s46, 57344
    buffer_load_dwordx4 v253, s[12:15], s51 offen nt lds
    v_mfma_f32_16x16x32_bf16 v[64:67], v[116:119], v[132:135], v[64:67]
    v_mfma_f32_16x16x32_bf16 v[68:71], v[116:119], v[136:139], v[68:71]
    s_waitcnt lgkmcnt(2)
    v_mfma_f32_16x16x32_bf16 v[72:75], v[120:123], v[128:131], v[72:75]
    v_mfma_f32_16x16x32_bf16 v[76:79], v[120:123], v[132:135], v[76:79]
    s_add_u32 m0, s50, 131072
    s_add_u32 s51, s46, 57472
    buffer_load_dwordx4 v253, s[12:15], s51 offen nt lds
    v_mfma_f32_16x16x32_bf16 v[80:83], v[120:123], v[136:139], v[80:83]
    s_waitcnt lgkmcnt(0)
    v_mfma_f32_16x16x32_bf16 v[84:87], v[124:127], v[128:131], v[84:87]
    v_mfma_f32_16x16x32_bf16 v[88:91], v[124:127], v[132:135], v[88:91]
    v_mfma_f32_16x16x32_bf16 v[92:95], v[124:127], v[136:139], v[92:95]
    s_waitcnt vmcnt(12)
    s_waitcnt lgkmcnt(0)
    s_barrier
    ds_read_b128 v[128:131], v196 offset:0
    ds_read_b128 v[132:135], v196 offset:2048
    ds_read_b128 v[136:139], v196 offset:4096
    ds_read_b64_tr_b16 v[96:97], v192 offset:0
    ds_read_b64_tr_b16 v[98:99], v192 offset:512
    ds_read_b64_tr_b16 v[100:101], v193 offset:0
    ds_read_b64_tr_b16 v[102:103], v193 offset:512
    ds_read_b64_tr_b16 v[104:105], v194 offset:0
    ds_read_b64_tr_b16 v[106:107], v194 offset:512
    ds_read_b64_tr_b16 v[108:109], v195 offset:0
    ds_read_b64_tr_b16 v[110:111], v195 offset:512
    ds_read_b64_tr_b16 v[112:113], v192 offset:4096
    ds_read_b64_tr_b16 v[114:115], v192 offset:4608
    ds_read_b64_tr_b16 v[116:117], v193 offset:4096
    ds_read_b64_tr_b16 v[118:119], v193 offset:4608
    ds_read_b64_tr_b16 v[120:121], v194 offset:4096
    ds_read_b64_tr_b16 v[122:123], v194 offset:4608
    ds_read_b64_tr_b16 v[124:125], v195 offset:4096
    ds_read_b64_tr_b16 v[126:127], v195 offset:4608
    s_add_u32 m0, s50, 32768
    s_add_u32 s51, s47, 2097664
    buffer_load_dwordx4 v250, s[20:23], s51 offen lds
    s_add_u32 m0, s50, 36864
    s_add_u32 s51, s47, 2097792
    buffer_load_dwordx4 v250, s[20:23], s51 offen lds
    s_waitcnt lgkmcnt(14)
    v_mfma_f32_16x16x32_bf16 v[0:3], v[96:99], v[128:131], v[0:3]
    v_mfma_f32_16x16x32_bf16 v[4:7], v[96:99], v[132:135], v[4:7]
    s_add_u32 m0, s50, 40960
    s_add_u32 s51, s47, 2097920
    buffer_load_dwordx4 v250, s[20:23], s51 offen lds
    v_mfma_f32_16x16x32_bf16 v[8:11], v[96:99], v[136:139], v[8:11]
    s_waitcnt lgkmcnt(12)
    v_mfma_f32_16x16x32_bf16 v[12:15], v[100:103], v[128:131], v[12:15]
    s_add_u32 m0, s50, 45056
    s_add_u32 s51, s47, 2098048
    buffer_load_dwordx4 v250, s[20:23], s51 offen lds
    v_mfma_f32_16x16x32_bf16 v[16:19], v[100:103], v[132:135], v[16:19]
    v_mfma_f32_16x16x32_bf16 v[20:23], v[100:103], v[136:139], v[20:23]
    s_add_u32 m0, s50, 61440
    s_add_u32 s51, s49, 512
    buffer_load_dwordx4 v251, s[8:11], s51 offen lds
    s_waitcnt lgkmcnt(10)
    v_mfma_f32_16x16x32_bf16 v[24:27], v[104:107], v[128:131], v[24:27]
    v_mfma_f32_16x16x32_bf16 v[28:31], v[104:107], v[132:135], v[28:31]
    v_mfma_f32_16x16x32_bf16 v[32:35], v[104:107], v[136:139], v[32:35]
    s_add_u32 m0, s50, 65536
    s_add_u32 s51, s49, 37376
    buffer_load_dwordx4 v251, s[8:11], s51 offen lds
    s_waitcnt lgkmcnt(8)
    v_mfma_f32_16x16x32_bf16 v[36:39], v[108:111], v[128:131], v[36:39]
    v_mfma_f32_16x16x32_bf16 v[40:43], v[108:111], v[132:135], v[40:43]
    s_add_u32 m0, s50, 69632
    s_add_u32 s51, s49, 74240
    buffer_load_dwordx4 v251, s[8:11], s51 offen lds
    v_mfma_f32_16x16x32_bf16 v[44:47], v[108:111], v[136:139], v[44:47]
    s_waitcnt lgkmcnt(6)
    v_mfma_f32_16x16x32_bf16 v[48:51], v[112:115], v[128:131], v[48:51]
    v_mfma_f32_16x16x32_bf16 v[52:55], v[112:115], v[132:135], v[52:55]
    s_add_u32 m0, s50, 135168
    s_add_u32 s51, s46, 57344
    buffer_load_dwordx4 v254, s[16:19], s51 offen nt lds
    v_mfma_f32_16x16x32_bf16 v[56:59], v[112:115], v[136:139], v[56:59]
    s_waitcnt lgkmcnt(4)
    v_mfma_f32_16x16x32_bf16 v[60:63], v[116:119], v[128:131], v[60:63]
    s_add_u32 m0, s50, 139264
    s_add_u32 s51, s46, 57472
    buffer_load_dwordx4 v254, s[16:19], s51 offen nt lds
    v_mfma_f32_16x16x32_bf16 v[64:67], v[116:119], v[132:135], v[64:67]
    v_mfma_f32_16x16x32_bf16 v[68:71], v[116:119], v[136:139], v[68:71]
    s_waitcnt lgkmcnt(2)
    v_mfma_f32_16x16x32_bf16 v[72:75], v[120:123], v[128:131], v[72:75]
    s_add_u32 m0, s50, 143360
    s_add_u32 s51, s46, 65536
    buffer_load_dwordx4 v253, s[12:15], s51 offen nt lds
    v_mfma_f32_16x16x32_bf16 v[76:79], v[120:123], v[132:135], v[76:79]
    v_mfma_f32_16x16x32_bf16 v[80:83], v[120:123], v[136:139], v[80:83]
    s_add_u32 m0, s50, 147456
    s_add_u32 s51, s46, 65664
    buffer_load_dwordx4 v253, s[12:15], s51 offen nt lds
    s_waitcnt lgkmcnt(0)
    v_mfma_f32_16x16x32_bf16 v[84:87], v[124:127], v[128:131], v[84:87]
    v_mfma_f32_16x16x32_bf16 v[88:91], v[124:127], v[132:135], v[88:91]
    v_mfma_f32_16x16x32_bf16 v[92:95], v[124:127], v[136:139], v[92:95]
    s_waitcnt vmcnt(15)
    s_waitcnt lgkmcnt(0)
    s_barrier
    ds_read_b128 v[128:131], v197 offset:0
    ds_read_b128 v[132:135], v197 offset:2048
    ds_read_b128 v[136:139], v197 offset:4096
    ds_read_b64_tr_b16 v[96:97], v192 offset:16384
    ds_read_b64_tr_b16 v[98:99], v192 offset:16896
    ds_read_b64_tr_b16 v[100:101], v193 offset:16384
    ds_read_b64_tr_b16 v[102:103], v193 offset:16896
    ds_read_b64_tr_b16 v[104:105], v194 offset:16384
    ds_read_b64_tr_b16 v[106:107], v194 offset:16896
    ds_read_b64_tr_b16 v[108:109], v195 offset:16384
    ds_read_b64_tr_b16 v[110:111], v195 offset:16896
    ds_read_b64_tr_b16 v[112:113], v192 offset:20480
    ds_read_b64_tr_b16 v[114:115], v192 offset:20992
    ds_read_b64_tr_b16 v[116:117], v193 offset:20480
    ds_read_b64_tr_b16 v[118:119], v193 offset:20992
    ds_read_b64_tr_b16 v[120:121], v194 offset:20480
    ds_read_b64_tr_b16 v[122:123], v194 offset:20992
    ds_read_b64_tr_b16 v[124:125], v195 offset:20480
    ds_read_b64_tr_b16 v[126:127], v195 offset:20992
    s_add_u32 m0, s50, 0
    s_add_u32 s51, s47, 2359808
    buffer_load_dwordx4 v250, s[20:23], s51 offen lds
    s_add_u32 m0, s50, 4096
    s_add_u32 s51, s47, 2359936
    buffer_load_dwordx4 v250, s[20:23], s51 offen lds
    s_waitcnt lgkmcnt(14)
    v_mfma_f32_16x16x32_bf16 v[0:3], v[96:99], v[128:131], v[0:3]
    v_mfma_f32_16x16x32_bf16 v[4:7], v[96:99], v[132:135], v[4:7]
    s_add_u32 m0, s50, 8192
    s_add_u32 s51, s47, 2360064
    buffer_load_dwordx4 v250, s[20:23], s51 offen lds
    v_mfma_f32_16x16x32_bf16 v[8:11], v[96:99], v[136:139], v[8:11]
    s_waitcnt lgkmcnt(12)
    v_mfma_f32_16x16x32_bf16 v[12:15], v[100:103], v[128:131], v[12:15]
    v_mfma_f32_16x16x32_bf16 v[16:19], v[100:103], v[132:135], v[16:19]
    s_add_u32 m0, s50, 12288
    s_add_u32 s51, s47, 2360192
    buffer_load_dwordx4 v250, s[20:23], s51 offen lds
    v_mfma_f32_16x16x32_bf16 v[20:23], v[100:103], v[136:139], v[20:23]
    s_waitcnt lgkmcnt(10)
    v_mfma_f32_16x16x32_bf16 v[24:27], v[104:107], v[128:131], v[24:27]
    v_mfma_f32_16x16x32_bf16 v[28:31], v[104:107], v[132:135], v[28:31]
    v_mfma_f32_16x16x32_bf16 v[32:35], v[104:107], v[136:139], v[32:35]
    s_add_u32 m0, s50, 86016
    s_add_u32 s51, s46, 65536
    buffer_load_dwordx4 v254, s[16:19], s51 offen nt lds
    s_waitcnt lgkmcnt(8)
    v_mfma_f32_16x16x32_bf16 v[36:39], v[108:111], v[128:131], v[36:39]
    v_mfma_f32_16x16x32_bf16 v[40:43], v[108:111], v[132:135], v[40:43]
    v_mfma_f32_16x16x32_bf16 v[44:47], v[108:111], v[136:139], v[44:47]
    s_waitcnt lgkmcnt(6)
    v_mfma_f32_16x16x32_bf16 v[48:51], v[112:115], v[128:131], v[48:51]
    s_add_u32 m0, s50, 90112
    s_add_u32 s51, s46, 65664
    buffer_load_dwordx4 v254, s[16:19], s51 offen nt lds
    v_mfma_f32_16x16x32_bf16 v[52:55], v[112:115], v[132:135], v[52:55]
    v_mfma_f32_16x16x32_bf16 v[56:59], v[112:115], v[136:139], v[56:59]
    s_waitcnt lgkmcnt(4)
    v_mfma_f32_16x16x32_bf16 v[60:63], v[116:119], v[128:131], v[60:63]
    s_add_u32 m0, s50, 94208
    s_add_u32 s51, s46, 73728
    buffer_load_dwordx4 v253, s[12:15], s51 offen nt lds
    v_mfma_f32_16x16x32_bf16 v[64:67], v[116:119], v[132:135], v[64:67]
    v_mfma_f32_16x16x32_bf16 v[68:71], v[116:119], v[136:139], v[68:71]
    s_waitcnt lgkmcnt(2)
    v_mfma_f32_16x16x32_bf16 v[72:75], v[120:123], v[128:131], v[72:75]
    v_mfma_f32_16x16x32_bf16 v[76:79], v[120:123], v[132:135], v[76:79]
    s_add_u32 m0, s50, 98304
    s_add_u32 s51, s46, 73856
    buffer_load_dwordx4 v253, s[12:15], s51 offen nt lds
    v_mfma_f32_16x16x32_bf16 v[80:83], v[120:123], v[136:139], v[80:83]
    s_waitcnt lgkmcnt(0)
    v_mfma_f32_16x16x32_bf16 v[84:87], v[124:127], v[128:131], v[84:87]
    v_mfma_f32_16x16x32_bf16 v[88:91], v[124:127], v[132:135], v[88:91]
    v_mfma_f32_16x16x32_bf16 v[92:95], v[124:127], v[136:139], v[92:95]
    s_waitcnt vmcnt(12)
    s_waitcnt lgkmcnt(0)
    s_barrier
    ds_read_b128 v[128:131], v196 offset:12288
    ds_read_b128 v[132:135], v196 offset:14336
    ds_read_b128 v[136:139], v196 offset:16384
    ds_read_b64_tr_b16 v[96:97], v192 offset:32768
    ds_read_b64_tr_b16 v[98:99], v192 offset:33280
    ds_read_b64_tr_b16 v[100:101], v193 offset:32768
    ds_read_b64_tr_b16 v[102:103], v193 offset:33280
    ds_read_b64_tr_b16 v[104:105], v194 offset:32768
    ds_read_b64_tr_b16 v[106:107], v194 offset:33280
    ds_read_b64_tr_b16 v[108:109], v195 offset:32768
    ds_read_b64_tr_b16 v[110:111], v195 offset:33280
    ds_read_b64_tr_b16 v[112:113], v192 offset:36864
    ds_read_b64_tr_b16 v[114:115], v192 offset:37376
    ds_read_b64_tr_b16 v[116:117], v193 offset:36864
    ds_read_b64_tr_b16 v[118:119], v193 offset:37376
    ds_read_b64_tr_b16 v[120:121], v194 offset:36864
    ds_read_b64_tr_b16 v[122:123], v194 offset:37376
    ds_read_b64_tr_b16 v[124:125], v195 offset:36864
    ds_read_b64_tr_b16 v[126:127], v195 offset:37376
    s_add_u32 m0, s50, 16384
    s_add_u32 s51, s47, 2621952
    buffer_load_dwordx4 v250, s[20:23], s51 offen lds
    s_add_u32 m0, s50, 20480
    s_add_u32 s51, s47, 2622080
    buffer_load_dwordx4 v250, s[20:23], s51 offen lds
    s_waitcnt lgkmcnt(14)
    v_mfma_f32_16x16x32_bf16 v[0:3], v[96:99], v[128:131], v[0:3]
    v_mfma_f32_16x16x32_bf16 v[4:7], v[96:99], v[132:135], v[4:7]
    s_add_u32 m0, s50, 24576
    s_add_u32 s51, s47, 2622208
    buffer_load_dwordx4 v250, s[20:23], s51 offen lds
    v_mfma_f32_16x16x32_bf16 v[8:11], v[96:99], v[136:139], v[8:11]
    s_waitcnt lgkmcnt(12)
    v_mfma_f32_16x16x32_bf16 v[12:15], v[100:103], v[128:131], v[12:15]
    s_add_u32 m0, s50, 28672
    s_add_u32 s51, s47, 2622336
    buffer_load_dwordx4 v250, s[20:23], s51 offen lds
    v_mfma_f32_16x16x32_bf16 v[16:19], v[100:103], v[132:135], v[16:19]
    v_mfma_f32_16x16x32_bf16 v[20:23], v[100:103], v[136:139], v[20:23]
    s_add_u32 m0, s50, 49152
    s_add_u32 s51, s49, 640
    buffer_load_dwordx4 v251, s[8:11], s51 offen lds
    s_waitcnt lgkmcnt(10)
    v_mfma_f32_16x16x32_bf16 v[24:27], v[104:107], v[128:131], v[24:27]
    v_mfma_f32_16x16x32_bf16 v[28:31], v[104:107], v[132:135], v[28:31]
    v_mfma_f32_16x16x32_bf16 v[32:35], v[104:107], v[136:139], v[32:35]
    s_add_u32 m0, s50, 53248
    s_add_u32 s51, s49, 37504
    buffer_load_dwordx4 v251, s[8:11], s51 offen lds
    s_waitcnt lgkmcnt(8)
    v_mfma_f32_16x16x32_bf16 v[36:39], v[108:111], v[128:131], v[36:39]
    v_mfma_f32_16x16x32_bf16 v[40:43], v[108:111], v[132:135], v[40:43]
    s_add_u32 m0, s50, 57344
    s_add_u32 s51, s49, 74368
    buffer_load_dwordx4 v251, s[8:11], s51 offen lds
    v_mfma_f32_16x16x32_bf16 v[44:47], v[108:111], v[136:139], v[44:47]
    s_waitcnt lgkmcnt(6)
    v_mfma_f32_16x16x32_bf16 v[48:51], v[112:115], v[128:131], v[48:51]
    v_mfma_f32_16x16x32_bf16 v[52:55], v[112:115], v[132:135], v[52:55]
    s_add_u32 m0, s50, 102400
    s_add_u32 s51, s46, 73728
    buffer_load_dwordx4 v254, s[16:19], s51 offen nt lds
    v_mfma_f32_16x16x32_bf16 v[56:59], v[112:115], v[136:139], v[56:59]
    s_waitcnt lgkmcnt(4)
    v_mfma_f32_16x16x32_bf16 v[60:63], v[116:119], v[128:131], v[60:63]
    s_add_u32 m0, s50, 106496
    s_add_u32 s51, s46, 73856
    buffer_load_dwordx4 v254, s[16:19], s51 offen nt lds
    v_mfma_f32_16x16x32_bf16 v[64:67], v[116:119], v[132:135], v[64:67]
    v_mfma_f32_16x16x32_bf16 v[68:71], v[116:119], v[136:139], v[68:71]
    s_waitcnt lgkmcnt(2)
    v_mfma_f32_16x16x32_bf16 v[72:75], v[120:123], v[128:131], v[72:75]
    s_add_u32 m0, s50, 110592
    s_add_u32 s51, s46, 81920
    buffer_load_dwordx4 v253, s[12:15], s51 offen nt lds
    v_mfma_f32_16x16x32_bf16 v[76:79], v[120:123], v[132:135], v[76:79]
    v_mfma_f32_16x16x32_bf16 v[80:83], v[120:123], v[136:139], v[80:83]
    s_add_u32 m0, s50, 114688
    s_add_u32 s51, s46, 82048
    buffer_load_dwordx4 v253, s[12:15], s51 offen nt lds
    s_waitcnt lgkmcnt(0)
    v_mfma_f32_16x16x32_bf16 v[84:87], v[124:127], v[128:131], v[84:87]
    v_mfma_f32_16x16x32_bf16 v[88:91], v[124:127], v[132:135], v[88:91]
    v_mfma_f32_16x16x32_bf16 v[92:95], v[124:127], v[136:139], v[92:95]
    s_waitcnt vmcnt(15)
    s_waitcnt lgkmcnt(0)
    s_barrier
    ds_read_b128 v[128:131], v197 offset:12288
    ds_read_b128 v[132:135], v197 offset:14336
    ds_read_b128 v[136:139], v197 offset:16384
    ds_read_b64_tr_b16 v[96:97], v192 offset:0
    ds_read_b64_tr_b16 v[98:99], v192 offset:512
    ds_read_b64_tr_b16 v[100:101], v193 offset:0
    ds_read_b64_tr_b16 v[102:103], v193 offset:512
    ds_read_b64_tr_b16 v[104:105], v194 offset:0
    ds_read_b64_tr_b16 v[106:107], v194 offset:512
    ds_read_b64_tr_b16 v[108:109], v195 offset:0
    ds_read_b64_tr_b16 v[110:111], v195 offset:512
    ds_read_b64_tr_b16 v[112:113], v192 offset:4096
    ds_read_b64_tr_b16 v[114:115], v192 offset:4608
    ds_read_b64_tr_b16 v[116:117], v193 offset:4096
    ds_read_b64_tr_b16 v[118:119], v193 offset:4608
    ds_read_b64_tr_b16 v[120:121], v194 offset:4096
    ds_read_b64_tr_b16 v[122:123], v194 offset:4608
    ds_read_b64_tr_b16 v[124:125], v195 offset:4096
    ds_read_b64_tr_b16 v[126:127], v195 offset:4608
    s_add_u32 m0, s50, 32768
    s_add_u32 s51, s47, 2884096
    buffer_load_dwordx4 v250, s[20:23], s51 offen lds
    s_add_u32 m0, s50, 36864
    s_add_u32 s51, s47, 2884224
    buffer_load_dwordx4 v250, s[20:23], s51 offen lds
    s_waitcnt lgkmcnt(14)
    v_mfma_f32_16x16x32_bf16 v[0:3], v[96:99], v[128:131], v[0:3]
    v_mfma_f32_16x16x32_bf16 v[4:7], v[96:99], v[132:135], v[4:7]
    s_add_u32 m0, s50, 40960
    s_add_u32 s51, s47, 2884352
    buffer_load_dwordx4 v250, s[20:23], s51 offen lds
    v_mfma_f32_16x16x32_bf16 v[8:11], v[96:99], v[136:139], v[8:11]
    s_waitcnt lgkmcnt(12)
    v_mfma_f32_16x16x32_bf16 v[12:15], v[100:103], v[128:131], v[12:15]
    v_mfma_f32_16x16x32_bf16 v[16:19], v[100:103], v[132:135], v[16:19]
    s_add_u32 m0, s50, 45056
    s_add_u32 s51, s47, 2884480
    buffer_load_dwordx4 v250, s[20:23], s51 offen lds
    v_mfma_f32_16x16x32_bf16 v[20:23], v[100:103], v[136:139], v[20:23]
    s_waitcnt lgkmcnt(10)
    v_mfma_f32_16x16x32_bf16 v[24:27], v[104:107], v[128:131], v[24:27]
    v_mfma_f32_16x16x32_bf16 v[28:31], v[104:107], v[132:135], v[28:31]
    v_mfma_f32_16x16x32_bf16 v[32:35], v[104:107], v[136:139], v[32:35]
    s_add_u32 m0, s50, 118784
    s_add_u32 s51, s46, 81920
    buffer_load_dwordx4 v254, s[16:19], s51 offen nt lds
    s_waitcnt lgkmcnt(8)
    v_mfma_f32_16x16x32_bf16 v[36:39], v[108:111], v[128:131], v[36:39]
    v_mfma_f32_16x16x32_bf16 v[40:43], v[108:111], v[132:135], v[40:43]
    v_mfma_f32_16x16x32_bf16 v[44:47], v[108:111], v[136:139], v[44:47]
    s_waitcnt lgkmcnt(6)
    v_mfma_f32_16x16x32_bf16 v[48:51], v[112:115], v[128:131], v[48:51]
    s_add_u32 m0, s50, 122880
    s_add_u32 s51, s46, 82048
    buffer_load_dwordx4 v254, s[16:19], s51 offen nt lds
    v_mfma_f32_16x16x32_bf16 v[52:55], v[112:115], v[132:135], v[52:55]
    v_mfma_f32_16x16x32_bf16 v[56:59], v[112:115], v[136:139], v[56:59]
    s_waitcnt lgkmcnt(4)
    v_mfma_f32_16x16x32_bf16 v[60:63], v[116:119], v[128:131], v[60:63]
    s_add_u32 m0, s50, 126976
    s_add_u32 s51, s46, 90112
    buffer_load_dwordx4 v253, s[12:15], s51 offen nt lds
    v_mfma_f32_16x16x32_bf16 v[64:67], v[116:119], v[132:135], v[64:67]
    v_mfma_f32_16x16x32_bf16 v[68:71], v[116:119], v[136:139], v[68:71]
    s_waitcnt lgkmcnt(2)
    v_mfma_f32_16x16x32_bf16 v[72:75], v[120:123], v[128:131], v[72:75]
    v_mfma_f32_16x16x32_bf16 v[76:79], v[120:123], v[132:135], v[76:79]
    s_add_u32 m0, s50, 131072
    s_add_u32 s51, s46, 90240
    buffer_load_dwordx4 v253, s[12:15], s51 offen nt lds
    v_mfma_f32_16x16x32_bf16 v[80:83], v[120:123], v[136:139], v[80:83]
    s_waitcnt lgkmcnt(0)
    v_mfma_f32_16x16x32_bf16 v[84:87], v[124:127], v[128:131], v[84:87]
    v_mfma_f32_16x16x32_bf16 v[88:91], v[124:127], v[132:135], v[88:91]
    v_mfma_f32_16x16x32_bf16 v[92:95], v[124:127], v[136:139], v[92:95]
    s_waitcnt vmcnt(12)
    s_waitcnt lgkmcnt(0)
    s_barrier
    ds_read_b128 v[128:131], v196 offset:0
    ds_read_b128 v[132:135], v196 offset:2048
    ds_read_b128 v[136:139], v196 offset:4096
    ds_read_b64_tr_b16 v[96:97], v192 offset:16384
    ds_read_b64_tr_b16 v[98:99], v192 offset:16896
    ds_read_b64_tr_b16 v[100:101], v193 offset:16384
    ds_read_b64_tr_b16 v[102:103], v193 offset:16896
    ds_read_b64_tr_b16 v[104:105], v194 offset:16384
    ds_read_b64_tr_b16 v[106:107], v194 offset:16896
    ds_read_b64_tr_b16 v[108:109], v195 offset:16384
    ds_read_b64_tr_b16 v[110:111], v195 offset:16896
    ds_read_b64_tr_b16 v[112:113], v192 offset:20480
    ds_read_b64_tr_b16 v[114:115], v192 offset:20992
    ds_read_b64_tr_b16 v[116:117], v193 offset:20480
    ds_read_b64_tr_b16 v[118:119], v193 offset:20992
    ds_read_b64_tr_b16 v[120:121], v194 offset:20480
    ds_read_b64_tr_b16 v[122:123], v194 offset:20992
    ds_read_b64_tr_b16 v[124:125], v195 offset:20480
    ds_read_b64_tr_b16 v[126:127], v195 offset:20992
    s_add_u32 m0, s50, 0
    s_add_u32 s51, s47, 3146240
    buffer_load_dwordx4 v250, s[20:23], s51 offen lds
    s_add_u32 m0, s50, 4096
    s_add_u32 s51, s47, 3146368
    buffer_load_dwordx4 v250, s[20:23], s51 offen lds
    s_waitcnt lgkmcnt(14)
    v_mfma_f32_16x16x32_bf16 v[0:3], v[96:99], v[128:131], v[0:3]
    v_mfma_f32_16x16x32_bf16 v[4:7], v[96:99], v[132:135], v[4:7]
    s_add_u32 m0, s50, 8192
    s_add_u32 s51, s47, 3146496
    buffer_load_dwordx4 v250, s[20:23], s51 offen lds
    v_mfma_f32_16x16x32_bf16 v[8:11], v[96:99], v[136:139], v[8:11]
    s_waitcnt lgkmcnt(12)
    v_mfma_f32_16x16x32_bf16 v[12:15], v[100:103], v[128:131], v[12:15]
    s_add_u32 m0, s50, 12288
    s_add_u32 s51, s47, 3146624
    buffer_load_dwordx4 v250, s[20:23], s51 offen lds
    v_mfma_f32_16x16x32_bf16 v[16:19], v[100:103], v[132:135], v[16:19]
    v_mfma_f32_16x16x32_bf16 v[20:23], v[100:103], v[136:139], v[20:23]
    s_add_u32 m0, s50, 61440
    s_add_u32 s51, s49, 768
    buffer_load_dwordx4 v251, s[8:11], s51 offen lds
    s_waitcnt lgkmcnt(10)
    v_mfma_f32_16x16x32_bf16 v[24:27], v[104:107], v[128:131], v[24:27]
    v_mfma_f32_16x16x32_bf16 v[28:31], v[104:107], v[132:135], v[28:31]
    v_mfma_f32_16x16x32_bf16 v[32:35], v[104:107], v[136:139], v[32:35]
    s_add_u32 m0, s50, 65536
    s_add_u32 s51, s49, 37632
    buffer_load_dwordx4 v251, s[8:11], s51 offen lds
    s_waitcnt lgkmcnt(8)
    v_mfma_f32_16x16x32_bf16 v[36:39], v[108:111], v[128:131], v[36:39]
    v_mfma_f32_16x16x32_bf16 v[40:43], v[108:111], v[132:135], v[40:43]
    s_add_u32 m0, s50, 69632
    s_add_u32 s51, s49, 74496
    buffer_load_dwordx4 v251, s[8:11], s51 offen lds
    v_mfma_f32_16x16x32_bf16 v[44:47], v[108:111], v[136:139], v[44:47]
    s_waitcnt lgkmcnt(6)
    v_mfma_f32_16x16x32_bf16 v[48:51], v[112:115], v[128:131], v[48:51]
    v_mfma_f32_16x16x32_bf16 v[52:55], v[112:115], v[132:135], v[52:55]
    s_add_u32 m0, s50, 135168
    s_add_u32 s51, s46, 90112
    buffer_load_dwordx4 v254, s[16:19], s51 offen nt lds
    v_mfma_f32_16x16x32_bf16 v[56:59], v[112:115], v[136:139], v[56:59]
    s_waitcnt lgkmcnt(4)
    v_mfma_f32_16x16x32_bf16 v[60:63], v[116:119], v[128:131], v[60:63]
    s_add_u32 m0, s50, 139264
    s_add_u32 s51, s46, 90240
    buffer_load_dwordx4 v254, s[16:19], s51 offen nt lds
    v_mfma_f32_16x16x32_bf16 v[64:67], v[116:119], v[132:135], v[64:67]
    v_mfma_f32_16x16x32_bf16 v[68:71], v[116:119], v[136:139], v[68:71]
    s_waitcnt lgkmcnt(2)
    v_mfma_f32_16x16x32_bf16 v[72:75], v[120:123], v[128:131], v[72:75]
    s_add_u32 m0, s50, 143360
    s_add_u32 s51, s46, 98304
    buffer_load_dwordx4 v253, s[12:15], s51 offen nt lds
    v_mfma_f32_16x16x32_bf16 v[76:79], v[120:123], v[132:135], v[76:79]
    v_mfma_f32_16x16x32_bf16 v[80:83], v[120:123], v[136:139], v[80:83]
    s_add_u32 m0, s50, 147456
    s_add_u32 s51, s46, 98432
    buffer_load_dwordx4 v253, s[12:15], s51 offen nt lds
    s_waitcnt lgkmcnt(0)
    v_mfma_f32_16x16x32_bf16 v[84:87], v[124:127], v[128:131], v[84:87]
    v_mfma_f32_16x16x32_bf16 v[88:91], v[124:127], v[132:135], v[88:91]
    v_mfma_f32_16x16x32_bf16 v[92:95], v[124:127], v[136:139], v[92:95]
    s_waitcnt vmcnt(15)
    s_waitcnt lgkmcnt(0)
    s_barrier
    ds_read_b128 v[128:131], v197 offset:0
    ds_read_b128 v[132:135], v197 offset:2048
    ds_read_b128 v[136:139], v197 offset:4096
    ds_read_b64_tr_b16 v[96:97], v192 offset:32768
    ds_read_b64_tr_b16 v[98:99], v192 offset:33280
    ds_read_b64_tr_b16 v[100:101], v193 offset:32768
    ds_read_b64_tr_b16 v[102:103], v193 offset:33280
    ds_read_b64_tr_b16 v[104:105], v194 offset:32768
    ds_read_b64_tr_b16 v[106:107], v194 offset:33280
    ds_read_b64_tr_b16 v[108:109], v195 offset:32768
    ds_read_b64_tr_b16 v[110:111], v195 offset:33280
    ds_read_b64_tr_b16 v[112:113], v192 offset:36864
    ds_read_b64_tr_b16 v[114:115], v192 offset:37376
    ds_read_b64_tr_b16 v[116:117], v193 offset:36864
    ds_read_b64_tr_b16 v[118:119], v193 offset:37376
    ds_read_b64_tr_b16 v[120:121], v194 offset:36864
    ds_read_b64_tr_b16 v[122:123], v194 offset:37376
    ds_read_b64_tr_b16 v[124:125], v195 offset:36864
    ds_read_b64_tr_b16 v[126:127], v195 offset:37376
    s_add_u32 m0, s50, 16384
    s_add_u32 s51, s47, 3408384
    buffer_load_dwordx4 v250, s[20:23], s51 offen lds
    s_add_u32 m0, s50, 20480
    s_add_u32 s51, s47, 3408512
    buffer_load_dwordx4 v250, s[20:23], s51 offen lds
    s_waitcnt lgkmcnt(14)
    v_mfma_f32_16x16x32_bf16 v[0:3], v[96:99], v[128:131], v[0:3]
    v_mfma_f32_16x16x32_bf16 v[4:7], v[96:99], v[132:135], v[4:7]
    s_add_u32 m0, s50, 24576
    s_add_u32 s51, s47, 3408640
    buffer_load_dwordx4 v250, s[20:23], s51 offen lds
    v_mfma_f32_16x16x32_bf16 v[8:11], v[96:99], v[136:139], v[8:11]
    s_waitcnt lgkmcnt(12)
    v_mfma_f32_16x16x32_bf16 v[12:15], v[100:103], v[128:131], v[12:15]
    v_mfma_f32_16x16x32_bf16 v[16:19], v[100:103], v[132:135], v[16:19]
    s_add_u32 m0, s50, 28672
    s_add_u32 s51, s47, 3408768
    buffer_load_dwordx4 v250, s[20:23], s51 offen lds
    v_mfma_f32_16x16x32_bf16 v[20:23], v[100:103], v[136:139], v[20:23]
    s_waitcnt lgkmcnt(10)
    v_mfma_f32_16x16x32_bf16 v[24:27], v[104:107], v[128:131], v[24:27]
    v_mfma_f32_16x16x32_bf16 v[28:31], v[104:107], v[132:135], v[28:31]
    v_mfma_f32_16x16x32_bf16 v[32:35], v[104:107], v[136:139], v[32:35]
    s_add_u32 m0, s50, 86016
    s_add_u32 s51, s46, 98304
    buffer_load_dwordx4 v254, s[16:19], s51 offen nt lds
    s_waitcnt lgkmcnt(8)
    v_mfma_f32_16x16x32_bf16 v[36:39], v[108:111], v[128:131], v[36:39]
    v_mfma_f32_16x16x32_bf16 v[40:43], v[108:111], v[132:135], v[40:43]
    v_mfma_f32_16x16x32_bf16 v[44:47], v[108:111], v[136:139], v[44:47]
    s_waitcnt lgkmcnt(6)
    v_mfma_f32_16x16x32_bf16 v[48:51], v[112:115], v[128:131], v[48:51]
    s_add_u32 m0, s50, 90112
    s_add_u32 s51, s46, 98432
    buffer_load_dwordx4 v254, s[16:19], s51 offen nt lds
    v_mfma_f32_16x16x32_bf16 v[52:55], v[112:115], v[132:135], v[52:55]
    v_mfma_f32_16x16x32_bf16 v[56:59], v[112:115], v[136:139], v[56:59]
    s_waitcnt lgkmcnt(4)
    v_mfma_f32_16x16x32_bf16 v[60:63], v[116:119], v[128:131], v[60:63]
    s_add_u32 m0, s50, 94208
    s_add_u32 s51, s46, 106496
    buffer_load_dwordx4 v253, s[12:15], s51 offen nt lds
    v_mfma_f32_16x16x32_bf16 v[64:67], v[116:119], v[132:135], v[64:67]
    v_mfma_f32_16x16x32_bf16 v[68:71], v[116:119], v[136:139], v[68:71]
    s_waitcnt lgkmcnt(2)
    v_mfma_f32_16x16x32_bf16 v[72:75], v[120:123], v[128:131], v[72:75]
    v_mfma_f32_16x16x32_bf16 v[76:79], v[120:123], v[132:135], v[76:79]
    s_add_u32 m0, s50, 98304
    s_add_u32 s51, s46, 106624
    buffer_load_dwordx4 v253, s[12:15], s51 offen nt lds
    v_mfma_f32_16x16x32_bf16 v[80:83], v[120:123], v[136:139], v[80:83]
    s_waitcnt lgkmcnt(0)
    v_mfma_f32_16x16x32_bf16 v[84:87], v[124:127], v[128:131], v[84:87]
    v_mfma_f32_16x16x32_bf16 v[88:91], v[124:127], v[132:135], v[88:91]
    v_mfma_f32_16x16x32_bf16 v[92:95], v[124:127], v[136:139], v[92:95]
    s_waitcnt vmcnt(12)
    s_waitcnt lgkmcnt(0)
    s_barrier
    ds_read_b128 v[128:131], v196 offset:12288
    ds_read_b128 v[132:135], v196 offset:14336
    ds_read_b128 v[136:139], v196 offset:16384
    ds_read_b64_tr_b16 v[96:97], v192 offset:0
    ds_read_b64_tr_b16 v[98:99], v192 offset:512
    ds_read_b64_tr_b16 v[100:101], v193 offset:0
    ds_read_b64_tr_b16 v[102:103], v193 offset:512
    ds_read_b64_tr_b16 v[104:105], v194 offset:0
    ds_read_b64_tr_b16 v[106:107], v194 offset:512
    ds_read_b64_tr_b16 v[108:109], v195 offset:0
    ds_read_b64_tr_b16 v[110:111], v195 offset:512
    ds_read_b64_tr_b16 v[112:113], v192 offset:4096
    ds_read_b64_tr_b16 v[114:115], v192 offset:4608
    ds_read_b64_tr_b16 v[116:117], v193 offset:4096
    ds_read_b64_tr_b16 v[118:119], v193 offset:4608
    ds_read_b64_tr_b16 v[120:121], v194 offset:4096
    ds_read_b64_tr_b16 v[122:123], v194 offset:4608
    ds_read_b64_tr_b16 v[124:125], v195 offset:4096
    ds_read_b64_tr_b16 v[126:127], v195 offset:4608
    s_add_u32 m0, s50, 32768
    s_add_u32 s51, s47, 3670528
    buffer_load_dwordx4 v250, s[20:23], s51 offen lds
    s_add_u32 m0, s50, 36864
    s_add_u32 s51, s47, 3670656
    buffer_load_dwordx4 v250, s[20:23], s51 offen lds
    s_waitcnt lgkmcnt(14)
    v_mfma_f32_16x16x32_bf16 v[0:3], v[96:99], v[128:131], v[0:3]
    v_mfma_f32_16x16x32_bf16 v[4:7], v[96:99], v[132:135], v[4:7]
    s_add_u32 m0, s50, 40960
    s_add_u32 s51, s47, 3670784
    buffer_load_dwordx4 v250, s[20:23], s51 offen lds
    v_mfma_f32_16x16x32_bf16 v[8:11], v[96:99], v[136:139], v[8:11]
    s_waitcnt lgkmcnt(12)
    v_mfma_f32_16x16x32_bf16 v[12:15], v[100:103], v[128:131], v[12:15]
    s_add_u32 m0, s50, 45056
    s_add_u32 s51, s47, 3670912
    buffer_load_dwordx4 v250, s[20:23], s51 offen lds
    v_mfma_f32_16x16x32_bf16 v[16:19], v[100:103], v[132:135], v[16:19]
    v_mfma_f32_16x16x32_bf16 v[20:23], v[100:103], v[136:139], v[20:23]
    s_add_u32 m0, s50, 49152
    s_add_u32 s51, s49, 896
    buffer_load_dwordx4 v251, s[8:11], s51 offen lds
    s_waitcnt lgkmcnt(10)
    v_mfma_f32_16x16x32_bf16 v[24:27], v[104:107], v[128:131], v[24:27]
    v_mfma_f32_16x16x32_bf16 v[28:31], v[104:107], v[132:135], v[28:31]
    v_mfma_f32_16x16x32_bf16 v[32:35], v[104:107], v[136:139], v[32:35]
    s_add_u32 m0, s50, 53248
    s_add_u32 s51, s49, 37760
    buffer_load_dwordx4 v251, s[8:11], s51 offen lds
    s_waitcnt lgkmcnt(8)
    v_mfma_f32_16x16x32_bf16 v[36:39], v[108:111], v[128:131], v[36:39]
    v_mfma_f32_16x16x32_bf16 v[40:43], v[108:111], v[132:135], v[40:43]
    s_add_u32 m0, s50, 57344
    s_add_u32 s51, s49, 74624
    buffer_load_dwordx4 v251, s[8:11], s51 offen lds
    v_mfma_f32_16x16x32_bf16 v[44:47], v[108:111], v[136:139], v[44:47]
    s_waitcnt lgkmcnt(6)
    v_mfma_f32_16x16x32_bf16 v[48:51], v[112:115], v[128:131], v[48:51]
    v_mfma_f32_16x16x32_bf16 v[52:55], v[112:115], v[132:135], v[52:55]
    s_add_u32 m0, s50, 102400
    s_add_u32 s51, s46, 106496
    buffer_load_dwordx4 v254, s[16:19], s51 offen nt lds
    v_mfma_f32_16x16x32_bf16 v[56:59], v[112:115], v[136:139], v[56:59]
    s_waitcnt lgkmcnt(4)
    v_mfma_f32_16x16x32_bf16 v[60:63], v[116:119], v[128:131], v[60:63]
    s_add_u32 m0, s50, 106496
    s_add_u32 s51, s46, 106624
    buffer_load_dwordx4 v254, s[16:19], s51 offen nt lds
    v_mfma_f32_16x16x32_bf16 v[64:67], v[116:119], v[132:135], v[64:67]
    v_mfma_f32_16x16x32_bf16 v[68:71], v[116:119], v[136:139], v[68:71]
    s_waitcnt lgkmcnt(2)
    v_mfma_f32_16x16x32_bf16 v[72:75], v[120:123], v[128:131], v[72:75]
    s_add_u32 m0, s50, 110592
    s_add_u32 s51, s46, 114688
    buffer_load_dwordx4 v253, s[12:15], s51 offen nt lds
    v_mfma_f32_16x16x32_bf16 v[76:79], v[120:123], v[132:135], v[76:79]
    v_mfma_f32_16x16x32_bf16 v[80:83], v[120:123], v[136:139], v[80:83]
    s_add_u32 m0, s50, 114688
    s_add_u32 s51, s46, 114816
    buffer_load_dwordx4 v253, s[12:15], s51 offen nt lds
    s_waitcnt lgkmcnt(0)
    v_mfma_f32_16x16x32_bf16 v[84:87], v[124:127], v[128:131], v[84:87]
    v_mfma_f32_16x16x32_bf16 v[88:91], v[124:127], v[132:135], v[88:91]
    v_mfma_f32_16x16x32_bf16 v[92:95], v[124:127], v[136:139], v[92:95]
    s_waitcnt vmcnt(15)
    s_waitcnt lgkmcnt(0)
    s_barrier
    ds_read_b128 v[128:131], v197 offset:12288
    ds_read_b128 v[132:135], v197 offset:14336
    ds_read_b128 v[136:139], v197 offset:16384
    ds_read_b64_tr_b16 v[96:97], v192 offset:16384
    ds_read_b64_tr_b16 v[98:99], v192 offset:16896
    ds_read_b64_tr_b16 v[100:101], v193 offset:16384
    ds_read_b64_tr_b16 v[102:103], v193 offset:16896
    ds_read_b64_tr_b16 v[104:105], v194 offset:16384
    ds_read_b64_tr_b16 v[106:107], v194 offset:16896
    ds_read_b64_tr_b16 v[108:109], v195 offset:16384
    ds_read_b64_tr_b16 v[110:111], v195 offset:16896
    ds_read_b64_tr_b16 v[112:113], v192 offset:20480
    ds_read_b64_tr_b16 v[114:115], v192 offset:20992
    ds_read_b64_tr_b16 v[116:117], v193 offset:20480
    ds_read_b64_tr_b16 v[118:119], v193 offset:20992
    ds_read_b64_tr_b16 v[120:121], v194 offset:20480
    ds_read_b64_tr_b16 v[122:123], v194 offset:20992
    ds_read_b64_tr_b16 v[124:125], v195 offset:20480
    ds_read_b64_tr_b16 v[126:127], v195 offset:20992
    s_add_u32 m0, s50, 0
    s_add_u32 s51, s47, 3932672
    buffer_load_dwordx4 v250, s[20:23], s51 offen lds
    s_add_u32 m0, s50, 4096
    s_add_u32 s51, s47, 3932800
    buffer_load_dwordx4 v250, s[20:23], s51 offen lds
    s_waitcnt lgkmcnt(14)
    v_mfma_f32_16x16x32_bf16 v[0:3], v[96:99], v[128:131], v[0:3]
    v_mfma_f32_16x16x32_bf16 v[4:7], v[96:99], v[132:135], v[4:7]
    s_add_u32 m0, s50, 8192
    s_add_u32 s51, s47, 3932928
    buffer_load_dwordx4 v250, s[20:23], s51 offen lds
    v_mfma_f32_16x16x32_bf16 v[8:11], v[96:99], v[136:139], v[8:11]
    s_waitcnt lgkmcnt(12)
    v_mfma_f32_16x16x32_bf16 v[12:15], v[100:103], v[128:131], v[12:15]
    v_mfma_f32_16x16x32_bf16 v[16:19], v[100:103], v[132:135], v[16:19]
    s_add_u32 m0, s50, 12288
    s_add_u32 s51, s47, 3933056
    buffer_load_dwordx4 v250, s[20:23], s51 offen lds
    v_mfma_f32_16x16x32_bf16 v[20:23], v[100:103], v[136:139], v[20:23]
    s_waitcnt lgkmcnt(10)
    v_mfma_f32_16x16x32_bf16 v[24:27], v[104:107], v[128:131], v[24:27]
    v_mfma_f32_16x16x32_bf16 v[28:31], v[104:107], v[132:135], v[28:31]
    v_mfma_f32_16x16x32_bf16 v[32:35], v[104:107], v[136:139], v[32:35]
    s_add_u32 m0, s50, 118784
    s_add_u32 s51, s46, 114688
    buffer_load_dwordx4 v254, s[16:19], s51 offen nt lds
    s_waitcnt lgkmcnt(8)
    v_mfma_f32_16x16x32_bf16 v[36:39], v[108:111], v[128:131], v[36:39]
    v_mfma_f32_16x16x32_bf16 v[40:43], v[108:111], v[132:135], v[40:43]
    v_mfma_f32_16x16x32_bf16 v[44:47], v[108:111], v[136:139], v[44:47]
    s_waitcnt lgkmcnt(6)
    v_mfma_f32_16x16x32_bf16 v[48:51], v[112:115], v[128:131], v[48:51]
    s_add_u32 m0, s50, 122880
    s_add_u32 s51, s46, 114816
    buffer_load_dwordx4 v254, s[16:19], s51 offen nt lds
    v_mfma_f32_16x16x32_bf16 v[52:55], v[112:115], v[132:135], v[52:55]
    v_mfma_f32_16x16x32_bf16 v[56:59], v[112:115], v[136:139], v[56:59]
    s_waitcnt lgkmcnt(4)
    v_mfma_f32_16x16x32_bf16 v[60:63], v[116:119], v[128:131], v[60:63]
    s_add_u32 m0, s50, 126976
    s_add_u32 s51, s46, 122880
    buffer_load_dwordx4 v253, s[12:15], s51 offen nt lds
    v_mfma_f32_16x16x32_bf16 v[64:67], v[116:119], v[132:135], v[64:67]
    v_mfma_f32_16x16x32_bf16 v[68:71], v[116:119], v[136:139], v[68:71]
    s_waitcnt lgkmcnt(2)
    v_mfma_f32_16x16x32_bf16 v[72:75], v[120:123], v[128:131], v[72:75]
    v_mfma_f32_16x16x32_bf16 v[76:79], v[120:123], v[132:135], v[76:79]
    s_add_u32 m0, s50, 131072
    s_add_u32 s51, s46, 123008
    buffer_load_dwordx4 v253, s[12:15], s51 offen nt lds
    v_mfma_f32_16x16x32_bf16 v[80:83], v[120:123], v[136:139], v[80:83]
    s_waitcnt lgkmcnt(0)
    v_mfma_f32_16x16x32_bf16 v[84:87], v[124:127], v[128:131], v[84:87]
    v_mfma_f32_16x16x32_bf16 v[88:91], v[124:127], v[132:135], v[88:91]
    v_mfma_f32_16x16x32_bf16 v[92:95], v[124:127], v[136:139], v[92:95]
    s_waitcnt vmcnt(12)
    s_waitcnt lgkmcnt(0)
    s_barrier
    ds_read_b128 v[128:131], v196 offset:0
    ds_read_b128 v[132:135], v196 offset:2048
    ds_read_b128 v[136:139], v196 offset:4096
    ds_read_b64_tr_b16 v[96:97], v192 offset:32768
    ds_read_b64_tr_b16 v[98:99], v192 offset:33280
    ds_read_b64_tr_b16 v[100:101], v193 offset:32768
    ds_read_b64_tr_b16 v[102:103], v193 offset:33280
    ds_read_b64_tr_b16 v[104:105], v194 offset:32768
    ds_read_b64_tr_b16 v[106:107], v194 offset:33280
    ds_read_b64_tr_b16 v[108:109], v195 offset:32768
    ds_read_b64_tr_b16 v[110:111], v195 offset:33280
    ds_read_b64_tr_b16 v[112:113], v192 offset:36864
    ds_read_b64_tr_b16 v[114:115], v192 offset:37376
    ds_read_b64_tr_b16 v[116:117], v193 offset:36864
    ds_read_b64_tr_b16 v[118:119], v193 offset:37376
    ds_read_b64_tr_b16 v[120:121], v194 offset:36864
    ds_read_b64_tr_b16 v[122:123], v194 offset:37376
    ds_read_b64_tr_b16 v[124:125], v195 offset:36864
    ds_read_b64_tr_b16 v[126:127], v195 offset:37376
    s_add_u32 m0, s50, 16384
    s_add_u32 s51, s47, 4194816
    buffer_load_dwordx4 v250, s[20:23], s51 offen lds
    s_add_u32 m0, s50, 20480
    s_add_u32 s51, s47, 4194944
    buffer_load_dwordx4 v250, s[20:23], s51 offen lds
    s_waitcnt lgkmcnt(14)
    v_mfma_f32_16x16x32_bf16 v[0:3], v[96:99], v[128:131], v[0:3]
    v_mfma_f32_16x16x32_bf16 v[4:7], v[96:99], v[132:135], v[4:7]
    s_add_u32 m0, s50, 24576
    s_add_u32 s51, s47, 4195072
    buffer_load_dwordx4 v250, s[20:23], s51 offen lds
    v_mfma_f32_16x16x32_bf16 v[8:11], v[96:99], v[136:139], v[8:11]
    s_waitcnt lgkmcnt(12)
    v_mfma_f32_16x16x32_bf16 v[12:15], v[100:103], v[128:131], v[12:15]
    s_add_u32 m0, s50, 28672
    s_add_u32 s51, s47, 4195200
    buffer_load_dwordx4 v250, s[20:23], s51 offen lds
    v_mfma_f32_16x16x32_bf16 v[16:19], v[100:103], v[132:135], v[16:19]
    v_mfma_f32_16x16x32_bf16 v[20:23], v[100:103], v[136:139], v[20:23]
    s_add_u32 m0, s50, 61440
    s_add_u32 s51, s49, 1024
    buffer_load_dwordx4 v251, s[8:11], s51 offen lds
    s_waitcnt lgkmcnt(10)
    v_mfma_f32_16x16x32_bf16 v[24:27], v[104:107], v[128:131], v[24:27]
    v_mfma_f32_16x16x32_bf16 v[28:31], v[104:107], v[132:135], v[28:31]
    v_mfma_f32_16x16x32_bf16 v[32:35], v[104:107], v[136:139], v[32:35]
    s_add_u32 m0, s50, 65536
    s_add_u32 s51, s49, 37888
    buffer_load_dwordx4 v251, s[8:11], s51 offen lds
    s_waitcnt lgkmcnt(8)
    v_mfma_f32_16x16x32_bf16 v[36:39], v[108:111], v[128:131], v[36:39]
    v_mfma_f32_16x16x32_bf16 v[40:43], v[108:111], v[132:135], v[40:43]
    s_add_u32 m0, s50, 69632
    s_add_u32 s51, s49, 74752
    buffer_load_dwordx4 v251, s[8:11], s51 offen lds
    v_mfma_f32_16x16x32_bf16 v[44:47], v[108:111], v[136:139], v[44:47]
    s_waitcnt lgkmcnt(6)
    v_mfma_f32_16x16x32_bf16 v[48:51], v[112:115], v[128:131], v[48:51]
    v_mfma_f32_16x16x32_bf16 v[52:55], v[112:115], v[132:135], v[52:55]
    s_add_u32 m0, s50, 135168
    s_add_u32 s51, s46, 122880
    buffer_load_dwordx4 v254, s[16:19], s51 offen nt lds
    v_mfma_f32_16x16x32_bf16 v[56:59], v[112:115], v[136:139], v[56:59]
    s_waitcnt lgkmcnt(4)
    v_mfma_f32_16x16x32_bf16 v[60:63], v[116:119], v[128:131], v[60:63]
    s_add_u32 m0, s50, 139264
    s_add_u32 s51, s46, 123008
    buffer_load_dwordx4 v254, s[16:19], s51 offen nt lds
    v_mfma_f32_16x16x32_bf16 v[64:67], v[116:119], v[132:135], v[64:67]
    v_mfma_f32_16x16x32_bf16 v[68:71], v[116:119], v[136:139], v[68:71]
    s_waitcnt lgkmcnt(2)
    v_mfma_f32_16x16x32_bf16 v[72:75], v[120:123], v[128:131], v[72:75]
    s_add_u32 m0, s50, 151552
    s_add_u32 s51, s46, 131072
    buffer_load_dwordx4 v253, s[12:15], s51 offen nt lds
    v_mfma_f32_16x16x32_bf16 v[76:79], v[120:123], v[132:135], v[76:79]
    v_mfma_f32_16x16x32_bf16 v[80:83], v[120:123], v[136:139], v[80:83]
    s_add_u32 m0, s50, 155648
    s_add_u32 s51, s46, 131200
    buffer_load_dwordx4 v253, s[12:15], s51 offen nt lds
    s_waitcnt lgkmcnt(0)
    v_mfma_f32_16x16x32_bf16 v[84:87], v[124:127], v[128:131], v[84:87]
    v_mfma_f32_16x16x32_bf16 v[88:91], v[124:127], v[132:135], v[88:91]
    v_mfma_f32_16x16x32_bf16 v[92:95], v[124:127], v[136:139], v[92:95]
    s_waitcnt vmcnt(15)
    s_waitcnt lgkmcnt(0)
    s_barrier
    ds_read_b128 v[128:131], v197 offset:0
    ds_read_b128 v[132:135], v197 offset:2048
    ds_read_b128 v[136:139], v197 offset:4096
    ds_read_b64_tr_b16 v[96:97], v192 offset:0
    ds_read_b64_tr_b16 v[98:99], v192 offset:512
    ds_read_b64_tr_b16 v[100:101], v193 offset:0
    ds_read_b64_tr_b16 v[102:103], v193 offset:512
    ds_read_b64_tr_b16 v[104:105], v194 offset:0
    ds_read_b64_tr_b16 v[106:107], v194 offset:512
    ds_read_b64_tr_b16 v[108:109], v195 offset:0
    ds_read_b64_tr_b16 v[110:111], v195 offset:512
    ds_read_b64_tr_b16 v[112:113], v192 offset:4096
    ds_read_b64_tr_b16 v[114:115], v192 offset:4608
    ds_read_b64_tr_b16 v[116:117], v193 offset:4096
    ds_read_b64_tr_b16 v[118:119], v193 offset:4608
    ds_read_b64_tr_b16 v[120:121], v194 offset:4096
    ds_read_b64_tr_b16 v[122:123], v194 offset:4608
    ds_read_b64_tr_b16 v[124:125], v195 offset:4096
    ds_read_b64_tr_b16 v[126:127], v195 offset:4608
    s_add_u32 m0, s50, 32768
    s_add_u32 s51, s47, 4456960
    buffer_load_dwordx4 v250, s[20:23], s51 offen lds
    s_add_u32 m0, s50, 36864
    s_add_u32 s51, s47, 4457088
    buffer_load_dwordx4 v250, s[20:23], s51 offen lds
    s_waitcnt lgkmcnt(14)
    v_mfma_f32_16x16x32_bf16 v[0:3], v[96:99], v[128:131], v[0:3]
    v_mfma_f32_16x16x32_bf16 v[4:7], v[96:99], v[132:135], v[4:7]
    s_add_u32 m0, s50, 40960
    s_add_u32 s51, s47, 4457216
    buffer_load_dwordx4 v250, s[20:23], s51 offen lds
    v_mfma_f32_16x16x32_bf16 v[8:11], v[96:99], v[136:139], v[8:11]
    s_waitcnt lgkmcnt(12)
    v_mfma_f32_16x16x32_bf16 v[12:15], v[100:103], v[128:131], v[12:15]
    v_mfma_f32_16x16x32_bf16 v[16:19], v[100:103], v[132:135], v[16:19]
    s_add_u32 m0, s50, 45056
    s_add_u32 s51, s47, 4457344
    buffer_load_dwordx4 v250, s[20:23], s51 offen lds
    v_mfma_f32_16x16x32_bf16 v[20:23], v[100:103], v[136:139], v[20:23]
    s_waitcnt lgkmcnt(10)
    v_mfma_f32_16x16x32_bf16 v[24:27], v[104:107], v[128:131], v[24:27]
    v_mfma_f32_16x16x32_bf16 v[28:31], v[104:107], v[132:135], v[28:31]
    v_mfma_f32_16x16x32_bf16 v[32:35], v[104:107], v[136:139], v[32:35]
    s_add_u32 m0, s50, 86016
    s_add_u32 s51, s46, 131072
    buffer_load_dwordx4 v254, s[16:19], s51 offen nt lds
    s_waitcnt lgkmcnt(8)
    v_mfma_f32_16x16x32_bf16 v[36:39], v[108:111], v[128:131], v[36:39]
    v_mfma_f32_16x16x32_bf16 v[40:43], v[108:111], v[132:135], v[40:43]
    v_mfma_f32_16x16x32_bf16 v[44:47], v[108:111], v[136:139], v[44:47]
    s_waitcnt lgkmcnt(6)
    v_mfma_f32_16x16x32_bf16 v[48:51], v[112:115], v[128:131], v[48:51]
    s_add_u32 m0, s50, 90112
    s_add_u32 s51, s46, 131200
    buffer_load_dwordx4 v254, s[16:19], s51 offen nt lds
    v_mfma_f32_16x16x32_bf16 v[52:55], v[112:115], v[132:135], v[52:55]
    v_mfma_f32_16x16x32_bf16 v[56:59], v[112:115], v[136:139], v[56:59]
    s_waitcnt lgkmcnt(4)
    v_mfma_f32_16x16x32_bf16 v[60:63], v[116:119], v[128:131], v[60:63]
    s_add_u32 m0, s50, 94208
    s_add_u32 s51, s46, 139264
    buffer_load_dwordx4 v253, s[12:15], s51 offen nt lds
    v_mfma_f32_16x16x32_bf16 v[64:67], v[116:119], v[132:135], v[64:67]
    v_mfma_f32_16x16x32_bf16 v[68:71], v[116:119], v[136:139], v[68:71]
    s_waitcnt lgkmcnt(2)
    v_mfma_f32_16x16x32_bf16 v[72:75], v[120:123], v[128:131], v[72:75]
    v_mfma_f32_16x16x32_bf16 v[76:79], v[120:123], v[132:135], v[76:79]
    s_add_u32 m0, s50, 98304
    s_add_u32 s51, s46, 139392
    buffer_load_dwordx4 v253, s[12:15], s51 offen nt lds
    v_mfma_f32_16x16x32_bf16 v[80:83], v[120:123], v[136:139], v[80:83]
    s_waitcnt lgkmcnt(0)
    v_mfma_f32_16x16x32_bf16 v[84:87], v[124:127], v[128:131], v[84:87]
    v_mfma_f32_16x16x32_bf16 v[88:91], v[124:127], v[132:135], v[88:91]
    v_mfma_f32_16x16x32_bf16 v[92:95], v[124:127], v[136:139], v[92:95]
    s_waitcnt vmcnt(4)
    s_waitcnt lgkmcnt(0)
    s_barrier
    ds_read_b128 v[128:131], v196 offset:12288
    ds_read_b128 v[132:135], v196 offset:14336
    ds_read_b128 v[136:139], v196 offset:16384
    ds_read_b64_tr_b16 v[96:97], v192 offset:16384
    ds_read_b64_tr_b16 v[98:99], v192 offset:16896
    ds_read_b64_tr_b16 v[100:101], v193 offset:16384
    ds_read_b64_tr_b16 v[102:103], v193 offset:16896
    ds_read_b64_tr_b16 v[104:105], v194 offset:16384
    ds_read_b64_tr_b16 v[106:107], v194 offset:16896
    ds_read_b64_tr_b16 v[108:109], v195 offset:16384
    ds_read_b64_tr_b16 v[110:111], v195 offset:16896
    ds_read_b64_tr_b16 v[112:113], v192 offset:20480
    ds_read_b64_tr_b16 v[114:115], v192 offset:20992
    ds_read_b64_tr_b16 v[116:117], v193 offset:20480
    ds_read_b64_tr_b16 v[118:119], v193 offset:20992
    ds_read_b64_tr_b16 v[120:121], v194 offset:20480
    ds_read_b64_tr_b16 v[122:123], v194 offset:20992
    ds_read_b64_tr_b16 v[124:125], v195 offset:20480
    ds_read_b64_tr_b16 v[126:127], v195 offset:20992
    s_add_u32 m0, s50, 102400
    s_add_u32 s51, s46, 139264
    buffer_load_dwordx4 v254, s[16:19], s51 offen nt lds
    s_add_u32 m0, s50, 106496
    s_add_u32 s51, s46, 139392
    buffer_load_dwordx4 v254, s[16:19], s51 offen nt lds
    s_waitcnt lgkmcnt(14)
    v_mfma_f32_16x16x32_bf16 v[0:3], v[96:99], v[128:131], v[0:3]
    v_mfma_f32_16x16x32_bf16 v[4:7], v[96:99], v[132:135], v[4:7]
    s_add_u32 m0, s50, 110592
    s_add_u32 s51, s46, 147456
    buffer_load_dwordx4 v253, s[12:15], s51 offen nt lds
    v_mfma_f32_16x16x32_bf16 v[8:11], v[96:99], v[136:139], v[8:11]
    s_waitcnt lgkmcnt(12)
    v_mfma_f32_16x16x32_bf16 v[12:15], v[100:103], v[128:131], v[12:15]
    v_mfma_f32_16x16x32_bf16 v[16:19], v[100:103], v[132:135], v[16:19]
    v_mfma_f32_16x16x32_bf16 v[20:23], v[100:103], v[136:139], v[20:23]
    s_waitcnt lgkmcnt(10)
    v_mfma_f32_16x16x32_bf16 v[24:27], v[104:107], v[128:131], v[24:27]
    v_mfma_f32_16x16x32_bf16 v[28:31], v[104:107], v[132:135], v[28:31]
    v_mfma_f32_16x16x32_bf16 v[32:35], v[104:107], v[136:139], v[32:35]
    s_waitcnt lgkmcnt(8)
    v_mfma_f32_16x16x32_bf16 v[36:39], v[108:111], v[128:131], v[36:39]
    v_mfma_f32_16x16x32_bf16 v[40:43], v[108:111], v[132:135], v[40:43]
    v_mfma_f32_16x16x32_bf16 v[44:47], v[108:111], v[136:139], v[44:47]
    s_waitcnt lgkmcnt(6)
    v_mfma_f32_16x16x32_bf16 v[48:51], v[112:115], v[128:131], v[48:51]
    s_add_u32 m0, s50, 114688
    s_add_u32 s51, s46, 147584
    buffer_load_dwordx4 v253, s[12:15], s51 offen nt lds
    v_mfma_f32_16x16x32_bf16 v[52:55], v[112:115], v[132:135], v[52:55]
    v_mfma_f32_16x16x32_bf16 v[56:59], v[112:115], v[136:139], v[56:59]
    s_waitcnt lgkmcnt(4)
    v_mfma_f32_16x16x32_bf16 v[60:63], v[116:119], v[128:131], v[60:63]
    v_mfma_f32_16x16x32_bf16 v[64:67], v[116:119], v[132:135], v[64:67]
    v_mfma_f32_16x16x32_bf16 v[68:71], v[116:119], v[136:139], v[68:71]
    s_waitcnt lgkmcnt(2)
    v_mfma_f32_16x16x32_bf16 v[72:75], v[120:123], v[128:131], v[72:75]
    v_mfma_f32_16x16x32_bf16 v[76:79], v[120:123], v[132:135], v[76:79]
    v_mfma_f32_16x16x32_bf16 v[80:83], v[120:123], v[136:139], v[80:83]
    s_waitcnt lgkmcnt(0)
    v_mfma_f32_16x16x32_bf16 v[84:87], v[124:127], v[128:131], v[84:87]
    v_mfma_f32_16x16x32_bf16 v[88:91], v[124:127], v[132:135], v[88:91]
    v_mfma_f32_16x16x32_bf16 v[92:95], v[124:127], v[136:139], v[92:95]
    ds_read_b128 v[128:131], v197 offset:12288
    ds_read_b128 v[132:135], v197 offset:14336
    ds_read_b128 v[136:139], v197 offset:16384
    ds_read_b64_tr_b16 v[96:97], v192 offset:32768
    ds_read_b64_tr_b16 v[98:99], v192 offset:33280
    ds_read_b64_tr_b16 v[100:101], v193 offset:32768
    ds_read_b64_tr_b16 v[102:103], v193 offset:33280
    ds_read_b64_tr_b16 v[104:105], v194 offset:32768
    ds_read_b64_tr_b16 v[106:107], v194 offset:33280
    ds_read_b64_tr_b16 v[108:109], v195 offset:32768
    ds_read_b64_tr_b16 v[110:111], v195 offset:33280
    ds_read_b64_tr_b16 v[112:113], v192 offset:36864
    ds_read_b64_tr_b16 v[114:115], v192 offset:37376
    ds_read_b64_tr_b16 v[116:117], v193 offset:36864
    ds_read_b64_tr_b16 v[118:119], v193 offset:37376
    ds_read_b64_tr_b16 v[120:121], v194 offset:36864
    ds_read_b64_tr_b16 v[122:123], v194 offset:37376
    ds_read_b64_tr_b16 v[124:125], v195 offset:36864
    ds_read_b64_tr_b16 v[126:127], v195 offset:37376
    s_waitcnt lgkmcnt(14)
    v_mfma_f32_16x16x32_bf16 v[0:3], v[96:99], v[128:131], v[0:3]
    v_mfma_f32_16x16x32_bf16 v[4:7], v[96:99], v[132:135], v[4:7]
    v_mfma_f32_16x16x32_bf16 v[8:11], v[96:99], v[136:139], v[8:11]
    s_waitcnt lgkmcnt(12)
    v_mfma_f32_16x16x32_bf16 v[12:15], v[100:103], v[128:131], v[12:15]
    v_mfma_f32_16x16x32_bf16 v[16:19], v[100:103], v[132:135], v[16:19]
    v_mfma_f32_16x16x32_bf16 v[20:23], v[100:103], v[136:139], v[20:23]
    s_waitcnt lgkmcnt(10)
    v_mfma_f32_16x16x32_bf16 v[24:27], v[104:107], v[128:131], v[24:27]
    v_mfma_f32_16x16x32_bf16 v[28:31], v[104:107], v[132:135], v[28:31]
    v_mfma_f32_16x16x32_bf16 v[32:35], v[104:107], v[136:139], v[32:35]
    s_waitcnt lgkmcnt(8)
    v_mfma_f32_16x16x32_bf16 v[36:39], v[108:111], v[128:131], v[36:39]
    v_mfma_f32_16x16x32_bf16 v[40:43], v[108:111], v[132:135], v[40:43]
    v_mfma_f32_16x16x32_bf16 v[44:47], v[108:111], v[136:139], v[44:47]
    s_waitcnt lgkmcnt(6)
    v_mfma_f32_16x16x32_bf16 v[48:51], v[112:115], v[128:131], v[48:51]
    v_mfma_f32_16x16x32_bf16 v[52:55], v[112:115], v[132:135], v[52:55]
    v_mfma_f32_16x16x32_bf16 v[56:59], v[112:115], v[136:139], v[56:59]
    s_waitcnt lgkmcnt(4)
    v_mfma_f32_16x16x32_bf16 v[60:63], v[116:119], v[128:131], v[60:63]
    v_mfma_f32_16x16x32_bf16 v[64:67], v[116:119], v[132:135], v[64:67]
    v_mfma_f32_16x16x32_bf16 v[68:71], v[116:119], v[136:139], v[68:71]
    s_waitcnt lgkmcnt(2)
    v_mfma_f32_16x16x32_bf16 v[72:75], v[120:123], v[128:131], v[72:75]
    v_mfma_f32_16x16x32_bf16 v[76:79], v[120:123], v[132:135], v[76:79]
    v_mfma_f32_16x16x32_bf16 v[80:83], v[120:123], v[136:139], v[80:83]
    s_waitcnt lgkmcnt(0)
    v_mfma_f32_16x16x32_bf16 v[84:87], v[124:127], v[128:131], v[84:87]
    v_mfma_f32_16x16x32_bf16 v[88:91], v[124:127], v[132:135], v[88:91]
    v_mfma_f32_16x16x32_bf16 v[92:95], v[124:127], v[136:139], v[92:95]
    s_waitcnt lgkmcnt(0)
    s_barrier
    s_add_u32 m0, s50, 49152
    s_add_u32 s51, s64, 294912
    buffer_load_dwordx4 v252, s[24:27], s51 offen lds
    s_add_u32 m0, s50, 53248
    s_add_u32 s51, s65, 294912
    buffer_load_dwordx4 v252, s[24:27], s51 offen lds
    s_add_u32 m0, s50, 57344
    s_add_u32 s51, s66, 294912
    buffer_load_dwordx4 v252, s[24:27], s51 offen lds
    s_add_u32 m0, s50, 61440
    s_add_u32 s51, s67, 294912
    buffer_load_dwordx4 v252, s[24:27], s51 offen lds
    s_add_u32 m0, s50, 65536
    s_add_u32 s51, s68, 294912
    buffer_load_dwordx4 v252, s[24:27], s51 offen lds
    s_add_u32 m0, s50, 69632
    s_add_u32 s51, s69, 294912
    buffer_load_dwordx4 v252, s[24:27], s51 offen lds
    s_add_u32 m0, s50, 73728
    s_add_u32 s51, s70, 294912
    buffer_load_dwordx4 v252, s[24:27], s51 offen lds
    s_add_u32 m0, s50, 77824
    s_add_u32 s51, s71, 294912
    buffer_load_dwordx4 v252, s[24:27], s51 offen lds
    s_add_u32 m0, s50, 81920
    s_add_u32 s51, s72, 294912
    buffer_load_dwordx4 v252, s[24:27], s51 offen lds
    s_add_u32 m0, s50, 118784
    s_add_u32 s51, s46, 147456
    buffer_load_dwordx4 v254, s[16:19], s51 offen nt lds
    s_add_u32 m0, s50, 122880
    s_add_u32 s51, s46, 147584
    buffer_load_dwordx4 v254, s[16:19], s51 offen nt lds
    s_add_u32 m0, s50, 126976
    s_add_u32 s51, s46, 155648
    buffer_load_dwordx4 v253, s[12:15], s51 offen nt lds
    s_add_u32 m0, s50, 131072
    s_add_u32 s51, s46, 155776
    buffer_load_dwordx4 v253, s[12:15], s51 offen nt lds
    v_mul_f32 v0, s58, v0
    v_mul_f32 v1, s58, v1
    v_mul_f32 v2, s58, v2
    v_mul_f32 v3, s58, v3
    v_mul_f32 v12, s58, v12
    v_mul_f32 v13, s58, v13
    v_mul_f32 v14, s58, v14
    v_mul_f32 v15, s58, v15
    v_cvt_pk_bf16_f32 v144, v0, v1
    v_cvt_pk_bf16_f32 v145, v2, v3
    v_cvt_pk_bf16_f32 v146, v12, v13
    v_cvt_pk_bf16_f32 v147, v14, v15
    v_mul_f32 v24, s58, v24
    v_mul_f32 v25, s58, v25
    v_mul_f32 v26, s58, v26
    v_mul_f32 v27, s58, v27
    v_mul_f32 v36, s58, v36
    v_mul_f32 v37, s58, v37
    v_mul_f32 v38, s58, v38
    v_mul_f32 v39, s58, v39
    v_cvt_pk_bf16_f32 v156, v24, v25
    v_cvt_pk_bf16_f32 v157, v26, v27
    v_cvt_pk_bf16_f32 v158, v36, v37
    v_cvt_pk_bf16_f32 v159, v38, v39
    v_mul_f32 v48, s58, v48
    v_mul_f32 v49, s58, v49
    v_mul_f32 v50, s58, v50
    v_mul_f32 v51, s58, v51
    v_mul_f32 v60, s58, v60
    v_mul_f32 v61, s58, v61
    v_mul_f32 v62, s58, v62
    v_mul_f32 v63, s58, v63
    v_cvt_pk_bf16_f32 v168, v48, v49
    v_cvt_pk_bf16_f32 v169, v50, v51
    v_cvt_pk_bf16_f32 v170, v60, v61
    v_cvt_pk_bf16_f32 v171, v62, v63
    v_mul_f32 v72, s58, v72
    v_mul_f32 v73, s58, v73
    v_mul_f32 v74, s58, v74
    v_mul_f32 v75, s58, v75
    v_mul_f32 v84, s58, v84
    v_mul_f32 v85, s58, v85
    v_mul_f32 v86, s58, v86
    v_mul_f32 v87, s58, v87
    v_cvt_pk_bf16_f32 v180, v72, v73
    v_cvt_pk_bf16_f32 v181, v74, v75
    v_cvt_pk_bf16_f32 v182, v84, v85
    v_cvt_pk_bf16_f32 v183, v86, v87
    v_permlane32_swap_b32 v144, v146
    v_permlane32_swap_b32 v145, v147
    v_permlane32_swap_b32 v156, v158
    v_permlane32_swap_b32 v157, v159
    v_permlane32_swap_b32 v168, v170
    v_permlane32_swap_b32 v169, v171
    v_permlane32_swap_b32 v180, v182
    v_permlane32_swap_b32 v181, v183
    v_permlane16_swap_b32 v144, v146
    v_permlane16_swap_b32 v145, v147
    v_permlane16_swap_b32 v156, v158
    v_permlane16_swap_b32 v157, v159
    v_permlane16_swap_b32 v168, v170
    v_permlane16_swap_b32 v169, v171
    v_permlane16_swap_b32 v180, v182
    v_permlane16_swap_b32 v181, v183
    ds_write_b128 v198, v[144:147] offset:0
    ds_write_b128 v198, v[156:159] offset:6144
    ds_write_b128 v198, v[168:171] offset:12288
    ds_write_b128 v198, v[180:183] offset:18432
    v_mul_f32 v4, s58, v4
    v_mul_f32 v5, s58, v5
    v_mul_f32 v6, s58, v6
    v_mul_f32 v7, s58, v7
    v_mul_f32 v16, s58, v16
    v_mul_f32 v17, s58, v17
    v_mul_f32 v18, s58, v18
    v_mul_f32 v19, s58, v19
    v_cvt_pk_bf16_f32 v148, v4, v5
    v_cvt_pk_bf16_f32 v149, v6, v7
    v_cvt_pk_bf16_f32 v150, v16, v17
    v_cvt_pk_bf16_f32 v151, v18, v19
    v_mul_f32 v28, s58, v28
    v_mul_f32 v29, s58, v29
    v_mul_f32 v30, s58, v30
    v_mul_f32 v31, s58, v31
    v_mul_f32 v40, s58, v40
    v_mul_f32 v41, s58, v41
    v_mul_f32 v42, s58, v42
    v_mul_f32 v43, s58, v43
    v_cvt_pk_bf16_f32 v160, v28, v29
    v_cvt_pk_bf16_f32 v161, v30, v31
    v_cvt_pk_bf16_f32 v162, v40, v41
    v_cvt_pk_bf16_f32 v163, v42, v43
    v_mul_f32 v52, s58, v52
    v_mul_f32 v53, s58, v53
    v_mul_f32 v54, s58, v54
    v_mul_f32 v55, s58, v55
    v_mul_f32 v64, s58, v64
    v_mul_f32 v65, s58, v65
    v_mul_f32 v66, s58, v66
    v_mul_f32 v67, s58, v67
    v_cvt_pk_bf16_f32 v172, v52, v53
    v_cvt_pk_bf16_f32 v173, v54, v55
    v_cvt_pk_bf16_f32 v174, v64, v65
    v_cvt_pk_bf16_f32 v175, v66, v67
    v_mul_f32 v76, s58, v76
    v_mul_f32 v77, s58, v77
    v_mul_f32 v78, s58, v78
    v_mul_f32 v79, s58, v79
    v_mul_f32 v88, s58, v88
    v_mul_f32 v89, s58, v89
    v_mul_f32 v90, s58, v90
    v_mul_f32 v91, s58, v91
    v_cvt_pk_bf16_f32 v184, v76, v77
    v_cvt_pk_bf16_f32 v185, v78, v79
    v_cvt_pk_bf16_f32 v186, v88, v89
    v_cvt_pk_bf16_f32 v187, v90, v91
    v_permlane32_swap_b32 v148, v150
    v_permlane32_swap_b32 v149, v151
    v_permlane32_swap_b32 v160, v162
    v_permlane32_swap_b32 v161, v163
    v_permlane32_swap_b32 v172, v174
    v_permlane32_swap_b32 v173, v175
    v_permlane32_swap_b32 v184, v186
    v_permlane32_swap_b32 v185, v187
    v_permlane16_swap_b32 v148, v150
    v_permlane16_swap_b32 v149, v151
    v_permlane16_swap_b32 v160, v162
    v_permlane16_swap_b32 v161, v163
    v_permlane16_swap_b32 v172, v174
    v_permlane16_swap_b32 v173, v175
    v_permlane16_swap_b32 v184, v186
    v_permlane16_swap_b32 v185, v187
    ds_write_b128 v198, v[148:151] offset:1024
    ds_write_b128 v198, v[160:163] offset:7168
    ds_write_b128 v198, v[172:175] offset:13312
    ds_write_b128 v198, v[184:187] offset:19456
    v_mul_f32 v8, s58, v8
    v_mul_f32 v9, s58, v9
    v_mul_f32 v10, s58, v10
    v_mul_f32 v11, s58, v11
    v_mul_f32 v20, s58, v20
    v_mul_f32 v21, s58, v21
    v_mul_f32 v22, s58, v22
    v_mul_f32 v23, s58, v23
    v_cvt_pk_bf16_f32 v152, v8, v9
    v_cvt_pk_bf16_f32 v153, v10, v11
    v_cvt_pk_bf16_f32 v154, v20, v21
    v_cvt_pk_bf16_f32 v155, v22, v23
    v_mul_f32 v32, s58, v32
    v_mul_f32 v33, s58, v33
    v_mul_f32 v34, s58, v34
    v_mul_f32 v35, s58, v35
    v_mul_f32 v44, s58, v44
    v_mul_f32 v45, s58, v45
    v_mul_f32 v46, s58, v46
    v_mul_f32 v47, s58, v47
    v_cvt_pk_bf16_f32 v164, v32, v33
    v_cvt_pk_bf16_f32 v165, v34, v35
    v_cvt_pk_bf16_f32 v166, v44, v45
    v_cvt_pk_bf16_f32 v167, v46, v47
    v_mul_f32 v56, s58, v56
    v_mul_f32 v57, s58, v57
    v_mul_f32 v58, s58, v58
    v_mul_f32 v59, s58, v59
    v_mul_f32 v68, s58, v68
    v_mul_f32 v69, s58, v69
    v_mul_f32 v70, s58, v70
    v_mul_f32 v71, s58, v71
    v_cvt_pk_bf16_f32 v176, v56, v57
    v_cvt_pk_bf16_f32 v177, v58, v59
    v_cvt_pk_bf16_f32 v178, v68, v69
    v_cvt_pk_bf16_f32 v179, v70, v71
    v_mul_f32 v80, s58, v80
    v_mul_f32 v81, s58, v81
    v_mul_f32 v82, s58, v82
    v_mul_f32 v83, s58, v83
    v_mul_f32 v92, s58, v92
    v_mul_f32 v93, s58, v93
    v_mul_f32 v94, s58, v94
    v_mul_f32 v95, s58, v95
    v_cvt_pk_bf16_f32 v188, v80, v81
    v_cvt_pk_bf16_f32 v189, v82, v83
    v_cvt_pk_bf16_f32 v190, v92, v93
    v_cvt_pk_bf16_f32 v191, v94, v95
    v_permlane32_swap_b32 v152, v154
    v_permlane32_swap_b32 v153, v155
    v_permlane32_swap_b32 v164, v166
    v_permlane32_swap_b32 v165, v167
    v_permlane32_swap_b32 v176, v178
    v_permlane32_swap_b32 v177, v179
    v_permlane32_swap_b32 v188, v190
    v_permlane32_swap_b32 v189, v191
    v_permlane16_swap_b32 v152, v154
    v_permlane16_swap_b32 v153, v155
    v_permlane16_swap_b32 v164, v166
    v_permlane16_swap_b32 v165, v167
    v_permlane16_swap_b32 v176, v178
    v_permlane16_swap_b32 v177, v179
    v_permlane16_swap_b32 v188, v190
    v_permlane16_swap_b32 v189, v191
    ds_write_b128 v198, v[152:155] offset:2048
    ds_write_b128 v198, v[164:167] offset:8192
    ds_write_b128 v198, v[176:179] offset:14336
    ds_write_b128 v198, v[188:191] offset:20480
    s_waitcnt lgkmcnt(0)
    s_barrier
    v_mov_b32 v0, 0
    v_mov_b32 v1, 0
    v_mov_b32 v2, 0
    v_mov_b32 v3, 0
    v_mov_b32 v4, 0
    v_mov_b32 v5, 0
    v_mov_b32 v6, 0
    v_mov_b32 v7, 0
    v_mov_b32 v8, 0
    v_mov_b32 v9, 0
    v_mov_b32 v10, 0
    v_mov_b32 v11, 0
    v_mov_b32 v12, 0
    v_mov_b32 v13, 0
    v_mov_b32 v14, 0
    v_mov_b32 v15, 0
    v_mov_b32 v16, 0
    v_mov_b32 v17, 0
    v_mov_b32 v18, 0
    v_mov_b32 v19, 0
    v_mov_b32 v20, 0
    v_mov_b32 v21, 0
    v_mov_b32 v22, 0
    v_mov_b32 v23, 0
    v_mov_b32 v24, 0
    v_mov_b32 v25, 0
    v_mov_b32 v26, 0
    v_mov_b32 v27, 0
    v_mov_b32 v28, 0
    v_mov_b32 v29, 0
    v_mov_b32 v30, 0
    v_mov_b32 v31, 0
    v_mov_b32 v32, 0
    v_mov_b32 v33, 0
    v_mov_b32 v34, 0
    v_mov_b32 v35, 0
    v_mov_b32 v36, 0
    v_mov_b32 v37, 0
    v_mov_b32 v38, 0
    v_mov_b32 v39, 0
    v_mov_b32 v40, 0
    v_mov_b32 v41, 0
    v_mov_b32 v42, 0
    v_mov_b32 v43, 0
    v_mov_b32 v44, 0
    v_mov_b32 v45, 0
    v_mov_b32 v46, 0
    v_mov_b32 v47, 0
    v_mov_b32 v48, 0
    v_mov_b32 v49, 0
    v_mov_b32 v50, 0
    v_mov_b32 v51, 0
    v_mov_b32 v52, 0
    v_mov_b32 v53, 0
    v_mov_b32 v54, 0
    v_mov_b32 v55, 0
    v_mov_b32 v56, 0
    v_mov_b32 v57, 0
    v_mov_b32 v58, 0
    v_mov_b32 v59, 0
    v_mov_b32 v60, 0
    v_mov_b32 v61, 0
    v_mov_b32 v62, 0
    v_mov_b32 v63, 0
    v_mov_b32 v64, 0
    v_mov_b32 v65, 0
    v_mov_b32 v66, 0
    v_mov_b32 v67, 0
    v_mov_b32 v68, 0
    v_mov_b32 v69, 0
    v_mov_b32 v70, 0
    v_mov_b32 v71, 0
    v_mov_b32 v72, 0
    v_mov_b32 v73, 0
    v_mov_b32 v74, 0
    v_mov_b32 v75, 0
    v_mov_b32 v76, 0
    v_mov_b32 v77, 0
    v_mov_b32 v78, 0
    v_mov_b32 v79, 0
    v_mov_b32 v80, 0
    v_mov_b32 v81, 0
    v_mov_b32 v82, 0
    v_mov_b32 v83, 0
    v_mov_b32 v84, 0
    v_mov_b32 v85, 0
    v_mov_b32 v86, 0
    v_mov_b32 v87, 0
    v_mov_b32 v88, 0
    v_mov_b32 v89, 0
    v_mov_b32 v90, 0
    v_mov_b32 v91, 0
    v_mov_b32 v92, 0
    v_mov_b32 v93, 0
    v_mov_b32 v94, 0
    v_mov_b32 v95, 0
    v_mov_b32 v96, 0
    v_mov_b32 v97, 0
    v_mov_b32 v98, 0
    v_mov_b32 v99, 0
    v_mov_b32 v100, 0
    v_mov_b32 v101, 0
    v_mov_b32 v102, 0
    v_mov_b32 v103, 0
    v_mov_b32 v104, 0
    v_mov_b32 v105, 0
    v_mov_b32 v106, 0
    v_mov_b32 v107, 0
    v_mov_b32 v108, 0
    v_mov_b32 v109, 0
    v_mov_b32 v110, 0
    v_mov_b32 v111, 0
    v_mov_b32 v112, 0
    v_mov_b32 v113, 0
    v_mov_b32 v114, 0
    v_mov_b32 v115, 0
    v_mov_b32 v116, 0
    v_mov_b32 v117, 0
    v_mov_b32 v118, 0
    v_mov_b32 v119, 0
    v_mov_b32 v120, 0
    v_mov_b32 v121, 0
    v_mov_b32 v122, 0
    v_mov_b32 v123, 0
    v_mov_b32 v124, 0
    v_mov_b32 v125, 0
    v_mov_b32 v126, 0
    v_mov_b32 v127, 0
    v_mov_b32 v128, 0
    v_mov_b32 v129, 0
    v_mov_b32 v130, 0
    v_mov_b32 v131, 0
    v_mov_b32 v132, 0
    v_mov_b32 v133, 0
    v_mov_b32 v134, 0
    v_mov_b32 v135, 0
    v_mov_b32 v136, 0
    v_mov_b32 v137, 0
    v_mov_b32 v138, 0
    v_mov_b32 v139, 0
    v_mov_b32 v140, 0
    v_mov_b32 v141, 0
    v_mov_b32 v142, 0
    v_mov_b32 v143, 0
    v_mov_b32 v144, 0
    v_mov_b32 v145, 0
    v_mov_b32 v146, 0
    v_mov_b32 v147, 0
    v_mov_b32 v148, 0
    v_mov_b32 v149, 0
    v_mov_b32 v150, 0
    v_mov_b32 v151, 0
    v_mov_b32 v152, 0
    v_mov_b32 v153, 0
    v_mov_b32 v154, 0
    v_mov_b32 v155, 0
    v_mov_b32 v156, 0
    v_mov_b32 v157, 0
    v_mov_b32 v158, 0
    v_mov_b32 v159, 0
    v_mov_b32 v160, 0
    v_mov_b32 v161, 0
    v_mov_b32 v162, 0
    v_mov_b32 v163, 0
    v_mov_b32 v164, 0
    v_mov_b32 v165, 0
    v_mov_b32 v166, 0
    v_mov_b32 v167, 0
    v_mov_b32 v168, 0
    v_mov_b32 v169, 0
    v_mov_b32 v170, 0
    v_mov_b32 v171, 0
    v_mov_b32 v172, 0
    v_mov_b32 v173, 0
    v_mov_b32 v174, 0
    v_mov_b32 v175, 0
    v_mov_b32 v176, 0
    v_mov_b32 v177, 0
    v_mov_b32 v178, 0
    v_mov_b32 v179, 0
    v_mov_b32 v180, 0
    v_mov_b32 v181, 0
    v_mov_b32 v182, 0
    v_mov_b32 v183, 0
    v_mov_b32 v184, 0
    v_mov_b32 v185, 0
    v_mov_b32 v186, 0
    v_mov_b32 v187, 0
    v_mov_b32 v188, 0
    v_mov_b32 v189, 0
    v_mov_b32 v190, 0
    v_mov_b32 v191, 0
    v_mov_b32 v192, 0
    v_mov_b32 v193, 0
    v_mov_b32 v194, 0
    v_mov_b32 v195, 0
    v_mov_b32 v196, 0
    v_mov_b32 v197, 0
    v_mov_b32 v198, 0
    v_mov_b32 v199, 0
    v_mov_b32 v200, 0
    v_mov_b32 v201, 0
    v_mov_b32 v202, 0
    v_mov_b32 v203, 0
    v_mov_b32 v204, 0
    v_mov_b32 v205, 0
    v_mov_b32 v206, 0
    v_mov_b32 v207, 0
    v_mov_b32 v208, 0
    v_mov_b32 v209, 0
    v_mov_b32 v210, 0
    v_mov_b32 v211, 0
    v_mov_b32 v212, 0
    v_mov_b32 v213, 0
    v_mov_b32 v214, 0
    v_mov_b32 v215, 0
    s_waitcnt vmcnt(9)
    s_waitcnt lgkmcnt(0)
    s_add_u32 s47, s47, 512
    s_add_u32 s46, s46, 131072
    s_add_u32 s83, s83, 512
    s_add_u32 s89, s89, 294912
    s_add_u32 s64, s64, 294912
    s_add_u32 s65, s65, 294912
    s_add_u32 s66, s66, 294912
    s_add_u32 s67, s67, 294912
    s_add_u32 s68, s68, 294912
    s_add_u32 s69, s69, 294912
    s_add_u32 s70, s70, 294912
    s_add_u32 s71, s71, 294912
    s_add_u32 s72, s72, 294912
    s_barrier
    ds_read_b64_tr_b16 v[240:241], v248 offset:0
    ds_read_b64_tr_b16 v[242:243], v248 offset:2048
    ds_read_b128 v[216:219], v249 offset:0
    ds_read_b128 v[220:223], v249 offset:1024
    ds_read_b128 v[224:227], v249 offset:2048
    ds_read_b128 v[228:231], v249 offset:3072
    ds_read_b128 v[232:235], v249 offset:4096
    ds_read_b128 v[236:239], v249 offset:5120
    ds_read_b64_tr_b16 v[244:245], v248 offset:4096
    ds_read_b64_tr_b16 v[246:247], v248 offset:6144
    s_waitcnt lgkmcnt(7)
    v_mfma_f32_16x16x32_bf16 v[0:3], v[240:243], v[216:219], v[0:3]
    s_waitcnt lgkmcnt(6)
    v_mfma_f32_16x16x32_bf16 v[4:7], v[240:243], v[220:223], v[4:7]
    s_waitcnt lgkmcnt(5)
    v_mfma_f32_16x16x32_bf16 v[8:11], v[240:243], v[224:227], v[8:11]
    s_waitcnt lgkmcnt(4)
    v_mfma_f32_16x16x32_bf16 v[12:15], v[240:243], v[228:231], v[12:15]
    s_waitcnt lgkmcnt(3)
    v_mfma_f32_16x16x32_bf16 v[16:19], v[240:243], v[232:235], v[16:19]
    s_waitcnt lgkmcnt(2)
    v_mfma_f32_16x16x32_bf16 v[20:23], v[240:243], v[236:239], v[20:23]
    ds_read_b64_tr_b16 v[240:241], v248 offset:8192
    ds_read_b64_tr_b16 v[242:243], v248 offset:10240
    s_waitcnt lgkmcnt(2)
    v_mfma_f32_16x16x32_bf16 v[24:27], v[244:247], v[216:219], v[24:27]
    v_mfma_f32_16x16x32_bf16 v[28:31], v[244:247], v[220:223], v[28:31]
    v_mfma_f32_16x16x32_bf16 v[32:35], v[244:247], v[224:227], v[32:35]
    v_mfma_f32_16x16x32_bf16 v[36:39], v[244:247], v[228:231], v[36:39]
    v_mfma_f32_16x16x32_bf16 v[40:43], v[244:247], v[232:235], v[40:43]
    v_mfma_f32_16x16x32_bf16 v[44:47], v[244:247], v[236:239], v[44:47]
    ds_read_b64_tr_b16 v[244:245], v248 offset:12288
    ds_read_b64_tr_b16 v[246:247], v248 offset:14336
    s_waitcnt lgkmcnt(2)
    v_mfma_f32_16x16x32_bf16 v[48:51], v[240:243], v[216:219], v[48:51]
    v_mfma_f32_16x16x32_bf16 v[52:55], v[240:243], v[220:223], v[52:55]
    v_mfma_f32_16x16x32_bf16 v[56:59], v[240:243], v[224:227], v[56:59]
    v_mfma_f32_16x16x32_bf16 v[60:63], v[240:243], v[228:231], v[60:63]
    v_mfma_f32_16x16x32_bf16 v[64:67], v[240:243], v[232:235], v[64:67]
    v_mfma_f32_16x16x32_bf16 v[68:71], v[240:243], v[236:239], v[68:71]
    s_waitcnt lgkmcnt(0)
    v_mfma_f32_16x16x32_bf16 v[72:75], v[244:247], v[216:219], v[72:75]
    v_mfma_f32_16x16x32_bf16 v[76:79], v[244:247], v[220:223], v[76:79]
    v_mfma_f32_16x16x32_bf16 v[80:83], v[244:247], v[224:227], v[80:83]
    v_mfma_f32_16x16x32_bf16 v[84:87], v[244:247], v[228:231], v[84:87]
    v_mfma_f32_16x16x32_bf16 v[88:91], v[244:247], v[232:235], v[88:91]
    v_mfma_f32_16x16x32_bf16 v[92:95], v[244:247], v[236:239], v[92:95]
    s_waitcnt vmcnt(4)
    s_waitcnt lgkmcnt(0)
    s_barrier
    ds_read_b64_tr_b16 v[240:241], v248 offset:16384
    ds_read_b64_tr_b16 v[242:243], v248 offset:18432
    ds_read_b64_tr_b16 v[244:245], v248 offset:20480
    ds_read_b64_tr_b16 v[246:247], v248 offset:22528
    s_add_u32 m0, s50, 49152
    s_add_u32 s51, s64, 147456
    buffer_load_dwordx4 v252, s[24:27], s51 offen lds
    s_add_u32 m0, s50, 53248
    s_add_u32 s51, s65, 147456
    buffer_load_dwordx4 v252, s[24:27], s51 offen lds
    s_waitcnt lgkmcnt(2)
    v_mfma_f32_16x16x32_bf16 v[96:99], v[240:243], v[216:219], v[96:99]
    v_mfma_f32_16x16x32_bf16 v[100:103], v[240:243], v[220:223], v[100:103]
    s_add_u32 m0, s50, 57344
    s_add_u32 s51, s66, 147456
    buffer_load_dwordx4 v252, s[24:27], s51 offen lds
    v_mfma_f32_16x16x32_bf16 v[104:107], v[240:243], v[224:227], v[104:107]
    v_mfma_f32_16x16x32_bf16 v[108:111], v[240:243], v[228:231], v[108:111]
    v_mfma_f32_16x16x32_bf16 v[112:115], v[240:243], v[232:235], v[112:115]
    v_mfma_f32_16x16x32_bf16 v[116:119], v[240:243], v[236:239], v[116:119]
    ds_read_b64_tr_b16 v[240:241], v248 offset:24576
    ds_read_b64_tr_b16 v[242:243], v248 offset:26624
    s_waitcnt lgkmcnt(2)
    v_mfma_f32_16x16x32_bf16 v[120:123], v[244:247], v[216:219], v[120:123]
    s_add_u32 m0, s50, 61440
    s_add_u32 s51, s67, 147456
    buffer_load_dwordx4 v252, s[24:27], s51 offen lds
    v_mfma_f32_16x16x32_bf16 v[124:127], v[244:247], v[220:223], v[124:127]
    v_mfma_f32_16x16x32_bf16 v[128:131], v[244:247], v[224:227], v[128:131]
    v_mfma_f32_16x16x32_bf16 v[132:135], v[244:247], v[228:231], v[132:135]
    v_mfma_f32_16x16x32_bf16 v[136:139], v[244:247], v[232:235], v[136:139]
    v_mfma_f32_16x16x32_bf16 v[140:143], v[244:247], v[236:239], v[140:143]
    ds_read_b64_tr_b16 v[244:245], v248 offset:28672
    ds_read_b64_tr_b16 v[246:247], v248 offset:30720
    s_add_u32 m0, s50, 135168
    s_add_u32 s51, s46, 24576
    buffer_load_dwordx4 v254, s[16:19], s51 offen nt lds
    s_waitcnt lgkmcnt(2)
    v_mfma_f32_16x16x32_bf16 v[144:147], v[240:243], v[216:219], v[144:147]
    v_mfma_f32_16x16x32_bf16 v[148:151], v[240:243], v[220:223], v[148:151]
    v_mfma_f32_16x16x32_bf16 v[152:155], v[240:243], v[224:227], v[152:155]
    v_mfma_f32_16x16x32_bf16 v[156:159], v[240:243], v[228:231], v[156:159]
    v_mfma_f32_16x16x32_bf16 v[160:163], v[240:243], v[232:235], v[160:163]
    s_add_u32 m0, s50, 139264
    s_add_u32 s51, s46, 24704
    buffer_load_dwordx4 v254, s[16:19], s51 offen nt lds
    v_mfma_f32_16x16x32_bf16 v[164:167], v[240:243], v[236:239], v[164:167]
    ds_read_b64_tr_b16 v[240:241], v248 offset:32768
    ds_read_b64_tr_b16 v[242:243], v248 offset:34816
    s_waitcnt lgkmcnt(2)
    v_mfma_f32_16x16x32_bf16 v[168:171], v[244:247], v[216:219], v[168:171]
    v_mfma_f32_16x16x32_bf16 v[172:175], v[244:247], v[220:223], v[172:175]
    v_mfma_f32_16x16x32_bf16 v[176:179], v[244:247], v[224:227], v[176:179]
    v_mfma_f32_16x16x32_bf16 v[180:183], v[244:247], v[228:231], v[180:183]
    s_add_u32 m0, s50, 143360
    s_add_u32 s51, s46, 32768
    buffer_load_dwordx4 v253, s[12:15], s51 offen nt lds
    v_mfma_f32_16x16x32_bf16 v[184:187], v[244:247], v[232:235], v[184:187]
    v_mfma_f32_16x16x32_bf16 v[188:191], v[244:247], v[236:239], v[188:191]
    s_waitcnt lgkmcnt(0)
    v_mfma_f32_16x16x32_bf16 v[192:195], v[240:243], v[216:219], v[192:195]
    v_mfma_f32_16x16x32_bf16 v[196:199], v[240:243], v[220:223], v[196:199]
    v_mfma_f32_16x16x32_bf16 v[200:203], v[240:243], v[224:227], v[200:203]
    s_add_u32 m0, s50, 147456
    s_add_u32 s51, s46, 32896
    buffer_load_dwordx4 v253, s[12:15], s51 offen nt lds
    v_mfma_f32_16x16x32_bf16 v[204:207], v[240:243], v[228:231], v[204:207]
    v_mfma_f32_16x16x32_bf16 v[208:211], v[240:243], v[232:235], v[208:211]
    v_mfma_f32_16x16x32_bf16 v[212:215], v[240:243], v[236:239], v[212:215]
    s_waitcnt vmcnt(4)
    s_waitcnt lgkmcnt(0)
    s_barrier
    ds_read_b64_tr_b16 v[240:241], v248 offset:0
    ds_read_b64_tr_b16 v[242:243], v248 offset:2048
    ds_read_b128 v[216:219], v249 offset:24576
    ds_read_b128 v[220:223], v249 offset:25600
    ds_read_b128 v[224:227], v249 offset:26624
    ds_read_b128 v[228:231], v249 offset:27648
    ds_read_b128 v[232:235], v249 offset:28672
    ds_read_b128 v[236:239], v249 offset:29696
    ds_read_b64_tr_b16 v[244:245], v248 offset:4096
    ds_read_b64_tr_b16 v[246:247], v248 offset:6144
    s_add_u32 m0, s50, 65536
    s_add_u32 s51, s68, 147456
    buffer_load_dwordx4 v252, s[24:27], s51 offen lds
    s_add_u32 m0, s50, 69632
    s_add_u32 s51, s69, 147456
    buffer_load_dwordx4 v252, s[24:27], s51 offen lds
    s_waitcnt lgkmcnt(7)
    v_mfma_f32_16x16x32_bf16 v[0:3], v[240:243], v[216:219], v[0:3]
    s_waitcnt lgkmcnt(6)
    v_mfma_f32_16x16x32_bf16 v[4:7], v[240:243], v[220:223], v[4:7]
    s_add_u32 m0, s50, 73728
    s_add_u32 s51, s70, 147456
    buffer_load_dwordx4 v252, s[24:27], s51 offen lds
    s_waitcnt lgkmcnt(5)
    v_mfma_f32_16x16x32_bf16 v[8:11], v[240:243], v[224:227], v[8:11]
    s_waitcnt lgkmcnt(4)
    v_mfma_f32_16x16x32_bf16 v[12:15], v[240:243], v[228:231], v[12:15]
    s_waitcnt lgkmcnt(3)
    v_mfma_f32_16x16x32_bf16 v[16:19], v[240:243], v[232:235], v[16:19]
    s_add_u32 m0, s50, 77824
    s_add_u32 s51, s71, 147456
    buffer_load_dwordx4 v252, s[24:27], s51 offen lds
    s_waitcnt lgkmcnt(2)
    v_mfma_f32_16x16x32_bf16 v[20:23], v[240:243], v[236:239], v[20:23]
    ds_read_b64_tr_b16 v[240:241], v248 offset:8192
    ds_read_b64_tr_b16 v[242:243], v248 offset:10240
    s_waitcnt lgkmcnt(2)
    v_mfma_f32_16x16x32_bf16 v[24:27], v[244:247], v[216:219], v[24:27]
    v_mfma_f32_16x16x32_bf16 v[28:31], v[244:247], v[220:223], v[28:31]
    s_add_u32 m0, s50, 81920
    s_add_u32 s51, s72, 147456
    buffer_load_dwordx4 v252, s[24:27], s51 offen lds
    v_mfma_f32_16x16x32_bf16 v[32:35], v[244:247], v[224:227], v[32:35]
    v_mfma_f32_16x16x32_bf16 v[36:39], v[244:247], v[228:231], v[36:39]
    v_mfma_f32_16x16x32_bf16 v[40:43], v[244:247], v[232:235], v[40:43]
    v_mfma_f32_16x16x32_bf16 v[44:47], v[244:247], v[236:239], v[44:47]
    ds_read_b64_tr_b16 v[244:245], v248 offset:12288
    ds_read_b64_tr_b16 v[246:247], v248 offset:14336
    s_add_u32 m0, s50, 86016
    s_add_u32 s51, s46, 32768
    buffer_load_dwordx4 v254, s[16:19], s51 offen nt lds
    s_waitcnt lgkmcnt(2)
    v_mfma_f32_16x16x32_bf16 v[48:51], v[240:243], v[216:219], v[48:51]
    v_mfma_f32_16x16x32_bf16 v[52:55], v[240:243], v[220:223], v[52:55]
    v_mfma_f32_16x16x32_bf16 v[56:59], v[240:243], v[224:227], v[56:59]
    s_add_u32 m0, s50, 90112
    s_add_u32 s51, s46, 32896
    buffer_load_dwordx4 v254, s[16:19], s51 offen nt lds
    v_mfma_f32_16x16x32_bf16 v[60:63], v[240:243], v[228:231], v[60:63]
    v_mfma_f32_16x16x32_bf16 v[64:67], v[240:243], v[232:235], v[64:67]
    v_mfma_f32_16x16x32_bf16 v[68:71], v[240:243], v[236:239], v[68:71]
    s_waitcnt lgkmcnt(0)
    v_mfma_f32_16x16x32_bf16 v[72:75], v[244:247], v[216:219], v[72:75]
    s_add_u32 m0, s50, 94208
    s_add_u32 s51, s46, 40960
    buffer_load_dwordx4 v253, s[12:15], s51 offen nt lds
    v_mfma_f32_16x16x32_bf16 v[76:79], v[244:247], v[220:223], v[76:79]
    v_mfma_f32_16x16x32_bf16 v[80:83], v[244:247], v[224:227], v[80:83]
    v_mfma_f32_16x16x32_bf16 v[84:87], v[244:247], v[228:231], v[84:87]
    s_add_u32 m0, s50, 98304
    s_add_u32 s51, s46, 41088
    buffer_load_dwordx4 v253, s[12:15], s51 offen nt lds
    v_mfma_f32_16x16x32_bf16 v[88:91], v[244:247], v[232:235], v[88:91]
    v_mfma_f32_16x16x32_bf16 v[92:95], v[244:247], v[236:239], v[92:95]
    s_waitcnt vmcnt(4)
    s_waitcnt lgkmcnt(0)
    s_barrier
    ds_read_b64_tr_b16 v[240:241], v248 offset:16384
    ds_read_b64_tr_b16 v[242:243], v248 offset:18432
    ds_read_b64_tr_b16 v[244:245], v248 offset:20480
    ds_read_b64_tr_b16 v[246:247], v248 offset:22528
    s_add_u32 m0, s50, 49152
    s_add_u32 s51, s64, 36864
    buffer_load_dwordx4 v252, s[24:27], s51 offen lds
    s_add_u32 m0, s50, 53248
    s_add_u32 s51, s65, 36864
    buffer_load_dwordx4 v252, s[24:27], s51 offen lds
    s_waitcnt lgkmcnt(2)
    v_mfma_f32_16x16x32_bf16 v[96:99], v[240:243], v[216:219], v[96:99]
    v_mfma_f32_16x16x32_bf16 v[100:103], v[240:243], v[220:223], v[100:103]
    s_add_u32 m0, s50, 57344
    s_add_u32 s51, s66, 36864
    buffer_load_dwordx4 v252, s[24:27], s51 offen lds
    v_mfma_f32_16x16x32_bf16 v[104:107], v[240:243], v[224:227], v[104:107]
    v_mfma_f32_16x16x32_bf16 v[108:111], v[240:243], v[228:231], v[108:111]
    v_mfma_f32_16x16x32_bf16 v[112:115], v[240:243], v[232:235], v[112:115]
    v_mfma_f32_16x16x32_bf16 v[116:119], v[240:243], v[236:239], v[116:119]
    ds_read_b64_tr_b16 v[240:241], v248 offset:24576
    ds_read_b64_tr_b16 v[242:243], v248 offset:26624
    s_waitcnt lgkmcnt(2)
    v_mfma_f32_16x16x32_bf16 v[120:123], v[244:247], v[216:219], v[120:123]
    s_add_u32 m0, s50, 61440
    s_add_u32 s51, s67, 36864
    buffer_load_dwordx4 v252, s[24:27], s51 offen lds
    v_mfma_f32_16x16x32_bf16 v[124:127], v[244:247], v[220:223], v[124:127]
    v_mfma_f32_16x16x32_bf16 v[128:131], v[244:247], v[224:227], v[128:131]
    v_mfma_f32_16x16x32_bf16 v[132:135], v[244:247], v[228:231], v[132:135]
    v_mfma_f32_16x16x32_bf16 v[136:139], v[244:247], v[232:235], v[136:139]
    v_mfma_f32_16x16x32_bf16 v[140:143], v[244:247], v[236:239], v[140:143]
    ds_read_b64_tr_b16 v[244:245], v248 offset:28672
    ds_read_b64_tr_b16 v[246:247], v248 offset:30720
    s_add_u32 m0, s50, 102400
    s_add_u32 s51, s46, 40960
    buffer_load_dwordx4 v254, s[16:19], s51 offen nt lds
    s_waitcnt lgkmcnt(2)
    v_mfma_f32_16x16x32_bf16 v[144:147], v[240:243], v[216:219], v[144:147]
    v_mfma_f32_16x16x32_bf16 v[148:151], v[240:243], v[220:223], v[148:151]
    v_mfma_f32_16x16x32_bf16 v[152:155], v[240:243], v[224:227], v[152:155]
    v_mfma_f32_16x16x32_bf16 v[156:159], v[240:243], v[228:231], v[156:159]
    v_mfma_f32_16x16x32_bf16 v[160:163], v[240:243], v[232:235], v[160:163]
    s_add_u32 m0, s50, 106496
    s_add_u32 s51, s46, 41088
    buffer_load_dwordx4 v254, s[16:19], s51 offen nt lds
    v_mfma_f32_16x16x32_bf16 v[164:167], v[240:243], v[236:239], v[164:167]
    ds_read_b64_tr_b16 v[240:241], v248 offset:32768
    ds_read_b64_tr_b16 v[242:243], v248 offset:34816
    s_waitcnt lgkmcnt(2)
    v_mfma_f32_16x16x32_bf16 v[168:171], v[244:247], v[216:219], v[168:171]
    v_mfma_f32_16x16x32_bf16 v[172:175], v[244:247], v[220:223], v[172:175]
    v_mfma_f32_16x16x32_bf16 v[176:179], v[244:247], v[224:227], v[176:179]
    v_mfma_f32_16x16x32_bf16 v[180:183], v[244:247], v[228:231], v[180:183]
    s_add_u32 m0, s50, 110592
    s_add_u32 s51, s46, 49152
    buffer_load_dwordx4 v253, s[12:15], s51 offen nt lds
    v_mfma_f32_16x16x32_bf16 v[184:187], v[244:247], v[232:235], v[184:187]
    v_mfma_f32_16x16x32_bf16 v[188:191], v[244:247], v[236:239], v[188:191]
    s_waitcnt lgkmcnt(0)
    v_mfma_f32_16x16x32_bf16 v[192:195], v[240:243], v[216:219], v[192:195]
    v_mfma_f32_16x16x32_bf16 v[196:199], v[240:243], v[220:223], v[196:199]
    v_mfma_f32_16x16x32_bf16 v[200:203], v[240:243], v[224:227], v[200:203]
    s_add_u32 m0, s50, 114688
    s_add_u32 s51, s46, 49280
    buffer_load_dwordx4 v253, s[12:15], s51 offen nt lds
    v_mfma_f32_16x16x32_bf16 v[204:207], v[240:243], v[228:231], v[204:207]
    v_mfma_f32_16x16x32_bf16 v[208:211], v[240:243], v[232:235], v[208:211]
    v_mfma_f32_16x16x32_bf16 v[212:215], v[240:243], v[236:239], v[212:215]
    s_waitcnt vmcnt(4)
    s_waitcnt lgkmcnt(0)
    s_barrier
    ds_read_b64_tr_b16 v[240:241], v248 offset:0
    ds_read_b64_tr_b16 v[242:243], v248 offset:2048
    ds_read_b128 v[216:219], v249 offset:6144
    ds_read_b128 v[220:223], v249 offset:7168
    ds_read_b128 v[224:227], v249 offset:8192
    ds_read_b128 v[228:231], v249 offset:9216
    ds_read_b128 v[232:235], v249 offset:10240
    ds_read_b128 v[236:239], v249 offset:11264
    ds_read_b64_tr_b16 v[244:245], v248 offset:4096
    ds_read_b64_tr_b16 v[246:247], v248 offset:6144
    s_add_u32 m0, s50, 65536
    s_add_u32 s51, s68, 36864
    buffer_load_dwordx4 v252, s[24:27], s51 offen lds
    s_add_u32 m0, s50, 69632
    s_add_u32 s51, s69, 36864
    buffer_load_dwordx4 v252, s[24:27], s51 offen lds
    s_waitcnt lgkmcnt(7)
    v_mfma_f32_16x16x32_bf16 v[0:3], v[240:243], v[216:219], v[0:3]
    s_waitcnt lgkmcnt(6)
    v_mfma_f32_16x16x32_bf16 v[4:7], v[240:243], v[220:223], v[4:7]
    s_add_u32 m0, s50, 73728
    s_add_u32 s51, s70, 36864
    buffer_load_dwordx4 v252, s[24:27], s51 offen lds
    s_waitcnt lgkmcnt(5)
    v_mfma_f32_16x16x32_bf16 v[8:11], v[240:243], v[224:227], v[8:11]
    s_waitcnt lgkmcnt(4)
    v_mfma_f32_16x16x32_bf16 v[12:15], v[240:243], v[228:231], v[12:15]
    s_waitcnt lgkmcnt(3)
    v_mfma_f32_16x16x32_bf16 v[16:19], v[240:243], v[232:235], v[16:19]
    s_add_u32 m0, s50, 77824
    s_add_u32 s51, s71, 36864
    buffer_load_dwordx4 v252, s[24:27], s51 offen lds
    s_waitcnt lgkmcnt(2)
    v_mfma_f32_16x16x32_bf16 v[20:23], v[240:243], v[236:239], v[20:23]
    ds_read_b64_tr_b16 v[240:241], v248 offset:8192
    ds_read_b64_tr_b16 v[242:243], v248 offset:10240
    s_waitcnt lgkmcnt(2)
    v_mfma_f32_16x16x32_bf16 v[24:27], v[244:247], v[216:219], v[24:27]
    v_mfma_f32_16x16x32_bf16 v[28:31], v[244:247], v[220:223], v[28:31]
    s_add_u32 m0, s50, 81920
    s_add_u32 s51, s72, 36864
    buffer_load_dwordx4 v252, s[24:27], s51 offen lds
    v_mfma_f32_16x16x32_bf16 v[32:35], v[244:247], v[224:227], v[32:35]
    v_mfma_f32_16x16x32_bf16 v[36:39], v[244:247], v[228:231], v[36:39]
    v_mfma_f32_16x16x32_bf16 v[40:43], v[244:247], v[232:235], v[40:43]
    v_mfma_f32_16x16x32_bf16 v[44:47], v[244:247], v[236:239], v[44:47]
    ds_read_b64_tr_b16 v[244:245], v248 offset:12288
    ds_read_b64_tr_b16 v[246:247], v248 offset:14336
    s_add_u32 m0, s50, 118784
    s_add_u32 s51, s46, 49152
    buffer_load_dwordx4 v254, s[16:19], s51 offen nt lds
    s_waitcnt lgkmcnt(2)
    v_mfma_f32_16x16x32_bf16 v[48:51], v[240:243], v[216:219], v[48:51]
    v_mfma_f32_16x16x32_bf16 v[52:55], v[240:243], v[220:223], v[52:55]
    v_mfma_f32_16x16x32_bf16 v[56:59], v[240:243], v[224:227], v[56:59]
    s_add_u32 m0, s50, 122880
    s_add_u32 s51, s46, 49280
    buffer_load_dwordx4 v254, s[16:19], s51 offen nt lds
    v_mfma_f32_16x16x32_bf16 v[60:63], v[240:243], v[228:231], v[60:63]
    v_mfma_f32_16x16x32_bf16 v[64:67], v[240:243], v[232:235], v[64:67]
    v_mfma_f32_16x16x32_bf16 v[68:71], v[240:243], v[236:239], v[68:71]
    s_waitcnt lgkmcnt(0)
    v_mfma_f32_16x16x32_bf16 v[72:75], v[244:247], v[216:219], v[72:75]
    s_add_u32 m0, s50, 126976
    s_add_u32 s51, s46, 57344
    buffer_load_dwordx4 v253, s[12:15], s51 offen nt lds
    v_mfma_f32_16x16x32_bf16 v[76:79], v[244:247], v[220:223], v[76:79]
    v_mfma_f32_16x16x32_bf16 v[80:83], v[244:247], v[224:227], v[80:83]
    v_mfma_f32_16x16x32_bf16 v[84:87], v[244:247], v[228:231], v[84:87]
    s_add_u32 m0, s50, 131072
    s_add_u32 s51, s46, 57472
    buffer_load_dwordx4 v253, s[12:15], s51 offen nt lds
    v_mfma_f32_16x16x32_bf16 v[88:91], v[244:247], v[232:235], v[88:91]
    v_mfma_f32_16x16x32_bf16 v[92:95], v[244:247], v[236:239], v[92:95]
    s_waitcnt vmcnt(4)
    s_waitcnt lgkmcnt(0)
    s_barrier
    ds_read_b64_tr_b16 v[240:241], v248 offset:16384
    ds_read_b64_tr_b16 v[242:243], v248 offset:18432
    ds_read_b64_tr_b16 v[244:245], v248 offset:20480
    ds_read_b64_tr_b16 v[246:247], v248 offset:22528
    s_add_u32 m0, s50, 49152
    s_add_u32 s51, s64, 184320
    buffer_load_dwordx4 v252, s[24:27], s51 offen lds
    s_add_u32 m0, s50, 53248
    s_add_u32 s51, s65, 184320
    buffer_load_dwordx4 v252, s[24:27], s51 offen lds
    s_waitcnt lgkmcnt(2)
    v_mfma_f32_16x16x32_bf16 v[96:99], v[240:243], v[216:219], v[96:99]
    v_mfma_f32_16x16x32_bf16 v[100:103], v[240:243], v[220:223], v[100:103]
    s_add_u32 m0, s50, 57344
    s_add_u32 s51, s66, 184320
    buffer_load_dwordx4 v252, s[24:27], s51 offen lds
    v_mfma_f32_16x16x32_bf16 v[104:107], v[240:243], v[224:227], v[104:107]
    v_mfma_f32_16x16x32_bf16 v[108:111], v[240:243], v[228:231], v[108:111]
    v_mfma_f32_16x16x32_bf16 v[112:115], v[240:243], v[232:235], v[112:115]
    v_mfma_f32_16x16x32_bf16 v[116:119], v[240:243], v[236:239], v[116:119]
    ds_read_b64_tr_b16 v[240:241], v248 offset:24576
    ds_read_b64_tr_b16 v[242:243], v248 offset:26624
    s_waitcnt lgkmcnt(2)
    v_mfma_f32_16x16x32_bf16 v[120:123], v[244:247], v[216:219], v[120:123]
    s_add_u32 m0, s50, 61440
    s_add_u32 s51, s67, 184320
    buffer_load_dwordx4 v252, s[24:27], s51 offen lds
    v_mfma_f32_16x16x32_bf16 v[124:127], v[244:247], v[220:223], v[124:127]
    v_mfma_f32_16x16x32_bf16 v[128:131], v[244:247], v[224:227], v[128:131]
    v_mfma_f32_16x16x32_bf16 v[132:135], v[244:247], v[228:231], v[132:135]
    v_mfma_f32_16x16x32_bf16 v[136:139], v[244:247], v[232:235], v[136:139]
    v_mfma_f32_16x16x32_bf16 v[140:143], v[244:247], v[236:239], v[140:143]
    ds_read_b64_tr_b16 v[244:245], v248 offset:28672
    ds_read_b64_tr_b16 v[246:247], v248 offset:30720
    s_add_u32 m0, s50, 135168
    s_add_u32 s51, s46, 57344
    buffer_load_dwordx4 v254, s[16:19], s51 offen nt lds
    s_waitcnt lgkmcnt(2)
    v_mfma_f32_16x16x32_bf16 v[144:147], v[240:243], v[216:219], v[144:147]
    v_mfma_f32_16x16x32_bf16 v[148:151], v[240:243], v[220:223], v[148:151]
    v_mfma_f32_16x16x32_bf16 v[152:155], v[240:243], v[224:227], v[152:155]
    v_mfma_f32_16x16x32_bf16 v[156:159], v[240:243], v[228:231], v[156:159]
    v_mfma_f32_16x16x32_bf16 v[160:163], v[240:243], v[232:235], v[160:163]
    s_add_u32 m0, s50, 139264
    s_add_u32 s51, s46, 57472
    buffer_load_dwordx4 v254, s[16:19], s51 offen nt lds
    v_mfma_f32_16x16x32_bf16 v[164:167], v[240:243], v[236:239], v[164:167]
    ds_read_b64_tr_b16 v[240:241], v248 offset:32768
    ds_read_b64_tr_b16 v[242:243], v248 offset:34816
    s_waitcnt lgkmcnt(2)
    v_mfma_f32_16x16x32_bf16 v[168:171], v[244:247], v[216:219], v[168:171]
    v_mfma_f32_16x16x32_bf16 v[172:175], v[244:247], v[220:223], v[172:175]
    v_mfma_f32_16x16x32_bf16 v[176:179], v[244:247], v[224:227], v[176:179]
    v_mfma_f32_16x16x32_bf16 v[180:183], v[244:247], v[228:231], v[180:183]
    s_add_u32 m0, s50, 143360
    s_add_u32 s51, s46, 65536
    buffer_load_dwordx4 v253, s[12:15], s51 offen nt lds
    v_mfma_f32_16x16x32_bf16 v[184:187], v[244:247], v[232:235], v[184:187]
    v_mfma_f32_16x16x32_bf16 v[188:191], v[244:247], v[236:239], v[188:191]
    s_waitcnt lgkmcnt(0)
    v_mfma_f32_16x16x32_bf16 v[192:195], v[240:243], v[216:219], v[192:195]
    v_mfma_f32_16x16x32_bf16 v[196:199], v[240:243], v[220:223], v[196:199]
    v_mfma_f32_16x16x32_bf16 v[200:203], v[240:243], v[224:227], v[200:203]
    s_add_u32 m0, s50, 147456
    s_add_u32 s51, s46, 65664
    buffer_load_dwordx4 v253, s[12:15], s51 offen nt lds
    v_mfma_f32_16x16x32_bf16 v[204:207], v[240:243], v[228:231], v[204:207]
    v_mfma_f32_16x16x32_bf16 v[208:211], v[240:243], v[232:235], v[208:211]
    v_mfma_f32_16x16x32_bf16 v[212:215], v[240:243], v[236:239], v[212:215]
    s_waitcnt vmcnt(4)
    s_waitcnt lgkmcnt(0)
    s_barrier
    ds_read_b64_tr_b16 v[240:241], v248 offset:0
    ds_read_b64_tr_b16 v[242:243], v248 offset:2048
    ds_read_b128 v[216:219], v249 offset:30720
    ds_read_b128 v[220:223], v249 offset:31744
    ds_read_b128 v[224:227], v249 offset:32768
    ds_read_b128 v[228:231], v249 offset:33792
    ds_read_b128 v[232:235], v249 offset:34816
    ds_read_b128 v[236:239], v249 offset:35840
    ds_read_b64_tr_b16 v[244:245], v248 offset:4096
    ds_read_b64_tr_b16 v[246:247], v248 offset:6144
    s_add_u32 m0, s50, 65536
    s_add_u32 s51, s68, 184320
    buffer_load_dwordx4 v252, s[24:27], s51 offen lds
    s_add_u32 m0, s50, 69632
    s_add_u32 s51, s69, 184320
    buffer_load_dwordx4 v252, s[24:27], s51 offen lds
    s_waitcnt lgkmcnt(7)
    v_mfma_f32_16x16x32_bf16 v[0:3], v[240:243], v[216:219], v[0:3]
    s_waitcnt lgkmcnt(6)
    v_mfma_f32_16x16x32_bf16 v[4:7], v[240:243], v[220:223], v[4:7]
    s_add_u32 m0, s50, 73728
    s_add_u32 s51, s70, 184320
    buffer_load_dwordx4 v252, s[24:27], s51 offen lds
    s_waitcnt lgkmcnt(5)
    v_mfma_f32_16x16x32_bf16 v[8:11], v[240:243], v[224:227], v[8:11]
    s_waitcnt lgkmcnt(4)
    v_mfma_f32_16x16x32_bf16 v[12:15], v[240:243], v[228:231], v[12:15]
    s_waitcnt lgkmcnt(3)
    v_mfma_f32_16x16x32_bf16 v[16:19], v[240:243], v[232:235], v[16:19]
    s_add_u32 m0, s50, 77824
    s_add_u32 s51, s71, 184320
    buffer_load_dwordx4 v252, s[24:27], s51 offen lds
    s_waitcnt lgkmcnt(2)
    v_mfma_f32_16x16x32_bf16 v[20:23], v[240:243], v[236:239], v[20:23]
    ds_read_b64_tr_b16 v[240:241], v248 offset:8192
    ds_read_b64_tr_b16 v[242:243], v248 offset:10240
    s_waitcnt lgkmcnt(2)
    v_mfma_f32_16x16x32_bf16 v[24:27], v[244:247], v[216:219], v[24:27]
    v_mfma_f32_16x16x32_bf16 v[28:31], v[244:247], v[220:223], v[28:31]
    s_add_u32 m0, s50, 81920
    s_add_u32 s51, s72, 184320
    buffer_load_dwordx4 v252, s[24:27], s51 offen lds
    v_mfma_f32_16x16x32_bf16 v[32:35], v[244:247], v[224:227], v[32:35]
    v_mfma_f32_16x16x32_bf16 v[36:39], v[244:247], v[228:231], v[36:39]
    v_mfma_f32_16x16x32_bf16 v[40:43], v[244:247], v[232:235], v[40:43]
    v_mfma_f32_16x16x32_bf16 v[44:47], v[244:247], v[236:239], v[44:47]
    ds_read_b64_tr_b16 v[244:245], v248 offset:12288
    ds_read_b64_tr_b16 v[246:247], v248 offset:14336
    s_add_u32 m0, s50, 86016
    s_add_u32 s51, s46, 65536
    buffer_load_dwordx4 v254, s[16:19], s51 offen nt lds
    s_waitcnt lgkmcnt(2)
    v_mfma_f32_16x16x32_bf16 v[48:51], v[240:243], v[216:219], v[48:51]
    v_mfma_f32_16x16x32_bf16 v[52:55], v[240:243], v[220:223], v[52:55]
    v_mfma_f32_16x16x32_bf16 v[56:59], v[240:243], v[224:227], v[56:59]
    s_add_u32 m0, s50, 90112
    s_add_u32 s51, s46, 65664
    buffer_load_dwordx4 v254, s[16:19], s51 offen nt lds
    v_mfma_f32_16x16x32_bf16 v[60:63], v[240:243], v[228:231], v[60:63]
    v_mfma_f32_16x16x32_bf16 v[64:67], v[240:243], v[232:235], v[64:67]
    v_mfma_f32_16x16x32_bf16 v[68:71], v[240:243], v[236:239], v[68:71]
    s_waitcnt lgkmcnt(0)
    v_mfma_f32_16x16x32_bf16 v[72:75], v[244:247], v[216:219], v[72:75]
    s_add_u32 m0, s50, 94208
    s_add_u32 s51, s46, 73728
    buffer_load_dwordx4 v253, s[12:15], s51 offen nt lds
    v_mfma_f32_16x16x32_bf16 v[76:79], v[244:247], v[220:223], v[76:79]
    v_mfma_f32_16x16x32_bf16 v[80:83], v[244:247], v[224:227], v[80:83]
    v_mfma_f32_16x16x32_bf16 v[84:87], v[244:247], v[228:231], v[84:87]
    s_add_u32 m0, s50, 98304
    s_add_u32 s51, s46, 73856
    buffer_load_dwordx4 v253, s[12:15], s51 offen nt lds
    v_mfma_f32_16x16x32_bf16 v[88:91], v[244:247], v[232:235], v[88:91]
    v_mfma_f32_16x16x32_bf16 v[92:95], v[244:247], v[236:239], v[92:95]
    s_waitcnt vmcnt(4)
    s_waitcnt lgkmcnt(0)
    s_barrier
    ds_read_b64_tr_b16 v[240:241], v248 offset:16384
    ds_read_b64_tr_b16 v[242:243], v248 offset:18432
    ds_read_b64_tr_b16 v[244:245], v248 offset:20480
    ds_read_b64_tr_b16 v[246:247], v248 offset:22528
    s_add_u32 m0, s50, 49152
    s_add_u32 s51, s64, 73728
    buffer_load_dwordx4 v252, s[24:27], s51 offen lds
    s_add_u32 m0, s50, 53248
    s_add_u32 s51, s65, 73728
    buffer_load_dwordx4 v252, s[24:27], s51 offen lds
    s_waitcnt lgkmcnt(2)
    v_mfma_f32_16x16x32_bf16 v[96:99], v[240:243], v[216:219], v[96:99]
    v_mfma_f32_16x16x32_bf16 v[100:103], v[240:243], v[220:223], v[100:103]
    s_add_u32 m0, s50, 57344
    s_add_u32 s51, s66, 73728
    buffer_load_dwordx4 v252, s[24:27], s51 offen lds
    v_mfma_f32_16x16x32_bf16 v[104:107], v[240:243], v[224:227], v[104:107]
    v_mfma_f32_16x16x32_bf16 v[108:111], v[240:243], v[228:231], v[108:111]
    v_mfma_f32_16x16x32_bf16 v[112:115], v[240:243], v[232:235], v[112:115]
    v_mfma_f32_16x16x32_bf16 v[116:119], v[240:243], v[236:239], v[116:119]
    ds_read_b64_tr_b16 v[240:241], v248 offset:24576
    ds_read_b64_tr_b16 v[242:243], v248 offset:26624
    s_waitcnt lgkmcnt(2)
    v_mfma_f32_16x16x32_bf16 v[120:123], v[244:247], v[216:219], v[120:123]
    s_add_u32 m0, s50, 61440
    s_add_u32 s51, s67, 73728
    buffer_load_dwordx4 v252, s[24:27], s51 offen lds
    v_mfma_f32_16x16x32_bf16 v[124:127], v[244:247], v[220:223], v[124:127]
    v_mfma_f32_16x16x32_bf16 v[128:131], v[244:247], v[224:227], v[128:131]
    v_mfma_f32_16x16x32_bf16 v[132:135], v[244:247], v[228:231], v[132:135]
    v_mfma_f32_16x16x32_bf16 v[136:139], v[244:247], v[232:235], v[136:139]
    v_mfma_f32_16x16x32_bf16 v[140:143], v[244:247], v[236:239], v[140:143]
    ds_read_b64_tr_b16 v[244:245], v248 offset:28672
    ds_read_b64_tr_b16 v[246:247], v248 offset:30720
    s_add_u32 m0, s50, 102400
    s_add_u32 s51, s46, 73728
    buffer_load_dwordx4 v254, s[16:19], s51 offen nt lds
    s_waitcnt lgkmcnt(2)
    v_mfma_f32_16x16x32_bf16 v[144:147], v[240:243], v[216:219], v[144:147]
    v_mfma_f32_16x16x32_bf16 v[148:151], v[240:243], v[220:223], v[148:151]
    v_mfma_f32_16x16x32_bf16 v[152:155], v[240:243], v[224:227], v[152:155]
    v_mfma_f32_16x16x32_bf16 v[156:159], v[240:243], v[228:231], v[156:159]
    v_mfma_f32_16x16x32_bf16 v[160:163], v[240:243], v[232:235], v[160:163]
    s_add_u32 m0, s50, 106496
    s_add_u32 s51, s46, 73856
    buffer_load_dwordx4 v254, s[16:19], s51 offen nt lds
    v_mfma_f32_16x16x32_bf16 v[164:167], v[240:243], v[236:239], v[164:167]
    ds_read_b64_tr_b16 v[240:241], v248 offset:32768
    ds_read_b64_tr_b16 v[242:243], v248 offset:34816
    s_waitcnt lgkmcnt(2)
    v_mfma_f32_16x16x32_bf16 v[168:171], v[244:247], v[216:219], v[168:171]
    v_mfma_f32_16x16x32_bf16 v[172:175], v[244:247], v[220:223], v[172:175]
    v_mfma_f32_16x16x32_bf16 v[176:179], v[244:247], v[224:227], v[176:179]
    v_mfma_f32_16x16x32_bf16 v[180:183], v[244:247], v[228:231], v[180:183]
    s_add_u32 m0, s50, 110592
    s_add_u32 s51, s46, 81920
    buffer_load_dwordx4 v253, s[12:15], s51 offen nt lds
    v_mfma_f32_16x16x32_bf16 v[184:187], v[244:247], v[232:235], v[184:187]
    v_mfma_f32_16x16x32_bf16 v[188:191], v[244:247], v[236:239], v[188:191]
    s_waitcnt lgkmcnt(0)
    v_mfma_f32_16x16x32_bf16 v[192:195], v[240:243], v[216:219], v[192:195]
    v_mfma_f32_16x16x32_bf16 v[196:199], v[240:243], v[220:223], v[196:199]
    v_mfma_f32_16x16x32_bf16 v[200:203], v[240:243], v[224:227], v[200:203]
    s_add_u32 m0, s50, 114688
    s_add_u32 s51, s46, 82048
    buffer_load_dwordx4 v253, s[12:15], s51 offen nt lds
    v_mfma_f32_16x16x32_bf16 v[204:207], v[240:243], v[228:231], v[204:207]
    v_mfma_f32_16x16x32_bf16 v[208:211], v[240:243], v[232:235], v[208:211]
    v_mfma_f32_16x16x32_bf16 v[212:215], v[240:243], v[236:239], v[212:215]
    s_waitcnt vmcnt(4)
    s_waitcnt lgkmcnt(0)
    s_barrier
    ds_read_b64_tr_b16 v[240:241], v248 offset:0
    ds_read_b64_tr_b16 v[242:243], v248 offset:2048
    ds_read_b128 v[216:219], v249 offset:12288
    ds_read_b128 v[220:223], v249 offset:13312
    ds_read_b128 v[224:227], v249 offset:14336
    ds_read_b128 v[228:231], v249 offset:15360
    ds_read_b128 v[232:235], v249 offset:16384
    ds_read_b128 v[236:239], v249 offset:17408
    ds_read_b64_tr_b16 v[244:245], v248 offset:4096
    ds_read_b64_tr_b16 v[246:247], v248 offset:6144
    s_add_u32 m0, s50, 65536
    s_add_u32 s51, s68, 73728
    buffer_load_dwordx4 v252, s[24:27], s51 offen lds
    s_add_u32 m0, s50, 69632
    s_add_u32 s51, s69, 73728
    buffer_load_dwordx4 v252, s[24:27], s51 offen lds
    s_waitcnt lgkmcnt(7)
    v_mfma_f32_16x16x32_bf16 v[0:3], v[240:243], v[216:219], v[0:3]
    s_waitcnt lgkmcnt(6)
    v_mfma_f32_16x16x32_bf16 v[4:7], v[240:243], v[220:223], v[4:7]
    s_add_u32 m0, s50, 73728
    s_add_u32 s51, s70, 73728
    buffer_load_dwordx4 v252, s[24:27], s51 offen lds
    s_waitcnt lgkmcnt(5)
    v_mfma_f32_16x16x32_bf16 v[8:11], v[240:243], v[224:227], v[8:11]
    s_waitcnt lgkmcnt(4)
    v_mfma_f32_16x16x32_bf16 v[12:15], v[240:243], v[228:231], v[12:15]
    s_waitcnt lgkmcnt(3)
    v_mfma_f32_16x16x32_bf16 v[16:19], v[240:243], v[232:235], v[16:19]
    s_add_u32 m0, s50, 77824
    s_add_u32 s51, s71, 73728
    buffer_load_dwordx4 v252, s[24:27], s51 offen lds
    s_waitcnt lgkmcnt(2)
    v_mfma_f32_16x16x32_bf16 v[20:23], v[240:243], v[236:239], v[20:23]
    ds_read_b64_tr_b16 v[240:241], v248 offset:8192
    ds_read_b64_tr_b16 v[242:243], v248 offset:10240
    s_waitcnt lgkmcnt(2)
    v_mfma_f32_16x16x32_bf16 v[24:27], v[244:247], v[216:219], v[24:27]
    v_mfma_f32_16x16x32_bf16 v[28:31], v[244:247], v[220:223], v[28:31]
    s_add_u32 m0, s50, 81920
    s_add_u32 s51, s72, 73728
    buffer_load_dwordx4 v252, s[24:27], s51 offen lds
    v_mfma_f32_16x16x32_bf16 v[32:35], v[244:247], v[224:227], v[32:35]
    v_mfma_f32_16x16x32_bf16 v[36:39], v[244:247], v[228:231], v[36:39]
    v_mfma_f32_16x16x32_bf16 v[40:43], v[244:247], v[232:235], v[40:43]
    v_mfma_f32_16x16x32_bf16 v[44:47], v[244:247], v[236:239], v[44:47]
    ds_read_b64_tr_b16 v[244:245], v248 offset:12288
    ds_read_b64_tr_b16 v[246:247], v248 offset:14336
    s_add_u32 m0, s50, 118784
    s_add_u32 s51, s46, 81920
    buffer_load_dwordx4 v254, s[16:19], s51 offen nt lds
    s_waitcnt lgkmcnt(2)
    v_mfma_f32_16x16x32_bf16 v[48:51], v[240:243], v[216:219], v[48:51]
    v_mfma_f32_16x16x32_bf16 v[52:55], v[240:243], v[220:223], v[52:55]
    v_mfma_f32_16x16x32_bf16 v[56:59], v[240:243], v[224:227], v[56:59]
    s_add_u32 m0, s50, 122880
    s_add_u32 s51, s46, 82048
    buffer_load_dwordx4 v254, s[16:19], s51 offen nt lds
    v_mfma_f32_16x16x32_bf16 v[60:63], v[240:243], v[228:231], v[60:63]
    v_mfma_f32_16x16x32_bf16 v[64:67], v[240:243], v[232:235], v[64:67]
    v_mfma_f32_16x16x32_bf16 v[68:71], v[240:243], v[236:239], v[68:71]
    s_waitcnt lgkmcnt(0)
    v_mfma_f32_16x16x32_bf16 v[72:75], v[244:247], v[216:219], v[72:75]
    s_add_u32 m0, s50, 126976
    s_add_u32 s51, s46, 90112
    buffer_load_dwordx4 v253, s[12:15], s51 offen nt lds
    v_mfma_f32_16x16x32_bf16 v[76:79], v[244:247], v[220:223], v[76:79]
    v_mfma_f32_16x16x32_bf16 v[80:83], v[244:247], v[224:227], v[80:83]
    v_mfma_f32_16x16x32_bf16 v[84:87], v[244:247], v[228:231], v[84:87]
    s_add_u32 m0, s50, 131072
    s_add_u32 s51, s46, 90240
    buffer_load_dwordx4 v253, s[12:15], s51 offen nt lds
    v_mfma_f32_16x16x32_bf16 v[88:91], v[244:247], v[232:235], v[88:91]
    v_mfma_f32_16x16x32_bf16 v[92:95], v[244:247], v[236:239], v[92:95]
    s_waitcnt vmcnt(4)
    s_waitcnt lgkmcnt(0)
    s_barrier
    ds_read_b64_tr_b16 v[240:241], v248 offset:16384
    ds_read_b64_tr_b16 v[242:243], v248 offset:18432
    ds_read_b64_tr_b16 v[244:245], v248 offset:20480
    ds_read_b64_tr_b16 v[246:247], v248 offset:22528
    s_add_u32 m0, s50, 49152
    s_add_u32 s51, s64, 221184
    buffer_load_dwordx4 v252, s[24:27], s51 offen lds
    s_add_u32 m0, s50, 53248
    s_add_u32 s51, s65, 221184
    buffer_load_dwordx4 v252, s[24:27], s51 offen lds
    s_waitcnt lgkmcnt(2)
    v_mfma_f32_16x16x32_bf16 v[96:99], v[240:243], v[216:219], v[96:99]
    v_mfma_f32_16x16x32_bf16 v[100:103], v[240:243], v[220:223], v[100:103]
    s_add_u32 m0, s50, 57344
    s_add_u32 s51, s66, 221184
    buffer_load_dwordx4 v252, s[24:27], s51 offen lds
    v_mfma_f32_16x16x32_bf16 v[104:107], v[240:243], v[224:227], v[104:107]
    v_mfma_f32_16x16x32_bf16 v[108:111], v[240:243], v[228:231], v[108:111]
    v_mfma_f32_16x16x32_bf16 v[112:115], v[240:243], v[232:235], v[112:115]
    v_mfma_f32_16x16x32_bf16 v[116:119], v[240:243], v[236:239], v[116:119]
    ds_read_b64_tr_b16 v[240:241], v248 offset:24576
    ds_read_b64_tr_b16 v[242:243], v248 offset:26624
    s_waitcnt lgkmcnt(2)
    v_mfma_f32_16x16x32_bf16 v[120:123], v[244:247], v[216:219], v[120:123]
    s_add_u32 m0, s50, 61440
    s_add_u32 s51, s67, 221184
    buffer_load_dwordx4 v252, s[24:27], s51 offen lds
    v_mfma_f32_16x16x32_bf16 v[124:127], v[244:247], v[220:223], v[124:127]
    v_mfma_f32_16x16x32_bf16 v[128:131], v[244:247], v[224:227], v[128:131]
    v_mfma_f32_16x16x32_bf16 v[132:135], v[244:247], v[228:231], v[132:135]
    v_mfma_f32_16x16x32_bf16 v[136:139], v[244:247], v[232:235], v[136:139]
    v_mfma_f32_16x16x32_bf16 v[140:143], v[244:247], v[236:239], v[140:143]
    ds_read_b64_tr_b16 v[244:245], v248 offset:28672
    ds_read_b64_tr_b16 v[246:247], v248 offset:30720
    s_add_u32 m0, s50, 135168
    s_add_u32 s51, s46, 90112
    buffer_load_dwordx4 v254, s[16:19], s51 offen nt lds
    s_waitcnt lgkmcnt(2)
    v_mfma_f32_16x16x32_bf16 v[144:147], v[240:243], v[216:219], v[144:147]
    v_mfma_f32_16x16x32_bf16 v[148:151], v[240:243], v[220:223], v[148:151]
    v_mfma_f32_16x16x32_bf16 v[152:155], v[240:243], v[224:227], v[152:155]
    v_mfma_f32_16x16x32_bf16 v[156:159], v[240:243], v[228:231], v[156:159]
    v_mfma_f32_16x16x32_bf16 v[160:163], v[240:243], v[232:235], v[160:163]
    s_add_u32 m0, s50, 139264
    s_add_u32 s51, s46, 90240
    buffer_load_dwordx4 v254, s[16:19], s51 offen nt lds
    v_mfma_f32_16x16x32_bf16 v[164:167], v[240:243], v[236:239], v[164:167]
    ds_read_b64_tr_b16 v[240:241], v248 offset:32768
    ds_read_b64_tr_b16 v[242:243], v248 offset:34816
    s_waitcnt lgkmcnt(2)
    v_mfma_f32_16x16x32_bf16 v[168:171], v[244:247], v[216:219], v[168:171]
    v_mfma_f32_16x16x32_bf16 v[172:175], v[244:247], v[220:223], v[172:175]
    v_mfma_f32_16x16x32_bf16 v[176:179], v[244:247], v[224:227], v[176:179]
    v_mfma_f32_16x16x32_bf16 v[180:183], v[244:247], v[228:231], v[180:183]
    s_add_u32 m0, s50, 143360
    s_add_u32 s51, s46, 98304
    buffer_load_dwordx4 v253, s[12:15], s51 offen nt lds
    v_mfma_f32_16x16x32_bf16 v[184:187], v[244:247], v[232:235], v[184:187]
    v_mfma_f32_16x16x32_bf16 v[188:191], v[244:247], v[236:239], v[188:191]
    s_waitcnt lgkmcnt(0)
    v_mfma_f32_16x16x32_bf16 v[192:195], v[240:243], v[216:219], v[192:195]
    v_mfma_f32_16x16x32_bf16 v[196:199], v[240:243], v[220:223], v[196:199]
    v_mfma_f32_16x16x32_bf16 v[200:203], v[240:243], v[224:227], v[200:203]
    s_add_u32 m0, s50, 147456
    s_add_u32 s51, s46, 98432
    buffer_load_dwordx4 v253, s[12:15], s51 offen nt lds
    v_mfma_f32_16x16x32_bf16 v[204:207], v[240:243], v[228:231], v[204:207]
    v_mfma_f32_16x16x32_bf16 v[208:211], v[240:243], v[232:235], v[208:211]
    v_mfma_f32_16x16x32_bf16 v[212:215], v[240:243], v[236:239], v[212:215]
    s_waitcnt vmcnt(4)
    s_waitcnt lgkmcnt(0)
    s_barrier
    ds_read_b64_tr_b16 v[240:241], v248 offset:0
    ds_read_b64_tr_b16 v[242:243], v248 offset:2048
    ds_read_b128 v[216:219], v249 offset:36864
    ds_read_b128 v[220:223], v249 offset:37888
    ds_read_b128 v[224:227], v249 offset:38912
    ds_read_b128 v[228:231], v249 offset:39936
    ds_read_b128 v[232:235], v249 offset:40960
    ds_read_b128 v[236:239], v249 offset:41984
    ds_read_b64_tr_b16 v[244:245], v248 offset:4096
    ds_read_b64_tr_b16 v[246:247], v248 offset:6144
    s_add_u32 m0, s50, 65536
    s_add_u32 s51, s68, 221184
    buffer_load_dwordx4 v252, s[24:27], s51 offen lds
    s_add_u32 m0, s50, 69632
    s_add_u32 s51, s69, 221184
    buffer_load_dwordx4 v252, s[24:27], s51 offen lds
    s_waitcnt lgkmcnt(7)
    v_mfma_f32_16x16x32_bf16 v[0:3], v[240:243], v[216:219], v[0:3]
    s_waitcnt lgkmcnt(6)
    v_mfma_f32_16x16x32_bf16 v[4:7], v[240:243], v[220:223], v[4:7]
    s_add_u32 m0, s50, 73728
    s_add_u32 s51, s70, 221184
    buffer_load_dwordx4 v252, s[24:27], s51 offen lds
    s_waitcnt lgkmcnt(5)
    v_mfma_f32_16x16x32_bf16 v[8:11], v[240:243], v[224:227], v[8:11]
    s_waitcnt lgkmcnt(4)
    v_mfma_f32_16x16x32_bf16 v[12:15], v[240:243], v[228:231], v[12:15]
    s_waitcnt lgkmcnt(3)
    v_mfma_f32_16x16x32_bf16 v[16:19], v[240:243], v[232:235], v[16:19]
    s_add_u32 m0, s50, 77824
    s_add_u32 s51, s71, 221184
    buffer_load_dwordx4 v252, s[24:27], s51 offen lds
    s_waitcnt lgkmcnt(2)
    v_mfma_f32_16x16x32_bf16 v[20:23], v[240:243], v[236:239], v[20:23]
    ds_read_b64_tr_b16 v[240:241], v248 offset:8192
    ds_read_b64_tr_b16 v[242:243], v248 offset:10240
    s_waitcnt lgkmcnt(2)
    v_mfma_f32_16x16x32_bf16 v[24:27], v[244:247], v[216:219], v[24:27]
    v_mfma_f32_16x16x32_bf16 v[28:31], v[244:247], v[220:223], v[28:31]
    s_add_u32 m0, s50, 81920
    s_add_u32 s51, s72, 221184
    buffer_load_dwordx4 v252, s[24:27], s51 offen lds
    v_mfma_f32_16x16x32_bf16 v[32:35], v[244:247], v[224:227], v[32:35]
    v_mfma_f32_16x16x32_bf16 v[36:39], v[244:247], v[228:231], v[36:39]
    v_mfma_f32_16x16x32_bf16 v[40:43], v[244:247], v[232:235], v[40:43]
    v_mfma_f32_16x16x32_bf16 v[44:47], v[244:247], v[236:239], v[44:47]
    ds_read_b64_tr_b16 v[244:245], v248 offset:12288
    ds_read_b64_tr_b16 v[246:247], v248 offset:14336
    s_add_u32 m0, s50, 86016
    s_add_u32 s51, s46, 98304
    buffer_load_dwordx4 v254, s[16:19], s51 offen nt lds
    s_waitcnt lgkmcnt(2)
    v_mfma_f32_16x16x32_bf16 v[48:51], v[240:243], v[216:219], v[48:51]
    v_mfma_f32_16x16x32_bf16 v[52:55], v[240:243], v[220:223], v[52:55]
    v_mfma_f32_16x16x32_bf16 v[56:59], v[240:243], v[224:227], v[56:59]
    s_add_u32 m0, s50, 90112
    s_add_u32 s51, s46, 98432
    buffer_load_dwordx4 v254, s[16:19], s51 offen nt lds
    v_mfma_f32_16x16x32_bf16 v[60:63], v[240:243], v[228:231], v[60:63]
    v_mfma_f32_16x16x32_bf16 v[64:67], v[240:243], v[232:235], v[64:67]
    v_mfma_f32_16x16x32_bf16 v[68:71], v[240:243], v[236:239], v[68:71]
    s_waitcnt lgkmcnt(0)
    v_mfma_f32_16x16x32_bf16 v[72:75], v[244:247], v[216:219], v[72:75]
    s_add_u32 m0, s50, 94208
    s_add_u32 s51, s46, 106496
    buffer_load_dwordx4 v253, s[12:15], s51 offen nt lds
    v_mfma_f32_16x16x32_bf16 v[76:79], v[244:247], v[220:223], v[76:79]
    v_mfma_f32_16x16x32_bf16 v[80:83], v[244:247], v[224:227], v[80:83]
    v_mfma_f32_16x16x32_bf16 v[84:87], v[244:247], v[228:231], v[84:87]
    s_add_u32 m0, s50, 98304
    s_add_u32 s51, s46, 106624
    buffer_load_dwordx4 v253, s[12:15], s51 offen nt lds
    v_mfma_f32_16x16x32_bf16 v[88:91], v[244:247], v[232:235], v[88:91]
    v_mfma_f32_16x16x32_bf16 v[92:95], v[244:247], v[236:239], v[92:95]
    s_waitcnt vmcnt(4)
    s_waitcnt lgkmcnt(0)
    s_barrier
    ds_read_b64_tr_b16 v[240:241], v248 offset:16384
    ds_read_b64_tr_b16 v[242:243], v248 offset:18432
    ds_read_b64_tr_b16 v[244:245], v248 offset:20480
    ds_read_b64_tr_b16 v[246:247], v248 offset:22528
    s_add_u32 m0, s50, 49152
    s_add_u32 s51, s64, 110592
    buffer_load_dwordx4 v252, s[24:27], s51 offen lds
    s_add_u32 m0, s50, 53248
    s_add_u32 s51, s65, 110592
    buffer_load_dwordx4 v252, s[24:27], s51 offen lds
    s_waitcnt lgkmcnt(2)
    v_mfma_f32_16x16x32_bf16 v[96:99], v[240:243], v[216:219], v[96:99]
    v_mfma_f32_16x16x32_bf16 v[100:103], v[240:243], v[220:223], v[100:103]
    s_add_u32 m0, s50, 57344
    s_add_u32 s51, s66, 110592
    buffer_load_dwordx4 v252, s[24:27], s51 offen lds
    v_mfma_f32_16x16x32_bf16 v[104:107], v[240:243], v[224:227], v[104:107]
    v_mfma_f32_16x16x32_bf16 v[108:111], v[240:243], v[228:231], v[108:111]
    v_mfma_f32_16x16x32_bf16 v[112:115], v[240:243], v[232:235], v[112:115]
    v_mfma_f32_16x16x32_bf16 v[116:119], v[240:243], v[236:239], v[116:119]
    ds_read_b64_tr_b16 v[240:241], v248 offset:24576
    ds_read_b64_tr_b16 v[242:243], v248 offset:26624
    s_waitcnt lgkmcnt(2)
    v_mfma_f32_16x16x32_bf16 v[120:123], v[244:247], v[216:219], v[120:123]
    s_add_u32 m0, s50, 61440
    s_add_u32 s51, s67, 110592
    buffer_load_dwordx4 v252, s[24:27], s51 offen lds
    v_mfma_f32_16x16x32_bf16 v[124:127], v[244:247], v[220:223], v[124:127]
    v_mfma_f32_16x16x32_bf16 v[128:131], v[244:247], v[224:227], v[128:131]
    v_mfma_f32_16x16x32_bf16 v[132:135], v[244:247], v[228:231], v[132:135]
    v_mfma_f32_16x16x32_bf16 v[136:139], v[244:247], v[232:235], v[136:139]
    v_mfma_f32_16x16x32_bf16 v[140:143], v[244:247], v[236:239], v[140:143]
    ds_read_b64_tr_b16 v[244:245], v248 offset:28672
    ds_read_b64_tr_b16 v[246:247], v248 offset:30720
    s_add_u32 m0, s50, 102400
    s_add_u32 s51, s46, 106496
    buffer_load_dwordx4 v254, s[16:19], s51 offen nt lds
    s_waitcnt lgkmcnt(2)
    v_mfma_f32_16x16x32_bf16 v[144:147], v[240:243], v[216:219], v[144:147]
    v_mfma_f32_16x16x32_bf16 v[148:151], v[240:243], v[220:223], v[148:151]
    v_mfma_f32_16x16x32_bf16 v[152:155], v[240:243], v[224:227], v[152:155]
    v_mfma_f32_16x16x32_bf16 v[156:159], v[240:243], v[228:231], v[156:159]
    v_mfma_f32_16x16x32_bf16 v[160:163], v[240:243], v[232:235], v[160:163]
    s_add_u32 m0, s50, 106496
    s_add_u32 s51, s46, 106624
    buffer_load_dwordx4 v254, s[16:19], s51 offen nt lds
    v_mfma_f32_16x16x32_bf16 v[164:167], v[240:243], v[236:239], v[164:167]
    ds_read_b64_tr_b16 v[240:241], v248 offset:32768
    ds_read_b64_tr_b16 v[242:243], v248 offset:34816
    s_waitcnt lgkmcnt(2)
    v_mfma_f32_16x16x32_bf16 v[168:171], v[244:247], v[216:219], v[168:171]
    v_mfma_f32_16x16x32_bf16 v[172:175], v[244:247], v[220:223], v[172:175]
    v_mfma_f32_16x16x32_bf16 v[176:179], v[244:247], v[224:227], v[176:179]
    v_mfma_f32_16x16x32_bf16 v[180:183], v[244:247], v[228:231], v[180:183]
    s_add_u32 m0, s50, 110592
    s_add_u32 s51, s46, 114688
    buffer_load_dwordx4 v253, s[12:15], s51 offen nt lds
    v_mfma_f32_16x16x32_bf16 v[184:187], v[244:247], v[232:235], v[184:187]
    v_mfma_f32_16x16x32_bf16 v[188:191], v[244:247], v[236:239], v[188:191]
    s_waitcnt lgkmcnt(0)
    v_mfma_f32_16x16x32_bf16 v[192:195], v[240:243], v[216:219], v[192:195]
    v_mfma_f32_16x16x32_bf16 v[196:199], v[240:243], v[220:223], v[196:199]
    v_mfma_f32_16x16x32_bf16 v[200:203], v[240:243], v[224:227], v[200:203]
    s_add_u32 m0, s50, 114688
    s_add_u32 s51, s46, 114816
    buffer_load_dwordx4 v253, s[12:15], s51 offen nt lds
    v_mfma_f32_16x16x32_bf16 v[204:207], v[240:243], v[228:231], v[204:207]
    v_mfma_f32_16x16x32_bf16 v[208:211], v[240:243], v[232:235], v[208:211]
    v_mfma_f32_16x16x32_bf16 v[212:215], v[240:243], v[236:239], v[212:215]
    s_waitcnt vmcnt(4)
    s_waitcnt lgkmcnt(0)
    s_barrier
    ds_read_b64_tr_b16 v[240:241], v248 offset:0
    ds_read_b64_tr_b16 v[242:243], v248 offset:2048
    ds_read_b128 v[216:219], v249 offset:18432
    ds_read_b128 v[220:223], v249 offset:19456
    ds_read_b128 v[224:227], v249 offset:20480
    ds_read_b128 v[228:231], v249 offset:21504
    ds_read_b128 v[232:235], v249 offset:22528
    ds_read_b128 v[236:239], v249 offset:23552
    ds_read_b64_tr_b16 v[244:245], v248 offset:4096
    ds_read_b64_tr_b16 v[246:247], v248 offset:6144
    s_add_u32 m0, s50, 65536
    s_add_u32 s51, s68, 110592
    buffer_load_dwordx4 v252, s[24:27], s51 offen lds
    s_add_u32 m0, s50, 69632
    s_add_u32 s51, s69, 110592
    buffer_load_dwordx4 v252, s[24:27], s51 offen lds
    s_waitcnt lgkmcnt(7)
    v_mfma_f32_16x16x32_bf16 v[0:3], v[240:243], v[216:219], v[0:3]
    s_waitcnt lgkmcnt(6)
    v_mfma_f32_16x16x32_bf16 v[4:7], v[240:243], v[220:223], v[4:7]
    s_add_u32 m0, s50, 73728
    s_add_u32 s51, s70, 110592
    buffer_load_dwordx4 v252, s[24:27], s51 offen lds
    s_waitcnt lgkmcnt(5)
    v_mfma_f32_16x16x32_bf16 v[8:11], v[240:243], v[224:227], v[8:11]
    s_waitcnt lgkmcnt(4)
    v_mfma_f32_16x16x32_bf16 v[12:15], v[240:243], v[228:231], v[12:15]
    s_waitcnt lgkmcnt(3)
    v_mfma_f32_16x16x32_bf16 v[16:19], v[240:243], v[232:235], v[16:19]
    s_add_u32 m0, s50, 77824
    s_add_u32 s51, s71, 110592
    buffer_load_dwordx4 v252, s[24:27], s51 offen lds
    s_waitcnt lgkmcnt(2)
    v_mfma_f32_16x16x32_bf16 v[20:23], v[240:243], v[236:239], v[20:23]
    ds_read_b64_tr_b16 v[240:241], v248 offset:8192
    ds_read_b64_tr_b16 v[242:243], v248 offset:10240
    s_waitcnt lgkmcnt(2)
    v_mfma_f32_16x16x32_bf16 v[24:27], v[244:247], v[216:219], v[24:27]
    v_mfma_f32_16x16x32_bf16 v[28:31], v[244:247], v[220:223], v[28:31]
    s_add_u32 m0, s50, 81920
    s_add_u32 s51, s72, 110592
    buffer_load_dwordx4 v252, s[24:27], s51 offen lds
    v_mfma_f32_16x16x32_bf16 v[32:35], v[244:247], v[224:227], v[32:35]
    v_mfma_f32_16x16x32_bf16 v[36:39], v[244:247], v[228:231], v[36:39]
    v_mfma_f32_16x16x32_bf16 v[40:43], v[244:247], v[232:235], v[40:43]
    v_mfma_f32_16x16x32_bf16 v[44:47], v[244:247], v[236:239], v[44:47]
    ds_read_b64_tr_b16 v[244:245], v248 offset:12288
    ds_read_b64_tr_b16 v[246:247], v248 offset:14336
    s_add_u32 m0, s50, 118784
    s_add_u32 s51, s46, 114688
    buffer_load_dwordx4 v254, s[16:19], s51 offen nt lds
    s_waitcnt lgkmcnt(2)
    v_mfma_f32_16x16x32_bf16 v[48:51], v[240:243], v[216:219], v[48:51]
    v_mfma_f32_16x16x32_bf16 v[52:55], v[240:243], v[220:223], v[52:55]
    v_mfma_f32_16x16x32_bf16 v[56:59], v[240:243], v[224:227], v[56:59]
    s_add_u32 m0, s50, 122880
    s_add_u32 s51, s46, 114816
    buffer_load_dwordx4 v254, s[16:19], s51 offen nt lds
    v_mfma_f32_16x16x32_bf16 v[60:63], v[240:243], v[228:231], v[60:63]
    v_mfma_f32_16x16x32_bf16 v[64:67], v[240:243], v[232:235], v[64:67]
    v_mfma_f32_16x16x32_bf16 v[68:71], v[240:243], v[236:239], v[68:71]
    s_waitcnt lgkmcnt(0)
    v_mfma_f32_16x16x32_bf16 v[72:75], v[244:247], v[216:219], v[72:75]
    s_add_u32 m0, s50, 126976
    s_add_u32 s51, s46, 122880
    buffer_load_dwordx4 v253, s[12:15], s51 offen nt lds
    v_mfma_f32_16x16x32_bf16 v[76:79], v[244:247], v[220:223], v[76:79]
    v_mfma_f32_16x16x32_bf16 v[80:83], v[244:247], v[224:227], v[80:83]
    v_mfma_f32_16x16x32_bf16 v[84:87], v[244:247], v[228:231], v[84:87]
    s_add_u32 m0, s50, 131072
    s_add_u32 s51, s46, 123008
    buffer_load_dwordx4 v253, s[12:15], s51 offen nt lds
    v_mfma_f32_16x16x32_bf16 v[88:91], v[244:247], v[232:235], v[88:91]
    v_mfma_f32_16x16x32_bf16 v[92:95], v[244:247], v[236:239], v[92:95]
    s_waitcnt vmcnt(4)
    s_waitcnt lgkmcnt(0)
    s_barrier
    ds_read_b64_tr_b16 v[240:241], v248 offset:16384
    ds_read_b64_tr_b16 v[242:243], v248 offset:18432
    ds_read_b64_tr_b16 v[244:245], v248 offset:20480
    ds_read_b64_tr_b16 v[246:247], v248 offset:22528
    s_add_u32 m0, s50, 49152
    s_add_u32 s51, s64, 258048
    buffer_load_dwordx4 v252, s[24:27], s51 offen lds
    s_add_u32 m0, s50, 53248
    s_add_u32 s51, s65, 258048
    buffer_load_dwordx4 v252, s[24:27], s51 offen lds
    s_waitcnt lgkmcnt(2)
    v_mfma_f32_16x16x32_bf16 v[96:99], v[240:243], v[216:219], v[96:99]
    v_mfma_f32_16x16x32_bf16 v[100:103], v[240:243], v[220:223], v[100:103]
    s_add_u32 m0, s50, 57344
    s_add_u32 s51, s66, 258048
    buffer_load_dwordx4 v252, s[24:27], s51 offen lds
    v_mfma_f32_16x16x32_bf16 v[104:107], v[240:243], v[224:227], v[104:107]
    v_mfma_f32_16x16x32_bf16 v[108:111], v[240:243], v[228:231], v[108:111]
    v_mfma_f32_16x16x32_bf16 v[112:115], v[240:243], v[232:235], v[112:115]
    v_mfma_f32_16x16x32_bf16 v[116:119], v[240:243], v[236:239], v[116:119]
    ds_read_b64_tr_b16 v[240:241], v248 offset:24576
    ds_read_b64_tr_b16 v[242:243], v248 offset:26624
    s_add_u32 m0, s50, 61440
    s_add_u32 s51, s67, 258048
    buffer_load_dwordx4 v252, s[24:27], s51 offen lds
    s_waitcnt lgkmcnt(2)
    v_mfma_f32_16x16x32_bf16 v[120:123], v[244:247], v[216:219], v[120:123]
    v_mfma_f32_16x16x32_bf16 v[124:127], v[244:247], v[220:223], v[124:127]
    v_mfma_f32_16x16x32_bf16 v[128:131], v[244:247], v[224:227], v[128:131]
    v_mfma_f32_16x16x32_bf16 v[132:135], v[244:247], v[228:231], v[132:135]
    s_add_u32 m0, s50, 135168
    s_add_u32 s51, s46, 122880
    buffer_load_dwordx4 v254, s[16:19], s51 offen nt lds
    v_mfma_f32_16x16x32_bf16 v[136:139], v[244:247], v[232:235], v[136:139]
    v_mfma_f32_16x16x32_bf16 v[140:143], v[244:247], v[236:239], v[140:143]
    ds_read_b64_tr_b16 v[244:245], v248 offset:28672
    ds_read_b64_tr_b16 v[246:247], v248 offset:30720
    s_waitcnt lgkmcnt(2)
    v_mfma_f32_16x16x32_bf16 v[144:147], v[240:243], v[216:219], v[144:147]
    v_mfma_f32_16x16x32_bf16 v[148:151], v[240:243], v[220:223], v[148:151]
    s_add_u32 m0, s50, 139264
    s_add_u32 s51, s46, 123008
    buffer_load_dwordx4 v254, s[16:19], s51 offen nt lds
    v_mfma_f32_16x16x32_bf16 v[152:155], v[240:243], v[224:227], v[152:155]
    v_mfma_f32_16x16x32_bf16 v[156:159], v[240:243], v[228:231], v[156:159]
    v_mfma_f32_16x16x32_bf16 v[160:163], v[240:243], v[232:235], v[160:163]
    v_mfma_f32_16x16x32_bf16 v[164:167], v[240:243], v[236:239], v[164:167]
    ds_read_b64_tr_b16 v[240:241], v248 offset:32768
    ds_read_b64_tr_b16 v[242:243], v248 offset:34816
    s_waitcnt lgkmcnt(2)
    v_mfma_f32_16x16x32_bf16 v[168:171], v[244:247], v[216:219], v[168:171]
    s_add_u32 m0, s50, 147456
    s_add_u32 s51, s49, 0
    buffer_load_dwordx4 v251, s[8:11], s51 offen lds
    v_mfma_f32_16x16x32_bf16 v[172:175], v[244:247], v[220:223], v[172:175]
    v_mfma_f32_16x16x32_bf16 v[176:179], v[244:247], v[224:227], v[176:179]
    v_mfma_f32_16x16x32_bf16 v[180:183], v[244:247], v[228:231], v[180:183]
    v_mfma_f32_16x16x32_bf16 v[184:187], v[244:247], v[232:235], v[184:187]
    s_add_u32 m0, s50, 151552
    s_add_u32 s51, s49, 36864
    buffer_load_dwordx4 v251, s[8:11], s51 offen lds
    v_mfma_f32_16x16x32_bf16 v[188:191], v[244:247], v[236:239], v[188:191]
    s_waitcnt lgkmcnt(0)
    v_mfma_f32_16x16x32_bf16 v[192:195], v[240:243], v[216:219], v[192:195]
    v_mfma_f32_16x16x32_bf16 v[196:199], v[240:243], v[220:223], v[196:199]
    v_mfma_f32_16x16x32_bf16 v[200:203], v[240:243], v[224:227], v[200:203]
    s_add_u32 m0, s50, 155648
    s_add_u32 s51, s49, 73728
    buffer_load_dwordx4 v251, s[8:11], s51 offen lds
    v_mfma_f32_16x16x32_bf16 v[204:207], v[240:243], v[228:231], v[204:207]
    v_mfma_f32_16x16x32_bf16 v[208:211], v[240:243], v[232:235], v[208:211]
    v_mfma_f32_16x16x32_bf16 v[212:215], v[240:243], v[236:239], v[212:215]
    s_waitcnt vmcnt(6)
    s_waitcnt lgkmcnt(0)
    s_barrier
    ds_read_b64_tr_b16 v[240:241], v248 offset:0
    ds_read_b64_tr_b16 v[242:243], v248 offset:2048
    ds_read_b128 v[216:219], v249 offset:43008
    ds_read_b128 v[220:223], v249 offset:44032
    ds_read_b128 v[224:227], v249 offset:45056
    ds_read_b128 v[228:231], v249 offset:46080
    ds_read_b128 v[232:235], v249 offset:47104
    ds_read_b128 v[236:239], v249 offset:48128
    ds_read_b64_tr_b16 v[244:245], v248 offset:4096
    ds_read_b64_tr_b16 v[246:247], v248 offset:6144
    s_add_u32 m0, s50, 65536
    s_add_u32 s51, s68, 258048
    buffer_load_dwordx4 v252, s[24:27], s51 offen lds
    s_add_u32 m0, s50, 69632
    s_add_u32 s51, s69, 258048
    buffer_load_dwordx4 v252, s[24:27], s51 offen lds
    s_add_u32 m0, s50, 73728
    s_add_u32 s51, s70, 258048
    buffer_load_dwordx4 v252, s[24:27], s51 offen lds
    s_add_u32 m0, s50, 77824
    s_add_u32 s51, s71, 258048
    buffer_load_dwordx4 v252, s[24:27], s51 offen lds
    s_add_u32 m0, s50, 81920
    s_add_u32 s51, s72, 258048
    buffer_load_dwordx4 v252, s[24:27], s51 offen lds
    s_add_u32 m0, s50, 86016
    s_add_u32 s51, s47, 512
    buffer_load_dwordx4 v250, s[20:23], s51 offen lds
    s_add_u32 m0, s50, 90112
    s_add_u32 s51, s47, 640
    buffer_load_dwordx4 v250, s[20:23], s51 offen lds
    s_add_u32 m0, s50, 94208
    s_add_u32 s51, s47, 768
    buffer_load_dwordx4 v250, s[20:23], s51 offen lds
    s_add_u32 m0, s50, 98304
    s_add_u32 s51, s47, 896
    buffer_load_dwordx4 v250, s[20:23], s51 offen lds
    s_waitcnt lgkmcnt(7)
    v_mfma_f32_16x16x32_bf16 v[0:3], v[240:243], v[216:219], v[0:3]
    s_waitcnt lgkmcnt(6)
    v_mfma_f32_16x16x32_bf16 v[4:7], v[240:243], v[220:223], v[4:7]
    s_waitcnt lgkmcnt(5)
    v_mfma_f32_16x16x32_bf16 v[8:11], v[240:243], v[224:227], v[8:11]
    s_waitcnt lgkmcnt(4)
    v_mfma_f32_16x16x32_bf16 v[12:15], v[240:243], v[228:231], v[12:15]
    s_waitcnt lgkmcnt(3)
    v_mfma_f32_16x16x32_bf16 v[16:19], v[240:243], v[232:235], v[16:19]
    s_waitcnt lgkmcnt(2)
    v_mfma_f32_16x16x32_bf16 v[20:23], v[240:243], v[236:239], v[20:23]
    ds_read_b64_tr_b16 v[240:241], v248 offset:8192
    ds_read_b64_tr_b16 v[242:243], v248 offset:10240
    s_waitcnt lgkmcnt(2)
    v_mfma_f32_16x16x32_bf16 v[24:27], v[244:247], v[216:219], v[24:27]
    v_mfma_f32_16x16x32_bf16 v[28:31], v[244:247], v[220:223], v[28:31]
    v_mfma_f32_16x16x32_bf16 v[32:35], v[244:247], v[224:227], v[32:35]
    v_mfma_f32_16x16x32_bf16 v[36:39], v[244:247], v[228:231], v[36:39]
    v_mfma_f32_16x16x32_bf16 v[40:43], v[244:247], v[232:235], v[40:43]
    v_mfma_f32_16x16x32_bf16 v[44:47], v[244:247], v[236:239], v[44:47]
    s_waitcnt lgkmcnt(0)
    v_mfma_f32_16x16x32_bf16 v[48:51], v[240:243], v[216:219], v[48:51]
    v_mfma_f32_16x16x32_bf16 v[52:55], v[240:243], v[220:223], v[52:55]
    v_mfma_f32_16x16x32_bf16 v[56:59], v[240:243], v[224:227], v[56:59]
    v_mfma_f32_16x16x32_bf16 v[60:63], v[240:243], v[228:231], v[60:63]
    v_mfma_f32_16x16x32_bf16 v[64:67], v[240:243], v[232:235], v[64:67]
    v_mfma_f32_16x16x32_bf16 v[68:71], v[240:243], v[236:239], v[68:71]
    s_waitcnt vmcnt(8)
    s_waitcnt lgkmcnt(0)
    s_barrier
    ds_read_b64_tr_b16 v[240:241], v248 offset:12288
    ds_read_b64_tr_b16 v[242:243], v248 offset:14336
    ds_read_b64_tr_b16 v[244:245], v248 offset:16384
    ds_read_b64_tr_b16 v[246:247], v248 offset:18432
    s_add_u32 m0, s50, 49152
    s_add_u32 s51, s64, 294912
    buffer_load_dwordx4 v252, s[24:27], s51 offen lds
    s_add_u32 m0, s50, 53248
    s_add_u32 s51, s65, 294912
    buffer_load_dwordx4 v252, s[24:27], s51 offen lds
    s_waitcnt lgkmcnt(2)
    v_mfma_f32_16x16x32_bf16 v[72:75], v[240:243], v[216:219], v[72:75]
    v_mfma_f32_16x16x32_bf16 v[76:79], v[240:243], v[220:223], v[76:79]
    s_add_u32 m0, s50, 57344
    s_add_u32 s51, s66, 294912
    buffer_load_dwordx4 v252, s[24:27], s51 offen lds
    v_mfma_f32_16x16x32_bf16 v[80:83], v[240:243], v[224:227], v[80:83]
    v_mfma_f32_16x16x32_bf16 v[84:87], v[240:243], v[228:231], v[84:87]
    s_add_u32 m0, s50, 102400
    s_add_u32 s51, s47, 262656
    buffer_load_dwordx4 v250, s[20:23], s51 offen lds
    v_mfma_f32_16x16x32_bf16 v[88:91], v[240:243], v[232:235], v[88:91]
    v_mfma_f32_16x16x32_bf16 v[92:95], v[240:243], v[236:239], v[92:95]
    s_add_u32 m0, s50, 106496
    s_add_u32 s51, s47, 262784
    buffer_load_dwordx4 v250, s[20:23], s51 offen lds
    s_waitcnt lgkmcnt(0)
    v_mfma_f32_16x16x32_bf16 v[96:99], v[244:247], v[216:219], v[96:99]
    v_mfma_f32_16x16x32_bf16 v[100:103], v[244:247], v[220:223], v[100:103]
    v_mfma_f32_16x16x32_bf16 v[104:107], v[244:247], v[224:227], v[104:107]
    s_add_u32 m0, s50, 110592
    s_add_u32 s51, s47, 262912
    buffer_load_dwordx4 v250, s[20:23], s51 offen lds
    v_mfma_f32_16x16x32_bf16 v[108:111], v[244:247], v[228:231], v[108:111]
    v_mfma_f32_16x16x32_bf16 v[112:115], v[244:247], v[232:235], v[112:115]
    s_add_u32 m0, s50, 114688
    s_add_u32 s51, s47, 263040
    buffer_load_dwordx4 v250, s[20:23], s51 offen lds
    v_mfma_f32_16x16x32_bf16 v[116:119], v[244:247], v[236:239], v[116:119]
    s_waitcnt vmcnt(14)
    s_waitcnt lgkmcnt(0)
    s_barrier
    ds_read_b64_tr_b16 v[240:241], v248 offset:20480
    ds_read_b64_tr_b16 v[242:243], v248 offset:22528
    s_add_u32 m0, s50, 61440
    s_add_u32 s51, s67, 294912
    buffer_load_dwordx4 v252, s[24:27], s51 offen lds
    s_add_u32 m0, s50, 65536
    s_add_u32 s51, s68, 294912
    buffer_load_dwordx4 v252, s[24:27], s51 offen lds
    s_waitcnt lgkmcnt(0)
    v_mfma_f32_16x16x32_bf16 v[120:123], v[240:243], v[216:219], v[120:123]
    v_mfma_f32_16x16x32_bf16 v[124:127], v[240:243], v[220:223], v[124:127]
    s_add_u32 m0, s50, 118784
    s_add_u32 s51, s47, 524800
    buffer_load_dwordx4 v250, s[20:23], s51 offen lds
    v_mfma_f32_16x16x32_bf16 v[128:131], v[240:243], v[224:227], v[128:131]
    s_add_u32 m0, s50, 122880
    s_add_u32 s51, s47, 524928
    buffer_load_dwordx4 v250, s[20:23], s51 offen lds
    v_mfma_f32_16x16x32_bf16 v[132:135], v[240:243], v[228:231], v[132:135]
    v_mfma_f32_16x16x32_bf16 v[136:139], v[240:243], v[232:235], v[136:139]
    s_add_u32 m0, s50, 126976
    s_add_u32 s51, s47, 525056
    buffer_load_dwordx4 v250, s[20:23], s51 offen lds
    v_mfma_f32_16x16x32_bf16 v[140:143], v[240:243], v[236:239], v[140:143]
    s_add_u32 m0, s50, 131072
    s_add_u32 s51, s47, 525184
    buffer_load_dwordx4 v250, s[20:23], s51 offen lds
    s_waitcnt vmcnt(17)
    s_waitcnt lgkmcnt(0)
    s_barrier
    ds_read_b64_tr_b16 v[240:241], v248 offset:24576
    ds_read_b64_tr_b16 v[242:243], v248 offset:26624
    ds_read_b64_tr_b16 v[244:245], v248 offset:28672
    ds_read_b64_tr_b16 v[246:247], v248 offset:30720
    s_add_u32 m0, s50, 69632
    s_add_u32 s51, s69, 294912
    buffer_load_dwordx4 v252, s[24:27], s51 offen lds
    s_waitcnt lgkmcnt(2)
    v_mfma_f32_16x16x32_bf16 v[144:147], v[240:243], v[216:219], v[144:147]
    v_mfma_f32_16x16x32_bf16 v[148:151], v[240:243], v[220:223], v[148:151]
    v_mfma_f32_16x16x32_bf16 v[152:155], v[240:243], v[224:227], v[152:155]
    v_mfma_f32_16x16x32_bf16 v[156:159], v[240:243], v[228:231], v[156:159]
    v_mfma_f32_16x16x32_bf16 v[160:163], v[240:243], v[232:235], v[160:163]
    v_mfma_f32_16x16x32_bf16 v[164:167], v[240:243], v[236:239], v[164:167]
    ds_read_b64_tr_b16 v[240:241], v248 offset:32768
    ds_read_b64_tr_b16 v[242:243], v248 offset:34816
    s_waitcnt lgkmcnt(2)
    v_mfma_f32_16x16x32_bf16 v[168:171], v[244:247], v[216:219], v[168:171]
    v_mfma_f32_16x16x32_bf16 v[172:175], v[244:247], v[220:223], v[172:175]
    v_mfma_f32_16x16x32_bf16 v[176:179], v[244:247], v[224:227], v[176:179]
    v_mfma_f32_16x16x32_bf16 v[180:183], v[244:247], v[228:231], v[180:183]
    v_mfma_f32_16x16x32_bf16 v[184:187], v[244:247], v[232:235], v[184:187]
    v_mfma_f32_16x16x32_bf16 v[188:191], v[244:247], v[236:239], v[188:191]
    s_waitcnt lgkmcnt(0)
    v_mfma_f32_16x16x32_bf16 v[192:195], v[240:243], v[216:219], v[192:195]
    v_mfma_f32_16x16x32_bf16 v[196:199], v[240:243], v[220:223], v[196:199]
    v_mfma_f32_16x16x32_bf16 v[200:203], v[240:243], v[224:227], v[200:203]
    v_mfma_f32_16x16x32_bf16 v[204:207], v[240:243], v[228:231], v[204:207]
    v_mfma_f32_16x16x32_bf16 v[208:211], v[240:243], v[232:235], v[208:211]
    v_mfma_f32_16x16x32_bf16 v[212:215], v[240:243], v[236:239], v[212:215]
    s_waitcnt vmcnt(14)
    s_waitcnt lgkmcnt(0)
    s_add_u32 s47, s47, 512
    s_add_u32 s46, s46, 131072
    s_add_u32 s83, s83, 512
    s_add_u32 s89, s89, 294912
    s_add_u32 s64, s64, 294912
    s_add_u32 s65, s65, 294912
    s_add_u32 s66, s66, 294912
    s_add_u32 s67, s67, 294912
    s_add_u32 s68, s68, 294912
    s_add_u32 s69, s69, 294912
    s_add_u32 s70, s70, 294912
    s_add_u32 s71, s71, 294912
    s_add_u32 s72, s72, 294912
    s_mov_b32 s45, 2
L_G_loop:
    s_barrier
    s_add_u32 m0, s50, 135168
    s_add_u32 s51, s49, 128
    buffer_load_dwordx4 v251, s[8:11], s51 offen lds
    s_add_u32 m0, s50, 139264
    s_add_u32 s51, s49, 36992
    buffer_load_dwordx4 v251, s[8:11], s51 offen lds
    s_add_u32 m0, s50, 143360
    s_add_u32 s51, s49, 73856
    buffer_load_dwordx4 v251, s[8:11], s51 offen lds
    s_add_u32 m0, s50, 73728
    s_add_u32 s51, s70, 0
    buffer_load_dwordx4 v252, s[24:27], s51 offen lds
    s_add_u32 m0, s50, 77824
    s_add_u32 s51, s71, 0
    buffer_load_dwordx4 v252, s[24:27], s51 offen lds
    s_add_u32 m0, s50, 81920
    s_add_u32 s51, s72, 0
    buffer_load_dwordx4 v252, s[24:27], s51 offen lds
    s_waitcnt vmcnt(13)
    s_waitcnt lgkmcnt(0)
    s_barrier
    s_add_u32 m0, s50, 86016
    s_add_u32 s51, s47, 786432
    buffer_load_dwordx4 v250, s[20:23], s51 offen lds
    s_add_u32 m0, s50, 90112
    s_add_u32 s51, s47, 786560
    buffer_load_dwordx4 v250, s[20:23], s51 offen lds
    s_add_u32 m0, s50, 94208
    s_add_u32 s51, s47, 786688
    buffer_load_dwordx4 v250, s[20:23], s51 offen lds
    s_add_u32 m0, s50, 98304
    s_add_u32 s51, s47, 786816
    buffer_load_dwordx4 v250, s[20:23], s51 offen lds
    s_waitcnt vmcnt(7)
    s_waitcnt lgkmcnt(0)
    s_barrier
    s_add_u32 m0, s50, 102400
    s_add_u32 s51, s47, 1048576
    buffer_load_dwordx4 v250, s[20:23], s51 offen lds
    s_add_u32 m0, s50, 106496
    s_add_u32 s51, s47, 1048704
    buffer_load_dwordx4 v250, s[20:23], s51 offen lds
    s_add_u32 m0, s50, 110592
    s_add_u32 s51, s47, 1048832
    buffer_load_dwordx4 v250, s[20:23], s51 offen lds
    s_add_u32 m0, s50, 114688
    s_add_u32 s51, s47, 1048960
    buffer_load_dwordx4 v250, s[20:23], s51 offen lds
    s_add_u32 m0, s50, 147456
    s_add_u32 s51, s49, 256
    buffer_load_dwordx4 v251, s[8:11], s51 offen lds
    s_add_u32 m0, s50, 151552
    s_add_u32 s51, s49, 37120
    buffer_load_dwordx4 v251, s[8:11], s51 offen lds
    s_add_u32 m0, s50, 155648
    s_add_u32 s51, s49, 73984
    buffer_load_dwordx4 v251, s[8:11], s51 offen lds
    s_waitcnt vmcnt(7)
    s_waitcnt lgkmcnt(0)
    s_barrier
    s_add_u32 m0, s50, 118784
    s_add_u32 s51, s47, 1310720
    buffer_load_dwordx4 v250, s[20:23], s51 offen lds
    s_add_u32 m0, s50, 122880
    s_add_u32 s51, s47, 1310848
    buffer_load_dwordx4 v250, s[20:23], s51 offen lds
    s_add_u32 m0, s50, 126976
    s_add_u32 s51, s47, 1310976
    buffer_load_dwordx4 v250, s[20:23], s51 offen lds
    s_add_u32 m0, s50, 131072
    s_add_u32 s51, s47, 1311104
    buffer_load_dwordx4 v250, s[20:23], s51 offen lds
    s_waitcnt vmcnt(4)
    s_waitcnt lgkmcnt(0)
    s_barrier
    s_add_u32 m0, s50, 86016
    s_add_u32 s51, s47, 1572864
    buffer_load_dwordx4 v250, s[20:23], s51 offen lds
    s_add_u32 m0, s50, 90112
    s_add_u32 s51, s47, 1572992
    buffer_load_dwordx4 v250, s[20:23], s51 offen lds
    s_add_u32 m0, s50, 94208
    s_add_u32 s51, s47, 1573120
    buffer_load_dwordx4 v250, s[20:23], s51 offen lds
    s_add_u32 m0, s50, 98304
    s_add_u32 s51, s47, 1573248
    buffer_load_dwordx4 v250, s[20:23], s51 offen lds
    s_add_u32 m0, s50, 135168
    s_add_u32 s51, s49, 384
    buffer_load_dwordx4 v251, s[8:11], s51 offen lds
    s_add_u32 m0, s50, 139264
    s_add_u32 s51, s49, 37248
    buffer_load_dwordx4 v251, s[8:11], s51 offen lds
    s_add_u32 m0, s50, 143360
    s_add_u32 s51, s49, 74112
    buffer_load_dwordx4 v251, s[8:11], s51 offen lds
    s_waitcnt vmcnt(7)
    s_waitcnt lgkmcnt(0)
    s_barrier
    s_add_u32 m0, s50, 102400
    s_add_u32 s51, s47, 1835008
    buffer_load_dwordx4 v250, s[20:23], s51 offen lds
    s_add_u32 m0, s50, 106496
    s_add_u32 s51, s47, 1835136
    buffer_load_dwordx4 v250, s[20:23], s51 offen lds
    s_add_u32 m0, s50, 110592
    s_add_u32 s51, s47, 1835264
    buffer_load_dwordx4 v250, s[20:23], s51 offen lds
    s_add_u32 m0, s50, 114688
    s_add_u32 s51, s47, 1835392
    buffer_load_dwordx4 v250, s[20:23], s51 offen lds
    s_waitcnt vmcnt(4)
    s_waitcnt lgkmcnt(0)
    s_barrier
    s_add_u32 m0, s50, 118784
    s_add_u32 s51, s47, 2097152
    buffer_load_dwordx4 v250, s[20:23], s51 offen lds
    s_add_u32 m0, s50, 122880
    s_add_u32 s51, s47, 2097280
    buffer_load_dwordx4 v250, s[20:23], s51 offen lds
    s_add_u32 m0, s50, 126976
    s_add_u32 s51, s47, 2097408
    buffer_load_dwordx4 v250, s[20:23], s51 offen lds
    s_add_u32 m0, s50, 131072
    s_add_u32 s51, s47, 2097536
    buffer_load_dwordx4 v250, s[20:23], s51 offen lds
    s_add_u32 m0, s50, 147456
    s_add_u32 s51, s49, 512
    buffer_load_dwordx4 v251, s[8:11], s51 offen lds
    s_add_u32 m0, s50, 151552
    s_add_u32 s51, s49, 37376
    buffer_load_dwordx4 v251, s[8:11], s51 offen lds
    s_add_u32 m0, s50, 155648
    s_add_u32 s51, s49, 74240
    buffer_load_dwordx4 v251, s[8:11], s51 offen lds
    s_waitcnt vmcnt(7)
    s_waitcnt lgkmcnt(0)
    s_barrier
    s_add_u32 m0, s50, 86016
    s_add_u32 s51, s47, 2359296
    buffer_load_dwordx4 v250, s[20:23], s51 offen lds
    s_add_u32 m0, s50, 90112
    s_add_u32 s51, s47, 2359424
    buffer_load_dwordx4 v250, s[20:23], s51 offen lds
    s_add_u32 m0, s50, 94208
    s_add_u32 s51, s47, 2359552
    buffer_load_dwordx4 v250, s[20:23], s51 offen lds
    s_add_u32 m0, s50, 98304
    s_add_u32 s51, s47, 2359680
    buffer_load_dwordx4 v250, s[20:23], s51 offen lds
    s_waitcnt vmcnt(4)
    s_waitcnt lgkmcnt(0)
    s_barrier
    s_add_u32 m0, s50, 102400
    s_add_u32 s51, s47, 2621440
    buffer_load_dwordx4 v250, s[20:23], s51 offen lds
    s_add_u32 m0, s50, 106496
    s_add_u32 s51, s47, 2621568
    buffer_load_dwordx4 v250, s[20:23], s51 offen lds
    s_add_u32 m0, s50, 110592
    s_add_u32 s51, s47, 2621696
    buffer_load_dwordx4 v250, s[20:23], s51 offen lds
    s_add_u32 m0, s50, 114688
    s_add_u32 s51, s47, 2621824
    buffer_load_dwordx4 v250, s[20:23], s51 offen lds
    s_add_u32 m0, s50, 135168
    s_add_u32 s51, s49, 640
    buffer_load_dwordx4 v251, s[8:11], s51 offen lds
    s_add_u32 m0, s50, 139264
    s_add_u32 s51, s49, 37504
    buffer_load_dwordx4 v251, s[8:11], s51 offen lds
    s_add_u32 m0, s50, 143360
    s_add_u32 s51, s49, 74368
    buffer_load_dwordx4 v251, s[8:11], s51 offen lds
    s_waitcnt vmcnt(7)
    s_waitcnt lgkmcnt(0)
    s_barrier
    s_add_u32 m0, s50, 118784
    s_add_u32 s51, s47, 2883584
    buffer_load_dwordx4 v250, s[20:23], s51 offen lds
    s_add_u32 m0, s50, 122880
    s_add_u32 s51, s47, 2883712
    buffer_load_dwordx4 v250, s[20:23], s51 offen lds
    s_add_u32 m0, s50, 126976
    s_add_u32 s51, s47, 2883840
    buffer_load_dwordx4 v250, s[20:23], s51 offen lds
    s_add_u32 m0, s50, 131072
    s_add_u32 s51, s47, 2883968
    buffer_load_dwordx4 v250, s[20:23], s51 offen lds
    s_waitcnt vmcnt(4)
    s_waitcnt lgkmcnt(0)
    s_barrier
    s_add_u32 m0, s50, 86016
    s_add_u32 s51, s47, 3145728
    buffer_load_dwordx4 v250, s[20:23], s51 offen lds
    s_add_u32 m0, s50, 90112
    s_add_u32 s51, s47, 3145856
    buffer_load_dwordx4 v250, s[20:23], s51 offen lds
    s_add_u32 m0, s50, 94208
    s_add_u32 s51, s47, 3145984
    buffer_load_dwordx4 v250, s[20:23], s51 offen lds
    s_add_u32 m0, s50, 98304
    s_add_u32 s51, s47, 3146112
    buffer_load_dwordx4 v250, s[20:23], s51 offen lds
    s_add_u32 m0, s50, 147456
    s_add_u32 s51, s49, 768
    buffer_load_dwordx4 v251, s[8:11], s51 offen lds
    s_add_u32 m0, s50, 151552
    s_add_u32 s51, s49, 37632
    buffer_load_dwordx4 v251, s[8:11], s51 offen lds
    s_add_u32 m0, s50, 155648
    s_add_u32 s51, s49, 74496
    buffer_load_dwordx4 v251, s[8:11], s51 offen lds
    s_waitcnt vmcnt(7)
    s_waitcnt lgkmcnt(0)
    s_barrier
    s_add_u32 m0, s50, 102400
    s_add_u32 s51, s47, 3407872
    buffer_load_dwordx4 v250, s[20:23], s51 offen lds
    s_add_u32 m0, s50, 106496
    s_add_u32 s51, s47, 3408000
    buffer_load_dwordx4 v250, s[20:23], s51 offen lds
    s_add_u32 m0, s50, 110592
    s_add_u32 s51, s47, 3408128
    buffer_load_dwordx4 v250, s[20:23], s51 offen lds
    s_add_u32 m0, s50, 114688
    s_add_u32 s51, s47, 3408256
    buffer_load_dwordx4 v250, s[20:23], s51 offen lds
    s_waitcnt vmcnt(4)
    s_waitcnt lgkmcnt(0)
    s_barrier
    s_add_u32 m0, s50, 118784
    s_add_u32 s51, s47, 3670016
    buffer_load_dwordx4 v250, s[20:23], s51 offen lds
    s_add_u32 m0, s50, 122880
    s_add_u32 s51, s47, 3670144
    buffer_load_dwordx4 v250, s[20:23], s51 offen lds
    s_add_u32 m0, s50, 126976
    s_add_u32 s51, s47, 3670272
    buffer_load_dwordx4 v250, s[20:23], s51 offen lds
    s_add_u32 m0, s50, 131072
    s_add_u32 s51, s47, 3670400
    buffer_load_dwordx4 v250, s[20:23], s51 offen lds
    s_add_u32 m0, s50, 135168
    s_add_u32 s51, s49, 896
    buffer_load_dwordx4 v251, s[8:11], s51 offen lds
    s_add_u32 m0, s50, 139264
    s_add_u32 s51, s49, 37760
    buffer_load_dwordx4 v251, s[8:11], s51 offen lds
    s_add_u32 m0, s50, 143360
    s_add_u32 s51, s49, 74624
    buffer_load_dwordx4 v251, s[8:11], s51 offen lds
    s_waitcnt vmcnt(7)
    s_waitcnt lgkmcnt(0)
    s_barrier
    s_add_u32 m0, s50, 86016
    s_add_u32 s51, s47, 3932160
    buffer_load_dwordx4 v250, s[20:23], s51 offen lds
    s_add_u32 m0, s50, 90112
    s_add_u32 s51, s47, 3932288
    buffer_load_dwordx4 v250, s[20:23], s51 offen lds
    s_add_u32 m0, s50, 94208
    s_add_u32 s51, s47, 3932416
    buffer_load_dwordx4 v250, s[20:23], s51 offen lds
    s_add_u32 m0, s50, 98304
    s_add_u32 s51, s47, 3932544
    buffer_load_dwordx4 v250, s[20:23], s51 offen lds
    s_waitcnt vmcnt(4)
    s_waitcnt lgkmcnt(0)
    s_barrier
    s_add_u32 m0, s50, 102400
    s_add_u32 s51, s47, 4194304
    buffer_load_dwordx4 v250, s[20:23], s51 offen lds
    s_add_u32 m0, s50, 106496
    s_add_u32 s51, s47, 4194432
    buffer_load_dwordx4 v250, s[20:23], s51 offen lds
    s_add_u32 m0, s50, 110592
    s_add_u32 s51, s47, 4194560
    buffer_load_dwordx4 v250, s[20:23], s51 offen lds
    s_add_u32 m0, s50, 114688
    s_add_u32 s51, s47, 4194688
    buffer_load_dwordx4 v250, s[20:23], s51 offen lds
    s_add_u32 m0, s50, 147456
    s_add_u32 s51, s49, 1024
    buffer_load_dwordx4 v251, s[8:11], s51 offen lds
    s_add_u32 m0, s50, 151552
    s_add_u32 s51, s49, 37888
    buffer_load_dwordx4 v251, s[8:11], s51 offen lds
    s_add_u32 m0, s50, 155648
    s_add_u32 s51, s49, 74752
    buffer_load_dwordx4 v251, s[8:11], s51 offen lds
    s_waitcnt vmcnt(7)
    s_waitcnt lgkmcnt(0)
    s_barrier
    s_add_u32 m0, s50, 118784
    s_add_u32 s51, s47, 4456448
    buffer_load_dwordx4 v250, s[20:23], s51 offen lds
    s_add_u32 m0, s50, 122880
    s_add_u32 s51, s47, 4456576
    buffer_load_dwordx4 v250, s[20:23], s51 offen lds
    s_add_u32 m0, s50, 126976
    s_add_u32 s51, s47, 4456704
    buffer_load_dwordx4 v250, s[20:23], s51 offen lds
    s_add_u32 m0, s50, 131072
    s_add_u32 s51, s47, 4456832
    buffer_load_dwordx4 v250, s[20:23], s51 offen lds
    s_waitcnt vmcnt(4)
    s_waitcnt lgkmcnt(0)
    s_barrier
    s_add_u32 m0, s50, 135168
    s_add_u32 s51, s46, 0
    buffer_load_dwordx4 v253, s[12:15], s51 offen nt lds
    s_add_u32 m0, s50, 139264
    s_add_u32 s51, s46, 128
    buffer_load_dwordx4 v253, s[12:15], s51 offen nt lds
    s_add_u32 m0, s50, 86016
    s_add_u32 s51, s46, 0
    buffer_load_dwordx4 v254, s[16:19], s51 offen nt lds
    s_add_u32 m0, s50, 90112
    s_add_u32 s51, s46, 128
    buffer_load_dwordx4 v254, s[16:19], s51 offen nt lds
    s_add_u32 m0, s50, 94208
    s_add_u32 s51, s46, 8192
    buffer_load_dwordx4 v253, s[12:15], s51 offen nt lds
    s_add_u32 m0, s50, 98304
    s_add_u32 s51, s46, 8320
    buffer_load_dwordx4 v253, s[12:15], s51 offen nt lds
    s_waitcnt vmcnt(6)
    s_waitcnt lgkmcnt(0)
    s_barrier
    s_add_u32 m0, s50, 102400
    s_add_u32 s51, s46, 8192
    buffer_load_dwordx4 v254, s[16:19], s51 offen nt lds
    s_add_u32 m0, s50, 106496
    s_add_u32 s51, s46, 8320
    buffer_load_dwordx4 v254, s[16:19], s51 offen nt lds
    s_add_u32 m0, s50, 110592
    s_add_u32 s51, s46, 16384
    buffer_load_dwordx4 v253, s[12:15], s51 offen nt lds
    s_add_u32 m0, s50, 114688
    s_add_u32 s51, s46, 16512
    buffer_load_dwordx4 v253, s[12:15], s51 offen nt lds
    s_waitcnt lgkmcnt(0)
    s_barrier
    s_add_u32 m0, s50, 118784
    s_add_u32 s51, s46, 16384
    buffer_load_dwordx4 v254, s[16:19], s51 offen nt lds
    s_add_u32 m0, s50, 122880
    s_add_u32 s51, s46, 16512
    buffer_load_dwordx4 v254, s[16:19], s51 offen nt lds
    s_add_u32 m0, s50, 126976
    s_add_u32 s51, s46, 24576
    buffer_load_dwordx4 v253, s[12:15], s51 offen nt lds
    s_add_u32 m0, s50, 131072
    s_add_u32 s51, s46, 24704
    buffer_load_dwordx4 v253, s[12:15], s51 offen nt lds
    s_waitcnt vmcnt(12)
    s_waitcnt lgkmcnt(0)
    s_barrier
    ds_read_b64_tr_b16 v[240:241], v248 offset:0
    ds_read_b64_tr_b16 v[242:243], v248 offset:2048
    ds_read_b128 v[216:219], v249 offset:0
    ds_read_b128 v[220:223], v249 offset:1024
    ds_read_b128 v[224:227], v249 offset:2048
    ds_read_b128 v[228:231], v249 offset:3072
    ds_read_b128 v[232:235], v249 offset:4096
    ds_read_b128 v[236:239], v249 offset:5120
    ds_read_b64_tr_b16 v[244:245], v248 offset:4096
    ds_read_b64_tr_b16 v[246:247], v248 offset:6144
    s_waitcnt lgkmcnt(7)
    v_mfma_f32_16x16x32_bf16 v[0:3], v[240:243], v[216:219], v[0:3]
    s_waitcnt lgkmcnt(6)
    v_mfma_f32_16x16x32_bf16 v[4:7], v[240:243], v[220:223], v[4:7]
    s_waitcnt lgkmcnt(5)
    v_mfma_f32_16x16x32_bf16 v[8:11], v[240:243], v[224:227], v[8:11]
    s_waitcnt lgkmcnt(4)
    v_mfma_f32_16x16x32_bf16 v[12:15], v[240:243], v[228:231], v[12:15]
    s_waitcnt lgkmcnt(3)
    v_mfma_f32_16x16x32_bf16 v[16:19], v[240:243], v[232:235], v[16:19]
    s_waitcnt lgkmcnt(2)
    v_mfma_f32_16x16x32_bf16 v[20:23], v[240:243], v[236:239], v[20:23]
    ds_read_b64_tr_b16 v[240:241], v248 offset:8192
    ds_read_b64_tr_b16 v[242:243], v248 offset:10240
    s_waitcnt lgkmcnt(2)
    v_mfma_f32_16x16x32_bf16 v[24:27], v[244:247], v[216:219], v[24:27]
    v_mfma_f32_16x16x32_bf16 v[28:31], v[244:247], v[220:223], v[28:31]
    v_mfma_f32_16x16x32_bf16 v[32:35], v[244:247], v[224:227], v[32:35]
    v_mfma_f32_16x16x32_bf16 v[36:39], v[244:247], v[228:231], v[36:39]
    v_mfma_f32_16x16x32_bf16 v[40:43], v[244:247], v[232:235], v[40:43]
    v_mfma_f32_16x16x32_bf16 v[44:47], v[244:247], v[236:239], v[44:47]
    ds_read_b64_tr_b16 v[244:245], v248 offset:12288
    ds_read_b64_tr_b16 v[246:247], v248 offset:14336
    s_waitcnt lgkmcnt(2)
    v_mfma_f32_16x16x32_bf16 v[48:51], v[240:243], v[216:219], v[48:51]
    v_mfma_f32_16x16x32_bf16 v[52:55], v[240:243], v[220:223], v[52:55]
    v_mfma_f32_16x16x32_bf16 v[56:59], v[240:243], v[224:227], v[56:59]
    v_mfma_f32_16x16x32_bf16 v[60:63], v[240:243], v[228:231], v[60:63]
    v_mfma_f32_16x16x32_bf16 v[64:67], v[240:243], v[232:235], v[64:67]
    v_mfma_f32_16x16x32_bf16 v[68:71], v[240:243], v[236:239], v[68:71]
    ds_read_b64_tr_b16 v[240:241], v248 offset:16384
    ds_read_b64_tr_b16 v[242:243], v248 offset:18432
    s_waitcnt lgkmcnt(2)
    v_mfma_f32_16x16x32_bf16 v[72:75], v[244:247], v[216:219], v[72:75]
    v_mfma_f32_16x16x32_bf16 v[76:79], v[244:247], v[220:223], v[76:79]
    v_mfma_f32_16x16x32_bf16 v[80:83], v[244:247], v[224:227], v[80:83]
    v_mfma_f32_16x16x32_bf16 v[84:87], v[244:247], v[228:231], v[84:87]
    v_mfma_f32_16x16x32_bf16 v[88:91], v[244:247], v[232:235], v[88:91]
    v_mfma_f32_16x16x32_bf16 v[92:95], v[244:247], v[236:239], v[92:95]
    s_waitcnt lgkmcnt(0)
    v_mfma_f32_16x16x32_bf16 v[96:99], v[240:243], v[216:219], v[96:99]
    v_mfma_f32_16x16x32_bf16 v[100:103], v[240:243], v[220:223], v[100:103]
    v_mfma_f32_16x16x32_bf16 v[104:107], v[240:243], v[224:227], v[104:107]
    v_mfma_f32_16x16x32_bf16 v[108:111], v[240:243], v[228:231], v[108:111]
    v_mfma_f32_16x16x32_bf16 v[112:115], v[240:243], v[232:235], v[112:115]
    v_mfma_f32_16x16x32_bf16 v[116:119], v[240:243], v[236:239], v[116:119]
    s_waitcnt vmcnt(8)
    s_waitcnt lgkmcnt(0)
    s_barrier
    ds_read_b64_tr_b16 v[240:241], v248 offset:20480
    ds_read_b64_tr_b16 v[242:243], v248 offset:22528
    ds_read_b64_tr_b16 v[244:245], v248 offset:24576
    ds_read_b64_tr_b16 v[246:247], v248 offset:26624
    s_add_u32 m0, s50, 49152
    s_add_u32 s51, s64, 147456
    buffer_load_dwordx4 v252, s[24:27], s51 offen lds
    s_add_u32 m0, s50, 53248
    s_add_u32 s51, s65, 147456
    buffer_load_dwordx4 v252, s[24:27], s51 offen lds
    s_waitcnt lgkmcnt(2)
    v_mfma_f32_16x16x32_bf16 v[120:123], v[240:243], v[216:219], v[120:123]
    v_mfma_f32_16x16x32_bf16 v[124:127], v[240:243], v[220:223], v[124:127]
    s_add_u32 m0, s50, 57344
    s_add_u32 s51, s66, 147456
    buffer_load_dwordx4 v252, s[24:27], s51 offen lds
    v_mfma_f32_16x16x32_bf16 v[128:131], v[240:243], v[224:227], v[128:131]
    v_mfma_f32_16x16x32_bf16 v[132:135], v[240:243], v[228:231], v[132:135]
    v_mfma_f32_16x16x32_bf16 v[136:139], v[240:243], v[232:235], v[136:139]
    s_add_u32 m0, s50, 61440
    s_add_u32 s51, s67, 147456
    buffer_load_dwordx4 v252, s[24:27], s51 offen lds
    v_mfma_f32_16x16x32_bf16 v[140:143], v[240:243], v[236:239], v[140:143]
    ds_read_b64_tr_b16 v[240:241], v248 offset:28672
    ds_read_b64_tr_b16 v[242:243], v248 offset:30720
    s_waitcnt lgkmcnt(2)
    v_mfma_f32_16x16x32_bf16 v[144:147], v[244:247], v[216:219], v[144:147]
    v_mfma_f32_16x16x32_bf16 v[148:151], v[244:247], v[220:223], v[148:151]
    s_add_u32 m0, s50, 65536
    s_add_u32 s51, s68, 147456
    buffer_load_dwordx4 v252, s[24:27], s51 offen lds
    v_mfma_f32_16x16x32_bf16 v[152:155], v[244:247], v[224:227], v[152:155]
    v_mfma_f32_16x16x32_bf16 v[156:159], v[244:247], v[228:231], v[156:159]
    v_mfma_f32_16x16x32_bf16 v[160:163], v[244:247], v[232:235], v[160:163]
    v_mfma_f32_16x16x32_bf16 v[164:167], v[244:247], v[236:239], v[164:167]
    ds_read_b64_tr_b16 v[244:245], v248 offset:32768
    ds_read_b64_tr_b16 v[246:247], v248 offset:34816
    s_add_u32 m0, s50, 135168
    s_add_u32 s51, s46, 24576
    buffer_load_dwordx4 v254, s[16:19], s51 offen nt lds
    s_waitcnt lgkmcnt(2)
    v_mfma_f32_16x16x32_bf16 v[168:171], v[240:243], v[216:219], v[168:171]
    v_mfma_f32_16x16x32_bf16 v[172:175], v[240:243], v[220:223], v[172:175]
    v_mfma_f32_16x16x32_bf16 v[176:179], v[240:243], v[224:227], v[176:179]
    s_add_u32 m0, s50, 139264
    s_add_u32 s51, s46, 24704
    buffer_load_dwordx4 v254, s[16:19], s51 offen nt lds
    v_mfma_f32_16x16x32_bf16 v[180:183], v[240:243], v[228:231], v[180:183]
    v_mfma_f32_16x16x32_bf16 v[184:187], v[240:243], v[232:235], v[184:187]
    v_mfma_f32_16x16x32_bf16 v[188:191], v[240:243], v[236:239], v[188:191]
    s_waitcnt lgkmcnt(0)
    v_mfma_f32_16x16x32_bf16 v[192:195], v[244:247], v[216:219], v[192:195]
    s_add_u32 m0, s50, 143360
    s_add_u32 s51, s46, 32768
    buffer_load_dwordx4 v253, s[12:15], s51 offen nt lds
    v_mfma_f32_16x16x32_bf16 v[196:199], v[244:247], v[220:223], v[196:199]
    v_mfma_f32_16x16x32_bf16 v[200:203], v[244:247], v[224:227], v[200:203]
    v_mfma_f32_16x16x32_bf16 v[204:207], v[244:247], v[228:231], v[204:207]
    s_add_u32 m0, s50, 147456
    s_add_u32 s51, s46, 32896
    buffer_load_dwordx4 v253, s[12:15], s51 offen nt lds
    v_mfma_f32_16x16x32_bf16 v[208:211], v[244:247], v[232:235], v[208:211]
    v_mfma_f32_16x16x32_bf16 v[212:215], v[244:247], v[236:239], v[212:215]
    s_waitcnt vmcnt(5)
    s_waitcnt lgkmcnt(0)
    s_barrier
    ds_read_b64_tr_b16 v[240:241], v248 offset:0
    ds_read_b64_tr_b16 v[242:243], v248 offset:2048
    ds_read_b128 v[216:219], v249 offset:24576
    ds_read_b128 v[220:223], v249 offset:25600
    ds_read_b128 v[224:227], v249 offset:26624
    ds_read_b128 v[228:231], v249 offset:27648
    ds_read_b128 v[232:235], v249 offset:28672
    ds_read_b128 v[236:239], v249 offset:29696
    ds_read_b64_tr_b16 v[244:245], v248 offset:4096
    ds_read_b64_tr_b16 v[246:247], v248 offset:6144
    s_add_u32 m0, s50, 69632
    s_add_u32 s51, s69, 147456
    buffer_load_dwordx4 v252, s[24:27], s51 offen lds
    s_add_u32 m0, s50, 73728
    s_add_u32 s51, s70, 147456
    buffer_load_dwordx4 v252, s[24:27], s51 offen lds
    s_waitcnt lgkmcnt(7)
    v_mfma_f32_16x16x32_bf16 v[0:3], v[240:243], v[216:219], v[0:3]
    s_waitcnt lgkmcnt(6)
    v_mfma_f32_16x16x32_bf16 v[4:7], v[240:243], v[220:223], v[4:7]
    s_add_u32 m0, s50, 77824
    s_add_u32 s51, s71, 147456
    buffer_load_dwordx4 v252, s[24:27], s51 offen lds
    s_waitcnt lgkmcnt(5)
    v_mfma_f32_16x16x32_bf16 v[8:11], v[240:243], v[224:227], v[8:11]
    s_waitcnt lgkmcnt(4)
    v_mfma_f32_16x16x32_bf16 v[12:15], v[240:243], v[228:231], v[12:15]
    s_waitcnt lgkmcnt(3)
    v_mfma_f32_16x16x32_bf16 v[16:19], v[240:243], v[232:235], v[16:19]
    s_waitcnt lgkmcnt(2)
    v_mfma_f32_16x16x32_bf16 v[20:23], v[240:243], v[236:239], v[20:23]
    ds_read_b64_tr_b16 v[240:241], v248 offset:8192
    ds_read_b64_tr_b16 v[242:243], v248 offset:10240
    s_add_u32 m0, s50, 81920
    s_add_u32 s51, s72, 147456
    buffer_load_dwordx4 v252, s[24:27], s51 offen lds
    s_waitcnt lgkmcnt(2)
    v_mfma_f32_16x16x32_bf16 v[24:27], v[244:247], v[216:219], v[24:27]
    v_mfma_f32_16x16x32_bf16 v[28:31], v[244:247], v[220:223], v[28:31]
    v_mfma_f32_16x16x32_bf16 v[32:35], v[244:247], v[224:227], v[32:35]
    v_mfma_f32_16x16x32_bf16 v[36:39], v[244:247], v[228:231], v[36:39]
    s_add_u32 m0, s50, 86016
    s_add_u32 s51, s46, 32768
    buffer_load_dwordx4 v254, s[16:19], s51 offen nt lds
    v_mfma_f32_16x16x32_bf16 v[40:43], v[244:247], v[232:235], v[40:43]
    v_mfma_f32_16x16x32_bf16 v[44:47], v[244:247], v[236:239], v[44:47]
    ds_read_b64_tr_b16 v[244:245], v248 offset:12288
    ds_read_b64_tr_b16 v[246:247], v248 offset:14336
    s_waitcnt lgkmcnt(2)
    v_mfma_f32_16x16x32_bf16 v[48:51], v[240:243], v[216:219], v[48:51]
    v_mfma_f32_16x16x32_bf16 v[52:55], v[240:243], v[220:223], v[52:55]
    s_add_u32 m0, s50, 90112
    s_add_u32 s51, s46, 32896
    buffer_load_dwordx4 v254, s[16:19], s51 offen nt lds
    v_mfma_f32_16x16x32_bf16 v[56:59], v[240:243], v[224:227], v[56:59]
    v_mfma_f32_16x16x32_bf16 v[60:63], v[240:243], v[228:231], v[60:63]
    v_mfma_f32_16x16x32_bf16 v[64:67], v[240:243], v[232:235], v[64:67]
    v_mfma_f32_16x16x32_bf16 v[68:71], v[240:243], v[236:239], v[68:71]
    s_add_u32 m0, s50, 94208
    s_add_u32 s51, s46, 40960
    buffer_load_dwordx4 v253, s[12:15], s51 offen nt lds
    s_waitcnt lgkmcnt(0)
    v_mfma_f32_16x16x32_bf16 v[72:75], v[244:247], v[216:219], v[72:75]
    v_mfma_f32_16x16x32_bf16 v[76:79], v[244:247], v[220:223], v[76:79]
    v_mfma_f32_16x16x32_bf16 v[80:83], v[244:247], v[224:227], v[80:83]
    v_mfma_f32_16x16x32_bf16 v[84:87], v[244:247], v[228:231], v[84:87]
    s_add_u32 m0, s50, 98304
    s_add_u32 s51, s46, 41088
    buffer_load_dwordx4 v253, s[12:15], s51 offen nt lds
    v_mfma_f32_16x16x32_bf16 v[88:91], v[244:247], v[232:235], v[88:91]
    v_mfma_f32_16x16x32_bf16 v[92:95], v[244:247], v[236:239], v[92:95]
    s_waitcnt vmcnt(4)
    s_waitcnt lgkmcnt(0)
    s_barrier
    ds_read_b64_tr_b16 v[240:241], v248 offset:16384
    ds_read_b64_tr_b16 v[242:243], v248 offset:18432
    ds_read_b64_tr_b16 v[244:245], v248 offset:20480
    ds_read_b64_tr_b16 v[246:247], v248 offset:22528
    s_add_u32 m0, s50, 49152
    s_add_u32 s51, s64, 36864
    buffer_load_dwordx4 v252, s[24:27], s51 offen lds
    s_add_u32 m0, s50, 53248
    s_add_u32 s51, s65, 36864
    buffer_load_dwordx4 v252, s[24:27], s51 offen lds
    s_waitcnt lgkmcnt(2)
    v_mfma_f32_16x16x32_bf16 v[96:99], v[240:243], v[216:219], v[96:99]
    v_mfma_f32_16x16x32_bf16 v[100:103], v[240:243], v[220:223], v[100:103]
    s_add_u32 m0, s50, 57344
    s_add_u32 s51, s66, 36864
    buffer_load_dwordx4 v252, s[24:27], s51 offen lds
    v_mfma_f32_16x16x32_bf16 v[104:107], v[240:243], v[224:227], v[104:107]
    v_mfma_f32_16x16x32_bf16 v[108:111], v[240:243], v[228:231], v[108:111]
    v_mfma_f32_16x16x32_bf16 v[112:115], v[240:243], v[232:235], v[112:115]
    v_mfma_f32_16x16x32_bf16 v[116:119], v[240:243], v[236:239], v[116:119]
    ds_read_b64_tr_b16 v[240:241], v248 offset:24576
    ds_read_b64_tr_b16 v[242:243], v248 offset:26624
    s_waitcnt lgkmcnt(2)
    v_mfma_f32_16x16x32_bf16 v[120:123], v[244:247], v[216:219], v[120:123]
    s_add_u32 m0, s50, 61440
    s_add_u32 s51, s67, 36864
    buffer_load_dwordx4 v252, s[24:27], s51 offen lds
    v_mfma_f32_16x16x32_bf16 v[124:127], v[244:247], v[220:223], v[124:127]
    v_mfma_f32_16x16x32_bf16 v[128:131], v[244:247], v[224:227], v[128:131]
    v_mfma_f32_16x16x32_bf16 v[132:135], v[244:247], v[228:231], v[132:135]
    v_mfma_f32_16x16x32_bf16 v[136:139], v[244:247], v[232:235], v[136:139]
    v_mfma_f32_16x16x32_bf16 v[140:143], v[244:247], v[236:239], v[140:143]
    ds_read_b64_tr_b16 v[244:245], v248 offset:28672
    ds_read_b64_tr_b16 v[246:247], v248 offset:30720
    s_add_u32 m0, s50, 102400
    s_add_u32 s51, s46, 40960
    buffer_load_dwordx4 v254, s[16:19], s51 offen nt lds
    s_waitcnt lgkmcnt(2)
    v_mfma_f32_16x16x32_bf16 v[144:147], v[240:243], v[216:219], v[144:147]
    v_mfma_f32_16x16x32_bf16 v[148:151], v[240:243], v[220:223], v[148:151]
    v_mfma_f32_16x16x32_bf16 v[152:155], v[240:243], v[224:227], v[152:155]
    v_mfma_f32_16x16x32_bf16 v[156:159], v[240:243], v[228:231], v[156:159]
    v_mfma_f32_16x16x32_bf16 v[160:163], v[240:243], v[232:235], v[160:163]
    s_add_u32 m0, s50, 106496
    s_add_u32 s51, s46, 41088
    buffer_load_dwordx4 v254, s[16:19], s51 offen nt lds
    v_mfma_f32_16x16x32_bf16 v[164:167], v[240:243], v[236:239], v[164:167]
    ds_read_b64_tr_b16 v[240:241], v248 offset:32768
    ds_read_b64_tr_b16 v[242:243], v248 offset:34816
    s_waitcnt lgkmcnt(2)
    v_mfma_f32_16x16x32_bf16 v[168:171], v[244:247], v[216:219], v[168:171]
    v_mfma_f32_16x16x32_bf16 v[172:175], v[244:247], v[220:223], v[172:175]
    v_mfma_f32_16x16x32_bf16 v[176:179], v[244:247], v[224:227], v[176:179]
    v_mfma_f32_16x16x32_bf16 v[180:183], v[244:247], v[228:231], v[180:183]
    s_add_u32 m0, s50, 110592
    s_add_u32 s51, s46, 49152
    buffer_load_dwordx4 v253, s[12:15], s51 offen nt lds
    v_mfma_f32_16x16x32_bf16 v[184:187], v[244:247], v[232:235], v[184:187]
    v_mfma_f32_16x16x32_bf16 v[188:191], v[244:247], v[236:239], v[188:191]
    s_waitcnt lgkmcnt(0)
    v_mfma_f32_16x16x32_bf16 v[192:195], v[240:243], v[216:219], v[192:195]
    v_mfma_f32_16x16x32_bf16 v[196:199], v[240:243], v[220:223], v[196:199]
    v_mfma_f32_16x16x32_bf16 v[200:203], v[240:243], v[224:227], v[200:203]
    s_add_u32 m0, s50, 114688
    s_add_u32 s51, s46, 49280
    buffer_load_dwordx4 v253, s[12:15], s51 offen nt lds
    v_mfma_f32_16x16x32_bf16 v[204:207], v[240:243], v[228:231], v[204:207]
    v_mfma_f32_16x16x32_bf16 v[208:211], v[240:243], v[232:235], v[208:211]
    v_mfma_f32_16x16x32_bf16 v[212:215], v[240:243], v[236:239], v[212:215]
    s_waitcnt vmcnt(4)
    s_waitcnt lgkmcnt(0)
    s_barrier
    ds_read_b64_tr_b16 v[240:241], v248 offset:0
    ds_read_b64_tr_b16 v[242:243], v248 offset:2048
    ds_read_b128 v[216:219], v249 offset:6144
    ds_read_b128 v[220:223], v249 offset:7168
    ds_read_b128 v[224:227], v249 offset:8192
    ds_read_b128 v[228:231], v249 offset:9216
    ds_read_b128 v[232:235], v249 offset:10240
    ds_read_b128 v[236:239], v249 offset:11264
    ds_read_b64_tr_b16 v[244:245], v248 offset:4096
    ds_read_b64_tr_b16 v[246:247], v248 offset:6144
    s_add_u32 m0, s50, 65536
    s_add_u32 s51, s68, 36864
    buffer_load_dwordx4 v252, s[24:27], s51 offen lds
    s_add_u32 m0, s50, 69632
    s_add_u32 s51, s69, 36864
    buffer_load_dwordx4 v252, s[24:27], s51 offen lds
    s_waitcnt lgkmcnt(7)
    v_mfma_f32_16x16x32_bf16 v[0:3], v[240:243], v[216:219], v[0:3]
    s_waitcnt lgkmcnt(6)
    v_mfma_f32_16x16x32_bf16 v[4:7], v[240:243], v[220:223], v[4:7]
    s_add_u32 m0, s50, 73728
    s_add_u32 s51, s70, 36864
    buffer_load_dwordx4 v252, s[24:27], s51 offen lds
    s_waitcnt lgkmcnt(5)
    v_mfma_f32_16x16x32_bf16 v[8:11], v[240:243], v[224:227], v[8:11]
    s_waitcnt lgkmcnt(4)
    v_mfma_f32_16x16x32_bf16 v[12:15], v[240:243], v[228:231], v[12:15]
    s_waitcnt lgkmcnt(3)
    v_mfma_f32_16x16x32_bf16 v[16:19], v[240:243], v[232:235], v[16:19]
    s_add_u32 m0, s50, 77824
    s_add_u32 s51, s71, 36864
    buffer_load_dwordx4 v252, s[24:27], s51 offen lds
    s_waitcnt lgkmcnt(2)
    v_mfma_f32_16x16x32_bf16 v[20:23], v[240:243], v[236:239], v[20:23]
    ds_read_b64_tr_b16 v[240:241], v248 offset:8192
    ds_read_b64_tr_b16 v[242:243], v248 offset:10240
    s_waitcnt lgkmcnt(2)
    v_mfma_f32_16x16x32_bf16 v[24:27], v[244:247], v[216:219], v[24:27]
    v_mfma_f32_16x16x32_bf16 v[28:31], v[244:247], v[220:223], v[28:31]
    s_add_u32 m0, s50, 81920
    s_add_u32 s51, s72, 36864
    buffer_load_dwordx4 v252, s[24:27], s51 offen lds
    v_mfma_f32_16x16x32_bf16 v[32:35], v[244:247], v[224:227], v[32:35]
    v_mfma_f32_16x16x32_bf16 v[36:39], v[244:247], v[228:231], v[36:39]
    v_mfma_f32_16x16x32_bf16 v[40:43], v[244:247], v[232:235], v[40:43]
    v_mfma_f32_16x16x32_bf16 v[44:47], v[244:247], v[236:239], v[44:47]
    ds_read_b64_tr_b16 v[244:245], v248 offset:12288
    ds_read_b64_tr_b16 v[246:247], v248 offset:14336
    s_add_u32 m0, s50, 118784
    s_add_u32 s51, s46, 49152
    buffer_load_dwordx4 v254, s[16:19], s51 offen nt lds
    s_waitcnt lgkmcnt(2)
    v_mfma_f32_16x16x32_bf16 v[48:51], v[240:243], v[216:219], v[48:51]
    v_mfma_f32_16x16x32_bf16 v[52:55], v[240:243], v[220:223], v[52:55]
    v_mfma_f32_16x16x32_bf16 v[56:59], v[240:243], v[224:227], v[56:59]
    s_add_u32 m0, s50, 122880
    s_add_u32 s51, s46, 49280
    buffer_load_dwordx4 v254, s[16:19], s51 offen nt lds
    v_mfma_f32_16x16x32_bf16 v[60:63], v[240:243], v[228:231], v[60:63]
    v_mfma_f32_16x16x32_bf16 v[64:67], v[240:243], v[232:235], v[64:67]
    v_mfma_f32_16x16x32_bf16 v[68:71], v[240:243], v[236:239], v[68:71]
    s_waitcnt lgkmcnt(0)
    v_mfma_f32_16x16x32_bf16 v[72:75], v[244:247], v[216:219], v[72:75]
    s_add_u32 m0, s50, 126976
    s_add_u32 s51, s46, 57344
    buffer_load_dwordx4 v253, s[12:15], s51 offen nt lds
    v_mfma_f32_16x16x32_bf16 v[76:79], v[244:247], v[220:223], v[76:79]
    v_mfma_f32_16x16x32_bf16 v[80:83], v[244:247], v[224:227], v[80:83]
    v_mfma_f32_16x16x32_bf16 v[84:87], v[244:247], v[228:231], v[84:87]
    s_add_u32 m0, s50, 131072
    s_add_u32 s51, s46, 57472
    buffer_load_dwordx4 v253, s[12:15], s51 offen nt lds
    v_mfma_f32_16x16x32_bf16 v[88:91], v[244:247], v[232:235], v[88:91]
    v_mfma_f32_16x16x32_bf16 v[92:95], v[244:247], v[236:239], v[92:95]
    s_waitcnt vmcnt(4)
    s_waitcnt lgkmcnt(0)
    s_barrier
    ds_read_b64_tr_b16 v[240:241], v248 offset:16384
    ds_read_b64_tr_b16 v[242:243], v248 offset:18432
    ds_read_b64_tr_b16 v[244:245], v248 offset:20480
    ds_read_b64_tr_b16 v[246:247], v248 offset:22528
    s_add_u32 m0, s50, 49152
    s_add_u32 s51, s64, 184320
    buffer_load_dwordx4 v252, s[24:27], s51 offen lds
    s_add_u32 m0, s50, 53248
    s_add_u32 s51, s65, 184320
    buffer_load_dwordx4 v252, s[24:27], s51 offen lds
    s_waitcnt lgkmcnt(2)
    v_mfma_f32_16x16x32_bf16 v[96:99], v[240:243], v[216:219], v[96:99]
    v_mfma_f32_16x16x32_bf16 v[100:103], v[240:243], v[220:223], v[100:103]
    s_add_u32 m0, s50, 57344
    s_add_u32 s51, s66, 184320
    buffer_load_dwordx4 v252, s[24:27], s51 offen lds
    v_mfma_f32_16x16x32_bf16 v[104:107], v[240:243], v[224:227], v[104:107]
    v_mfma_f32_16x16x32_bf16 v[108:111], v[240:243], v[228:231], v[108:111]
    v_mfma_f32_16x16x32_bf16 v[112:115], v[240:243], v[232:235], v[112:115]
    v_mfma_f32_16x16x32_bf16 v[116:119], v[240:243], v[236:239], v[116:119]
    ds_read_b64_tr_b16 v[240:241], v248 offset:24576
    ds_read_b64_tr_b16 v[242:243], v248 offset:26624
    s_waitcnt lgkmcnt(2)
    v_mfma_f32_16x16x32_bf16 v[120:123], v[244:247], v[216:219], v[120:123]
    s_add_u32 m0, s50, 61440
    s_add_u32 s51, s67, 184320
    buffer_load_dwordx4 v252, s[24:27], s51 offen lds
    v_mfma_f32_16x16x32_bf16 v[124:127], v[244:247], v[220:223], v[124:127]
    v_mfma_f32_16x16x32_bf16 v[128:131], v[244:247], v[224:227], v[128:131]
    v_mfma_f32_16x16x32_bf16 v[132:135], v[244:247], v[228:231], v[132:135]
    v_mfma_f32_16x16x32_bf16 v[136:139], v[244:247], v[232:235], v[136:139]
    v_mfma_f32_16x16x32_bf16 v[140:143], v[244:247], v[236:239], v[140:143]
    ds_read_b64_tr_b16 v[244:245], v248 offset:28672
    ds_read_b64_tr_b16 v[246:247], v248 offset:30720
    s_add_u32 m0, s50, 135168
    s_add_u32 s51, s46, 57344
    buffer_load_dwordx4 v254, s[16:19], s51 offen nt lds
    s_waitcnt lgkmcnt(2)
    v_mfma_f32_16x16x32_bf16 v[144:147], v[240:243], v[216:219], v[144:147]
    v_mfma_f32_16x16x32_bf16 v[148:151], v[240:243], v[220:223], v[148:151]
    v_mfma_f32_16x16x32_bf16 v[152:155], v[240:243], v[224:227], v[152:155]
    v_mfma_f32_16x16x32_bf16 v[156:159], v[240:243], v[228:231], v[156:159]
    v_mfma_f32_16x16x32_bf16 v[160:163], v[240:243], v[232:235], v[160:163]
    s_add_u32 m0, s50, 139264
    s_add_u32 s51, s46, 57472
    buffer_load_dwordx4 v254, s[16:19], s51 offen nt lds
    v_mfma_f32_16x16x32_bf16 v[164:167], v[240:243], v[236:239], v[164:167]
    ds_read_b64_tr_b16 v[240:241], v248 offset:32768
    ds_read_b64_tr_b16 v[242:243], v248 offset:34816
    s_waitcnt lgkmcnt(2)
    v_mfma_f32_16x16x32_bf16 v[168:171], v[244:247], v[216:219], v[168:171]
    v_mfma_f32_16x16x32_bf16 v[172:175], v[244:247], v[220:223], v[172:175]
    v_mfma_f32_16x16x32_bf16 v[176:179], v[244:247], v[224:227], v[176:179]
    v_mfma_f32_16x16x32_bf16 v[180:183], v[244:247], v[228:231], v[180:183]
    s_add_u32 m0, s50, 143360
    s_add_u32 s51, s46, 65536
    buffer_load_dwordx4 v253, s[12:15], s51 offen nt lds
    v_mfma_f32_16x16x32_bf16 v[184:187], v[244:247], v[232:235], v[184:187]
    v_mfma_f32_16x16x32_bf16 v[188:191], v[244:247], v[236:239], v[188:191]
    s_waitcnt lgkmcnt(0)
    v_mfma_f32_16x16x32_bf16 v[192:195], v[240:243], v[216:219], v[192:195]
    v_mfma_f32_16x16x32_bf16 v[196:199], v[240:243], v[220:223], v[196:199]
    v_mfma_f32_16x16x32_bf16 v[200:203], v[240:243], v[224:227], v[200:203]
    s_add_u32 m0, s50, 147456
    s_add_u32 s51, s46, 65664
    buffer_load_dwordx4 v253, s[12:15], s51 offen nt lds
    v_mfma_f32_16x16x32_bf16 v[204:207], v[240:243], v[228:231], v[204:207]
    v_mfma_f32_16x16x32_bf16 v[208:211], v[240:243], v[232:235], v[208:211]
    v_mfma_f32_16x16x32_bf16 v[212:215], v[240:243], v[236:239], v[212:215]
    s_waitcnt vmcnt(4)
    s_waitcnt lgkmcnt(0)
    s_barrier
    ds_read_b64_tr_b16 v[240:241], v248 offset:0
    ds_read_b64_tr_b16 v[242:243], v248 offset:2048
    ds_read_b128 v[216:219], v249 offset:30720
    ds_read_b128 v[220:223], v249 offset:31744
    ds_read_b128 v[224:227], v249 offset:32768
    ds_read_b128 v[228:231], v249 offset:33792
    ds_read_b128 v[232:235], v249 offset:34816
    ds_read_b128 v[236:239], v249 offset:35840
    ds_read_b64_tr_b16 v[244:245], v248 offset:4096
    ds_read_b64_tr_b16 v[246:247], v248 offset:6144
    s_add_u32 m0, s50, 65536
    s_add_u32 s51, s68, 184320
    buffer_load_dwordx4 v252, s[24:27], s51 offen lds
    s_add_u32 m0, s50, 69632
    s_add_u32 s51, s69, 184320
    buffer_load_dwordx4 v252, s[24:27], s51 offen lds
    s_waitcnt lgkmcnt(7)
    v_mfma_f32_16x16x32_bf16 v[0:3], v[240:243], v[216:219], v[0:3]
    s_waitcnt lgkmcnt(6)
    v_mfma_f32_16x16x32_bf16 v[4:7], v[240:243], v[220:223], v[4:7]
    s_add_u32 m0, s50, 73728
    s_add_u32 s51, s70, 184320
    buffer_load_dwordx4 v252, s[24:27], s51 offen lds
    s_waitcnt lgkmcnt(5)
    v_mfma_f32_16x16x32_bf16 v[8:11], v[240:243], v[224:227], v[8:11]
    s_waitcnt lgkmcnt(4)
    v_mfma_f32_16x16x32_bf16 v[12:15], v[240:243], v[228:231], v[12:15]
    s_waitcnt lgkmcnt(3)
    v_mfma_f32_16x16x32_bf16 v[16:19], v[240:243], v[232:235], v[16:19]
    s_add_u32 m0, s50, 77824
    s_add_u32 s51, s71, 184320
    buffer_load_dwordx4 v252, s[24:27], s51 offen lds
    s_waitcnt lgkmcnt(2)
    v_mfma_f32_16x16x32_bf16 v[20:23], v[240:243], v[236:239], v[20:23]
    ds_read_b64_tr_b16 v[240:241], v248 offset:8192
    ds_read_b64_tr_b16 v[242:243], v248 offset:10240
    s_waitcnt lgkmcnt(2)
    v_mfma_f32_16x16x32_bf16 v[24:27], v[244:247], v[216:219], v[24:27]
    v_mfma_f32_16x16x32_bf16 v[28:31], v[244:247], v[220:223], v[28:31]
    s_add_u32 m0, s50, 81920
    s_add_u32 s51, s72, 184320
    buffer_load_dwordx4 v252, s[24:27], s51 offen lds
    v_mfma_f32_16x16x32_bf16 v[32:35], v[244:247], v[224:227], v[32:35]
    v_mfma_f32_16x16x32_bf16 v[36:39], v[244:247], v[228:231], v[36:39]
    v_mfma_f32_16x16x32_bf16 v[40:43], v[244:247], v[232:235], v[40:43]
    v_mfma_f32_16x16x32_bf16 v[44:47], v[244:247], v[236:239], v[44:47]
    ds_read_b64_tr_b16 v[244:245], v248 offset:12288
    ds_read_b64_tr_b16 v[246:247], v248 offset:14336
    s_add_u32 m0, s50, 86016
    s_add_u32 s51, s46, 65536
    buffer_load_dwordx4 v254, s[16:19], s51 offen nt lds
    s_waitcnt lgkmcnt(2)
    v_mfma_f32_16x16x32_bf16 v[48:51], v[240:243], v[216:219], v[48:51]
    v_mfma_f32_16x16x32_bf16 v[52:55], v[240:243], v[220:223], v[52:55]
    v_mfma_f32_16x16x32_bf16 v[56:59], v[240:243], v[224:227], v[56:59]
    s_add_u32 m0, s50, 90112
    s_add_u32 s51, s46, 65664
    buffer_load_dwordx4 v254, s[16:19], s51 offen nt lds
    v_mfma_f32_16x16x32_bf16 v[60:63], v[240:243], v[228:231], v[60:63]
    v_mfma_f32_16x16x32_bf16 v[64:67], v[240:243], v[232:235], v[64:67]
    v_mfma_f32_16x16x32_bf16 v[68:71], v[240:243], v[236:239], v[68:71]
    s_waitcnt lgkmcnt(0)
    v_mfma_f32_16x16x32_bf16 v[72:75], v[244:247], v[216:219], v[72:75]
    s_add_u32 m0, s50, 94208
    s_add_u32 s51, s46, 73728
    buffer_load_dwordx4 v253, s[12:15], s51 offen nt lds
    v_mfma_f32_16x16x32_bf16 v[76:79], v[244:247], v[220:223], v[76:79]
    v_mfma_f32_16x16x32_bf16 v[80:83], v[244:247], v[224:227], v[80:83]
    v_mfma_f32_16x16x32_bf16 v[84:87], v[244:247], v[228:231], v[84:87]
    s_add_u32 m0, s50, 98304
    s_add_u32 s51, s46, 73856
    buffer_load_dwordx4 v253, s[12:15], s51 offen nt lds
    v_mfma_f32_16x16x32_bf16 v[88:91], v[244:247], v[232:235], v[88:91]
    v_mfma_f32_16x16x32_bf16 v[92:95], v[244:247], v[236:239], v[92:95]
    s_waitcnt vmcnt(4)
    s_waitcnt lgkmcnt(0)
    s_barrier
    ds_read_b64_tr_b16 v[240:241], v248 offset:16384
    ds_read_b64_tr_b16 v[242:243], v248 offset:18432
    ds_read_b64_tr_b16 v[244:245], v248 offset:20480
    ds_read_b64_tr_b16 v[246:247], v248 offset:22528
    s_add_u32 m0, s50, 49152
    s_add_u32 s51, s64, 73728
    buffer_load_dwordx4 v252, s[24:27], s51 offen lds
    s_add_u32 m0, s50, 53248
    s_add_u32 s51, s65, 73728
    buffer_load_dwordx4 v252, s[24:27], s51 offen lds
    s_waitcnt lgkmcnt(2)
    v_mfma_f32_16x16x32_bf16 v[96:99], v[240:243], v[216:219], v[96:99]
    v_mfma_f32_16x16x32_bf16 v[100:103], v[240:243], v[220:223], v[100:103]
    s_add_u32 m0, s50, 57344
    s_add_u32 s51, s66, 73728
    buffer_load_dwordx4 v252, s[24:27], s51 offen lds
    v_mfma_f32_16x16x32_bf16 v[104:107], v[240:243], v[224:227], v[104:107]
    v_mfma_f32_16x16x32_bf16 v[108:111], v[240:243], v[228:231], v[108:111]
    v_mfma_f32_16x16x32_bf16 v[112:115], v[240:243], v[232:235], v[112:115]
    v_mfma_f32_16x16x32_bf16 v[116:119], v[240:243], v[236:239], v[116:119]
    ds_read_b64_tr_b16 v[240:241], v248 offset:24576
    ds_read_b64_tr_b16 v[242:243], v248 offset:26624
    s_waitcnt lgkmcnt(2)
    v_mfma_f32_16x16x32_bf16 v[120:123], v[244:247], v[216:219], v[120:123]
    s_add_u32 m0, s50, 61440
    s_add_u32 s51, s67, 73728
    buffer_load_dwordx4 v252, s[24:27], s51 offen lds
    v_mfma_f32_16x16x32_bf16 v[124:127], v[244:247], v[220:223], v[124:127]
    v_mfma_f32_16x16x32_bf16 v[128:131], v[244:247], v[224:227], v[128:131]
    v_mfma_f32_16x16x32_bf16 v[132:135], v[244:247], v[228:231], v[132:135]
    v_mfma_f32_16x16x32_bf16 v[136:139], v[244:247], v[232:235], v[136:139]
    v_mfma_f32_16x16x32_bf16 v[140:143], v[244:247], v[236:239], v[140:143]
    ds_read_b64_tr_b16 v[244:245], v248 offset:28672
    ds_read_b64_tr_b16 v[246:247], v248 offset:30720
    s_add_u32 m0, s50, 102400
    s_add_u32 s51, s46, 73728
    buffer_load_dwordx4 v254, s[16:19], s51 offen nt lds
    s_waitcnt lgkmcnt(2)
    v_mfma_f32_16x16x32_bf16 v[144:147], v[240:243], v[216:219], v[144:147]
    v_mfma_f32_16x16x32_bf16 v[148:151], v[240:243], v[220:223], v[148:151]
    v_mfma_f32_16x16x32_bf16 v[152:155], v[240:243], v[224:227], v[152:155]
    v_mfma_f32_16x16x32_bf16 v[156:159], v[240:243], v[228:231], v[156:159]
    v_mfma_f32_16x16x32_bf16 v[160:163], v[240:243], v[232:235], v[160:163]
    s_add_u32 m0, s50, 106496
    s_add_u32 s51, s46, 73856
    buffer_load_dwordx4 v254, s[16:19], s51 offen nt lds
    v_mfma_f32_16x16x32_bf16 v[164:167], v[240:243], v[236:239], v[164:167]
    ds_read_b64_tr_b16 v[240:241], v248 offset:32768
    ds_read_b64_tr_b16 v[242:243], v248 offset:34816
    s_waitcnt lgkmcnt(2)
    v_mfma_f32_16x16x32_bf16 v[168:171], v[244:247], v[216:219], v[168:171]
    v_mfma_f32_16x16x32_bf16 v[172:175], v[244:247], v[220:223], v[172:175]
    v_mfma_f32_16x16x32_bf16 v[176:179], v[244:247], v[224:227], v[176:179]
    v_mfma_f32_16x16x32_bf16 v[180:183], v[244:247], v[228:231], v[180:183]
    s_add_u32 m0, s50, 110592
    s_add_u32 s51, s46, 81920
    buffer_load_dwordx4 v253, s[12:15], s51 offen nt lds
    v_mfma_f32_16x16x32_bf16 v[184:187], v[244:247], v[232:235], v[184:187]
    v_mfma_f32_16x16x32_bf16 v[188:191], v[244:247], v[236:239], v[188:191]
    s_waitcnt lgkmcnt(0)
    v_mfma_f32_16x16x32_bf16 v[192:195], v[240:243], v[216:219], v[192:195]
    v_mfma_f32_16x16x32_bf16 v[196:199], v[240:243], v[220:223], v[196:199]
    v_mfma_f32_16x16x32_bf16 v[200:203], v[240:243], v[224:227], v[200:203]
    s_add_u32 m0, s50, 114688
    s_add_u32 s51, s46, 82048
    buffer_load_dwordx4 v253, s[12:15], s51 offen nt lds
    v_mfma_f32_16x16x32_bf16 v[204:207], v[240:243], v[228:231], v[204:207]
    v_mfma_f32_16x16x32_bf16 v[208:211], v[240:243], v[232:235], v[208:211]
    v_mfma_f32_16x16x32_bf16 v[212:215], v[240:243], v[236:239], v[212:215]
    s_waitcnt vmcnt(4)
    s_waitcnt lgkmcnt(0)
    s_barrier
    ds_read_b64_tr_b16 v[240:241], v248 offset:0
    ds_read_b64_tr_b16 v[242:243], v248 offset:2048
    ds_read_b128 v[216:219], v249 offset:12288
    ds_read_b128 v[220:223], v249 offset:13312
    ds_read_b128 v[224:227], v249 offset:14336
    ds_read_b128 v[228:231], v249 offset:15360
    ds_read_b128 v[232:235], v249 offset:16384
    ds_read_b128 v[236:239], v249 offset:17408
    ds_read_b64_tr_b16 v[244:245], v248 offset:4096
    ds_read_b64_tr_b16 v[246:247], v248 offset:6144
    s_add_u32 m0, s50, 65536
    s_add_u32 s51, s68, 73728
    buffer_load_dwordx4 v252, s[24:27], s51 offen lds
    s_add_u32 m0, s50, 69632
    s_add_u32 s51, s69, 73728
    buffer_load_dwordx4 v252, s[24:27], s51 offen lds
    s_waitcnt lgkmcnt(7)
    v_mfma_f32_16x16x32_bf16 v[0:3], v[240:243], v[216:219], v[0:3]
    s_waitcnt lgkmcnt(6)
    v_mfma_f32_16x16x32_bf16 v[4:7], v[240:243], v[220:223], v[4:7]
    s_add_u32 m0, s50, 73728
    s_add_u32 s51, s70, 73728
    buffer_load_dwordx4 v252, s[24:27], s51 offen lds
    s_waitcnt lgkmcnt(5)
    v_mfma_f32_16x16x32_bf16 v[8:11], v[240:243], v[224:227], v[8:11]
    s_waitcnt lgkmcnt(4)
    v_mfma_f32_16x16x32_bf16 v[12:15], v[240:243], v[228:231], v[12:15]
    s_waitcnt lgkmcnt(3)
    v_mfma_f32_16x16x32_bf16 v[16:19], v[240:243], v[232:235], v[16:19]
    s_add_u32 m0, s50, 77824
    s_add_u32 s51, s71, 73728
    buffer_load_dwordx4 v252, s[24:27], s51 offen lds
    s_waitcnt lgkmcnt(2)
    v_mfma_f32_16x16x32_bf16 v[20:23], v[240:243], v[236:239], v[20:23]
    ds_read_b64_tr_b16 v[240:241], v248 offset:8192
    ds_read_b64_tr_b16 v[242:243], v248 offset:10240
    s_waitcnt lgkmcnt(2)
    v_mfma_f32_16x16x32_bf16 v[24:27], v[244:247], v[216:219], v[24:27]
    v_mfma_f32_16x16x32_bf16 v[28:31], v[244:247], v[220:223], v[28:31]
    s_add_u32 m0, s50, 81920
    s_add_u32 s51, s72, 73728
    buffer_load_dwordx4 v252, s[24:27], s51 offen lds
    v_mfma_f32_16x16x32_bf16 v[32:35], v[244:247], v[224:227], v[32:35]
    v_mfma_f32_16x16x32_bf16 v[36:39], v[244:247], v[228:231], v[36:39]
    v_mfma_f32_16x16x32_bf16 v[40:43], v[244:247], v[232:235], v[40:43]
    v_mfma_f32_16x16x32_bf16 v[44:47], v[244:247], v[236:239], v[44:47]
    ds_read_b64_tr_b16 v[244:245], v248 offset:12288
    ds_read_b64_tr_b16 v[246:247], v248 offset:14336
    s_add_u32 m0, s50, 118784
    s_add_u32 s51, s46, 81920
    buffer_load_dwordx4 v254, s[16:19], s51 offen nt lds
    s_waitcnt lgkmcnt(2)
    v_mfma_f32_16x16x32_bf16 v[48:51], v[240:243], v[216:219], v[48:51]
    v_mfma_f32_16x16x32_bf16 v[52:55], v[240:243], v[220:223], v[52:55]
    v_mfma_f32_16x16x32_bf16 v[56:59], v[240:243], v[224:227], v[56:59]
    s_add_u32 m0, s50, 122880
    s_add_u32 s51, s46, 82048
    buffer_load_dwordx4 v254, s[16:19], s51 offen nt lds
    v_mfma_f32_16x16x32_bf16 v[60:63], v[240:243], v[228:231], v[60:63]
    v_mfma_f32_16x16x32_bf16 v[64:67], v[240:243], v[232:235], v[64:67]
    v_mfma_f32_16x16x32_bf16 v[68:71], v[240:243], v[236:239], v[68:71]
    s_waitcnt lgkmcnt(0)
    v_mfma_f32_16x16x32_bf16 v[72:75], v[244:247], v[216:219], v[72:75]
    s_add_u32 m0, s50, 126976
    s_add_u32 s51, s46, 90112
    buffer_load_dwordx4 v253, s[12:15], s51 offen nt lds
    v_mfma_f32_16x16x32_bf16 v[76:79], v[244:247], v[220:223], v[76:79]
    v_mfma_f32_16x16x32_bf16 v[80:83], v[244:247], v[224:227], v[80:83]
    v_mfma_f32_16x16x32_bf16 v[84:87], v[244:247], v[228:231], v[84:87]
    s_add_u32 m0, s50, 131072
    s_add_u32 s51, s46, 90240
    buffer_load_dwordx4 v253, s[12:15], s51 offen nt lds
    v_mfma_f32_16x16x32_bf16 v[88:91], v[244:247], v[232:235], v[88:91]
    v_mfma_f32_16x16x32_bf16 v[92:95], v[244:247], v[236:239], v[92:95]
    s_waitcnt vmcnt(4)
    s_waitcnt lgkmcnt(0)
    s_barrier
    ds_read_b64_tr_b16 v[240:241], v248 offset:16384
    ds_read_b64_tr_b16 v[242:243], v248 offset:18432
    ds_read_b64_tr_b16 v[244:245], v248 offset:20480
    ds_read_b64_tr_b16 v[246:247], v248 offset:22528
    s_add_u32 m0, s50, 49152
    s_add_u32 s51, s64, 221184
    buffer_load_dwordx4 v252, s[24:27], s51 offen lds
    s_add_u32 m0, s50, 53248
    s_add_u32 s51, s65, 221184
    buffer_load_dwordx4 v252, s[24:27], s51 offen lds
    s_waitcnt lgkmcnt(2)
    v_mfma_f32_16x16x32_bf16 v[96:99], v[240:243], v[216:219], v[96:99]
    v_mfma_f32_16x16x32_bf16 v[100:103], v[240:243], v[220:223], v[100:103]
    s_add_u32 m0, s50, 57344
    s_add_u32 s51, s66, 221184
    buffer_load_dwordx4 v252, s[24:27], s51 offen lds
    v_mfma_f32_16x16x32_bf16 v[104:107], v[240:243], v[224:227], v[104:107]
    v_mfma_f32_16x16x32_bf16 v[108:111], v[240:243], v[228:231], v[108:111]
    v_mfma_f32_16x16x32_bf16 v[112:115], v[240:243], v[232:235], v[112:115]
    v_mfma_f32_16x16x32_bf16 v[116:119], v[240:243], v[236:239], v[116:119]
    ds_read_b64_tr_b16 v[240:241], v248 offset:24576
    ds_read_b64_tr_b16 v[242:243], v248 offset:26624
    s_waitcnt lgkmcnt(2)
    v_mfma_f32_16x16x32_bf16 v[120:123], v[244:247], v[216:219], v[120:123]
    s_add_u32 m0, s50, 61440
    s_add_u32 s51, s67, 221184
    buffer_load_dwordx4 v252, s[24:27], s51 offen lds
    v_mfma_f32_16x16x32_bf16 v[124:127], v[244:247], v[220:223], v[124:127]
    v_mfma_f32_16x16x32_bf16 v[128:131], v[244:247], v[224:227], v[128:131]
    v_mfma_f32_16x16x32_bf16 v[132:135], v[244:247], v[228:231], v[132:135]
    v_mfma_f32_16x16x32_bf16 v[136:139], v[244:247], v[232:235], v[136:139]
    v_mfma_f32_16x16x32_bf16 v[140:143], v[244:247], v[236:239], v[140:143]
    ds_read_b64_tr_b16 v[244:245], v248 offset:28672
    ds_read_b64_tr_b16 v[246:247], v248 offset:30720
    s_add_u32 m0, s50, 135168
    s_add_u32 s51, s46, 90112
    buffer_load_dwordx4 v254, s[16:19], s51 offen nt lds
    s_waitcnt lgkmcnt(2)
    v_mfma_f32_16x16x32_bf16 v[144:147], v[240:243], v[216:219], v[144:147]
    v_mfma_f32_16x16x32_bf16 v[148:151], v[240:243], v[220:223], v[148:151]
    v_mfma_f32_16x16x32_bf16 v[152:155], v[240:243], v[224:227], v[152:155]
    v_mfma_f32_16x16x32_bf16 v[156:159], v[240:243], v[228:231], v[156:159]
    v_mfma_f32_16x16x32_bf16 v[160:163], v[240:243], v[232:235], v[160:163]
    s_add_u32 m0, s50, 139264
    s_add_u32 s51, s46, 90240
    buffer_load_dwordx4 v254, s[16:19], s51 offen nt lds
    v_mfma_f32_16x16x32_bf16 v[164:167], v[240:243], v[236:239], v[164:167]
    ds_read_b64_tr_b16 v[240:241], v248 offset:32768
    ds_read_b64_tr_b16 v[242:243], v248 offset:34816
    s_waitcnt lgkmcnt(2)
    v_mfma_f32_16x16x32_bf16 v[168:171], v[244:247], v[216:219], v[168:171]
    v_mfma_f32_16x16x32_bf16 v[172:175], v[244:247], v[220:223], v[172:175]
    v_mfma_f32_16x16x32_bf16 v[176:179], v[244:247], v[224:227], v[176:179]
    v_mfma_f32_16x16x32_bf16 v[180:183], v[244:247], v[228:231], v[180:183]
    s_add_u32 m0, s50, 143360
    s_add_u32 s51, s46, 98304
    buffer_load_dwordx4 v253, s[12:15], s51 offen nt lds
    v_mfma_f32_16x16x32_bf16 v[184:187], v[244:247], v[232:235], v[184:187]
    v_mfma_f32_16x16x32_bf16 v[188:191], v[244:247], v[236:239], v[188:191]
    s_waitcnt lgkmcnt(0)
    v_mfma_f32_16x16x32_bf16 v[192:195], v[240:243], v[216:219], v[192:195]
    v_mfma_f32_16x16x32_bf16 v[196:199], v[240:243], v[220:223], v[196:199]
    v_mfma_f32_16x16x32_bf16 v[200:203], v[240:243], v[224:227], v[200:203]
    s_add_u32 m0, s50, 147456
    s_add_u32 s51, s46, 98432
    buffer_load_dwordx4 v253, s[12:15], s51 offen nt lds
    v_mfma_f32_16x16x32_bf16 v[204:207], v[240:243], v[228:231], v[204:207]
    v_mfma_f32_16x16x32_bf16 v[208:211], v[240:243], v[232:235], v[208:211]
    v_mfma_f32_16x16x32_bf16 v[212:215], v[240:243], v[236:239], v[212:215]
    s_waitcnt vmcnt(4)
    s_waitcnt lgkmcnt(0)
    s_barrier
    ds_read_b64_tr_b16 v[240:241], v248 offset:0
    ds_read_b64_tr_b16 v[242:243], v248 offset:2048
    ds_read_b128 v[216:219], v249 offset:36864
    ds_read_b128 v[220:223], v249 offset:37888
    ds_read_b128 v[224:227], v249 offset:38912
    ds_read_b128 v[228:231], v249 offset:39936
    ds_read_b128 v[232:235], v249 offset:40960
    ds_read_b128 v[236:239], v249 offset:41984
    ds_read_b64_tr_b16 v[244:245], v248 offset:4096
    ds_read_b64_tr_b16 v[246:247], v248 offset:6144
    s_add_u32 m0, s50, 65536
    s_add_u32 s51, s68, 221184
    buffer_load_dwordx4 v252, s[24:27], s51 offen lds
    s_add_u32 m0, s50, 69632
    s_add_u32 s51, s69, 221184
    buffer_load_dwordx4 v252, s[24:27], s51 offen lds
    s_waitcnt lgkmcnt(7)
    v_mfma_f32_16x16x32_bf16 v[0:3], v[240:243], v[216:219], v[0:3]
    s_waitcnt lgkmcnt(6)
    v_mfma_f32_16x16x32_bf16 v[4:7], v[240:243], v[220:223], v[4:7]
    s_add_u32 m0, s50, 73728
    s_add_u32 s51, s70, 221184
    buffer_load_dwordx4 v252, s[24:27], s51 offen lds
    s_waitcnt lgkmcnt(5)
    v_mfma_f32_16x16x32_bf16 v[8:11], v[240:243], v[224:227], v[8:11]
    s_waitcnt lgkmcnt(4)
    v_mfma_f32_16x16x32_bf16 v[12:15], v[240:243], v[228:231], v[12:15]
    s_waitcnt lgkmcnt(3)
    v_mfma_f32_16x16x32_bf16 v[16:19], v[240:243], v[232:235], v[16:19]
    s_add_u32 m0, s50, 77824
    s_add_u32 s51, s71, 221184
    buffer_load_dwordx4 v252, s[24:27], s51 offen lds
    s_waitcnt lgkmcnt(2)
    v_mfma_f32_16x16x32_bf16 v[20:23], v[240:243], v[236:239], v[20:23]
    ds_read_b64_tr_b16 v[240:241], v248 offset:8192
    ds_read_b64_tr_b16 v[242:243], v248 offset:10240
    s_waitcnt lgkmcnt(2)
    v_mfma_f32_16x16x32_bf16 v[24:27], v[244:247], v[216:219], v[24:27]
    v_mfma_f32_16x16x32_bf16 v[28:31], v[244:247], v[220:223], v[28:31]
    s_add_u32 m0, s50, 81920
    s_add_u32 s51, s72, 221184
    buffer_load_dwordx4 v252, s[24:27], s51 offen lds
    v_mfma_f32_16x16x32_bf16 v[32:35], v[244:247], v[224:227], v[32:35]
    v_mfma_f32_16x16x32_bf16 v[36:39], v[244:247], v[228:231], v[36:39]
    v_mfma_f32_16x16x32_bf16 v[40:43], v[244:247], v[232:235], v[40:43]
    v_mfma_f32_16x16x32_bf16 v[44:47], v[244:247], v[236:239], v[44:47]
    ds_read_b64_tr_b16 v[244:245], v248 offset:12288
    ds_read_b64_tr_b16 v[246:247], v248 offset:14336
    s_add_u32 m0, s50, 86016
    s_add_u32 s51, s46, 98304
    buffer_load_dwordx4 v254, s[16:19], s51 offen nt lds
    s_waitcnt lgkmcnt(2)
    v_mfma_f32_16x16x32_bf16 v[48:51], v[240:243], v[216:219], v[48:51]
    v_mfma_f32_16x16x32_bf16 v[52:55], v[240:243], v[220:223], v[52:55]
    v_mfma_f32_16x16x32_bf16 v[56:59], v[240:243], v[224:227], v[56:59]
    s_add_u32 m0, s50, 90112
    s_add_u32 s51, s46, 98432
    buffer_load_dwordx4 v254, s[16:19], s51 offen nt lds
    v_mfma_f32_16x16x32_bf16 v[60:63], v[240:243], v[228:231], v[60:63]
    v_mfma_f32_16x16x32_bf16 v[64:67], v[240:243], v[232:235], v[64:67]
    v_mfma_f32_16x16x32_bf16 v[68:71], v[240:243], v[236:239], v[68:71]
    s_waitcnt lgkmcnt(0)
    v_mfma_f32_16x16x32_bf16 v[72:75], v[244:247], v[216:219], v[72:75]
    s_add_u32 m0, s50, 94208
    s_add_u32 s51, s46, 106496
    buffer_load_dwordx4 v253, s[12:15], s51 offen nt lds
    v_mfma_f32_16x16x32_bf16 v[76:79], v[244:247], v[220:223], v[76:79]
    v_mfma_f32_16x16x32_bf16 v[80:83], v[244:247], v[224:227], v[80:83]
    v_mfma_f32_16x16x32_bf16 v[84:87], v[244:247], v[228:231], v[84:87]
    s_add_u32 m0, s50, 98304
    s_add_u32 s51, s46, 106624
    buffer_load_dwordx4 v253, s[12:15], s51 offen nt lds
    v_mfma_f32_16x16x32_bf16 v[88:91], v[244:247], v[232:235], v[88:91]
    v_mfma_f32_16x16x32_bf16 v[92:95], v[244:247], v[236:239], v[92:95]
    s_waitcnt vmcnt(4)
    s_waitcnt lgkmcnt(0)
    s_barrier
    ds_read_b64_tr_b16 v[240:241], v248 offset:16384
    ds_read_b64_tr_b16 v[242:243], v248 offset:18432
    ds_read_b64_tr_b16 v[244:245], v248 offset:20480
    ds_read_b64_tr_b16 v[246:247], v248 offset:22528
    s_add_u32 m0, s50, 49152
    s_add_u32 s51, s64, 110592
    buffer_load_dwordx4 v252, s[24:27], s51 offen lds
    s_add_u32 m0, s50, 53248
    s_add_u32 s51, s65, 110592
    buffer_load_dwordx4 v252, s[24:27], s51 offen lds
    s_waitcnt lgkmcnt(2)
    v_mfma_f32_16x16x32_bf16 v[96:99], v[240:243], v[216:219], v[96:99]
    v_mfma_f32_16x16x32_bf16 v[100:103], v[240:243], v[220:223], v[100:103]
    s_add_u32 m0, s50, 57344
    s_add_u32 s51, s66, 110592
    buffer_load_dwordx4 v252, s[24:27], s51 offen lds
    v_mfma_f32_16x16x32_bf16 v[104:107], v[240:243], v[224:227], v[104:107]
    v_mfma_f32_16x16x32_bf16 v[108:111], v[240:243], v[228:231], v[108:111]
    v_mfma_f32_16x16x32_bf16 v[112:115], v[240:243], v[232:235], v[112:115]
    v_mfma_f32_16x16x32_bf16 v[116:119], v[240:243], v[236:239], v[116:119]
    ds_read_b64_tr_b16 v[240:241], v248 offset:24576
    ds_read_b64_tr_b16 v[242:243], v248 offset:26624
    s_waitcnt lgkmcnt(2)
    v_mfma_f32_16x16x32_bf16 v[120:123], v[244:247], v[216:219], v[120:123]
    s_add_u32 m0, s50, 61440
    s_add_u32 s51, s67, 110592
    buffer_load_dwordx4 v252, s[24:27], s51 offen lds
    v_mfma_f32_16x16x32_bf16 v[124:127], v[244:247], v[220:223], v[124:127]
    v_mfma_f32_16x16x32_bf16 v[128:131], v[244:247], v[224:227], v[128:131]
    v_mfma_f32_16x16x32_bf16 v[132:135], v[244:247], v[228:231], v[132:135]
    v_mfma_f32_16x16x32_bf16 v[136:139], v[244:247], v[232:235], v[136:139]
    v_mfma_f32_16x16x32_bf16 v[140:143], v[244:247], v[236:239], v[140:143]
    ds_read_b64_tr_b16 v[244:245], v248 offset:28672
    ds_read_b64_tr_b16 v[246:247], v248 offset:30720
    s_add_u32 m0, s50, 102400
    s_add_u32 s51, s46, 106496
    buffer_load_dwordx4 v254, s[16:19], s51 offen nt lds
    s_waitcnt lgkmcnt(2)
    v_mfma_f32_16x16x32_bf16 v[144:147], v[240:243], v[216:219], v[144:147]
    v_mfma_f32_16x16x32_bf16 v[148:151], v[240:243], v[220:223], v[148:151]
    v_mfma_f32_16x16x32_bf16 v[152:155], v[240:243], v[224:227], v[152:155]
    v_mfma_f32_16x16x32_bf16 v[156:159], v[240:243], v[228:231], v[156:159]
    v_mfma_f32_16x16x32_bf16 v[160:163], v[240:243], v[232:235], v[160:163]
    s_add_u32 m0, s50, 106496
    s_add_u32 s51, s46, 106624
    buffer_load_dwordx4 v254, s[16:19], s51 offen nt lds
    v_mfma_f32_16x16x32_bf16 v[164:167], v[240:243], v[236:239], v[164:167]
    ds_read_b64_tr_b16 v[240:241], v248 offset:32768
    ds_read_b64_tr_b16 v[242:243], v248 offset:34816
    s_waitcnt lgkmcnt(2)
    v_mfma_f32_16x16x32_bf16 v[168:171], v[244:247], v[216:219], v[168:171]
    v_mfma_f32_16x16x32_bf16 v[172:175], v[244:247], v[220:223], v[172:175]
    v_mfma_f32_16x16x32_bf16 v[176:179], v[244:247], v[224:227], v[176:179]
    v_mfma_f32_16x16x32_bf16 v[180:183], v[244:247], v[228:231], v[180:183]
    s_add_u32 m0, s50, 110592
    s_add_u32 s51, s46, 114688
    buffer_load_dwordx4 v253, s[12:15], s51 offen nt lds
    v_mfma_f32_16x16x32_bf16 v[184:187], v[244:247], v[232:235], v[184:187]
    v_mfma_f32_16x16x32_bf16 v[188:191], v[244:247], v[236:239], v[188:191]
    s_waitcnt lgkmcnt(0)
    v_mfma_f32_16x16x32_bf16 v[192:195], v[240:243], v[216:219], v[192:195]
    v_mfma_f32_16x16x32_bf16 v[196:199], v[240:243], v[220:223], v[196:199]
    v_mfma_f32_16x16x32_bf16 v[200:203], v[240:243], v[224:227], v[200:203]
    s_add_u32 m0, s50, 114688
    s_add_u32 s51, s46, 114816
    buffer_load_dwordx4 v253, s[12:15], s51 offen nt lds
    v_mfma_f32_16x16x32_bf16 v[204:207], v[240:243], v[228:231], v[204:207]
    v_mfma_f32_16x16x32_bf16 v[208:211], v[240:243], v[232:235], v[208:211]
    v_mfma_f32_16x16x32_bf16 v[212:215], v[240:243], v[236:239], v[212:215]
    s_waitcnt vmcnt(4)
    s_waitcnt lgkmcnt(0)
    s_barrier
    ds_read_b64_tr_b16 v[240:241], v248 offset:0
    ds_read_b64_tr_b16 v[242:243], v248 offset:2048
    ds_read_b128 v[216:219], v249 offset:18432
    ds_read_b128 v[220:223], v249 offset:19456
    ds_read_b128 v[224:227], v249 offset:20480
    ds_read_b128 v[228:231], v249 offset:21504
    ds_read_b128 v[232:235], v249 offset:22528
    ds_read_b128 v[236:239], v249 offset:23552
    ds_read_b64_tr_b16 v[244:245], v248 offset:4096
    ds_read_b64_tr_b16 v[246:247], v248 offset:6144
    s_add_u32 m0, s50, 65536
    s_add_u32 s51, s68, 110592
    buffer_load_dwordx4 v252, s[24:27], s51 offen lds
    s_add_u32 m0, s50, 69632
    s_add_u32 s51, s69, 110592
    buffer_load_dwordx4 v252, s[24:27], s51 offen lds
    s_waitcnt lgkmcnt(7)
    v_mfma_f32_16x16x32_bf16 v[0:3], v[240:243], v[216:219], v[0:3]
    s_waitcnt lgkmcnt(6)
    v_mfma_f32_16x16x32_bf16 v[4:7], v[240:243], v[220:223], v[4:7]
    s_add_u32 m0, s50, 73728
    s_add_u32 s51, s70, 110592
    buffer_load_dwordx4 v252, s[24:27], s51 offen lds
    s_waitcnt lgkmcnt(5)
    v_mfma_f32_16x16x32_bf16 v[8:11], v[240:243], v[224:227], v[8:11]
    s_waitcnt lgkmcnt(4)
    v_mfma_f32_16x16x32_bf16 v[12:15], v[240:243], v[228:231], v[12:15]
    s_waitcnt lgkmcnt(3)
    v_mfma_f32_16x16x32_bf16 v[16:19], v[240:243], v[232:235], v[16:19]
    s_add_u32 m0, s50, 77824
    s_add_u32 s51, s71, 110592
    buffer_load_dwordx4 v252, s[24:27], s51 offen lds
    s_waitcnt lgkmcnt(2)
    v_mfma_f32_16x16x32_bf16 v[20:23], v[240:243], v[236:239], v[20:23]
    ds_read_b64_tr_b16 v[240:241], v248 offset:8192
    ds_read_b64_tr_b16 v[242:243], v248 offset:10240
    s_waitcnt lgkmcnt(2)
    v_mfma_f32_16x16x32_bf16 v[24:27], v[244:247], v[216:219], v[24:27]
    v_mfma_f32_16x16x32_bf16 v[28:31], v[244:247], v[220:223], v[28:31]
    s_add_u32 m0, s50, 81920
    s_add_u32 s51, s72, 110592
    buffer_load_dwordx4 v252, s[24:27], s51 offen lds
    v_mfma_f32_16x16x32_bf16 v[32:35], v[244:247], v[224:227], v[32:35]
    v_mfma_f32_16x16x32_bf16 v[36:39], v[244:247], v[228:231], v[36:39]
    v_mfma_f32_16x16x32_bf16 v[40:43], v[244:247], v[232:235], v[40:43]
    v_mfma_f32_16x16x32_bf16 v[44:47], v[244:247], v[236:239], v[44:47]
    ds_read_b64_tr_b16 v[244:245], v248 offset:12288
    ds_read_b64_tr_b16 v[246:247], v248 offset:14336
    s_add_u32 m0, s50, 118784
    s_add_u32 s51, s46, 114688
    buffer_load_dwordx4 v254, s[16:19], s51 offen nt lds
    s_waitcnt lgkmcnt(2)
    v_mfma_f32_16x16x32_bf16 v[48:51], v[240:243], v[216:219], v[48:51]
    v_mfma_f32_16x16x32_bf16 v[52:55], v[240:243], v[220:223], v[52:55]
    v_mfma_f32_16x16x32_bf16 v[56:59], v[240:243], v[224:227], v[56:59]
    s_add_u32 m0, s50, 122880
    s_add_u32 s51, s46, 114816
    buffer_load_dwordx4 v254, s[16:19], s51 offen nt lds
    v_mfma_f32_16x16x32_bf16 v[60:63], v[240:243], v[228:231], v[60:63]
    v_mfma_f32_16x16x32_bf16 v[64:67], v[240:243], v[232:235], v[64:67]
    v_mfma_f32_16x16x32_bf16 v[68:71], v[240:243], v[236:239], v[68:71]
    s_waitcnt lgkmcnt(0)
    v_mfma_f32_16x16x32_bf16 v[72:75], v[244:247], v[216:219], v[72:75]
    s_add_u32 m0, s50, 126976
    s_add_u32 s51, s46, 122880
    buffer_load_dwordx4 v253, s[12:15], s51 offen nt lds
    v_mfma_f32_16x16x32_bf16 v[76:79], v[244:247], v[220:223], v[76:79]
    v_mfma_f32_16x16x32_bf16 v[80:83], v[244:247], v[224:227], v[80:83]
    v_mfma_f32_16x16x32_bf16 v[84:87], v[244:247], v[228:231], v[84:87]
    s_add_u32 m0, s50, 131072
    s_add_u32 s51, s46, 123008
    buffer_load_dwordx4 v253, s[12:15], s51 offen nt lds
    v_mfma_f32_16x16x32_bf16 v[88:91], v[244:247], v[232:235], v[88:91]
    v_mfma_f32_16x16x32_bf16 v[92:95], v[244:247], v[236:239], v[92:95]
    s_waitcnt vmcnt(4)
    s_waitcnt lgkmcnt(0)
    s_barrier
    ds_read_b64_tr_b16 v[240:241], v248 offset:16384
    ds_read_b64_tr_b16 v[242:243], v248 offset:18432
    ds_read_b64_tr_b16 v[244:245], v248 offset:20480
    ds_read_b64_tr_b16 v[246:247], v248 offset:22528
    s_add_u32 m0, s50, 49152
    s_add_u32 s51, s64, 258048
    buffer_load_dwordx4 v252, s[24:27], s51 offen lds
    s_add_u32 m0, s50, 53248
    s_add_u32 s51, s65, 258048
    buffer_load_dwordx4 v252, s[24:27], s51 offen lds
    s_waitcnt lgkmcnt(2)
    v_mfma_f32_16x16x32_bf16 v[96:99], v[240:243], v[216:219], v[96:99]
    v_mfma_f32_16x16x32_bf16 v[100:103], v[240:243], v[220:223], v[100:103]
    s_add_u32 m0, s50, 57344
    s_add_u32 s51, s66, 258048
    buffer_load_dwordx4 v252, s[24:27], s51 offen lds
    v_mfma_f32_16x16x32_bf16 v[104:107], v[240:243], v[224:227], v[104:107]
    v_mfma_f32_16x16x32_bf16 v[108:111], v[240:243], v[228:231], v[108:111]
    v_mfma_f32_16x16x32_bf16 v[112:115], v[240:243], v[232:235], v[112:115]
    v_mfma_f32_16x16x32_bf16 v[116:119], v[240:243], v[236:239], v[116:119]
    ds_read_b64_tr_b16 v[240:241], v248 offset:24576
    ds_read_b64_tr_b16 v[242:243], v248 offset:26624
    s_add_u32 m0, s50, 61440
    s_add_u32 s51, s67, 258048
    buffer_load_dwordx4 v252, s[24:27], s51 offen lds
    s_waitcnt lgkmcnt(2)
    v_mfma_f32_16x16x32_bf16 v[120:123], v[244:247], v[216:219], v[120:123]
    v_mfma_f32_16x16x32_bf16 v[124:127], v[244:247], v[220:223], v[124:127]
    v_mfma_f32_16x16x32_bf16 v[128:131], v[244:247], v[224:227], v[128:131]
    v_mfma_f32_16x16x32_bf16 v[132:135], v[244:247], v[228:231], v[132:135]
    s_add_u32 m0, s50, 135168
    s_add_u32 s51, s46, 122880
    buffer_load_dwordx4 v254, s[16:19], s51 offen nt lds
    v_mfma_f32_16x16x32_bf16 v[136:139], v[244:247], v[232:235], v[136:139]
    v_mfma_f32_16x16x32_bf16 v[140:143], v[244:247], v[236:239], v[140:143]
    ds_read_b64_tr_b16 v[244:245], v248 offset:28672
    ds_read_b64_tr_b16 v[246:247], v248 offset:30720
    s_waitcnt lgkmcnt(2)
    v_mfma_f32_16x16x32_bf16 v[144:147], v[240:243], v[216:219], v[144:147]
    v_mfma_f32_16x16x32_bf16 v[148:151], v[240:243], v[220:223], v[148:151]
    s_add_u32 m0, s50, 139264
    s_add_u32 s51, s46, 123008
    buffer_load_dwordx4 v254, s[16:19], s51 offen nt lds
    v_mfma_f32_16x16x32_bf16 v[152:155], v[240:243], v[224:227], v[152:155]
    v_mfma_f32_16x16x32_bf16 v[156:159], v[240:243], v[228:231], v[156:159]
    v_mfma_f32_16x16x32_bf16 v[160:163], v[240:243], v[232:235], v[160:163]
    v_mfma_f32_16x16x32_bf16 v[164:167], v[240:243], v[236:239], v[164:167]
    ds_read_b64_tr_b16 v[240:241], v248 offset:32768
    ds_read_b64_tr_b16 v[242:243], v248 offset:34816
    s_waitcnt lgkmcnt(2)
    v_mfma_f32_16x16x32_bf16 v[168:171], v[244:247], v[216:219], v[168:171]
    s_add_u32 m0, s50, 147456
    s_add_u32 s51, s49, 0
    buffer_load_dwordx4 v251, s[8:11], s51 offen lds
    v_mfma_f32_16x16x32_bf16 v[172:175], v[244:247], v[220:223], v[172:175]
    v_mfma_f32_16x16x32_bf16 v[176:179], v[244:247], v[224:227], v[176:179]
    v_mfma_f32_16x16x32_bf16 v[180:183], v[244:247], v[228:231], v[180:183]
    v_mfma_f32_16x16x32_bf16 v[184:187], v[244:247], v[232:235], v[184:187]
    s_add_u32 m0, s50, 151552
    s_add_u32 s51, s49, 36864
    buffer_load_dwordx4 v251, s[8:11], s51 offen lds
    v_mfma_f32_16x16x32_bf16 v[188:191], v[244:247], v[236:239], v[188:191]
    s_waitcnt lgkmcnt(0)
    v_mfma_f32_16x16x32_bf16 v[192:195], v[240:243], v[216:219], v[192:195]
    v_mfma_f32_16x16x32_bf16 v[196:199], v[240:243], v[220:223], v[196:199]
    v_mfma_f32_16x16x32_bf16 v[200:203], v[240:243], v[224:227], v[200:203]
    s_add_u32 m0, s50, 155648
    s_add_u32 s51, s49, 73728
    buffer_load_dwordx4 v251, s[8:11], s51 offen lds
    v_mfma_f32_16x16x32_bf16 v[204:207], v[240:243], v[228:231], v[204:207]
    v_mfma_f32_16x16x32_bf16 v[208:211], v[240:243], v[232:235], v[208:211]
    v_mfma_f32_16x16x32_bf16 v[212:215], v[240:243], v[236:239], v[212:215]
    s_waitcnt vmcnt(6)
    s_waitcnt lgkmcnt(0)
    s_barrier
    ds_read_b64_tr_b16 v[240:241], v248 offset:0
    ds_read_b64_tr_b16 v[242:243], v248 offset:2048
    ds_read_b128 v[216:219], v249 offset:43008
    ds_read_b128 v[220:223], v249 offset:44032
    ds_read_b128 v[224:227], v249 offset:45056
    ds_read_b128 v[228:231], v249 offset:46080
    ds_read_b128 v[232:235], v249 offset:47104
    ds_read_b128 v[236:239], v249 offset:48128
    ds_read_b64_tr_b16 v[244:245], v248 offset:4096
    ds_read_b64_tr_b16 v[246:247], v248 offset:6144
    s_add_u32 m0, s50, 65536
    s_add_u32 s51, s68, 258048
    buffer_load_dwordx4 v252, s[24:27], s51 offen lds
    s_add_u32 m0, s50, 69632
    s_add_u32 s51, s69, 258048
    buffer_load_dwordx4 v252, s[24:27], s51 offen lds
    s_add_u32 m0, s50, 73728
    s_add_u32 s51, s70, 258048
    buffer_load_dwordx4 v252, s[24:27], s51 offen lds
    s_add_u32 m0, s50, 77824
    s_add_u32 s51, s71, 258048
    buffer_load_dwordx4 v252, s[24:27], s51 offen lds
    s_add_u32 m0, s50, 81920
    s_add_u32 s51, s72, 258048
    buffer_load_dwordx4 v252, s[24:27], s51 offen lds
    s_add_u32 m0, s50, 86016
    s_add_u32 s51, s47, 512
    buffer_load_dwordx4 v250, s[20:23], s51 offen lds
    s_add_u32 m0, s50, 90112
    s_add_u32 s51, s47, 640
    buffer_load_dwordx4 v250, s[20:23], s51 offen lds
    s_add_u32 m0, s50, 94208
    s_add_u32 s51, s47, 768
    buffer_load_dwordx4 v250, s[20:23], s51 offen lds
    s_add_u32 m0, s50, 98304
    s_add_u32 s51, s47, 896
    buffer_load_dwordx4 v250, s[20:23], s51 offen lds
    s_waitcnt lgkmcnt(7)
    v_mfma_f32_16x16x32_bf16 v[0:3], v[240:243], v[216:219], v[0:3]
    s_waitcnt lgkmcnt(6)
    v_mfma_f32_16x16x32_bf16 v[4:7], v[240:243], v[220:223], v[4:7]
    s_waitcnt lgkmcnt(5)
    v_mfma_f32_16x16x32_bf16 v[8:11], v[240:243], v[224:227], v[8:11]
    s_waitcnt lgkmcnt(4)
    v_mfma_f32_16x16x32_bf16 v[12:15], v[240:243], v[228:231], v[12:15]
    s_waitcnt lgkmcnt(3)
    v_mfma_f32_16x16x32_bf16 v[16:19], v[240:243], v[232:235], v[16:19]
    s_waitcnt lgkmcnt(2)
    v_mfma_f32_16x16x32_bf16 v[20:23], v[240:243], v[236:239], v[20:23]
    ds_read_b64_tr_b16 v[240:241], v248 offset:8192
    ds_read_b64_tr_b16 v[242:243], v248 offset:10240
    s_waitcnt lgkmcnt(2)
    v_mfma_f32_16x16x32_bf16 v[24:27], v[244:247], v[216:219], v[24:27]
    v_mfma_f32_16x16x32_bf16 v[28:31], v[244:247], v[220:223], v[28:31]
    v_mfma_f32_16x16x32_bf16 v[32:35], v[244:247], v[224:227], v[32:35]
    v_mfma_f32_16x16x32_bf16 v[36:39], v[244:247], v[228:231], v[36:39]
    v_mfma_f32_16x16x32_bf16 v[40:43], v[244:247], v[232:235], v[40:43]
    v_mfma_f32_16x16x32_bf16 v[44:47], v[244:247], v[236:239], v[44:47]
    s_waitcnt lgkmcnt(0)
    v_mfma_f32_16x16x32_bf16 v[48:51], v[240:243], v[216:219], v[48:51]
    v_mfma_f32_16x16x32_bf16 v[52:55], v[240:243], v[220:223], v[52:55]
    v_mfma_f32_16x16x32_bf16 v[56:59], v[240:243], v[224:227], v[56:59]
    v_mfma_f32_16x16x32_bf16 v[60:63], v[240:243], v[228:231], v[60:63]
    v_mfma_f32_16x16x32_bf16 v[64:67], v[240:243], v[232:235], v[64:67]
    v_mfma_f32_16x16x32_bf16 v[68:71], v[240:243], v[236:239], v[68:71]
    s_waitcnt vmcnt(8)
    s_waitcnt lgkmcnt(0)
    s_barrier
    ds_read_b64_tr_b16 v[240:241], v248 offset:12288
    ds_read_b64_tr_b16 v[242:243], v248 offset:14336
    ds_read_b64_tr_b16 v[244:245], v248 offset:16384
    ds_read_b64_tr_b16 v[246:247], v248 offset:18432
    s_add_u32 m0, s50, 49152
    s_add_u32 s51, s64, 294912
    buffer_load_dwordx4 v252, s[24:27], s51 offen lds
    s_add_u32 m0, s50, 53248
    s_add_u32 s51, s65, 294912
    buffer_load_dwordx4 v252, s[24:27], s51 offen lds
    s_waitcnt lgkmcnt(2)
    v_mfma_f32_16x16x32_bf16 v[72:75], v[240:243], v[216:219], v[72:75]
    v_mfma_f32_16x16x32_bf16 v[76:79], v[240:243], v[220:223], v[76:79]
    s_add_u32 m0, s50, 57344
    s_add_u32 s51, s66, 294912
    buffer_load_dwordx4 v252, s[24:27], s51 offen lds
    v_mfma_f32_16x16x32_bf16 v[80:83], v[240:243], v[224:227], v[80:83]
    v_mfma_f32_16x16x32_bf16 v[84:87], v[240:243], v[228:231], v[84:87]
    s_add_u32 m0, s50, 102400
    s_add_u32 s51, s47, 262656
    buffer_load_dwordx4 v250, s[20:23], s51 offen lds
    v_mfma_f32_16x16x32_bf16 v[88:91], v[240:243], v[232:235], v[88:91]
    v_mfma_f32_16x16x32_bf16 v[92:95], v[240:243], v[236:239], v[92:95]
    s_add_u32 m0, s50, 106496
    s_add_u32 s51, s47, 262784
    buffer_load_dwordx4 v250, s[20:23], s51 offen lds
    s_waitcnt lgkmcnt(0)
    v_mfma_f32_16x16x32_bf16 v[96:99], v[244:247], v[216:219], v[96:99]
    v_mfma_f32_16x16x32_bf16 v[100:103], v[244:247], v[220:223], v[100:103]
    v_mfma_f32_16x16x32_bf16 v[104:107], v[244:247], v[224:227], v[104:107]
    s_add_u32 m0, s50, 110592
    s_add_u32 s51, s47, 262912
    buffer_load_dwordx4 v250, s[20:23], s51 offen lds
    v_mfma_f32_16x16x32_bf16 v[108:111], v[244:247], v[228:231], v[108:111]
    v_mfma_f32_16x16x32_bf16 v[112:115], v[244:247], v[232:235], v[112:115]
    s_add_u32 m0, s50, 114688
    s_add_u32 s51, s47, 263040
    buffer_load_dwordx4 v250, s[20:23], s51 offen lds
    v_mfma_f32_16x16x32_bf16 v[116:119], v[244:247], v[236:239], v[116:119]
    s_waitcnt vmcnt(14)
    s_waitcnt lgkmcnt(0)
    s_barrier
    ds_read_b64_tr_b16 v[240:241], v248 offset:20480
    ds_read_b64_tr_b16 v[242:243], v248 offset:22528
    s_add_u32 m0, s50, 61440
    s_add_u32 s51, s67, 294912
    buffer_load_dwordx4 v252, s[24:27], s51 offen lds
    s_add_u32 m0, s50, 65536
    s_add_u32 s51, s68, 294912
    buffer_load_dwordx4 v252, s[24:27], s51 offen lds
    s_waitcnt lgkmcnt(0)
    v_mfma_f32_16x16x32_bf16 v[120:123], v[240:243], v[216:219], v[120:123]
    v_mfma_f32_16x16x32_bf16 v[124:127], v[240:243], v[220:223], v[124:127]
    s_add_u32 m0, s50, 118784
    s_add_u32 s51, s47, 524800
    buffer_load_dwordx4 v250, s[20:23], s51 offen lds
    v_mfma_f32_16x16x32_bf16 v[128:131], v[240:243], v[224:227], v[128:131]
    s_add_u32 m0, s50, 122880
    s_add_u32 s51, s47, 524928
    buffer_load_dwordx4 v250, s[20:23], s51 offen lds
    v_mfma_f32_16x16x32_bf16 v[132:135], v[240:243], v[228:231], v[132:135]
    v_mfma_f32_16x16x32_bf16 v[136:139], v[240:243], v[232:235], v[136:139]
    s_add_u32 m0, s50, 126976
    s_add_u32 s51, s47, 525056
    buffer_load_dwordx4 v250, s[20:23], s51 offen lds
    v_mfma_f32_16x16x32_bf16 v[140:143], v[240:243], v[236:239], v[140:143]
    s_add_u32 m0, s50, 131072
    s_add_u32 s51, s47, 525184
    buffer_load_dwordx4 v250, s[20:23], s51 offen lds
    s_waitcnt vmcnt(17)
    s_waitcnt lgkmcnt(0)
    s_barrier
    ds_read_b64_tr_b16 v[240:241], v248 offset:24576
    ds_read_b64_tr_b16 v[242:243], v248 offset:26624
    ds_read_b64_tr_b16 v[244:245], v248 offset:28672
    ds_read_b64_tr_b16 v[246:247], v248 offset:30720
    s_add_u32 m0, s50, 69632
    s_add_u32 s51, s69, 294912
    buffer_load_dwordx4 v252, s[24:27], s51 offen lds
    s_waitcnt lgkmcnt(2)
    v_mfma_f32_16x16x32_bf16 v[144:147], v[240:243], v[216:219], v[144:147]
    v_mfma_f32_16x16x32_bf16 v[148:151], v[240:243], v[220:223], v[148:151]
    v_mfma_f32_16x16x32_bf16 v[152:155], v[240:243], v[224:227], v[152:155]
    v_mfma_f32_16x16x32_bf16 v[156:159], v[240:243], v[228:231], v[156:159]
    v_mfma_f32_16x16x32_bf16 v[160:163], v[240:243], v[232:235], v[160:163]
    v_mfma_f32_16x16x32_bf16 v[164:167], v[240:243], v[236:239], v[164:167]
    ds_read_b64_tr_b16 v[240:241], v248 offset:32768
    ds_read_b64_tr_b16 v[242:243], v248 offset:34816
    s_waitcnt lgkmcnt(2)
    v_mfma_f32_16x16x32_bf16 v[168:171], v[244:247], v[216:219], v[168:171]
    v_mfma_f32_16x16x32_bf16 v[172:175], v[244:247], v[220:223], v[172:175]
    v_mfma_f32_16x16x32_bf16 v[176:179], v[244:247], v[224:227], v[176:179]
    v_mfma_f32_16x16x32_bf16 v[180:183], v[244:247], v[228:231], v[180:183]
    v_mfma_f32_16x16x32_bf16 v[184:187], v[244:247], v[232:235], v[184:187]
    v_mfma_f32_16x16x32_bf16 v[188:191], v[244:247], v[236:239], v[188:191]
    s_waitcnt lgkmcnt(0)
    v_mfma_f32_16x16x32_bf16 v[192:195], v[240:243], v[216:219], v[192:195]
    v_mfma_f32_16x16x32_bf16 v[196:199], v[240:243], v[220:223], v[196:199]
    v_mfma_f32_16x16x32_bf16 v[200:203], v[240:243], v[224:227], v[200:203]
    v_mfma_f32_16x16x32_bf16 v[204:207], v[240:243], v[228:231], v[204:207]
    v_mfma_f32_16x16x32_bf16 v[208:211], v[240:243], v[232:235], v[208:211]
    v_mfma_f32_16x16x32_bf16 v[212:215], v[240:243], v[236:239], v[212:215]
    s_waitcnt vmcnt(14)
    s_waitcnt lgkmcnt(0)
    s_add_u32 s47, s47, 512
    s_add_u32 s46, s46, 131072
    s_add_u32 s83, s83, 512
    s_add_u32 s89, s89, 294912
    s_add_u32 s64, s64, 294912
    s_add_u32 s65, s65, 294912
    s_add_u32 s66, s66, 294912
    s_add_u32 s67, s67, 294912
    s_add_u32 s68, s68, 294912
    s_add_u32 s69, s69, 294912
    s_add_u32 s70, s70, 294912
    s_add_u32 s71, s71, 294912
    s_add_u32 s72, s72, 294912
    s_add_u32 s45, s45, 1
    s_cmp_lt_u32 s45, 4
    s_cbranch_scc1 L_G_loop
    s_lshl_b32 s52, s59, 2
    s_add_u32 s52, s52, s41
    s_lshl_b32 s52, s52, 2
    s_add_u32 s52, s52, s44
    s_mul_i32 s52, s52, 24576
    s_add_u32 s74, s52, 0
    s_add_u32 s75, s52, 6144
    s_add_u32 s76, s52, 15360
    s_add_u32 s51, s41, 1
    s_and_b32 s51, s51, 3
    s_lshl_b32 s12, 1, s51
    s_add_u32 s51, s41, 2
    s_and_b32 s51, s51, 3
    s_lshl_b32 s13, 1, s51
    s_add_u32 s51, s41, 3
    s_and_b32 s51, s51, 3
    s_lshl_b32 s14, 1, s51
    s_mov_b32 s15, s12
    s_lshl_b32 s51, 1, s41
    s_or_b32 s12, s12, s51
    s_lshl_b32 s51, s59, 2
    s_add_u32 s51, s51, s41
    s_lshl_b32 s51, s51, 7
    s_lshl_b32 s53, s44, 2
    s_add_u32 s51, s51, s53
    s_add_u32 s16, s51, 26214400
    s_add_u32 s51, s41, 1
    s_and_b32 s51, s51, 3
    s_lshl_b32 s53, s59, 2
    s_add_u32 s51, s51, s53
    s_lshl_b32 s51, s51, 2
    s_add_u32 s51, s51, s44
    s_mul_i32 s51, s51, 24576
    s_add_u32 s17, s51, 15360
    s_add_u32 s77, s52, 12288
    v_add_u32 v250, 0x10000, v248
    s_waitcnt vmcnt(0)
    s_barrier
    s_lshl_b32 s53, s59, 2
    v_mov_b32 v251, s53
    s_mov_b32 s80, 0
    buffer_load_dword v253, v251, s[36:39], 0 offen sc1
    s_branch L_rdy_chk
L_rdy:
    buffer_load_dword v253, v251, s[36:39], 0 offen sc1
    s_waitcnt vmcnt(0)
L_rdy_chk:
    s_waitcnt vmcnt(0)
    v_readfirstlane_b32 s52, v253
    s_nop 3
    s_sub_u32 s51, s52, 0x01010101
    s_andn2_b32 s51, s51, s52
    s_and_b32 s51, s51, 0x80808080
    s_cbranch_scc0 L_rdy_ok
    s_sleep 8
    s_add_u32 s80, s80, 1
    s_cmp_lt_u32 s80, 2000000
    s_cbranch_scc1 L_rdy
L_rdy_ok:
    v_lshlrev_b32 v251, 3, v249
    s_lshl_b32 s51, s59, 9
    s_lshl_b32 s52, s41, 4
    s_add_u32 s51, s51, s52
    s_lshl_b32 s52, s44, 2
    s_add_u32 s51, s51, s52
    s_add_u32 s73, s51, 26214400
    v_mov_b32 v253, 1
    s_mul_i32 s51, s44, 12288
    s_add_u32 s51, s51, 57344
    v_add_u32 v254, s51, v249
    v_lshrrev_b32 v240, 4, v249
    v_and_b32 v252, 15, v240
    s_movk_i32 s51, 2304
    v_mul_lo_u32 v252, v252, s51
    v_lshrrev_b32 v240, 4, v240
    v_lshl_add_u32 v252, v240, 3, v252
    s_mul_i32 s52, s42, 221184
    s_mul_i32 s53, s40, 1152
    s_add_u32 s52, s52, s53
    s_lshl_b32 s53, s44, 5
    s_add_u32 s78, s52, s53
    s_lshl_b32 s53, s41, 8
    s_add_u32 s55, s78, s53
    s_barrier
    ds_read_b64_tr_b16 v[240:241], v248 offset:8192
    ds_read_b64_tr_b16 v[242:243], v248 offset:10240
    ds_read_b128 v[216:219], v249 offset:0
    ds_read_b128 v[220:223], v249 offset:1024
    ds_read_b128 v[224:227], v249 offset:2048
    ds_read_b128 v[228:231], v249 offset:3072
    ds_read_b128 v[232:235], v249 offset:4096
    ds_read_b128 v[236:239], v249 offset:5120
    ds_read_b64_tr_b16 v[244:245], v248 offset:12288
    ds_read_b64_tr_b16 v[246:247], v248 offset:14336
    s_waitcnt lgkmcnt(7)
    v_mfma_f32_16x16x32_bf16 v[192:195], v[240:243], v[216:219], v[192:195]
    s_waitcnt lgkmcnt(6)
    v_mfma_f32_16x16x32_bf16 v[196:199], v[240:243], v[220:223], v[196:199]
    s_waitcnt lgkmcnt(5)
    v_mfma_f32_16x16x32_bf16 v[200:203], v[240:243], v[224:227], v[200:203]
    s_waitcnt lgkmcnt(4)
    v_mfma_f32_16x16x32_bf16 v[204:207], v[240:243], v[228:231], v[204:207]
    s_waitcnt lgkmcnt(3)
    v_mfma_f32_16x16x32_bf16 v[208:211], v[240:243], v[232:235], v[208:211]
    s_waitcnt lgkmcnt(2)
    v_mfma_f32_16x16x32_bf16 v[212:215], v[240:243], v[236:239], v[212:215]
    ds_read_b64_tr_b16 v[240:241], v248 offset:16384
    ds_read_b64_tr_b16 v[242:243], v248 offset:18432
    s_waitcnt lgkmcnt(2)
    v_mfma_f32_16x16x32_bf16 v[0:3], v[244:247], v[216:219], v[0:3]
    v_mfma_f32_16x16x32_bf16 v[4:7], v[244:247], v[220:223], v[4:7]
    v_mfma_f32_16x16x32_bf16 v[8:11], v[244:247], v[224:227], v[8:11]
    v_mfma_f32_16x16x32_bf16 v[12:15], v[244:247], v[228:231], v[12:15]
    v_mfma_f32_16x16x32_bf16 v[16:19], v[244:247], v[232:235], v[16:19]
    v_mfma_f32_16x16x32_bf16 v[20:23], v[244:247], v[236:239], v[20:23]
    ds_read_b64_tr_b16 v[244:245], v248 offset:20480
    ds_read_b64_tr_b16 v[246:247], v248 offset:22528
    s_waitcnt lgkmcnt(2)
    v_mfma_f32_16x16x32_bf16 v[24:27], v[240:243], v[216:219], v[24:27]
    ds_read_b128 v[216:219], v249 offset:24576
    v_mfma_f32_16x16x32_bf16 v[28:31], v[240:243], v[220:223], v[28:31]
    ds_read_b128 v[220:223], v249 offset:25600
    v_mfma_f32_16x16x32_bf16 v[32:35], v[240:243], v[224:227], v[32:35]
    ds_read_b128 v[224:227], v249 offset:26624
    v_mfma_f32_16x16x32_bf16 v[36:39], v[240:243], v[228:231], v[36:39]
    ds_read_b128 v[228:231], v249 offset:27648
    v_mfma_f32_16x16x32_bf16 v[40:43], v[240:243], v[232:235], v[40:43]
    ds_read_b128 v[232:235], v249 offset:28672
    v_mfma_f32_16x16x32_bf16 v[44:47], v[240:243], v[236:239], v[44:47]
    ds_read_b128 v[236:239], v249 offset:29696
    ds_read_b64_tr_b16 v[240:241], v248 offset:24576
    ds_read_b64_tr_b16 v[242:243], v248 offset:26624
    s_waitcnt lgkmcnt(7)
    v_mfma_f32_16x16x32_bf16 v[192:195], v[244:247], v[216:219], v[192:195]
    s_waitcnt lgkmcnt(6)
    v_mfma_f32_16x16x32_bf16 v[196:199], v[244:247], v[220:223], v[196:199]
    s_waitcnt lgkmcnt(5)
    v_mfma_f32_16x16x32_bf16 v[200:203], v[244:247], v[224:227], v[200:203]
    s_waitcnt lgkmcnt(4)
    v_mfma_f32_16x16x32_bf16 v[204:207], v[244:247], v[228:231], v[204:207]
    s_waitcnt lgkmcnt(3)
    v_mfma_f32_16x16x32_bf16 v[208:211], v[244:247], v[232:235], v[208:211]
    s_waitcnt lgkmcnt(2)
    v_mfma_f32_16x16x32_bf16 v[212:215], v[244:247], v[236:239], v[212:215]
    ds_read_b64_tr_b16 v[244:245], v248 offset:28672
    ds_read_b64_tr_b16 v[246:247], v248 offset:30720
    s_waitcnt lgkmcnt(2)
    v_mfma_f32_16x16x32_bf16 v[0:3], v[240:243], v[216:219], v[0:3]
    v_mfma_f32_16x16x32_bf16 v[4:7], v[240:243], v[220:223], v[4:7]
    v_mfma_f32_16x16x32_bf16 v[8:11], v[240:243], v[224:227], v[8:11]
    v_mfma_f32_16x16x32_bf16 v[12:15], v[240:243], v[228:231], v[12:15]
    v_mfma_f32_16x16x32_bf16 v[16:19], v[240:243], v[232:235], v[16:19]
    v_mfma_f32_16x16x32_bf16 v[20:23], v[240:243], v[236:239], v[20:23]
    s_waitcnt lgkmcnt(0)
    v_mfma_f32_16x16x32_bf16 v[24:27], v[244:247], v[216:219], v[24:27]
    ds_read_b128 v[216:219], v249 offset:6144
    v_mfma_f32_16x16x32_bf16 v[28:31], v[244:247], v[220:223], v[28:31]
    ds_read_b128 v[220:223], v249 offset:7168
    v_mfma_f32_16x16x32_bf16 v[32:35], v[244:247], v[224:227], v[32:35]
    ds_read_b128 v[224:227], v249 offset:8192
    v_mfma_f32_16x16x32_bf16 v[36:39], v[244:247], v[228:231], v[36:39]
    ds_read_b128 v[228:231], v249 offset:9216
    v_mfma_f32_16x16x32_bf16 v[40:43], v[244:247], v[232:235], v[40:43]
    ds_read_b128 v[232:235], v249 offset:10240
    v_mfma_f32_16x16x32_bf16 v[44:47], v[244:247], v[236:239], v[44:47]
    ds_read_b128 v[236:239], v249 offset:11264
    ds_read_b64_tr_b16 v[240:241], v248 offset:32768
    ds_read_b64_tr_b16 v[242:243], v248 offset:34816
    s_waitcnt lgkmcnt(8)
    s_barrier
    ds_read_b64_tr_b16 v[244:245], v248 offset:36864
    ds_read_b64_tr_b16 v[246:247], v248 offset:38912
    s_waitcnt lgkmcnt(2)
    v_mfma_f32_16x16x32_bf16 v[192:195], v[240:243], v[216:219], v[192:195]
    v_mfma_f32_16x16x32_bf16 v[196:199], v[240:243], v[220:223], v[196:199]
    v_mfma_f32_16x16x32_bf16 v[200:203], v[240:243], v[224:227], v[200:203]
    v_mfma_f32_16x16x32_bf16 v[204:207], v[240:243], v[228:231], v[204:207]
    v_mfma_f32_16x16x32_bf16 v[208:211], v[240:243], v[232:235], v[208:211]
    v_mfma_f32_16x16x32_bf16 v[212:215], v[240:243], v[236:239], v[212:215]
    ds_read_b64_tr_b16 v[240:241], v248 offset:40960
    ds_read_b64_tr_b16 v[242:243], v248 offset:43008
    s_waitcnt lgkmcnt(2)
    v_mfma_f32_16x16x32_bf16 v[0:3], v[244:247], v[216:219], v[0:3]
    v_mfma_f32_16x16x32_bf16 v[4:7], v[244:247], v[220:223], v[4:7]
    v_mfma_f32_16x16x32_bf16 v[8:11], v[244:247], v[224:227], v[8:11]
    v_mfma_f32_16x16x32_bf16 v[12:15], v[244:247], v[228:231], v[12:15]
    v_mfma_f32_16x16x32_bf16 v[16:19], v[244:247], v[232:235], v[16:19]
    v_mfma_f32_16x16x32_bf16 v[20:23], v[244:247], v[236:239], v[20:23]
    ds_read_b64_tr_b16 v[244:245], v248 offset:45056
    ds_read_b64_tr_b16 v[246:247], v248 offset:47104
    s_waitcnt lgkmcnt(2)
    v_mfma_f32_16x16x32_bf16 v[24:27], v[240:243], v[216:219], v[24:27]
    ds_read_b128 v[216:219], v249 offset:30720
    v_mfma_f32_16x16x32_bf16 v[28:31], v[240:243], v[220:223], v[28:31]
    ds_read_b128 v[220:223], v249 offset:31744
    v_mfma_f32_16x16x32_bf16 v[32:35], v[240:243], v[224:227], v[32:35]
    ds_read_b128 v[224:227], v249 offset:32768
    v_mfma_f32_16x16x32_bf16 v[36:39], v[240:243], v[228:231], v[36:39]
    ds_read_b128 v[228:231], v249 offset:33792
    v_mfma_f32_16x16x32_bf16 v[40:43], v[240:243], v[232:235], v[40:43]
    ds_read_b128 v[232:235], v249 offset:34816
    v_mfma_f32_16x16x32_bf16 v[44:47], v[240:243], v[236:239], v[44:47]
    ds_read_b128 v[236:239], v249 offset:35840
    ds_read_b64_tr_b16 v[240:241], v248 offset:49152
    ds_read_b64_tr_b16 v[242:243], v248 offset:51200
    s_waitcnt lgkmcnt(7)
    v_mfma_f32_16x16x32_bf16 v[192:195], v[244:247], v[216:219], v[192:195]
    s_waitcnt lgkmcnt(6)
    v_mfma_f32_16x16x32_bf16 v[196:199], v[244:247], v[220:223], v[196:199]
    s_waitcnt lgkmcnt(5)
    v_mfma_f32_16x16x32_bf16 v[200:203], v[244:247], v[224:227], v[200:203]
    s_waitcnt lgkmcnt(4)
    v_mfma_f32_16x16x32_bf16 v[204:207], v[244:247], v[228:231], v[204:207]
    s_waitcnt lgkmcnt(3)
    v_mfma_f32_16x16x32_bf16 v[208:211], v[244:247], v[232:235], v[208:211]
    s_waitcnt lgkmcnt(2)
    v_mfma_f32_16x16x32_bf16 v[212:215], v[244:247], v[236:239], v[212:215]
    ds_read_b64_tr_b16 v[244:245], v248 offset:53248
    ds_read_b64_tr_b16 v[246:247], v248 offset:55296
    s_waitcnt lgkmcnt(2)
    v_mfma_f32_16x16x32_bf16 v[0:3], v[240:243], v[216:219], v[0:3]
    v_mfma_f32_16x16x32_bf16 v[4:7], v[240:243], v[220:223], v[4:7]
    v_mfma_f32_16x16x32_bf16 v[8:11], v[240:243], v[224:227], v[8:11]
    v_mfma_f32_16x16x32_bf16 v[12:15], v[240:243], v[228:231], v[12:15]
    v_mfma_f32_16x16x32_bf16 v[16:19], v[240:243], v[232:235], v[16:19]
    v_mfma_f32_16x16x32_bf16 v[20:23], v[240:243], v[236:239], v[20:23]
    s_waitcnt lgkmcnt(0)
    v_mfma_f32_16x16x32_bf16 v[24:27], v[244:247], v[216:219], v[24:27]
    ds_read_b128 v[216:219], v249 offset:12288
    v_mfma_f32_16x16x32_bf16 v[28:31], v[244:247], v[220:223], v[28:31]
    ds_read_b128 v[220:223], v249 offset:13312
    v_mfma_f32_16x16x32_bf16 v[32:35], v[244:247], v[224:227], v[32:35]
    ds_read_b128 v[224:227], v249 offset:14336
    v_mfma_f32_16x16x32_bf16 v[36:39], v[244:247], v[228:231], v[36:39]
    ds_read_b128 v[228:231], v249 offset:15360
    v_mfma_f32_16x16x32_bf16 v[40:43], v[244:247], v[232:235], v[40:43]
    ds_read_b128 v[232:235], v249 offset:16384
    v_mfma_f32_16x16x32_bf16 v[44:47], v[244:247], v[236:239], v[44:47]
    ds_read_b128 v[236:239], v249 offset:17408
    ds_read_b64_tr_b16 v[240:241], v248 offset:0
    ds_read_b64_tr_b16 v[242:243], v248 offset:2048
    s_waitcnt lgkmcnt(8)
    s_barrier
    ds_read_b64_tr_b16 v[244:245], v248 offset:4096
    ds_read_b64_tr_b16 v[246:247], v248 offset:6144
    s_waitcnt lgkmcnt(2)
    v_mfma_f32_16x16x32_bf16 v[192:195], v[240:243], v[216:219], v[192:195]
    v_mfma_f32_16x16x32_bf16 v[196:199], v[240:243], v[220:223], v[196:199]
    v_mfma_f32_16x16x32_bf16 v[200:203], v[240:243], v[224:227], v[200:203]
    v_mfma_f32_16x16x32_bf16 v[204:207], v[240:243], v[228:231], v[204:207]
    v_mfma_f32_16x16x32_bf16 v[208:211], v[240:243], v[232:235], v[208:211]
    v_mfma_f32_16x16x32_bf16 v[212:215], v[240:243], v[236:239], v[212:215]
    ds_read_b64_tr_b16 v[240:241], v248 offset:57344
    ds_read_b64_tr_b16 v[242:243], v248 offset:59392
    s_waitcnt lgkmcnt(2)
    v_mfma_f32_16x16x32_bf16 v[0:3], v[244:247], v[216:219], v[0:3]
    v_mfma_f32_16x16x32_bf16 v[4:7], v[244:247], v[220:223], v[4:7]
    v_mfma_f32_16x16x32_bf16 v[8:11], v[244:247], v[224:227], v[8:11]
    v_mfma_f32_16x16x32_bf16 v[12:15], v[244:247], v[228:231], v[12:15]
    v_mfma_f32_16x16x32_bf16 v[16:19], v[244:247], v[232:235], v[16:19]
    v_mfma_f32_16x16x32_bf16 v[20:23], v[244:247], v[236:239], v[20:23]
    ds_read_b64_tr_b16 v[244:245], v248 offset:61440
    ds_read_b64_tr_b16 v[246:247], v248 offset:63488
    s_waitcnt lgkmcnt(2)
    v_mfma_f32_16x16x32_bf16 v[24:27], v[240:243], v[216:219], v[24:27]
    ds_read_b128 v[216:219], v249 offset:36864
    v_mfma_f32_16x16x32_bf16 v[28:31], v[240:243], v[220:223], v[28:31]
    ds_read_b128 v[220:223], v249 offset:37888
    v_mfma_f32_16x16x32_bf16 v[32:35], v[240:243], v[224:227], v[32:35]
    ds_read_b128 v[224:227], v249 offset:38912
    v_mfma_f32_16x16x32_bf16 v[36:39], v[240:243], v[228:231], v[36:39]
    ds_read_b128 v[228:231], v249 offset:39936
    v_mfma_f32_16x16x32_bf16 v[40:43], v[240:243], v[232:235], v[40:43]
    ds_read_b128 v[232:235], v249 offset:40960
    v_mfma_f32_16x16x32_bf16 v[44:47], v[240:243], v[236:239], v[44:47]
    ds_read_b128 v[236:239], v249 offset:41984
    ds_read_b64_tr_b16 v[240:241], v250 offset:0
    ds_read_b64_tr_b16 v[242:243], v250 offset:2048
    s_waitcnt lgkmcnt(7)
    v_mfma_f32_16x16x32_bf16 v[192:195], v[244:247], v[216:219], v[192:195]
    s_waitcnt lgkmcnt(6)
    v_mfma_f32_16x16x32_bf16 v[196:199], v[244:247], v[220:223], v[196:199]
    s_waitcnt lgkmcnt(5)
    v_mfma_f32_16x16x32_bf16 v[200:203], v[244:247], v[224:227], v[200:203]
    s_waitcnt lgkmcnt(4)
    v_mfma_f32_16x16x32_bf16 v[204:207], v[244:247], v[228:231], v[204:207]
    s_waitcnt lgkmcnt(3)
    v_mfma_f32_16x16x32_bf16 v[208:211], v[244:247], v[232:235], v[208:211]
    s_waitcnt lgkmcnt(2)
    v_mfma_f32_16x16x32_bf16 v[212:215], v[244:247], v[236:239], v[212:215]
    ds_read_b64_tr_b16 v[244:245], v250 offset:4096
    ds_read_b64_tr_b16 v[246:247], v250 offset:6144
    s_waitcnt lgkmcnt(2)
    v_mfma_f32_16x16x32_bf16 v[0:3], v[240:243], v[216:219], v[0:3]
    v_mfma_f32_16x16x32_bf16 v[4:7], v[240:243], v[220:223], v[4:7]
    v_mfma_f32_16x16x32_bf16 v[8:11], v[240:243], v[224:227], v[8:11]
    v_mfma_f32_16x16x32_bf16 v[12:15], v[240:243], v[228:231], v[12:15]
    v_mfma_f32_16x16x32_bf16 v[16:19], v[240:243], v[232:235], v[16:19]
    v_mfma_f32_16x16x32_bf16 v[20:23], v[240:243], v[236:239], v[20:23]
    s_waitcnt lgkmcnt(0)
    v_mfma_f32_16x16x32_bf16 v[24:27], v[244:247], v[216:219], v[24:27]
    ds_read_b128 v[216:219], v249 offset:18432
    v_mfma_f32_16x16x32_bf16 v[28:31], v[244:247], v[220:223], v[28:31]
    ds_read_b128 v[220:223], v249 offset:19456
    v_mfma_f32_16x16x32_bf16 v[32:35], v[244:247], v[224:227], v[32:35]
    ds_read_b128 v[224:227], v249 offset:20480
    v_mfma_f32_16x16x32_bf16 v[36:39], v[244:247], v[228:231], v[36:39]
    ds_read_b128 v[228:231], v249 offset:21504
    v_mfma_f32_16x16x32_bf16 v[40:43], v[244:247], v[232:235], v[40:43]
    ds_read_b128 v[232:235], v249 offset:22528
    v_mfma_f32_16x16x32_bf16 v[44:47], v[244:247], v[236:239], v[44:47]
    ds_read_b128 v[236:239], v249 offset:23552
    ds_read_b64_tr_b16 v[240:241], v248 offset:8192
    ds_read_b64_tr_b16 v[242:243], v248 offset:10240
    s_waitcnt lgkmcnt(8)
    s_barrier
    ds_read_b64_tr_b16 v[244:245], v248 offset:12288
    ds_read_b64_tr_b16 v[246:247], v248 offset:14336
    s_waitcnt lgkmcnt(2)
    v_mfma_f32_16x16x32_bf16 v[192:195], v[240:243], v[216:219], v[192:195]
    v_mfma_f32_16x16x32_bf16 v[196:199], v[240:243], v[220:223], v[196:199]
    v_mfma_f32_16x16x32_bf16 v[200:203], v[240:243], v[224:227], v[200:203]
    v_mfma_f32_16x16x32_bf16 v[204:207], v[240:243], v[228:231], v[204:207]
    v_mfma_f32_16x16x32_bf16 v[208:211], v[240:243], v[232:235], v[208:211]
    v_mfma_f32_16x16x32_bf16 v[212:215], v[240:243], v[236:239], v[212:215]
    ds_read_b64_tr_b16 v[240:241], v248 offset:16384
    ds_read_b64_tr_b16 v[242:243], v248 offset:18432
    s_waitcnt lgkmcnt(2)
    v_mfma_f32_16x16x32_bf16 v[0:3], v[244:247], v[216:219], v[0:3]
    v_mfma_f32_16x16x32_bf16 v[4:7], v[244:247], v[220:223], v[4:7]
    v_mfma_f32_16x16x32_bf16 v[8:11], v[244:247], v[224:227], v[8:11]
    v_mfma_f32_16x16x32_bf16 v[12:15], v[244:247], v[228:231], v[12:15]
    v_mfma_f32_16x16x32_bf16 v[16:19], v[244:247], v[232:235], v[16:19]
    v_mfma_f32_16x16x32_bf16 v[20:23], v[244:247], v[236:239], v[20:23]
    ds_read_b64_tr_b16 v[244:245], v248 offset:20480
    ds_read_b64_tr_b16 v[246:247], v248 offset:22528
    s_waitcnt lgkmcnt(2)
    v_mfma_f32_16x16x32_bf16 v[24:27], v[240:243], v[216:219], v[24:27]
    ds_read_b128 v[216:219], v249 offset:43008
    v_mfma_f32_16x16x32_bf16 v[28:31], v[240:243], v[220:223], v[28:31]
    ds_read_b128 v[220:223], v249 offset:44032
    v_mfma_f32_16x16x32_bf16 v[32:35], v[240:243], v[224:227], v[32:35]
    ds_read_b128 v[224:227], v249 offset:45056
    v_mfma_f32_16x16x32_bf16 v[36:39], v[240:243], v[228:231], v[36:39]
    ds_read_b128 v[228:231], v249 offset:46080
    v_mfma_f32_16x16x32_bf16 v[40:43], v[240:243], v[232:235], v[40:43]
    ds_read_b128 v[232:235], v249 offset:47104
    v_mfma_f32_16x16x32_bf16 v[44:47], v[240:243], v[236:239], v[44:47]
    ds_read_b128 v[236:239], v249 offset:48128
    ds_read_b64_tr_b16 v[240:241], v248 offset:24576
    ds_read_b64_tr_b16 v[242:243], v248 offset:26624
    s_waitcnt lgkmcnt(7)
    v_mfma_f32_16x16x32_bf16 v[192:195], v[244:247], v[216:219], v[192:195]
    s_waitcnt lgkmcnt(6)
    v_mfma_f32_16x16x32_bf16 v[196:199], v[244:247], v[220:223], v[196:199]
    s_waitcnt lgkmcnt(5)
    v_mfma_f32_16x16x32_bf16 v[200:203], v[244:247], v[224:227], v[200:203]
    s_waitcnt lgkmcnt(4)
    v_mfma_f32_16x16x32_bf16 v[204:207], v[244:247], v[228:231], v[204:207]
    s_waitcnt lgkmcnt(3)
    v_mfma_f32_16x16x32_bf16 v[208:211], v[244:247], v[232:235], v[208:211]
    s_waitcnt lgkmcnt(2)
    v_mfma_f32_16x16x32_bf16 v[212:215], v[244:247], v[236:239], v[212:215]
    ds_read_b64_tr_b16 v[244:245], v248 offset:28672
    ds_read_b64_tr_b16 v[246:247], v248 offset:30720
    s_waitcnt lgkmcnt(2)
    v_mfma_f32_16x16x32_bf16 v[0:3], v[240:243], v[216:219], v[0:3]
    v_mfma_f32_16x16x32_bf16 v[4:7], v[240:243], v[220:223], v[4:7]
    v_mfma_f32_16x16x32_bf16 v[8:11], v[240:243], v[224:227], v[8:11]
    v_mfma_f32_16x16x32_bf16 v[12:15], v[240:243], v[228:231], v[12:15]
    v_mfma_f32_16x16x32_bf16 v[16:19], v[240:243], v[232:235], v[16:19]
    v_mfma_f32_16x16x32_bf16 v[20:23], v[240:243], v[236:239], v[20:23]
    s_waitcnt lgkmcnt(0)
    v_mfma_f32_16x16x32_bf16 v[24:27], v[244:247], v[216:219], v[24:27]
    ds_read_b128 v[216:219], v249 offset:0
    v_mfma_f32_16x16x32_bf16 v[28:31], v[244:247], v[220:223], v[28:31]
    ds_read_b128 v[220:223], v249 offset:1024
    v_mfma_f32_16x16x32_bf16 v[32:35], v[244:247], v[224:227], v[32:35]
    ds_read_b128 v[224:227], v249 offset:2048
    v_mfma_f32_16x16x32_bf16 v[36:39], v[244:247], v[228:231], v[36:39]
    ds_read_b128 v[228:231], v249 offset:3072
    v_mfma_f32_16x16x32_bf16 v[40:43], v[244:247], v[232:235], v[40:43]
    ds_read_b128 v[232:235], v249 offset:4096
    v_mfma_f32_16x16x32_bf16 v[44:47], v[244:247], v[236:239], v[44:47]
    ds_read_b128 v[236:239], v249 offset:5120
    ds_read_b64_tr_b16 v[240:241], v248 offset:32768
    ds_read_b64_tr_b16 v[242:243], v248 offset:34816
    s_waitcnt lgkmcnt(8)
    s_barrier
    ds_read_b64_tr_b16 v[244:245], v248 offset:36864
    ds_read_b64_tr_b16 v[246:247], v248 offset:38912
    v_cvt_pk_bf16_f32 v192, v192, v193
    v_cvt_pk_bf16_f32 v193, v194, v195
    v_cvt_pk_bf16_f32 v194, v196, v197
    v_cvt_pk_bf16_f32 v195, v198, v199
    s_add_u32 s51, s77, 0
    buffer_store_dwordx4 v[192:195], v249, s[32:35], s51 offen sc1
    v_cvt_pk_bf16_f32 v200, v200, v201
    v_cvt_pk_bf16_f32 v201, v202, v203
    v_cvt_pk_bf16_f32 v202, v204, v205
    v_cvt_pk_bf16_f32 v203, v206, v207
    s_add_u32 s51, s77, 1024
    buffer_store_dwordx4 v[200:203], v249, s[32:35], s51 offen sc1
    s_waitcnt lgkmcnt(2)
    v_mfma_f32_16x16x32_bf16 v[48:51], v[240:243], v[216:219], v[48:51]
    v_mfma_f32_16x16x32_bf16 v[52:55], v[240:243], v[220:223], v[52:55]
    v_mfma_f32_16x16x32_bf16 v[56:59], v[240:243], v[224:227], v[56:59]
    v_mfma_f32_16x16x32_bf16 v[60:63], v[240:243], v[228:231], v[60:63]
    v_mfma_f32_16x16x32_bf16 v[64:67], v[240:243], v[232:235], v[64:67]
    v_mfma_f32_16x16x32_bf16 v[68:71], v[240:243], v[236:239], v[68:71]
    ds_read_b64_tr_b16 v[240:241], v248 offset:40960
    ds_read_b64_tr_b16 v[242:243], v248 offset:43008
    v_cvt_pk_bf16_f32 v208, v208, v209
    v_cvt_pk_bf16_f32 v209, v210, v211
    v_cvt_pk_bf16_f32 v210, v212, v213
    v_cvt_pk_bf16_f32 v211, v214, v215
    s_add_u32 s51, s77, 2048
    buffer_store_dwordx4 v[208:211], v249, s[32:35], s51 offen sc1
    v_cvt_pk_bf16_f32 v0, v0, v1
    v_cvt_pk_bf16_f32 v1, v2, v3
    v_cvt_pk_bf16_f32 v2, v4, v5
    v_cvt_pk_bf16_f32 v3, v6, v7
    s_add_u32 s51, s74, 0
    buffer_store_dwordx4 v[0:3], v249, s[32:35], s51 offen sc1
    s_waitcnt lgkmcnt(2)
    v_mfma_f32_16x16x32_bf16 v[72:75], v[244:247], v[216:219], v[72:75]
    ds_read_b128 v[216:219], v249 offset:24576
    v_mfma_f32_16x16x32_bf16 v[76:79], v[244:247], v[220:223], v[76:79]
    ds_read_b128 v[220:223], v249 offset:25600
    v_mfma_f32_16x16x32_bf16 v[80:83], v[244:247], v[224:227], v[80:83]
    ds_read_b128 v[224:227], v249 offset:26624
    v_mfma_f32_16x16x32_bf16 v[84:87], v[244:247], v[228:231], v[84:87]
    ds_read_b128 v[228:231], v249 offset:27648
    v_mfma_f32_16x16x32_bf16 v[88:91], v[244:247], v[232:235], v[88:91]
    ds_read_b128 v[232:235], v249 offset:28672
    v_mfma_f32_16x16x32_bf16 v[92:95], v[244:247], v[236:239], v[92:95]
    ds_read_b128 v[236:239], v249 offset:29696
    ds_read_b64_tr_b16 v[244:245], v248 offset:45056
    ds_read_b64_tr_b16 v[246:247], v248 offset:47104
    v_cvt_pk_bf16_f32 v8, v8, v9
    v_cvt_pk_bf16_f32 v9, v10, v11
    v_cvt_pk_bf16_f32 v10, v12, v13
    v_cvt_pk_bf16_f32 v11, v14, v15
    s_add_u32 s51, s74, 1024
    buffer_store_dwordx4 v[8:11], v249, s[32:35], s51 offen sc1
    v_cvt_pk_bf16_f32 v16, v16, v17
    v_cvt_pk_bf16_f32 v17, v18, v19
    v_cvt_pk_bf16_f32 v18, v20, v21
    v_cvt_pk_bf16_f32 v19, v22, v23
    s_add_u32 s51, s74, 2048
    buffer_store_dwordx4 v[16:19], v249, s[32:35], s51 offen sc1
    s_waitcnt lgkmcnt(7)
    v_mfma_f32_16x16x32_bf16 v[48:51], v[240:243], v[216:219], v[48:51]
    s_waitcnt lgkmcnt(6)
    v_mfma_f32_16x16x32_bf16 v[52:55], v[240:243], v[220:223], v[52:55]
    s_waitcnt lgkmcnt(5)
    v_mfma_f32_16x16x32_bf16 v[56:59], v[240:243], v[224:227], v[56:59]
    s_waitcnt lgkmcnt(4)
    v_mfma_f32_16x16x32_bf16 v[60:63], v[240:243], v[228:231], v[60:63]
    s_waitcnt lgkmcnt(3)
    v_mfma_f32_16x16x32_bf16 v[64:67], v[240:243], v[232:235], v[64:67]
    s_waitcnt lgkmcnt(2)
    v_mfma_f32_16x16x32_bf16 v[68:71], v[240:243], v[236:239], v[68:71]
    v_cvt_pk_bf16_f32 v24, v24, v25
    v_cvt_pk_bf16_f32 v25, v26, v27
    v_cvt_pk_bf16_f32 v26, v28, v29
    v_cvt_pk_bf16_f32 v27, v30, v31
    s_add_u32 s51, s74, 3072
    buffer_store_dwordx4 v[24:27], v249, s[32:35], s51 offen sc1
    v_cvt_pk_bf16_f32 v32, v32, v33
    v_cvt_pk_bf16_f32 v33, v34, v35
    v_cvt_pk_bf16_f32 v34, v36, v37
    v_cvt_pk_bf16_f32 v35, v38, v39
    s_add_u32 s51, s74, 4096
    buffer_store_dwordx4 v[32:35], v249, s[32:35], s51 offen sc1
    s_waitcnt lgkmcnt(0)
    v_mfma_f32_16x16x32_bf16 v[72:75], v[244:247], v[216:219], v[72:75]
    ds_read_b128 v[216:219], v249 offset:6144
    v_mfma_f32_16x16x32_bf16 v[76:79], v[244:247], v[220:223], v[76:79]
    ds_read_b128 v[220:223], v249 offset:7168
    v_mfma_f32_16x16x32_bf16 v[80:83], v[244:247], v[224:227], v[80:83]
    ds_read_b128 v[224:227], v249 offset:8192
    v_mfma_f32_16x16x32_bf16 v[84:87], v[244:247], v[228:231], v[84:87]
    ds_read_b128 v[228:231], v249 offset:9216
    v_mfma_f32_16x16x32_bf16 v[88:91], v[244:247], v[232:235], v[88:91]
    ds_read_b128 v[232:235], v249 offset:10240
    v_mfma_f32_16x16x32_bf16 v[92:95], v[244:247], v[236:239], v[92:95]
    ds_read_b128 v[236:239], v249 offset:11264
    ds_read_b64_tr_b16 v[240:241], v248 offset:49152
    ds_read_b64_tr_b16 v[242:243], v248 offset:51200
    s_waitcnt lgkmcnt(8)
    s_barrier
    ds_read_b64_tr_b16 v[244:245], v248 offset:53248
    ds_read_b64_tr_b16 v[246:247], v248 offset:55296
    v_cvt_pk_bf16_f32 v40, v40, v41
    v_cvt_pk_bf16_f32 v41, v42, v43
    v_cvt_pk_bf16_f32 v42, v44, v45
    v_cvt_pk_bf16_f32 v43, v46, v47
    s_add_u32 s51, s74, 5120
    buffer_store_dwordx4 v[40:43], v249, s[32:35], s51 offen sc1
    s_waitcnt lgkmcnt(2)
    v_mfma_f32_16x16x32_bf16 v[48:51], v[240:243], v[216:219], v[48:51]
    v_mfma_f32_16x16x32_bf16 v[52:55], v[240:243], v[220:223], v[52:55]
    v_mfma_f32_16x16x32_bf16 v[56:59], v[240:243], v[224:227], v[56:59]
    v_mfma_f32_16x16x32_bf16 v[60:63], v[240:243], v[228:231], v[60:63]
    v_mfma_f32_16x16x32_bf16 v[64:67], v[240:243], v[232:235], v[64:67]
    v_mfma_f32_16x16x32_bf16 v[68:71], v[240:243], v[236:239], v[68:71]
    ds_read_b64_tr_b16 v[240:241], v248 offset:0
    ds_read_b64_tr_b16 v[242:243], v248 offset:2048
    s_waitcnt lgkmcnt(2)
    v_mfma_f32_16x16x32_bf16 v[72:75], v[244:247], v[216:219], v[72:75]
    ds_read_b128 v[216:219], v249 offset:30720
    v_mfma_f32_16x16x32_bf16 v[76:79], v[244:247], v[220:223], v[76:79]
    ds_read_b128 v[220:223], v249 offset:31744
    v_mfma_f32_16x16x32_bf16 v[80:83], v[244:247], v[224:227], v[80:83]
    ds_read_b128 v[224:227], v249 offset:32768
    v_mfma_f32_16x16x32_bf16 v[84:87], v[244:247], v[228:231], v[84:87]
    ds_read_b128 v[228:231], v249 offset:33792
    v_mfma_f32_16x16x32_bf16 v[88:91], v[244:247], v[232:235], v[88:91]
    ds_read_b128 v[232:235], v249 offset:34816
    v_mfma_f32_16x16x32_bf16 v[92:95], v[244:247], v[236:239], v[92:95]
    ds_read_b128 v[236:239], v249 offset:35840
    ds_read_b64_tr_b16 v[244:245], v248 offset:4096
    ds_read_b64_tr_b16 v[246:247], v248 offset:6144
    s_waitcnt lgkmcnt(7)
    v_mfma_f32_16x16x32_bf16 v[48:51], v[240:243], v[216:219], v[48:51]
    s_waitcnt lgkmcnt(6)
    v_mfma_f32_16x16x32_bf16 v[52:55], v[240:243], v[220:223], v[52:55]
    s_waitcnt lgkmcnt(5)
    v_mfma_f32_16x16x32_bf16 v[56:59], v[240:243], v[224:227], v[56:59]
    s_waitcnt lgkmcnt(4)
    v_mfma_f32_16x16x32_bf16 v[60:63], v[240:243], v[228:231], v[60:63]
    s_waitcnt lgkmcnt(3)
    v_mfma_f32_16x16x32_bf16 v[64:67], v[240:243], v[232:235], v[64:67]
    s_waitcnt lgkmcnt(2)
    v_mfma_f32_16x16x32_bf16 v[68:71], v[240:243], v[236:239], v[68:71]
    s_waitcnt lgkmcnt(0)
    v_mfma_f32_16x16x32_bf16 v[72:75], v[244:247], v[216:219], v[72:75]
    ds_read_b128 v[216:219], v249 offset:12288
    v_mfma_f32_16x16x32_bf16 v[76:79], v[244:247], v[220:223], v[76:79]
    ds_read_b128 v[220:223], v249 offset:13312
    v_mfma_f32_16x16x32_bf16 v[80:83], v[244:247], v[224:227], v[80:83]
    ds_read_b128 v[224:227], v249 offset:14336
    v_mfma_f32_16x16x32_bf16 v[84:87], v[244:247], v[228:231], v[84:87]
    ds_read_b128 v[228:231], v249 offset:15360
    v_mfma_f32_16x16x32_bf16 v[88:91], v[244:247], v[232:235], v[88:91]
    ds_read_b128 v[232:235], v249 offset:16384
    v_mfma_f32_16x16x32_bf16 v[92:95], v[244:247], v[236:239], v[92:95]
    ds_read_b128 v[236:239], v249 offset:17408
    ds_read_b64_tr_b16 v[240:241], v248 offset:8192
    ds_read_b64_tr_b16 v[242:243], v248 offset:10240
    s_waitcnt lgkmcnt(8)
    s_barrier
    ds_read_b64_tr_b16 v[244:245], v248 offset:12288
    ds_read_b64_tr_b16 v[246:247], v248 offset:14336
    s_waitcnt lgkmcnt(2)
    v_mfma_f32_16x16x32_bf16 v[48:51], v[240:243], v[216:219], v[48:51]
    v_mfma_f32_16x16x32_bf16 v[52:55], v[240:243], v[220:223], v[52:55]
    v_mfma_f32_16x16x32_bf16 v[56:59], v[240:243], v[224:227], v[56:59]
    v_mfma_f32_16x16x32_bf16 v[60:63], v[240:243], v[228:231], v[60:63]
    v_mfma_f32_16x16x32_bf16 v[64:67], v[240:243], v[232:235], v[64:67]
    v_mfma_f32_16x16x32_bf16 v[68:71], v[240:243], v[236:239], v[68:71]
    ds_read_b64_tr_b16 v[240:241], v248 offset:16384
    ds_read_b64_tr_b16 v[242:243], v248 offset:18432
    s_waitcnt lgkmcnt(2)
    v_mfma_f32_16x16x32_bf16 v[72:75], v[244:247], v[216:219], v[72:75]
    ds_read_b128 v[216:219], v249 offset:36864
    v_mfma_f32_16x16x32_bf16 v[76:79], v[244:247], v[220:223], v[76:79]
    ds_read_b128 v[220:223], v249 offset:37888
    v_mfma_f32_16x16x32_bf16 v[80:83], v[244:247], v[224:227], v[80:83]
    ds_read_b128 v[224:227], v249 offset:38912
    v_mfma_f32_16x16x32_bf16 v[84:87], v[244:247], v[228:231], v[84:87]
    ds_read_b128 v[228:231], v249 offset:39936
    v_mfma_f32_16x16x32_bf16 v[88:91], v[244:247], v[232:235], v[88:91]
    ds_read_b128 v[232:235], v249 offset:40960
    v_mfma_f32_16x16x32_bf16 v[92:95], v[244:247], v[236:239], v[92:95]
    ds_read_b128 v[236:239], v249 offset:41984
    ds_read_b64_tr_b16 v[244:245], v248 offset:20480
    ds_read_b64_tr_b16 v[246:247], v248 offset:22528
    s_waitcnt lgkmcnt(7)
    v_mfma_f32_16x16x32_bf16 v[48:51], v[240:243], v[216:219], v[48:51]
    s_waitcnt lgkmcnt(6)
    v_mfma_f32_16x16x32_bf16 v[52:55], v[240:243], v[220:223], v[52:55]
    s_waitcnt lgkmcnt(5)
    v_mfma_f32_16x16x32_bf16 v[56:59], v[240:243], v[224:227], v[56:59]
    s_waitcnt lgkmcnt(4)
    v_mfma_f32_16x16x32_bf16 v[60:63], v[240:243], v[228:231], v[60:63]
    s_waitcnt lgkmcnt(3)
    v_mfma_f32_16x16x32_bf16 v[64:67], v[240:243], v[232:235], v[64:67]
    s_waitcnt lgkmcnt(2)
    v_mfma_f32_16x16x32_bf16 v[68:71], v[240:243], v[236:239], v[68:71]
    s_waitcnt lgkmcnt(0)
    v_mfma_f32_16x16x32_bf16 v[72:75], v[244:247], v[216:219], v[72:75]
    ds_read_b128 v[216:219], v249 offset:18432
    v_mfma_f32_16x16x32_bf16 v[76:79], v[244:247], v[220:223], v[76:79]
    ds_read_b128 v[220:223], v249 offset:19456
    v_mfma_f32_16x16x32_bf16 v[80:83], v[244:247], v[224:227], v[80:83]
    ds_read_b128 v[224:227], v249 offset:20480
    v_mfma_f32_16x16x32_bf16 v[84:87], v[244:247], v[228:231], v[84:87]
    ds_read_b128 v[228:231], v249 offset:21504
    v_mfma_f32_16x16x32_bf16 v[88:91], v[244:247], v[232:235], v[88:91]
    ds_read_b128 v[232:235], v249 offset:22528
    v_mfma_f32_16x16x32_bf16 v[92:95], v[244:247], v[236:239], v[92:95]
    ds_read_b128 v[236:239], v249 offset:23552
    ds_read_b64_tr_b16 v[240:241], v248 offset:24576
    ds_read_b64_tr_b16 v[242:243], v248 offset:26624
    s_waitcnt lgkmcnt(8)
    s_barrier
    ds_read_b64_tr_b16 v[244:245], v248 offset:28672
    ds_read_b64_tr_b16 v[246:247], v248 offset:30720
    s_waitcnt lgkmcnt(2)
    v_mfma_f32_16x16x32_bf16 v[48:51], v[240:243], v[216:219], v[48:51]
    v_mfma_f32_16x16x32_bf16 v[52:55], v[240:243], v[220:223], v[52:55]
    v_mfma_f32_16x16x32_bf16 v[56:59], v[240:243], v[224:227], v[56:59]
    v_mfma_f32_16x16x32_bf16 v[60:63], v[240:243], v[228:231], v[60:63]
    v_mfma_f32_16x16x32_bf16 v[64:67], v[240:243], v[232:235], v[64:67]
    v_mfma_f32_16x16x32_bf16 v[68:71], v[240:243], v[236:239], v[68:71]
    ds_read_b64_tr_b16 v[240:241], v248 offset:32768
    ds_read_b64_tr_b16 v[242:243], v248 offset:34816
    s_waitcnt lgkmcnt(2)
    v_mfma_f32_16x16x32_bf16 v[72:75], v[244:247], v[216:219], v[72:75]
    ds_read_b128 v[216:219], v249 offset:43008
    v_mfma_f32_16x16x32_bf16 v[76:79], v[244:247], v[220:223], v[76:79]
    ds_read_b128 v[220:223], v249 offset:44032
    v_mfma_f32_16x16x32_bf16 v[80:83], v[244:247], v[224:227], v[80:83]
    ds_read_b128 v[224:227], v249 offset:45056
    v_mfma_f32_16x16x32_bf16 v[84:87], v[244:247], v[228:231], v[84:87]
    ds_read_b128 v[228:231], v249 offset:46080
    v_mfma_f32_16x16x32_bf16 v[88:91], v[244:247], v[232:235], v[88:91]
    ds_read_b128 v[232:235], v249 offset:47104
    v_mfma_f32_16x16x32_bf16 v[92:95], v[244:247], v[236:239], v[92:95]
    ds_read_b128 v[236:239], v249 offset:48128
    ds_read_b64_tr_b16 v[244:245], v248 offset:36864
    ds_read_b64_tr_b16 v[246:247], v248 offset:38912
    s_waitcnt lgkmcnt(7)
    v_mfma_f32_16x16x32_bf16 v[48:51], v[240:243], v[216:219], v[48:51]
    s_waitcnt lgkmcnt(6)
    v_mfma_f32_16x16x32_bf16 v[52:55], v[240:243], v[220:223], v[52:55]
    s_waitcnt lgkmcnt(5)
    v_mfma_f32_16x16x32_bf16 v[56:59], v[240:243], v[224:227], v[56:59]
    s_waitcnt lgkmcnt(4)
    v_mfma_f32_16x16x32_bf16 v[60:63], v[240:243], v[228:231], v[60:63]
    s_waitcnt lgkmcnt(3)
    v_mfma_f32_16x16x32_bf16 v[64:67], v[240:243], v[232:235], v[64:67]
    s_waitcnt lgkmcnt(2)
    v_mfma_f32_16x16x32_bf16 v[68:71], v[240:243], v[236:239], v[68:71]
    s_waitcnt lgkmcnt(0)
    v_mfma_f32_16x16x32_bf16 v[72:75], v[244:247], v[216:219], v[72:75]
    ds_read_b128 v[216:219], v249 offset:0
    v_mfma_f32_16x16x32_bf16 v[76:79], v[244:247], v[220:223], v[76:79]
    ds_read_b128 v[220:223], v249 offset:1024
    v_mfma_f32_16x16x32_bf16 v[80:83], v[244:247], v[224:227], v[80:83]
    ds_read_b128 v[224:227], v249 offset:2048
    v_mfma_f32_16x16x32_bf16 v[84:87], v[244:247], v[228:231], v[84:87]
    ds_read_b128 v[228:231], v249 offset:3072
    v_mfma_f32_16x16x32_bf16 v[88:91], v[244:247], v[232:235], v[88:91]
    ds_read_b128 v[232:235], v249 offset:4096
    v_mfma_f32_16x16x32_bf16 v[92:95], v[244:247], v[236:239], v[92:95]
    ds_read_b128 v[236:239], v249 offset:5120
    ds_read_b64_tr_b16 v[240:241], v248 offset:40960
    ds_read_b64_tr_b16 v[242:243], v248 offset:43008
    s_waitcnt lgkmcnt(8)
    s_barrier
    ds_read_b64_tr_b16 v[244:245], v248 offset:45056
    ds_read_b64_tr_b16 v[246:247], v248 offset:47104
    v_cvt_pk_bf16_f32 v48, v48, v49
    v_cvt_pk_bf16_f32 v49, v50, v51
    v_cvt_pk_bf16_f32 v50, v52, v53
    v_cvt_pk_bf16_f32 v51, v54, v55
    s_add_u32 s51, s75, 0
    buffer_store_dwordx4 v[48:51], v249, s[32:35], s51 offen sc1
    v_cvt_pk_bf16_f32 v56, v56, v57
    v_cvt_pk_bf16_f32 v57, v58, v59
    v_cvt_pk_bf16_f32 v58, v60, v61
    v_cvt_pk_bf16_f32 v59, v62, v63
    s_add_u32 s51, s75, 1024
    buffer_store_dwordx4 v[56:59], v249, s[32:35], s51 offen sc1
    s_waitcnt lgkmcnt(2)
    v_mfma_f32_16x16x32_bf16 v[96:99], v[240:243], v[216:219], v[96:99]
    v_mfma_f32_16x16x32_bf16 v[100:103], v[240:243], v[220:223], v[100:103]
    v_mfma_f32_16x16x32_bf16 v[104:107], v[240:243], v[224:227], v[104:107]
    v_mfma_f32_16x16x32_bf16 v[108:111], v[240:243], v[228:231], v[108:111]
    v_mfma_f32_16x16x32_bf16 v[112:115], v[240:243], v[232:235], v[112:115]
    v_mfma_f32_16x16x32_bf16 v[116:119], v[240:243], v[236:239], v[116:119]
    ds_read_b64_tr_b16 v[240:241], v248 offset:49152
    ds_read_b64_tr_b16 v[242:243], v248 offset:51200
    v_cvt_pk_bf16_f32 v64, v64, v65
    v_cvt_pk_bf16_f32 v65, v66, v67
    v_cvt_pk_bf16_f32 v66, v68, v69
    v_cvt_pk_bf16_f32 v67, v70, v71
    s_add_u32 s51, s75, 2048
    buffer_store_dwordx4 v[64:67], v249, s[32:35], s51 offen sc1
    v_cvt_pk_bf16_f32 v72, v72, v73
    v_cvt_pk_bf16_f32 v73, v74, v75
    v_cvt_pk_bf16_f32 v74, v76, v77
    v_cvt_pk_bf16_f32 v75, v78, v79
    s_add_u32 s51, s75, 3072
    buffer_store_dwordx4 v[72:75], v249, s[32:35], s51 offen sc1
    s_waitcnt lgkmcnt(2)
    v_mfma_f32_16x16x32_bf16 v[120:123], v[244:247], v[216:219], v[120:123]
    ds_read_b128 v[216:219], v249 offset:24576
    v_mfma_f32_16x16x32_bf16 v[124:127], v[244:247], v[220:223], v[124:127]
    ds_read_b128 v[220:223], v249 offset:25600
    v_mfma_f32_16x16x32_bf16 v[128:131], v[244:247], v[224:227], v[128:131]
    ds_read_b128 v[224:227], v249 offset:26624
    v_mfma_f32_16x16x32_bf16 v[132:135], v[244:247], v[228:231], v[132:135]
    ds_read_b128 v[228:231], v249 offset:27648
    v_mfma_f32_16x16x32_bf16 v[136:139], v[244:247], v[232:235], v[136:139]
    ds_read_b128 v[232:235], v249 offset:28672
    v_mfma_f32_16x16x32_bf16 v[140:143], v[244:247], v[236:239], v[140:143]
    ds_read_b128 v[236:239], v249 offset:29696
    ds_read_b64_tr_b16 v[244:245], v248 offset:53248
    ds_read_b64_tr_b16 v[246:247], v248 offset:55296
    v_cvt_pk_bf16_f32 v80, v80, v81
    v_cvt_pk_bf16_f32 v81, v82, v83
    v_cvt_pk_bf16_f32 v82, v84, v85
    v_cvt_pk_bf16_f32 v83, v86, v87
    s_add_u32 s51, s75, 4096
    buffer_store_dwordx4 v[80:83], v249, s[32:35], s51 offen sc1
    v_cvt_pk_bf16_f32 v88, v88, v89
    v_cvt_pk_bf16_f32 v89, v90, v91
    v_cvt_pk_bf16_f32 v90, v92, v93
    v_cvt_pk_bf16_f32 v91, v94, v95
    s_add_u32 s51, s75, 5120
    buffer_store_dwordx4 v[88:91], v249, s[32:35], s51 offen sc1
    s_waitcnt lgkmcnt(7)
    v_mfma_f32_16x16x32_bf16 v[96:99], v[240:243], v[216:219], v[96:99]
    s_waitcnt lgkmcnt(6)
    v_mfma_f32_16x16x32_bf16 v[100:103], v[240:243], v[220:223], v[100:103]
    s_waitcnt lgkmcnt(5)
    v_mfma_f32_16x16x32_bf16 v[104:107], v[240:243], v[224:227], v[104:107]
    s_waitcnt lgkmcnt(4)
    v_mfma_f32_16x16x32_bf16 v[108:111], v[240:243], v[228:231], v[108:111]
    s_waitcnt lgkmcnt(3)
    v_mfma_f32_16x16x32_bf16 v[112:115], v[240:243], v[232:235], v[112:115]
    s_waitcnt lgkmcnt(2)
    v_mfma_f32_16x16x32_bf16 v[116:119], v[240:243], v[236:239], v[116:119]
    s_waitcnt lgkmcnt(0)
    v_mfma_f32_16x16x32_bf16 v[120:123], v[244:247], v[216:219], v[120:123]
    ds_read_b128 v[216:219], v249 offset:6144
    v_mfma_f32_16x16x32_bf16 v[124:127], v[244:247], v[220:223], v[124:127]
    ds_read_b128 v[220:223], v249 offset:7168
    v_mfma_f32_16x16x32_bf16 v[128:131], v[244:247], v[224:227], v[128:131]
    ds_read_b128 v[224:227], v249 offset:8192
    v_mfma_f32_16x16x32_bf16 v[132:135], v[244:247], v[228:231], v[132:135]
    ds_read_b128 v[228:231], v249 offset:9216
    v_mfma_f32_16x16x32_bf16 v[136:139], v[244:247], v[232:235], v[136:139]
    ds_read_b128 v[232:235], v249 offset:10240
    v_mfma_f32_16x16x32_bf16 v[140:143], v[244:247], v[236:239], v[140:143]
    ds_read_b128 v[236:239], v249 offset:11264
    ds_read_b64_tr_b16 v[240:241], v248 offset:8192
    ds_read_b64_tr_b16 v[242:243], v248 offset:10240
    s_waitcnt lgkmcnt(8)
    s_barrier
    ds_read_b64_tr_b16 v[244:245], v248 offset:12288
    ds_read_b64_tr_b16 v[246:247], v248 offset:14336
    s_waitcnt lgkmcnt(2)
    v_mfma_f32_16x16x32_bf16 v[96:99], v[240:243], v[216:219], v[96:99]
    v_mfma_f32_16x16x32_bf16 v[100:103], v[240:243], v[220:223], v[100:103]
    v_mfma_f32_16x16x32_bf16 v[104:107], v[240:243], v[224:227], v[104:107]
    v_mfma_f32_16x16x32_bf16 v[108:111], v[240:243], v[228:231], v[108:111]
    v_mfma_f32_16x16x32_bf16 v[112:115], v[240:243], v[232:235], v[112:115]
    v_mfma_f32_16x16x32_bf16 v[116:119], v[240:243], v[236:239], v[116:119]
    ds_read_b64_tr_b16 v[240:241], v248 offset:16384
    ds_read_b64_tr_b16 v[242:243], v248 offset:18432
    s_waitcnt lgkmcnt(2)
    v_mfma_f32_16x16x32_bf16 v[120:123], v[244:247], v[216:219], v[120:123]
    ds_read_b128 v[216:219], v249 offset:30720
    v_mfma_f32_16x16x32_bf16 v[124:127], v[244:247], v[220:223], v[124:127]
    ds_read_b128 v[220:223], v249 offset:31744
    v_mfma_f32_16x16x32_bf16 v[128:131], v[244:247], v[224:227], v[128:131]
    ds_read_b128 v[224:227], v249 offset:32768
    v_mfma_f32_16x16x32_bf16 v[132:135], v[244:247], v[228:231], v[132:135]
    ds_read_b128 v[228:231], v249 offset:33792
    v_mfma_f32_16x16x32_bf16 v[136:139], v[244:247], v[232:235], v[136:139]
    ds_read_b128 v[232:235], v249 offset:34816
    v_mfma_f32_16x16x32_bf16 v[140:143], v[244:247], v[236:239], v[140:143]
    ds_read_b128 v[236:239], v249 offset:35840
    ds_read_b64_tr_b16 v[244:245], v248 offset:20480
    ds_read_b64_tr_b16 v[246:247], v248 offset:22528
    s_waitcnt lgkmcnt(7)
    v_mfma_f32_16x16x32_bf16 v[96:99], v[240:243], v[216:219], v[96:99]
    s_waitcnt lgkmcnt(6)
    v_mfma_f32_16x16x32_bf16 v[100:103], v[240:243], v[220:223], v[100:103]
    s_waitcnt lgkmcnt(5)
    v_mfma_f32_16x16x32_bf16 v[104:107], v[240:243], v[224:227], v[104:107]
    s_waitcnt lgkmcnt(4)
    v_mfma_f32_16x16x32_bf16 v[108:111], v[240:243], v[228:231], v[108:111]
    s_waitcnt lgkmcnt(3)
    v_mfma_f32_16x16x32_bf16 v[112:115], v[240:243], v[232:235], v[112:115]
    s_waitcnt lgkmcnt(2)
    v_mfma_f32_16x16x32_bf16 v[116:119], v[240:243], v[236:239], v[116:119]
    s_waitcnt lgkmcnt(0)
    v_mfma_f32_16x16x32_bf16 v[120:123], v[244:247], v[216:219], v[120:123]
    ds_read_b128 v[216:219], v249 offset:12288
    v_mfma_f32_16x16x32_bf16 v[124:127], v[244:247], v[220:223], v[124:127]
    ds_read_b128 v[220:223], v249 offset:13312
    v_mfma_f32_16x16x32_bf16 v[128:131], v[244:247], v[224:227], v[128:131]
    ds_read_b128 v[224:227], v249 offset:14336
    v_mfma_f32_16x16x32_bf16 v[132:135], v[244:247], v[228:231], v[132:135]
    ds_read_b128 v[228:231], v249 offset:15360
    v_mfma_f32_16x16x32_bf16 v[136:139], v[244:247], v[232:235], v[136:139]
    ds_read_b128 v[232:235], v249 offset:16384
    v_mfma_f32_16x16x32_bf16 v[140:143], v[244:247], v[236:239], v[140:143]
    ds_read_b128 v[236:239], v249 offset:17408
    ds_read_b64_tr_b16 v[240:241], v248 offset:24576
    ds_read_b64_tr_b16 v[242:243], v248 offset:26624
    s_waitcnt lgkmcnt(8)
    s_barrier
    ds_read_b64_tr_b16 v[244:245], v248 offset:28672
    ds_read_b64_tr_b16 v[246:247], v248 offset:30720
    s_waitcnt lgkmcnt(2)
    v_mfma_f32_16x16x32_bf16 v[96:99], v[240:243], v[216:219], v[96:99]
    v_mfma_f32_16x16x32_bf16 v[100:103], v[240:243], v[220:223], v[100:103]
    v_mfma_f32_16x16x32_bf16 v[104:107], v[240:243], v[224:227], v[104:107]
    v_mfma_f32_16x16x32_bf16 v[108:111], v[240:243], v[228:231], v[108:111]
    v_mfma_f32_16x16x32_bf16 v[112:115], v[240:243], v[232:235], v[112:115]
    v_mfma_f32_16x16x32_bf16 v[116:119], v[240:243], v[236:239], v[116:119]
    ds_read_b64_tr_b16 v[240:241], v248 offset:32768
    ds_read_b64_tr_b16 v[242:243], v248 offset:34816
    s_waitcnt lgkmcnt(2)
    v_mfma_f32_16x16x32_bf16 v[120:123], v[244:247], v[216:219], v[120:123]
    ds_read_b128 v[216:219], v249 offset:36864
    v_mfma_f32_16x16x32_bf16 v[124:127], v[244:247], v[220:223], v[124:127]
    ds_read_b128 v[220:223], v249 offset:37888
    v_mfma_f32_16x16x32_bf16 v[128:131], v[244:247], v[224:227], v[128:131]
    ds_read_b128 v[224:227], v249 offset:38912
    v_mfma_f32_16x16x32_bf16 v[132:135], v[244:247], v[228:231], v[132:135]
    ds_read_b128 v[228:231], v249 offset:39936
    v_mfma_f32_16x16x32_bf16 v[136:139], v[244:247], v[232:235], v[136:139]
    ds_read_b128 v[232:235], v249 offset:40960
    v_mfma_f32_16x16x32_bf16 v[140:143], v[244:247], v[236:239], v[140:143]
    ds_read_b128 v[236:239], v249 offset:41984
    ds_read_b64_tr_b16 v[244:245], v248 offset:36864
    ds_read_b64_tr_b16 v[246:247], v248 offset:38912
    s_waitcnt lgkmcnt(7)
    v_mfma_f32_16x16x32_bf16 v[96:99], v[240:243], v[216:219], v[96:99]
    s_waitcnt lgkmcnt(6)
    v_mfma_f32_16x16x32_bf16 v[100:103], v[240:243], v[220:223], v[100:103]
    s_waitcnt lgkmcnt(5)
    v_mfma_f32_16x16x32_bf16 v[104:107], v[240:243], v[224:227], v[104:107]
    s_waitcnt lgkmcnt(4)
    v_mfma_f32_16x16x32_bf16 v[108:111], v[240:243], v[228:231], v[108:111]
    s_waitcnt lgkmcnt(3)
    v_mfma_f32_16x16x32_bf16 v[112:115], v[240:243], v[232:235], v[112:115]
    s_waitcnt lgkmcnt(2)
    v_mfma_f32_16x16x32_bf16 v[116:119], v[240:243], v[236:239], v[116:119]
    s_waitcnt lgkmcnt(0)
    v_mfma_f32_16x16x32_bf16 v[120:123], v[244:247], v[216:219], v[120:123]
    ds_read_b128 v[216:219], v249 offset:18432
    v_mfma_f32_16x16x32_bf16 v[124:127], v[244:247], v[220:223], v[124:127]
    ds_read_b128 v[220:223], v249 offset:19456
    v_mfma_f32_16x16x32_bf16 v[128:131], v[244:247], v[224:227], v[128:131]
    ds_read_b128 v[224:227], v249 offset:20480
    v_mfma_f32_16x16x32_bf16 v[132:135], v[244:247], v[228:231], v[132:135]
    ds_read_b128 v[228:231], v249 offset:21504
    v_mfma_f32_16x16x32_bf16 v[136:139], v[244:247], v[232:235], v[136:139]
    ds_read_b128 v[232:235], v249 offset:22528
    v_mfma_f32_16x16x32_bf16 v[140:143], v[244:247], v[236:239], v[140:143]
    ds_read_b128 v[236:239], v249 offset:23552
    ds_read_b64_tr_b16 v[240:241], v248 offset:40960
    ds_read_b64_tr_b16 v[242:243], v248 offset:43008
    s_waitcnt lgkmcnt(8)
    s_barrier
    ds_read_b64_tr_b16 v[244:245], v248 offset:45056
    ds_read_b64_tr_b16 v[246:247], v248 offset:47104
    s_waitcnt lgkmcnt(2)
    v_mfma_f32_16x16x32_bf16 v[96:99], v[240:243], v[216:219], v[96:99]
    v_mfma_f32_16x16x32_bf16 v[100:103], v[240:243], v[220:223], v[100:103]
    v_mfma_f32_16x16x32_bf16 v[104:107], v[240:243], v[224:227], v[104:107]
    v_mfma_f32_16x16x32_bf16 v[108:111], v[240:243], v[228:231], v[108:111]
    v_mfma_f32_16x16x32_bf16 v[112:115], v[240:243], v[232:235], v[112:115]
    v_mfma_f32_16x16x32_bf16 v[116:119], v[240:243], v[236:239], v[116:119]
    ds_read_b64_tr_b16 v[240:241], v248 offset:49152
    ds_read_b64_tr_b16 v[242:243], v248 offset:51200
    s_waitcnt lgkmcnt(2)
    v_mfma_f32_16x16x32_bf16 v[120:123], v[244:247], v[216:219], v[120:123]
    ds_read_b128 v[216:219], v249 offset:43008
    v_mfma_f32_16x16x32_bf16 v[124:127], v[244:247], v[220:223], v[124:127]
    ds_read_b128 v[220:223], v249 offset:44032
    v_mfma_f32_16x16x32_bf16 v[128:131], v[244:247], v[224:227], v[128:131]
    ds_read_b128 v[224:227], v249 offset:45056
    v_mfma_f32_16x16x32_bf16 v[132:135], v[244:247], v[228:231], v[132:135]
    ds_read_b128 v[228:231], v249 offset:46080
    v_mfma_f32_16x16x32_bf16 v[136:139], v[244:247], v[232:235], v[136:139]
    ds_read_b128 v[232:235], v249 offset:47104
    v_mfma_f32_16x16x32_bf16 v[140:143], v[244:247], v[236:239], v[140:143]
    ds_read_b128 v[236:239], v249 offset:48128
    ds_read_b64_tr_b16 v[244:245], v248 offset:53248
    ds_read_b64_tr_b16 v[246:247], v248 offset:55296
    s_waitcnt lgkmcnt(7)
    v_mfma_f32_16x16x32_bf16 v[96:99], v[240:243], v[216:219], v[96:99]
    s_waitcnt lgkmcnt(6)
    v_mfma_f32_16x16x32_bf16 v[100:103], v[240:243], v[220:223], v[100:103]
    s_waitcnt lgkmcnt(5)
    v_mfma_f32_16x16x32_bf16 v[104:107], v[240:243], v[224:227], v[104:107]
    s_waitcnt lgkmcnt(4)
    v_mfma_f32_16x16x32_bf16 v[108:111], v[240:243], v[228:231], v[108:111]
    s_waitcnt lgkmcnt(3)
    v_mfma_f32_16x16x32_bf16 v[112:115], v[240:243], v[232:235], v[112:115]
    s_waitcnt lgkmcnt(2)
    v_mfma_f32_16x16x32_bf16 v[116:119], v[240:243], v[236:239], v[116:119]
    s_waitcnt lgkmcnt(0)
    v_mfma_f32_16x16x32_bf16 v[120:123], v[244:247], v[216:219], v[120:123]
    ds_read_b128 v[216:219], v249 offset:0
    v_mfma_f32_16x16x32_bf16 v[124:127], v[244:247], v[220:223], v[124:127]
    ds_read_b128 v[220:223], v249 offset:1024
    v_mfma_f32_16x16x32_bf16 v[128:131], v[244:247], v[224:227], v[128:131]
    ds_read_b128 v[224:227], v249 offset:2048
    v_mfma_f32_16x16x32_bf16 v[132:135], v[244:247], v[228:231], v[132:135]
    ds_read_b128 v[228:231], v249 offset:3072
    v_mfma_f32_16x16x32_bf16 v[136:139], v[244:247], v[232:235], v[136:139]
    ds_read_b128 v[232:235], v249 offset:4096
    v_mfma_f32_16x16x32_bf16 v[140:143], v[244:247], v[236:239], v[140:143]
    ds_read_b128 v[236:239], v249 offset:5120
    s_waitcnt lgkmcnt(6)
    s_barrier
    ds_read_b64_tr_b16 v[240:241], v250 offset:45056
    ds_read_b64_tr_b16 v[242:243], v250 offset:47104
    ds_read_b64_tr_b16 v[244:245], v250 offset:40960
    ds_read_b64_tr_b16 v[246:247], v250 offset:43008
    v_cvt_pk_bf16_f32 v96, v96, v97
    v_cvt_pk_bf16_f32 v97, v98, v99
    v_cvt_pk_bf16_f32 v98, v100, v101
    v_cvt_pk_bf16_f32 v99, v102, v103
    s_add_u32 s51, s76, 0
    buffer_store_dwordx4 v[96:99], v249, s[32:35], s51 offen sc1
    v_cvt_pk_bf16_f32 v104, v104, v105
    v_cvt_pk_bf16_f32 v105, v106, v107
    v_cvt_pk_bf16_f32 v106, v108, v109
    v_cvt_pk_bf16_f32 v107, v110, v111
    s_add_u32 s51, s76, 1024
    buffer_store_dwordx4 v[104:107], v249, s[32:35], s51 offen sc1
    s_waitcnt lgkmcnt(2)
    v_mfma_f32_16x16x32_bf16 v[144:147], v[240:243], v[216:219], v[144:147]
    v_mfma_f32_16x16x32_bf16 v[148:151], v[240:243], v[220:223], v[148:151]
    v_mfma_f32_16x16x32_bf16 v[152:155], v[240:243], v[224:227], v[152:155]
    v_mfma_f32_16x16x32_bf16 v[156:159], v[240:243], v[228:231], v[156:159]
    v_mfma_f32_16x16x32_bf16 v[160:163], v[240:243], v[232:235], v[160:163]
    v_mfma_f32_16x16x32_bf16 v[164:167], v[240:243], v[236:239], v[164:167]
    ds_read_b64_tr_b16 v[240:241], v250 offset:36864
    ds_read_b64_tr_b16 v[242:243], v250 offset:38912
    v_cvt_pk_bf16_f32 v112, v112, v113
    v_cvt_pk_bf16_f32 v113, v114, v115
    v_cvt_pk_bf16_f32 v114, v116, v117
    v_cvt_pk_bf16_f32 v115, v118, v119
    s_add_u32 s51, s76, 2048
    buffer_store_dwordx4 v[112:115], v249, s[32:35], s51 offen sc1
    v_cvt_pk_bf16_f32 v120, v120, v121
    v_cvt_pk_bf16_f32 v121, v122, v123
    v_cvt_pk_bf16_f32 v122, v124, v125
    v_cvt_pk_bf16_f32 v123, v126, v127
    s_add_u32 s51, s76, 3072
    buffer_store_dwordx4 v[120:123], v249, s[32:35], s51 offen sc1
    s_waitcnt lgkmcnt(2)
    v_mfma_f32_16x16x32_bf16 v[168:171], v[244:247], v[216:219], v[168:171]
    ds_read_b128 v[216:219], v249 offset:24576
    v_mfma_f32_16x16x32_bf16 v[172:175], v[244:247], v[220:223], v[172:175]
    ds_read_b128 v[220:223], v249 offset:25600
    v_mfma_f32_16x16x32_bf16 v[176:179], v[244:247], v[224:227], v[176:179]
    ds_read_b128 v[224:227], v249 offset:26624
    v_mfma_f32_16x16x32_bf16 v[180:183], v[244:247], v[228:231], v[180:183]
    ds_read_b128 v[228:231], v249 offset:27648
    v_mfma_f32_16x16x32_bf16 v[184:187], v[244:247], v[232:235], v[184:187]
    ds_read_b128 v[232:235], v249 offset:28672
    v_mfma_f32_16x16x32_bf16 v[188:191], v[244:247], v[236:239], v[188:191]
    ds_read_b128 v[236:239], v249 offset:29696
    ds_read_b64_tr_b16 v[244:245], v250 offset:32768
    ds_read_b64_tr_b16 v[246:247], v250 offset:34816
    v_cvt_pk_bf16_f32 v128, v128, v129
    v_cvt_pk_bf16_f32 v129, v130, v131
    v_cvt_pk_bf16_f32 v130, v132, v133
    v_cvt_pk_bf16_f32 v131, v134, v135
    s_add_u32 s51, s76, 4096
    buffer_store_dwordx4 v[128:131], v249, s[32:35], s51 offen sc1
    v_cvt_pk_bf16_f32 v136, v136, v137
    v_cvt_pk_bf16_f32 v137, v138, v139
    v_cvt_pk_bf16_f32 v138, v140, v141
    v_cvt_pk_bf16_f32 v139, v142, v143
    s_add_u32 s51, s76, 5120
    buffer_store_dwordx4 v[136:139], v249, s[32:35], s51 offen sc1
    s_waitcnt lgkmcnt(7)
    v_mfma_f32_16x16x32_bf16 v[144:147], v[240:243], v[216:219], v[144:147]
    s_waitcnt lgkmcnt(6)
    v_mfma_f32_16x16x32_bf16 v[148:151], v[240:243], v[220:223], v[148:151]
    s_waitcnt lgkmcnt(5)
    v_mfma_f32_16x16x32_bf16 v[152:155], v[240:243], v[224:227], v[152:155]
    s_waitcnt lgkmcnt(4)
    v_mfma_f32_16x16x32_bf16 v[156:159], v[240:243], v[228:231], v[156:159]
    s_waitcnt lgkmcnt(3)
    v_mfma_f32_16x16x32_bf16 v[160:163], v[240:243], v[232:235], v[160:163]
    s_waitcnt lgkmcnt(2)
    v_mfma_f32_16x16x32_bf16 v[164:167], v[240:243], v[236:239], v[164:167]
    ds_read_b64_tr_b16 v[240:241], v250 offset:28672
    ds_read_b64_tr_b16 v[242:243], v250 offset:30720
    s_waitcnt lgkmcnt(2)
    v_mfma_f32_16x16x32_bf16 v[168:171], v[244:247], v[216:219], v[168:171]
    ds_read_b128 v[216:219], v249 offset:6144
    v_mfma_f32_16x16x32_bf16 v[172:175], v[244:247], v[220:223], v[172:175]
    ds_read_b128 v[220:223], v249 offset:7168
    v_mfma_f32_16x16x32_bf16 v[176:179], v[244:247], v[224:227], v[176:179]
    ds_read_b128 v[224:227], v249 offset:8192
    v_mfma_f32_16x16x32_bf16 v[180:183], v[244:247], v[228:231], v[180:183]
    ds_read_b128 v[228:231], v249 offset:9216
    v_mfma_f32_16x16x32_bf16 v[184:187], v[244:247], v[232:235], v[184:187]
    ds_read_b128 v[232:235], v249 offset:10240
    v_mfma_f32_16x16x32_bf16 v[188:191], v[244:247], v[236:239], v[188:191]
    ds_read_b128 v[236:239], v249 offset:11264
    s_barrier
    s_waitcnt vmcnt(12)
    s_mov_b32 exec_lo, s12
    s_mov_b32 exec_hi, 0
    buffer_store_dword v253, v251, s[32:35], s73 offen sc1
    s_mov_b64 exec, -1
    ds_read_b64_tr_b16 v[244:245], v250 offset:24576
    ds_read_b64_tr_b16 v[246:247], v250 offset:26624
    s_waitcnt lgkmcnt(7)
    v_mfma_f32_16x16x32_bf16 v[144:147], v[240:243], v[216:219], v[144:147]
    s_waitcnt lgkmcnt(6)
    v_mfma_f32_16x16x32_bf16 v[148:151], v[240:243], v[220:223], v[148:151]
    s_waitcnt lgkmcnt(5)
    v_mfma_f32_16x16x32_bf16 v[152:155], v[240:243], v[224:227], v[152:155]
    s_waitcnt lgkmcnt(4)
    v_mfma_f32_16x16x32_bf16 v[156:159], v[240:243], v[228:231], v[156:159]
    s_waitcnt lgkmcnt(3)
    v_mfma_f32_16x16x32_bf16 v[160:163], v[240:243], v[232:235], v[160:163]
    s_waitcnt lgkmcnt(2)
    v_mfma_f32_16x16x32_bf16 v[164:167], v[240:243], v[236:239], v[164:167]
    ds_read_b64_tr_b16 v[240:241], v250 offset:20480
    ds_read_b64_tr_b16 v[242:243], v250 offset:22528
    s_waitcnt lgkmcnt(2)
    v_mfma_f32_16x16x32_bf16 v[168:171], v[244:247], v[216:219], v[168:171]
    ds_read_b128 v[216:219], v249 offset:30720
    v_mfma_f32_16x16x32_bf16 v[172:175], v[244:247], v[220:223], v[172:175]
    ds_read_b128 v[220:223], v249 offset:31744
    v_mfma_f32_16x16x32_bf16 v[176:179], v[244:247], v[224:227], v[176:179]
    ds_read_b128 v[224:227], v249 offset:32768
    v_mfma_f32_16x16x32_bf16 v[180:183], v[244:247], v[228:231], v[180:183]
    ds_read_b128 v[228:231], v249 offset:33792
    v_mfma_f32_16x16x32_bf16 v[184:187], v[244:247], v[232:235], v[184:187]
    ds_read_b128 v[232:235], v249 offset:34816
    v_mfma_f32_16x16x32_bf16 v[188:191], v[244:247], v[236:239], v[188:191]
    ds_read_b128 v[236:239], v249 offset:35840
    ds_read_b64_tr_b16 v[244:245], v250 offset:16384
    ds_read_b64_tr_b16 v[246:247], v250 offset:18432
    s_waitcnt lgkmcnt(7)
    v_mfma_f32_16x16x32_bf16 v[144:147], v[240:243], v[216:219], v[144:147]
    s_waitcnt lgkmcnt(6)
    v_mfma_f32_16x16x32_bf16 v[148:151], v[240:243], v[220:223], v[148:151]
    s_waitcnt lgkmcnt(5)
    v_mfma_f32_16x16x32_bf16 v[152:155], v[240:243], v[224:227], v[152:155]
    s_waitcnt lgkmcnt(4)
    v_mfma_f32_16x16x32_bf16 v[156:159], v[240:243], v[228:231], v[156:159]
    s_waitcnt lgkmcnt(3)
    v_mfma_f32_16x16x32_bf16 v[160:163], v[240:243], v[232:235], v[160:163]
    s_waitcnt lgkmcnt(2)
    v_mfma_f32_16x16x32_bf16 v[164:167], v[240:243], v[236:239], v[164:167]
    ds_read_b64_tr_b16 v[240:241], v250 offset:12288
    ds_read_b64_tr_b16 v[242:243], v250 offset:14336
    s_waitcnt lgkmcnt(2)
    v_mfma_f32_16x16x32_bf16 v[168:171], v[244:247], v[216:219], v[168:171]
    ds_read_b128 v[216:219], v249 offset:12288
    v_mfma_f32_16x16x32_bf16 v[172:175], v[244:247], v[220:223], v[172:175]
    ds_read_b128 v[220:223], v249 offset:13312
    v_mfma_f32_16x16x32_bf16 v[176:179], v[244:247], v[224:227], v[176:179]
    ds_read_b128 v[224:227], v249 offset:14336
    v_mfma_f32_16x16x32_bf16 v[180:183], v[244:247], v[228:231], v[180:183]
    ds_read_b128 v[228:231], v249 offset:15360
    v_mfma_f32_16x16x32_bf16 v[184:187], v[244:247], v[232:235], v[184:187]
    ds_read_b128 v[232:235], v249 offset:16384
    v_mfma_f32_16x16x32_bf16 v[188:191], v[244:247], v[236:239], v[188:191]
    ds_read_b128 v[236:239], v249 offset:17408
    ds_read_b64_tr_b16 v[244:245], v250 offset:8192
    ds_read_b64_tr_b16 v[246:247], v250 offset:10240
    s_waitcnt lgkmcnt(7)
    v_mfma_f32_16x16x32_bf16 v[144:147], v[240:243], v[216:219], v[144:147]
    s_waitcnt lgkmcnt(6)
    v_mfma_f32_16x16x32_bf16 v[148:151], v[240:243], v[220:223], v[148:151]
    s_waitcnt lgkmcnt(5)
    v_mfma_f32_16x16x32_bf16 v[152:155], v[240:243], v[224:227], v[152:155]
    s_waitcnt lgkmcnt(4)
    v_mfma_f32_16x16x32_bf16 v[156:159], v[240:243], v[228:231], v[156:159]
    s_waitcnt lgkmcnt(3)
    v_mfma_f32_16x16x32_bf16 v[160:163], v[240:243], v[232:235], v[160:163]
    s_waitcnt lgkmcnt(2)
    v_mfma_f32_16x16x32_bf16 v[164:167], v[240:243], v[236:239], v[164:167]
    ds_read_b64_tr_b16 v[240:241], v250 offset:4096
    ds_read_b64_tr_b16 v[242:243], v250 offset:6144
    s_waitcnt lgkmcnt(2)
    v_mfma_f32_16x16x32_bf16 v[168:171], v[244:247], v[216:219], v[168:171]
    ds_read_b128 v[216:219], v249 offset:36864
    v_mfma_f32_16x16x32_bf16 v[172:175], v[244:247], v[220:223], v[172:175]
    ds_read_b128 v[220:223], v249 offset:37888
    v_mfma_f32_16x16x32_bf16 v[176:179], v[244:247], v[224:227], v[176:179]
    ds_read_b128 v[224:227], v249 offset:38912
    v_mfma_f32_16x16x32_bf16 v[180:183], v[244:247], v[228:231], v[180:183]
    ds_read_b128 v[228:231], v249 offset:39936
    v_mfma_f32_16x16x32_bf16 v[184:187], v[244:247], v[232:235], v[184:187]
    ds_read_b128 v[232:235], v249 offset:40960
    v_mfma_f32_16x16x32_bf16 v[188:191], v[244:247], v[236:239], v[188:191]
    ds_read_b128 v[236:239], v249 offset:41984
    ds_read_b64_tr_b16 v[244:245], v250 offset:0
    ds_read_b64_tr_b16 v[246:247], v250 offset:2048
    s_waitcnt lgkmcnt(7)
    v_mfma_f32_16x16x32_bf16 v[144:147], v[240:243], v[216:219], v[144:147]
    s_waitcnt lgkmcnt(6)
    v_mfma_f32_16x16x32_bf16 v[148:151], v[240:243], v[220:223], v[148:151]
    s_waitcnt lgkmcnt(5)
    v_mfma_f32_16x16x32_bf16 v[152:155], v[240:243], v[224:227], v[152:155]
    s_waitcnt lgkmcnt(4)
    v_mfma_f32_16x16x32_bf16 v[156:159], v[240:243], v[228:231], v[156:159]
    s_waitcnt lgkmcnt(3)
    v_mfma_f32_16x16x32_bf16 v[160:163], v[240:243], v[232:235], v[160:163]
    s_waitcnt lgkmcnt(2)
    v_mfma_f32_16x16x32_bf16 v[164:167], v[240:243], v[236:239], v[164:167]
    ds_read_b64_tr_b16 v[240:241], v248 offset:61440
    ds_read_b64_tr_b16 v[242:243], v248 offset:63488
    s_waitcnt lgkmcnt(2)
    v_mfma_f32_16x16x32_bf16 v[168:171], v[244:247], v[216:219], v[168:171]
    ds_read_b128 v[216:219], v249 offset:18432
    v_mfma_f32_16x16x32_bf16 v[172:175], v[244:247], v[220:223], v[172:175]
    ds_read_b128 v[220:223], v249 offset:19456
    v_mfma_f32_16x16x32_bf16 v[176:179], v[244:247], v[224:227], v[176:179]
    ds_read_b128 v[224:227], v249 offset:20480
    v_mfma_f32_16x16x32_bf16 v[180:183], v[244:247], v[228:231], v[180:183]
    ds_read_b128 v[228:231], v249 offset:21504
    v_mfma_f32_16x16x32_bf16 v[184:187], v[244:247], v[232:235], v[184:187]
    ds_read_b128 v[232:235], v249 offset:22528
    v_mfma_f32_16x16x32_bf16 v[188:191], v[244:247], v[236:239], v[188:191]
    ds_read_b128 v[236:239], v249 offset:23552
    ds_read_b64_tr_b16 v[244:245], v248 offset:57344
    ds_read_b64_tr_b16 v[246:247], v248 offset:59392
    s_waitcnt lgkmcnt(7)
    v_mfma_f32_16x16x32_bf16 v[144:147], v[240:243], v[216:219], v[144:147]
    s_waitcnt lgkmcnt(6)
    v_mfma_f32_16x16x32_bf16 v[148:151], v[240:243], v[220:223], v[148:151]
    s_waitcnt lgkmcnt(5)
    v_mfma_f32_16x16x32_bf16 v[152:155], v[240:243], v[224:227], v[152:155]
    s_waitcnt lgkmcnt(4)
    v_mfma_f32_16x16x32_bf16 v[156:159], v[240:243], v[228:231], v[156:159]
    s_waitcnt lgkmcnt(3)
    v_mfma_f32_16x16x32_bf16 v[160:163], v[240:243], v[232:235], v[160:163]
    s_waitcnt lgkmcnt(2)
    v_mfma_f32_16x16x32_bf16 v[164:167], v[240:243], v[236:239], v[164:167]
    ds_read_b64_tr_b16 v[240:241], v248 offset:4096
    ds_read_b64_tr_b16 v[242:243], v248 offset:6144
    s_waitcnt lgkmcnt(2)
    v_mfma_f32_16x16x32_bf16 v[168:171], v[244:247], v[216:219], v[168:171]
    ds_read_b128 v[216:219], v249 offset:43008
    v_mfma_f32_16x16x32_bf16 v[172:175], v[244:247], v[220:223], v[172:175]
    ds_read_b128 v[220:223], v249 offset:44032
    v_mfma_f32_16x16x32_bf16 v[176:179], v[244:247], v[224:227], v[176:179]
    ds_read_b128 v[224:227], v249 offset:45056
    v_mfma_f32_16x16x32_bf16 v[180:183], v[244:247], v[228:231], v[180:183]
    ds_read_b128 v[228:231], v249 offset:46080
    v_mfma_f32_16x16x32_bf16 v[184:187], v[244:247], v[232:235], v[184:187]
    ds_read_b128 v[232:235], v249 offset:47104
    v_mfma_f32_16x16x32_bf16 v[188:191], v[244:247], v[236:239], v[188:191]
    ds_read_b128 v[236:239], v249 offset:48128
    ds_read_b64_tr_b16 v[244:245], v248 offset:0
    ds_read_b64_tr_b16 v[246:247], v248 offset:2048
    s_waitcnt lgkmcnt(7)
    v_mfma_f32_16x16x32_bf16 v[144:147], v[240:243], v[216:219], v[144:147]
    s_waitcnt lgkmcnt(6)
    v_mfma_f32_16x16x32_bf16 v[148:151], v[240:243], v[220:223], v[148:151]
    s_waitcnt lgkmcnt(5)
    v_mfma_f32_16x16x32_bf16 v[152:155], v[240:243], v[224:227], v[152:155]
    s_waitcnt lgkmcnt(4)
    v_mfma_f32_16x16x32_bf16 v[156:159], v[240:243], v[228:231], v[156:159]
    s_waitcnt lgkmcnt(3)
    v_mfma_f32_16x16x32_bf16 v[160:163], v[240:243], v[232:235], v[160:163]
    s_waitcnt lgkmcnt(2)
    v_mfma_f32_16x16x32_bf16 v[164:167], v[240:243], v[236:239], v[164:167]
    s_waitcnt lgkmcnt(0)
    v_mfma_f32_16x16x32_bf16 v[168:171], v[244:247], v[216:219], v[168:171]
    v_mfma_f32_16x16x32_bf16 v[172:175], v[244:247], v[220:223], v[172:175]
    v_mfma_f32_16x16x32_bf16 v[176:179], v[244:247], v[224:227], v[176:179]
    v_mfma_f32_16x16x32_bf16 v[180:183], v[244:247], v[228:231], v[180:183]
    v_mfma_f32_16x16x32_bf16 v[184:187], v[244:247], v[232:235], v[184:187]
    v_mfma_f32_16x16x32_bf16 v[188:191], v[244:247], v[236:239], v[188:191]
    s_waitcnt vmcnt(7)
    s_mov_b32 exec_lo, s13
    s_mov_b32 exec_hi, 0
    buffer_store_dword v253, v251, s[32:35], s73 offen sc1
    s_mov_b64 exec, -1
    ds_write_b128 v254, v[144:147] offset:0
    ds_write_b128 v254, v[148:151] offset:1024
    ds_write_b128 v254, v[152:155] offset:2048
    ds_write_b128 v254, v[156:159] offset:3072
    ds_write_b128 v254, v[160:163] offset:4096
    ds_write_b128 v254, v[164:167] offset:5120
    s_waitcnt vmcnt(2)
    s_mov_b32 exec_lo, s14
    s_mov_b32 exec_hi, 0
    buffer_store_dword v253, v251, s[32:35], s73 offen sc1
    s_mov_b64 exec, -1
    s_waitcnt lgkmcnt(0)
    s_barrier
    ds_read_b128 v[216:219], v254 offset:6144
    ds_read_b128 v[220:223], v254 offset:7168
    ds_read_b128 v[224:227], v254 offset:8192
    ds_read_b128 v[228:231], v254 offset:9216
    ds_read_b128 v[232:235], v254 offset:10240
    ds_read_b128 v[236:239], v254 offset:11264
    s_waitcnt lgkmcnt(5)
    v_add_f32 v168, v168, v216
    v_add_f32 v169, v169, v217
    v_add_f32 v170, v170, v218
    v_add_f32 v171, v171, v219
    s_waitcnt lgkmcnt(4)
    v_add_f32 v172, v172, v220
    v_add_f32 v173, v173, v221
    v_add_f32 v174, v174, v222
    v_add_f32 v175, v175, v223
    s_waitcnt lgkmcnt(3)
    v_add_f32 v176, v176, v224
    v_add_f32 v177, v177, v225
    v_add_f32 v178, v178, v226
    v_add_f32 v179, v179, v227
    s_waitcnt lgkmcnt(2)
    v_add_f32 v180, v180, v228
    v_add_f32 v181, v181, v229
    v_add_f32 v182, v182, v230
    v_add_f32 v183, v183, v231
    s_waitcnt lgkmcnt(1)
    v_add_f32 v184, v184, v232
    v_add_f32 v185, v185, v233
    v_add_f32 v186, v186, v234
    v_add_f32 v187, v187, v235
    s_waitcnt lgkmcnt(0)
    v_add_f32 v188, v188, v236
    v_add_f32 v189, v189, v237
    v_add_f32 v190, v190, v238
    v_add_f32 v191, v191, v239
    s_mov_b32 s80, 0
    s_mov_b32 exec_lo, s15
    s_mov_b32 exec_hi, 0
L_pollgf:
    buffer_load_dword v240, v249, s[32:35], s16 offen sc1
    s_waitcnt vmcnt(0)
    v_cmp_eq_u32 vcc, 0, v240
    s_nop 3
    s_cbranch_vccz L_polledgf
    s_sleep 2
    s_add_u32 s80, s80, 1
    s_cmp_lt_u32 s80, 4000000
    s_cbranch_scc1 L_pollgf
L_polledgf:
    s_mov_b64 exec, -1
    s_add_u32 s51, s17, 3072
    buffer_load_dwordx4 v[216:219], v249, s[32:35], s51 offen sc1
    s_add_u32 s51, s17, 4096
    buffer_load_dwordx4 v[220:223], v249, s[32:35], s51 offen sc1
    s_add_u32 s51, s17, 5120
    buffer_load_dwordx4 v[224:227], v249, s[32:35], s51 offen sc1
    s_waitcnt vmcnt(2)
    v_lshlrev_b32 v240, 16, v216
    v_and_b32 v241, 0xffff0000, v216
    v_add_f32 v168, v168, v240
    v_add_f32 v169, v169, v241
    v_lshlrev_b32 v240, 16, v217
    v_and_b32 v241, 0xffff0000, v217
    v_add_f32 v170, v170, v240
    v_add_f32 v171, v171, v241
    v_lshlrev_b32 v240, 16, v218
    v_and_b32 v241, 0xffff0000, v218
    v_add_f32 v172, v172, v240
    v_add_f32 v173, v173, v241
    v_lshlrev_b32 v240, 16, v219
    v_and_b32 v241, 0xffff0000, v219
    v_add_f32 v174, v174, v240
    v_add_f32 v175, v175, v241
    v_cvt_pk_bf16_f32 v168, v168, v169
    v_cvt_pk_bf16_f32 v169, v170, v171
    s_add_u32 s51, s55, 128
    buffer_store_dwordx2 v[168:169], v252, s[28:31], s51 offen
    v_cvt_pk_bf16_f32 v172, v172, v173
    v_cvt_pk_bf16_f32 v173, v174, v175
    s_add_u32 s51, s55, 36992
    buffer_store_dwordx2 v[172:173], v252, s[28:31], s51 offen
    s_waitcnt vmcnt(3)
    v_lshlrev_b32 v240, 16, v220
    v_and_b32 v241, 0xffff0000, v220
    v_add_f32 v176, v176, v240
    v_add_f32 v177, v177, v241
    v_lshlrev_b32 v240, 16, v221
    v_and_b32 v241, 0xffff0000, v221
    v_add_f32 v178, v178, v240
    v_add_f32 v179, v179, v241
    v_lshlrev_b32 v240, 16, v222
    v_and_b32 v241, 0xffff0000, v222
    v_add_f32 v180, v180, v240
    v_add_f32 v181, v181, v241
    v_lshlrev_b32 v240, 16, v223
    v_and_b32 v241, 0xffff0000, v223
    v_add_f32 v182, v182, v240
    v_add_f32 v183, v183, v241
    v_cvt_pk_bf16_f32 v176, v176, v177
    v_cvt_pk_bf16_f32 v177, v178, v179
    s_add_u32 s51, s55, 73856
    buffer_store_dwordx2 v[176:177], v252, s[28:31], s51 offen
    v_cvt_pk_bf16_f32 v180, v180, v181
    v_cvt_pk_bf16_f32 v181, v182, v183
    s_add_u32 s51, s55, 110720
    buffer_store_dwordx2 v[180:181], v252, s[28:31], s51 offen
    s_waitcnt vmcnt(4)
    v_lshlrev_b32 v240, 16, v224
    v_and_b32 v241, 0xffff0000, v224
    v_add_f32 v184, v184, v240
    v_add_f32 v185, v185, v241
    v_lshlrev_b32 v240, 16, v225
    v_and_b32 v241, 0xffff0000, v225
    v_add_f32 v186, v186, v240
    v_add_f32 v187, v187, v241
    v_lshlrev_b32 v240, 16, v226
    v_and_b32 v241, 0xffff0000, v226
    v_add_f32 v188, v188, v240
    v_add_f32 v189, v189, v241
    v_lshlrev_b32 v240, 16, v227
    v_and_b32 v241, 0xffff0000, v227
    v_add_f32 v190, v190, v240
    v_add_f32 v191, v191, v241
    v_cvt_pk_bf16_f32 v184, v184, v185
    v_cvt_pk_bf16_f32 v185, v186, v187
    s_add_u32 s51, s55, 147584
    buffer_store_dwordx2 v[184:185], v252, s[28:31], s51 offen
    v_cvt_pk_bf16_f32 v188, v188, v189
    v_cvt_pk_bf16_f32 v189, v190, v191
    s_add_u32 s51, s55, 184448
    buffer_store_dwordx2 v[188:189], v252, s[28:31], s51 offen
    s_endpgm
L_done:
    s_endpgm
.section .rodata,"a"
.p2align 6
.amdhsa_kernel concat_heads__gqa_block_cached__gqa_block_cached__near_ridge_kernel
  .amdhsa_next_free_vgpr 256
  .amdhsa_next_free_sgpr 102
  .amdhsa_accum_offset 256
  .amdhsa_group_segment_fixed_size 0
  .amdhsa_kernarg_size 104
  .amdhsa_user_sgpr_count 2
  .amdhsa_user_sgpr_kernarg_segment_ptr 1
  .amdhsa_system_sgpr_workgroup_id_x 1
  .amdhsa_float_denorm_mode_32 3
  .amdhsa_float_denorm_mode_16_64 3
.end_amdhsa_kernel
```
